```python
import torch

def _softmax(x, axis=-1):
    return torch.softmax(x, dim=axis)

def _gelu(x):
    return torch.nn.functional.gelu(x, approximate='tanh')

def _silu(x):
    return torch.nn.functional.silu(x)

def _sigmoid(x):
    return torch.sigmoid(x)

def _layernorm(x, axis=-1, eps=1e-05):
    m = x.mean(dim=axis, keepdim=True)
    v = x.var(dim=axis, keepdim=True, unbiased=False)
    return (x - m) / torch.sqrt(v + eps)

def _scatter_add(tgt, idx, src, axis=0):
    return tgt.clone().index_add_(axis, idx, src)

def _segment_sum(src, seg, n):
    out = torch.zeros((n,) + src.shape[1:], dtype=src.dtype)
    return out.index_add_(0, seg, src)

def _pad(x, pw):
    flat = tuple((v for pair in reversed(pw) for v in pair))
    return torch.nn.functional.pad(x, flat)
kernel_name = 'concat_heads__linear_kernel_hedgehog__memory_aug_recurrent_mem_tr__prompt'

def setup_inputs():

    _w = lambda a: (lambda t: t.to(torch.bfloat16) if t.is_floating_point() else t)(torch.as_tensor(a))

    def _A_setup():
        B, S, D, H = (1, 2048, 640, 32)
        Dh = D // H
        return {'x': _w((lambda *s: torch.randn(*s, dtype=torch.bfloat16) * 0.8)(B, S, D)), 'wqkv': _w((lambda *s: torch.randn(*s, dtype=torch.bfloat16) * 0.8)(D, 3 * D)), 'w_phi': _w((lambda *s: torch.randn(*s, dtype=torch.bfloat16) * 0.8)(H, Dh, Dh) * Dh ** (-0.5)), 'wo': _w((lambda *s: torch.randn(*s, dtype=torch.bfloat16) * 0.05)(D, D))}
    _A_in = _A_setup()

    def _B_setup():
        B, S, Dm = (1, 2048, 640)
        H, Dh = (32, 192)
        M, seg = (8, 32)
        seg = min(seg, S)
        S = S // seg * seg
        return {'x': _w((lambda *s: torch.randn(*s, dtype=torch.bfloat16) * 0.05)(B, S, Dm)), 'mem0': _w((lambda *s: torch.randn(*s, dtype=torch.bfloat16) * 1.6)(B, M, Dm)), 'Wq': _w((lambda *s: torch.randn(*s, dtype=torch.bfloat16) * 0.8)(Dm, H, Dh) * Dm ** (-0.5)), 'Wk': _w((lambda *s: torch.randn(*s, dtype=torch.bfloat16) * 0.8)(Dm, H, Dh) * Dm ** (-0.5)), 'Wv': _w((lambda *s: torch.randn(*s, dtype=torch.bfloat16) * 1.6)(Dm, H, Dh) * Dm ** (-0.5)), 'Wo': _w((lambda *s: torch.randn(*s, dtype=torch.bfloat16) * 1.6)(H, Dh, Dm) * (H * Dh) ** (-0.5)), 'seg_len': seg}
    _B_in = _B_setup()
    return {'A_x': _A_in['x'], 'A_wqkv': _A_in['wqkv'], 'A_w_phi': _A_in['w_phi'], 'A_wo': _A_in['wo'], 'B_x': _B_in['x'], 'B_mem0': _B_in['mem0'], 'B_Wq': _B_in['Wq'], 'B_Wk': _B_in['Wk'], 'B_Wv': _B_in['Wv'], 'B_Wo': _B_in['Wo'], 'B_seg_len': _B_in['seg_len']}

def reference(A_x, A_wqkv, A_w_phi, A_wo, B_x, B_mem0, B_Wq, B_Wk, B_Wv, B_Wo, B_seg_len):

    def _A_ref(x, wqkv, w_phi, wo):
        B, S, D = x.shape
        H = 32
        Dh = D // H
        qkv = (lambda x, *d: x.permute(*d))((x @ wqkv).reshape(B, S, 3, H, Dh), 2, 0, 3, 1, 4)
        q, k, v = (qkv[0], qkv[1], qkv[2])
        pq = torch.einsum('bhsd,hdf->bhsf', q, w_phi)
        pk = torch.einsum('bhsd,hdf->bhsf', k, w_phi)
        phi_q = torch.concatenate([_softmax(pq, axis=-1), _softmax(-pq, axis=-1)], axis=-1)
        phi_k = torch.concatenate([_softmax(pk, axis=-1), _softmax(-pk, axis=-1)], axis=-1)
        kv = torch.einsum('bhsf,bhsd->bhfd', phi_k, v)
        z = torch.einsum('bhsf->bhf', phi_k)
        num = torch.einsum('bhqf,bhfd->bhqd', phi_q, kv)
        den = torch.einsum('bhqf,bhf->bhq', phi_q, z)[..., None] + 1e-06
        o = num / den
        return (lambda x, *d: x.permute(*d))(o, 0, 2, 1, 3).reshape(B, S, D) @ wo

    def _B_ref(x, mem0, Wq, Wk, Wv, Wo, seg_len):
        B, S, Dm = x.shape
        H, Dh = (Wq.shape[1], Wq.shape[2])
        M = mem0.shape[1]
        scale = Dh ** (-0.5)
        n_seg = S // seg_len
        L = M + seg_len
        idx = torch.arange(L)
        mask = (idx[:, None] < M) | (idx[:, None] >= idx[None, :])
        mem = mem0
        outs = []
        for s in range(n_seg):
            xs = x[:, s * seg_len:(s + 1) * seg_len, :].clone()
            h = torch.concatenate([mem, xs], axis=1)
            q = torch.einsum('btd,dhe->bhte', h, Wq)
            k = torch.einsum('btd,dhe->bhte', h, Wk)
            v = torch.einsum('btd,dhe->bhte', h, Wv)
            scores = torch.einsum('bhqe,bhke->bhqk', q, k) * scale
            scores = torch.where(mask[None, None], scores, -1000000000.0)
            p = _softmax(scores, axis=-1)
            o = torch.einsum('bhqk,bhke->bhqe', p, v)
            o = torch.einsum('bhte,hed->btd', o, Wo)
            mem = o[:, :M, :].clone()
            outs.append(o[:, M:, :])
        return torch.concatenate(outs, axis=1)
    a = _A_ref(A_x, A_wqkv, A_w_phi, A_wo)
    b = _B_ref(B_x, B_mem0, B_Wq, B_Wk, B_Wv, B_Wo, B_seg_len)
    return torch.concatenate([a, b], axis=-1)
```

```asm
; @launch grid=(256,1,1) block=(256,1,1) lds=163840
.amdgcn_target "amdgcn-amd-amdhsa--gfx950"
.text
.globl concat_heads__linear_kernel_hedgehog__memory_aug_recurrent_mem_tr__prompt_kernel
.p2align 8
.type concat_heads__linear_kernel_hedgehog__memory_aug_recurrent_mem_tr__prompt_kernel,@function
concat_heads__linear_kernel_hedgehog__memory_aug_recurrent_mem_tr__prompt_kernel:
  s_cmp_ge_u32 s2, 256
  s_cbranch_scc1 L_EXIT0
  s_load_dwordx16 s[4:19], s[0:1], 0
  s_load_dwordx8 s[20:27], s[0:1], 64
  s_load_dwordx4 s[28:31], s[0:1], 96
  s_getpc_b64 s[60:61]
L_PC:
  s_lshr_b32 s53, s2, 3
  s_mul_i32 s53, s53, 28
  v_min_u32 v2, 27, v0
  v_add_u32 v2, s53, v2
  v_lshlrev_b32 v2, 7, v2
  v_min_u32 v2, L_END-L_PC-4, v2
  v_mov_b32 v3, s61
  v_add_co_u32 v2, vcc, s60, v2
  s_nop 1
  v_addc_co_u32 v3, vcc, 0, v3, vcc
  global_load_dword a255, v[2:3], off
  v_lshrrev_b32 v1, 6, v0
  v_and_b32 v0, 63, v0
  v_readfirstlane_b32 s49, v1
  s_mov_b32 s3, 0
  s_getreg_b32 s53, hwreg(HW_REG_XCC_ID)
  s_waitcnt lgkmcnt(0)
  s_mov_b32 s32, s30
  s_and_b32 s33, s31, 0xffff
  s_mov_b32 s34, 0x10000000
  s_mov_b32 s35, 0x20000
  s_mov_b32 s24, s2
  s_and_b32 s25, s53, 7
  s_lshr_b32 s53, s2, 3
  s_or_b32 s53, s53, s49
  s_cbranch_scc1 L_DISPATCH
  s_lshl_b32 s53, s25, 3
  s_or_b32 s53, s53, s2
  s_or_b32 s53, s53, 64
  s_lshl_b32 s54, s2, 2
  v_mov_b32 v1, s54
  v_mov_b32 v2, s53
  global_store_dword v1, v2, s[28:29] offset:160 sc1
  s_branch L_DISPATCH
L_REDO:
  s_mov_b32 s25, s53
  s_waitcnt vmcnt(0) lgkmcnt(0)
  s_barrier
L_DISPATCH:
  s_and_b32 s2, s24, 0xf8
  s_or_b32 s2, s2, s25
  s_lshr_b32 s53, s2, 3
  s_and_b32 s54, s2, 3
  s_lshl_b32 s53, s53, 2
  s_add_u32 s55, s53, s54
  s_bitcmp1_b32 s2, 2
  s_cbranch_scc1 D_IODB
  s_cmp_ge_u32 s55, 32
  s_cbranch_scc1 D_1
  s_sub_u32 s48, s55, 0
  s_branch R_A
D_1:
  s_cmp_ge_u32 s55, 64
  s_cbranch_scc1 D_2
  s_sub_u32 s48, s55, 32
  s_branch R_V
D_2:
  s_cmp_ge_u32 s55, 104
  s_cbranch_scc1 D_3
  s_sub_u32 s48, s55, 64
  s_branch R_B
D_3:
  s_cmp_ge_u32 s55, 128
  s_cbranch_scc1 D_4
  s_sub_u32 s48, s55, 104
  s_branch R_FC
D_4:
  s_endpgm
D_IODB:
  s_cmp_ge_u32 s55, 32
  s_cbranch_scc1 D_5
  s_sub_u32 s48, s55, 0
  s_branch R_VC
D_5:
  s_cmp_ge_u32 s55, 64
  s_cbranch_scc1 D_6
  s_sub_u32 s48, s55, 32
  s_branch R_UC
D_6:
  s_cmp_ge_u32 s55, 96
  s_cbranch_scc1 D_7
  s_sub_u32 s48, s55, 64
  s_branch R_KC
D_7:
  s_cmp_ge_u32 s55, 128
  s_cbranch_scc1 D_8
  s_sub_u32 s48, s55, 96
  s_branch R_QC
D_8:
L_EXIT0:
  s_endpgm
R_B:
  s_cmp_lg_u32 s49, 0
  s_cbranch_scc1 B_HELP
  s_mov_b32 s36, s14
  s_and_b32 s37, s15, 0xffff
  s_mov_b32 s38, 0x2800
  s_mov_b32 s39, 0x20000
  s_and_b32 s82, s48, 3
  s_mul_i32 s82, s82, 10
  s_lshr_b32 s53, s48, 2
  s_add_u32 s82, s82, s53
  v_lshrrev_b32 v40, 4, v0
  v_and_b32 v41, 1, v0
  v_lshl_add_u32 v42, v40, 1, v41
  v_mul_u32_u24 v43, 1280, v42
  v_bfe_u32 v44, v0, 1, 3
  v_lshl_add_u32 v43, v44, 2, v43
  s_lshl_b32 s54, s82, 5
  buffer_load_dword v50, v43, s[36:39], s54 offen
  v_min_u32 v20, 47, v0
  v_max_u32 v20, 31, v20
  v_lshlrev_b32 v20, 2, v20
  s_mov_b32 s57, 0
WI_9:
  global_load_dword v21, v20, s[28:29] sc1
  s_add_u32 s57, s57, 1
  s_cmp_gt_u32 s57, 0x20000
  s_cbranch_scc1 L_EXIT
  s_waitcnt vmcnt(0)
  s_and_b32 s53, s24, 7
  s_add_u32 s53, s53, 40
  v_readlane_b32 s53, v21, s53
  s_nop 1
  v_cmp_gt_u32 vcc, s53, v21
  s_bfe_u32 s53, vcc_hi, 0x80008
  s_bcnt1_i32_b32 s53, s53
  v_cmp_eq_u32 vcc, 0, v21
  s_bfe_u32 s54, vcc_hi, 0x80008
  s_cbranch_scc1 WI_11
  s_cmp_lg_u32 s53, s25
  s_cbranch_scc1 L_REDO
WI_11:
  s_cbranch_vccz WI_10
  s_sleep 8
  s_branch WI_9
WI_10:
  v_readfirstlane_b32 s53, v21
  s_and_b32 s53, s53, 1
  s_lshl_b32 s50, s53, 13
  s_xor_b32 s51, s50, 0x2000
  v_and_b32 v20, 2, v0
  v_cmp_eq_u32 vcc, 0, v20
  v_mov_b32 v1, 0xeeee
  v_mov_b32 v20, 0x4444
  v_cndmask_b32 v1, v1, v20, vcc
  s_mov_b32 s78, 0x7f817f81
  v_lshlrev_b32 v45, 6, v40
  v_lshl_add_u32 v45, v41, 4, v45
  v_and_b32 v46, 1, v44
  v_lshl_add_u32 v45, v46, 5, v45
  v_lshrrev_b32 v46, 1, v44
  v_lshl_add_u32 v45, v46, 2, v45
  s_lshr_b32 s54, s82, 5
  s_lshl_b32 s54, s54, 13
  s_lshl_b32 s55, s82, 8
  s_add_u32 s54, s54, s55
  v_add_u32 v6, s54, v45
  v_mov_b32 v45, 0x05040100
  v_mov_b32 v46, 0x03020706
  v_cmp_eq_u32 vcc, 1, v41
  s_nop 1
  v_cndmask_b32 v9, v45, v46, vcc
  v_lshlrev_b32 v10, 4, v0
  s_add_u32 s54, s50, 65536
  v_lshl_add_u32 v13, v0, 7, s54
  v_lshrrev_b32 v45, 5, v0
  v_lshlrev_b32 v45, 9, v45
  v_bfe_u32 v46, v0, 2, 2
  v_lshl_add_u32 v45, v46, 7, v45
  v_bfe_u32 v46, v0, 4, 1
  v_lshl_add_u32 v45, v46, 6, v45
  v_and_b32 v46, 3, v0
  v_lshl_add_u32 v11, v46, 4, v45
  v_and_b32 v46, 15, v0
  v_lshlrev_b32 v46, 2, v46
  v_lshl_add_u32 v46, v40, 8, v46
  s_lshl_b32 s54, s82, 14
  v_add_u32 v12, s54, v46
  s_lshr_b32 s84, s48, 2
  s_mul_i32 s84, s84, 1
  s_and_b32 s84, s84, 3
  s_and_b32 s53, s48, 3
  s_lshl_b32 s53, s53, 2
  s_add_u32 s84, s84, s53
  s_add_u32 s54, s84, 0
  s_and_b32 s55, s54, 7
  s_lshl_b32 s55, s55, 10
  s_and_b32 s54, s54, 8
  s_lshl_b32 s54, s54, 11
  s_add_u32 s62, s54, s55
  s_add_u32 s54, s84, 1
  s_and_b32 s55, s54, 7
  s_lshl_b32 s55, s55, 10
  s_and_b32 s54, s54, 8
  s_lshl_b32 s54, s54, 11
  s_add_u32 s63, s54, s55
  s_add_u32 s54, s84, 2
  s_and_b32 s55, s54, 7
  s_lshl_b32 s55, s55, 10
  s_and_b32 s54, s54, 8
  s_lshl_b32 s54, s54, 11
  s_add_u32 s64, s54, s55
  s_add_u32 s54, s84, 3
  s_and_b32 s55, s54, 7
  s_lshl_b32 s55, s55, 10
  s_and_b32 s54, s54, 8
  s_lshl_b32 s54, s54, 11
  s_add_u32 s65, s54, s55
  s_add_u32 s54, s84, 4
  s_and_b32 s55, s54, 7
  s_lshl_b32 s55, s55, 10
  s_and_b32 s54, s54, 8
  s_lshl_b32 s54, s54, 11
  s_add_u32 s66, s54, s55
  s_add_u32 s54, s84, 5
  s_and_b32 s55, s54, 7
  s_lshl_b32 s55, s55, 10
  s_and_b32 s54, s54, 8
  s_lshl_b32 s54, s54, 11
  s_add_u32 s67, s54, s55
  s_add_u32 s54, s84, 6
  s_and_b32 s55, s54, 7
  s_lshl_b32 s55, s55, 10
  s_and_b32 s54, s54, 8
  s_lshl_b32 s54, s54, 11
  s_add_u32 s68, s54, s55
  s_add_u32 s54, s84, 7
  s_and_b32 s55, s54, 7
  s_lshl_b32 s55, s55, 10
  s_and_b32 s54, s54, 8
  s_lshl_b32 s54, s54, 11
  s_add_u32 s69, s54, s55
  s_add_u32 s54, s84, 8
  s_and_b32 s55, s54, 7
  s_lshl_b32 s55, s55, 10
  s_and_b32 s54, s54, 8
  s_lshl_b32 s54, s54, 11
  s_add_u32 s70, s54, s55
  s_add_u32 s54, s84, 9
  s_and_b32 s55, s54, 7
  s_lshl_b32 s55, s55, 10
  s_and_b32 s54, s54, 8
  s_lshl_b32 s54, s54, 11
  s_add_u32 s71, s54, s55
  s_add_u32 s54, s84, 10
  s_and_b32 s55, s54, 7
  s_lshl_b32 s55, s55, 10
  s_and_b32 s54, s54, 8
  s_lshl_b32 s54, s54, 11
  s_add_u32 s72, s54, s55
  s_add_u32 s54, s84, 11
  s_and_b32 s55, s54, 7
  s_lshl_b32 s55, s55, 10
  s_and_b32 s54, s54, 8
  s_lshl_b32 s54, s54, 11
  s_add_u32 s73, s54, s55
  s_add_u32 s54, s84, 12
  s_and_b32 s55, s54, 7
  s_lshl_b32 s55, s55, 10
  s_and_b32 s54, s54, 8
  s_lshl_b32 s54, s54, 11
  s_add_u32 s74, s54, s55
  s_add_u32 s54, s84, 13
  s_and_b32 s55, s54, 7
  s_lshl_b32 s55, s55, 10
  s_and_b32 s54, s54, 8
  s_lshl_b32 s54, s54, 11
  s_add_u32 s75, s54, s55
  s_add_u32 s54, s84, 14
  s_and_b32 s55, s54, 7
  s_lshl_b32 s55, s55, 10
  s_and_b32 s54, s54, 8
  s_lshl_b32 s54, s54, 11
  s_add_u32 s76, s54, s55
  s_add_u32 s54, s84, 15
  s_and_b32 s55, s54, 7
  s_lshl_b32 s55, s55, 10
  s_and_b32 s54, s54, 8
  s_lshl_b32 s54, s54, 11
  s_add_u32 s77, s54, s55
  s_lshl_b32 s83, s82, 15
  s_mov_b32 s81, 0
  s_mov_b32 s52, 0
  s_add_u32 s80, s52, 0
  s_and_b32 s80, s80, 31
  s_mul_i32 s80, s80, 0x4000
  s_add_u32 s80, s80, 0x100000
  s_lshr_b32 s53, s80, 7
  s_and_b32 s53, s53, 0x2000
  s_xor_b32 s53, s53, s50
  s_lshl_b32 s80, s80, 1
  s_or_b32 s80, s80, s53
  v_mov_b32 v51, 0x7fc07fc0
  v_cmp_eq_u32 vcc, s78, v50
  s_nop 1
  v_cndmask_b32 v50, v50, v51, vcc
  s_add_u32 s54, s48, 1
  s_and_b32 s54, s54, 0
  s_lshl_b32 s54, s54, 15
  s_add_u32 s54, s54, s80
  v_add_u32 v144, s54, v6
  buffer_store_dword v50, v144, s[32:35], 0 offen sc1
  s_add_u32 s80, s52, 1
  s_and_b32 s80, s80, 31
  s_mul_i32 s80, s80, 0x4000
  s_add_u32 s80, s80, 0x100000
  s_lshr_b32 s53, s80, 7
  s_and_b32 s53, s53, 0x2000
  s_xor_b32 s53, s53, s50
  s_lshl_b32 s80, s80, 1
  s_or_b32 s80, s80, s53
  v_mov_b32 v20, s78
  s_add_u32 s54, s48, 1
  s_and_b32 s54, s54, 0
  s_lshl_b32 s54, s54, 15
  s_add_u32 s54, s54, s80
  v_add_u32 v144, s54, v6
  buffer_store_dword v20, v144, s[32:35], 0 offen sc1
  s_waitcnt vmcnt(0)
  s_lshl_b32 s54, s48, 7
  s_add_u32 s54, s54, s50
  s_add_u32 s54, s54, 16384
  s_cmp_eq_u32 s49, 0
  s_cselect_b32 s54, s54, 0x40000000
  v_mov_b32 v20, 0x40000000
  s_nop 0
  v_writelane_b32 v20, s54, 0
  v_mov_b32 v21, 1
  buffer_store_dword v21, v20, s[32:35], 0 offen sc1
  v_mov_b32 v148, s78
  v_mov_b32 v149, s78
  v_mov_b32 v150, s78
  v_mov_b32 v151, s78
  s_mov_b32 s79, 1
B_PRE:
  s_and_b32 s54, s79, 15
  s_mul_i32 s54, s54, 0x80000
  s_add_u32 s54, s54, 0xc00000
  s_lshr_b32 s53, s54, 7
  s_and_b32 s53, s53, 0x2000
  s_xor_b32 s53, s53, s50
  s_lshl_b32 s54, s54, 1
  s_or_b32 s54, s54, s53
  s_lshr_b32 s55, s83, 1
  s_add_u32 s54, s54, s55
  buffer_store_dwordx4 v[148:151], v10, s[32:35], s54 offen sc1
  buffer_store_dwordx4 v[148:151], v10, s[32:35], s54 offen offset:1024 sc1
  buffer_store_dwordx4 v[148:151], v10, s[32:35], s54 offen offset:2048 sc1
  buffer_store_dwordx4 v[148:151], v10, s[32:35], s54 offen offset:3072 sc1
  s_add_u32 s54, s54, 4096
  buffer_store_dwordx4 v[148:151], v10, s[32:35], s54 offen sc1
  buffer_store_dwordx4 v[148:151], v10, s[32:35], s54 offen offset:1024 sc1
  buffer_store_dwordx4 v[148:151], v10, s[32:35], s54 offen offset:2048 sc1
  buffer_store_dwordx4 v[148:151], v10, s[32:35], s54 offen offset:3072 sc1
  s_add_u32 s79, s79, 1
  s_waitcnt vmcnt(8)
  s_cmp_le_u32 s79, 4
  s_cbranch_scc1 B_PRE
  s_cmp_ge_u32 s48, 32
  s_cbranch_scc1 BR_DONE
  s_lshr_b32 s53, s48, 2
  s_and_b32 s85, s53, 3
  s_lshl_b32 s85, s85, 11
  s_lshr_b32 s53, s53, 2
  s_lshl_b32 s53, s53, 14
  s_add_u32 s85, s85, s53
  s_and_b32 s53, s48, 3
  s_lshl_b32 s53, s53, 7
  s_add_u32 s85, s85, s53
  s_add_u32 s85, s85, 132160
  s_mov_b32 s86, 0xffff
  s_add_u32 s85, s85, s50
  s_barrier
  s_mov_b64 exec, 1
  v_mov_b32 v52, 0
  s_mov_b32 s87, 0
  s_waitcnt vmcnt(0)
BR_LOOP:
  v_mov_b32 v53, 0
  s_memtime s[88:89]
  s_waitcnt lgkmcnt(0)
  buffer_atomic_or v53, v52, s[32:35], s85 offen sc0
  s_waitcnt vmcnt(0)
  s_memtime s[60:61]
  s_waitcnt lgkmcnt(0)
  s_sub_u32 s60, s60, s88
  s_min_u32 s86, s86, s60
  s_add_u32 s87, s87, 1
  s_cmp_lt_u32 s87, 5
  s_cbranch_scc1 BR_LOOP
  s_or_b32 s86, s86, 1
  s_mov_b64 exec, -1
  s_waitcnt vmcnt(0)
  s_lshl_b32 s54, s48, 7
  s_add_u32 s54, s54, s50
  s_add_u32 s54, s54, 16388
  s_cmp_eq_u32 s49, 0
  s_cselect_b32 s54, s54, 0x40000000
  v_mov_b32 v52, 0x40000000
  s_nop 0
  v_writelane_b32 v52, s54, 0
  v_mov_b32 v53, s86
  buffer_store_dword v53, v52, s[32:35], 0 offen sc1
BR_DONE:
  v_mov_b32 v5, 0x40000000
  v_mov_b32 v7, 0x40000000
  s_and_b32 s54, s48, 1
  s_lshl_b32 s54, s54, 1
  s_bfe_u32 s55, s48, 0x10001
  s_or_b32 s54, s54, s55
  s_xor_b32 s54, s54, 0
  s_lshl_b32 s4, s54, 10
  s_lshl_b32 s8, s54, 11
  s_and_b32 s54, s48, 1
  s_lshl_b32 s54, s54, 1
  s_bfe_u32 s55, s48, 0x10001
  s_or_b32 s54, s54, s55
  s_xor_b32 s54, s54, 2
  s_lshl_b32 s5, s54, 10
  s_lshl_b32 s9, s54, 11
  s_and_b32 s54, s48, 1
  s_lshl_b32 s54, s54, 1
  s_bfe_u32 s55, s48, 0x10001
  s_or_b32 s54, s54, s55
  s_xor_b32 s54, s54, 1
  s_lshl_b32 s6, s54, 10
  s_lshl_b32 s10, s54, 11
  s_and_b32 s54, s48, 1
  s_lshl_b32 s54, s54, 1
  s_bfe_u32 s55, s48, 0x10001
  s_or_b32 s54, s54, s55
  s_xor_b32 s54, s54, 3
  s_lshl_b32 s7, s54, 10
  s_lshl_b32 s11, s54, 11
  s_getpc_b64 s[60:61]
PC_12:
  s_lshl_b32 s53, s49, 6
  v_add_u32 v20, s53, v0
  v_lshlrev_b32 v20, 7, v20
  v_min_u32 v20, B_END-B_STEP-4, v20
  v_add_u32 v20, B_STEP-PC_12, v20
  v_mov_b32 v21, s61
  v_add_co_u32 v20, vcc, s60, v20
  s_nop 1
  v_addc_co_u32 v21, vcc, 0, v21, vcc
  global_load_dword v22, v[20:21], off
  v_mov_b32 v14, 0
B_STEP:
  s_add_u32 s79, s52, 1
  v_cmp_gt_u32 vcc, s79, v14
  s_cmp_eq_u32 vcc_lo, 0
  s_cbranch_scc1 B_UOK
  s_cmp_ge_u32 s81, s79
  s_cbranch_scc1 WPD_13
  s_mov_b32 s57, 0
  s_mov_b32 exec_lo, 0xffffffff
  s_mov_b32 exec_hi, 0
WPL_14:
  buffer_load_dword v21, v13, s[32:35], 0 offen sc1
  s_add_u32 s57, s57, 1
  s_cmp_gt_u32 s57, 0x80000
  s_cbranch_scc1 L_EXIT
  s_waitcnt vmcnt(0)
  v_cmp_gt_u32 vcc, s79, v21
  s_cbranch_vccnz WPL_14
  s_mov_b32 s81, s79
  s_add_u32 s53, s79, 2
  s_min_u32 s53, s53, 64
  v_cmp_gt_u32 vcc, s53, v21
  s_nop 0
  s_cmp_eq_u64 vcc, 0
  s_cselect_b32 s81, s53, s81
  s_add_u32 s53, s79, 6
  s_min_u32 s53, s53, 64
  v_cmp_gt_u32 vcc, s53, v21
  s_nop 0
  s_cmp_eq_u64 vcc, 0
  s_cselect_b32 s81, s53, s81
  s_add_u32 s53, s79, 16
  s_min_u32 s53, s53, 64
  v_cmp_gt_u32 vcc, s53, v21
  s_nop 0
  s_cmp_eq_u64 vcc, 0
  s_cselect_b32 s81, s53, s81
  s_mov_b64 exec, -1
WPD_13:
B_UOK:
  s_and_b32 s56, s52, 15
  s_mul_i32 s56, s56, 0x140000
  s_add_u32 s56, s56, 0x2400000
  s_add_u32 s56, s56, s83
  s_lshr_b32 s53, s56, 7
  s_and_b32 s53, s53, 0x2000
  s_xor_b32 s53, s53, s50
  s_lshl_b32 s56, s56, 1
  s_or_b32 s56, s56, s53
  s_add_u32 s54, s84, 0
  s_and_b32 s55, s54, 3
  s_lshl_b32 s55, s55, 11
  s_and_b32 s54, s54, 12
  s_lshl_b32 s54, s54, 12
  s_add_u32 s54, s54, s55
  s_add_u32 s54, s54, s56
  buffer_load_dwordx4 a[0:3], v10, s[32:35], s54 offen sc1
  buffer_load_dwordx4 a[4:7], v10, s[32:35], s54 offen offset:1024 sc1
  s_add_u32 s54, s84, 1
  s_and_b32 s55, s54, 3
  s_lshl_b32 s55, s55, 11
  s_and_b32 s54, s54, 12
  s_lshl_b32 s54, s54, 12
  s_add_u32 s54, s54, s55
  s_add_u32 s54, s54, s56
  buffer_load_dwordx4 a[8:11], v10, s[32:35], s54 offen sc1
  buffer_load_dwordx4 a[12:15], v10, s[32:35], s54 offen offset:1024 sc1
  s_add_u32 s54, s84, 2
  s_and_b32 s55, s54, 3
  s_lshl_b32 s55, s55, 11
  s_and_b32 s54, s54, 12
  s_lshl_b32 s54, s54, 12
  s_add_u32 s54, s54, s55
  s_add_u32 s54, s54, s56
  buffer_load_dwordx4 a[16:19], v10, s[32:35], s54 offen sc1
  buffer_load_dwordx4 a[20:23], v10, s[32:35], s54 offen offset:1024 sc1
  s_add_u32 s54, s84, 3
  s_and_b32 s55, s54, 3
  s_lshl_b32 s55, s55, 11
  s_and_b32 s54, s54, 12
  s_lshl_b32 s54, s54, 12
  s_add_u32 s54, s54, s55
  s_add_u32 s54, s54, s56
  buffer_load_dwordx4 a[24:27], v10, s[32:35], s54 offen sc1
  buffer_load_dwordx4 a[28:31], v10, s[32:35], s54 offen offset:1024 sc1
  s_add_u32 s54, s84, 4
  s_and_b32 s55, s54, 3
  s_lshl_b32 s55, s55, 11
  s_and_b32 s54, s54, 12
  s_lshl_b32 s54, s54, 12
  s_add_u32 s54, s54, s55
  s_add_u32 s54, s54, s56
  buffer_load_dwordx4 a[32:35], v10, s[32:35], s54 offen sc1
  buffer_load_dwordx4 a[36:39], v10, s[32:35], s54 offen offset:1024 sc1
  s_add_u32 s54, s84, 5
  s_and_b32 s55, s54, 3
  s_lshl_b32 s55, s55, 11
  s_and_b32 s54, s54, 12
  s_lshl_b32 s54, s54, 12
  s_add_u32 s54, s54, s55
  s_add_u32 s54, s54, s56
  buffer_load_dwordx4 a[40:43], v10, s[32:35], s54 offen sc1
  buffer_load_dwordx4 a[44:47], v10, s[32:35], s54 offen offset:1024 sc1
  s_add_u32 s54, s84, 6
  s_and_b32 s55, s54, 3
  s_lshl_b32 s55, s55, 11
  s_and_b32 s54, s54, 12
  s_lshl_b32 s54, s54, 12
  s_add_u32 s54, s54, s55
  s_add_u32 s54, s54, s56
  buffer_load_dwordx4 a[48:51], v10, s[32:35], s54 offen sc1
  buffer_load_dwordx4 a[52:55], v10, s[32:35], s54 offen offset:1024 sc1
  s_add_u32 s54, s84, 7
  s_and_b32 s55, s54, 3
  s_lshl_b32 s55, s55, 11
  s_and_b32 s54, s54, 12
  s_lshl_b32 s54, s54, 12
  s_add_u32 s54, s54, s55
  s_add_u32 s54, s54, s56
  buffer_load_dwordx4 a[56:59], v10, s[32:35], s54 offen sc1
  buffer_load_dwordx4 a[60:63], v10, s[32:35], s54 offen offset:1024 sc1
  s_add_u32 s54, s84, 8
  s_and_b32 s55, s54, 3
  s_lshl_b32 s55, s55, 11
  s_and_b32 s54, s54, 12
  s_lshl_b32 s54, s54, 12
  s_add_u32 s54, s54, s55
  s_add_u32 s54, s54, s56
  buffer_load_dwordx4 a[64:67], v10, s[32:35], s54 offen sc1
  buffer_load_dwordx4 a[68:71], v10, s[32:35], s54 offen offset:1024 sc1
  s_add_u32 s54, s84, 9
  s_and_b32 s55, s54, 3
  s_lshl_b32 s55, s55, 11
  s_and_b32 s54, s54, 12
  s_lshl_b32 s54, s54, 12
  s_add_u32 s54, s54, s55
  s_add_u32 s54, s54, s56
  buffer_load_dwordx4 a[72:75], v10, s[32:35], s54 offen sc1
  buffer_load_dwordx4 a[76:79], v10, s[32:35], s54 offen offset:1024 sc1
  s_add_u32 s54, s84, 10
  s_and_b32 s55, s54, 3
  s_lshl_b32 s55, s55, 11
  s_and_b32 s54, s54, 12
  s_lshl_b32 s54, s54, 12
  s_add_u32 s54, s54, s55
  s_add_u32 s54, s54, s56
  buffer_load_dwordx4 a[80:83], v10, s[32:35], s54 offen sc1
  buffer_load_dwordx4 a[84:87], v10, s[32:35], s54 offen offset:1024 sc1
  s_add_u32 s54, s84, 11
  s_and_b32 s55, s54, 3
  s_lshl_b32 s55, s55, 11
  s_and_b32 s54, s54, 12
  s_lshl_b32 s54, s54, 12
  s_add_u32 s54, s54, s55
  s_add_u32 s54, s54, s56
  buffer_load_dwordx4 a[88:91], v10, s[32:35], s54 offen sc1
  buffer_load_dwordx4 a[92:95], v10, s[32:35], s54 offen offset:1024 sc1
  s_add_u32 s54, s84, 12
  s_and_b32 s55, s54, 3
  s_lshl_b32 s55, s55, 11
  s_and_b32 s54, s54, 12
  s_lshl_b32 s54, s54, 12
  s_add_u32 s54, s54, s55
  s_add_u32 s54, s54, s56
  buffer_load_dwordx4 a[96:99], v10, s[32:35], s54 offen sc1
  buffer_load_dwordx4 a[100:103], v10, s[32:35], s54 offen offset:1024 sc1
  s_add_u32 s54, s84, 13
  s_and_b32 s55, s54, 3
  s_lshl_b32 s55, s55, 11
  s_and_b32 s54, s54, 12
  s_lshl_b32 s54, s54, 12
  s_add_u32 s54, s54, s55
  s_add_u32 s54, s54, s56
  buffer_load_dwordx4 a[104:107], v10, s[32:35], s54 offen sc1
  buffer_load_dwordx4 a[108:111], v10, s[32:35], s54 offen offset:1024 sc1
  s_add_u32 s54, s84, 14
  s_and_b32 s55, s54, 3
  s_lshl_b32 s55, s55, 11
  s_and_b32 s54, s54, 12
  s_lshl_b32 s54, s54, 12
  s_add_u32 s54, s54, s55
  s_add_u32 s54, s54, s56
  buffer_load_dwordx4 a[112:115], v10, s[32:35], s54 offen sc1
  buffer_load_dwordx4 a[116:119], v10, s[32:35], s54 offen offset:1024 sc1
  s_add_u32 s54, s84, 15
  s_and_b32 s55, s54, 3
  s_lshl_b32 s55, s55, 11
  s_and_b32 s54, s54, 12
  s_lshl_b32 s54, s54, 12
  s_add_u32 s54, s54, s55
  s_add_u32 s54, s54, s56
  buffer_load_dwordx4 a[120:123], v10, s[32:35], s54 offen sc1
  buffer_load_dwordx4 a[124:127], v10, s[32:35], s54 offen offset:1024 sc1
  s_add_u32 s80, s52, 2
  s_and_b32 s80, s80, 31
  s_mul_i32 s80, s80, 0x4000
  s_add_u32 s80, s80, 0x100000
  s_lshr_b32 s53, s80, 7
  s_and_b32 s53, s53, 0x2000
  s_xor_b32 s53, s53, s50
  s_lshl_b32 s80, s80, 1
  s_or_b32 s80, s80, s53
  s_cmp_lt_u32 s52, 62
  s_cselect_b32 s80, s80, 0x40000000
  v_mov_b32 v20, s78
  s_add_u32 s54, s48, 1
  s_and_b32 s54, s54, 0
  s_lshl_b32 s54, s54, 15
  s_add_u32 s54, s54, s80
  v_add_u32 v144, s54, v6
  buffer_store_dword v20, v144, s[32:35], 0 offen sc1
  s_add_u32 s80, s52, 1
  s_and_b32 s80, s80, 31
  s_mul_i32 s80, s80, 0x4000
  s_add_u32 s80, s80, 0x100000
  s_lshr_b32 s53, s80, 7
  s_and_b32 s53, s53, 0x2000
  s_xor_b32 s53, s53, s50
  s_lshl_b32 s80, s80, 1
  s_or_b32 s80, s80, s53
  s_add_u32 s54, s48, 1
  s_and_b32 s54, s54, 0
  s_lshl_b32 s54, s54, 15
  s_add_u32 s54, s54, s80
  v_add_u32 v144, s54, v6
  s_add_u32 s54, s52, 0
  s_and_b32 s54, s54, 31
  s_mul_i32 s54, s54, 0x8000
  s_add_u32 s54, s54, 0x200000
  s_lshr_b32 s53, s54, 7
  s_and_b32 s53, s53, 0x2000
  s_xor_b32 s53, s53, s50
  s_lshl_b32 s54, s54, 1
  s_or_b32 s54, s54, s53
  v_add_u32 v2, s54, v11
  s_add_u32 s54, s54, 32768
  v_add_u32 v3, s54, v10
  s_and_b32 s54, s52, 15
  s_mul_i32 s54, s54, 0x80000
  s_add_u32 s54, s54, 0xc00000
  s_lshr_b32 s53, s54, 7
  s_and_b32 s53, s53, 0x2000
  s_xor_b32 s53, s53, s50
  s_lshl_b32 s54, s54, 1
  s_or_b32 s54, s54, s53
  v_add_u32 v4, s54, v12
  v_add_u32 v28, s8, v4
  v_add_u32 v29, s9, v4
  v_add_u32 v30, s10, v4
  v_add_u32 v31, s11, v4
  v_mov_b64 v[16:17], 0
  v_mov_b64 v[18:19], 0
  s_add_u32 s54, s52, 2
  v_mov_b32 v8, s54
  s_mov_b32 s58, 0
  s_mov_b32 s59, 0
  s_waitcnt vmcnt(8)
  s_cmp_le_u32 s79, 4
  s_cbranch_scc1 B_NOCL
  s_and_b32 s54, s79, 15
  s_mul_i32 s54, s54, 0x80000
  s_add_u32 s54, s54, 0xc00000
  s_lshr_b32 s53, s54, 7
  s_and_b32 s53, s53, 0x2000
  s_xor_b32 s53, s53, s50
  s_lshl_b32 s54, s54, 1
  s_or_b32 s54, s54, s53
  s_lshr_b32 s55, s83, 1
  s_add_u32 s54, s54, s55
  buffer_store_dwordx4 v[148:151], v10, s[32:35], s54 offen sc1
  buffer_store_dwordx4 v[148:151], v10, s[32:35], s54 offen offset:1024 sc1
  buffer_store_dwordx4 v[148:151], v10, s[32:35], s54 offen offset:2048 sc1
  buffer_store_dwordx4 v[148:151], v10, s[32:35], s54 offen offset:3072 sc1
  s_add_u32 s54, s54, 4096
  buffer_store_dwordx4 v[148:151], v10, s[32:35], s54 offen sc1
  buffer_store_dwordx4 v[148:151], v10, s[32:35], s54 offen offset:1024 sc1
  buffer_store_dwordx4 v[148:151], v10, s[32:35], s54 offen offset:2048 sc1
  buffer_store_dwordx4 v[148:151], v10, s[32:35], s54 offen offset:3072 sc1
B_NOCL:
  s_add_u32 s54, s79, 2
  v_cmp_gt_u32 vcc, s54, v14
  s_cmp_eq_u32 vcc_lo, 0
  s_cbranch_scc1 B_NOUP
  s_mov_b32 exec_hi, 0
  buffer_load_dword v14, v13, s[32:35], 0 offen sc1
  s_mov_b32 exec_hi, -1
B_NOUP:
  s_waitcnt vmcnt(0)
  s_cmp_eq_u32 s52, 0
  s_cbranch_scc1 B_FIRST
  s_mov_b64 exec, 1
  s_mov_b32 s57, 0
  buffer_load_dword v20, v5, s[32:35], 0 offen sc1
  buffer_load_dword v21, v5, s[32:35], 0 offen sc1
  buffer_load_dword v22, v5, s[32:35], 0 offen sc1
PL_15:
  buffer_load_dword v23, v5, s[32:35], 0 offen sc1
  s_waitcnt vmcnt(3)
  v_cmp_gt_u32 vcc, s79, v20
  s_cbranch_vccz PR_16
  buffer_load_dword v20, v5, s[32:35], 0 offen sc1
  s_waitcnt vmcnt(3)
  v_cmp_gt_u32 vcc, s79, v21
  s_cbranch_vccz PR_16
  buffer_load_dword v21, v5, s[32:35], 0 offen sc1
  s_waitcnt vmcnt(3)
  v_cmp_gt_u32 vcc, s79, v22
  s_cbranch_vccz PR_16
  buffer_load_dword v22, v5, s[32:35], 0 offen sc1
  s_waitcnt vmcnt(3)
  v_cmp_gt_u32 vcc, s79, v23
  s_cbranch_vccz PR_16
  s_add_u32 s57, s57, 1
  s_cmp_lt_u32 s57, 0x80000
  s_cbranch_scc1 PL_15
  s_branch L_EXIT
PR_16:
  s_mov_b64 exec, -1
B_FDONE:
B_LOADS:
B_LOADP:
  buffer_load_dword v32, v28, s[32:35], 0 offen sc1
  buffer_load_dword v33, v28, s[32:35], 0 offen offset:64 sc1
  buffer_load_dword v34, v28, s[32:35], 0 offen offset:128 sc1
  buffer_load_dword v35, v28, s[32:35], 0 offen offset:192 sc1
  buffer_load_dword v36, v28, s[32:35], 0 offen offset:1024 sc1
  buffer_load_dword v37, v28, s[32:35], 0 offen offset:1088 sc1
  buffer_load_dword v38, v28, s[32:35], 0 offen offset:1152 sc1
  buffer_load_dword v39, v28, s[32:35], 0 offen offset:1216 sc1
  buffer_load_dword v40, v29, s[32:35], 0 offen sc1
  buffer_load_dword v41, v29, s[32:35], 0 offen offset:64 sc1
  buffer_load_dword v42, v29, s[32:35], 0 offen offset:128 sc1
  buffer_load_dword v43, v29, s[32:35], 0 offen offset:192 sc1
  buffer_load_dword v44, v29, s[32:35], 0 offen offset:1024 sc1
  buffer_load_dword v45, v29, s[32:35], 0 offen offset:1088 sc1
  buffer_load_dword v46, v29, s[32:35], 0 offen offset:1152 sc1
  buffer_load_dword v47, v29, s[32:35], 0 offen offset:1216 sc1
  buffer_load_dwordx4 v[128:131], v3, s[32:35], s4 offen sc1
  buffer_load_dwordx4 v[132:135], v3, s[32:35], s5 offen sc1
  buffer_load_dwordx4 v[136:139], v3, s[32:35], s6 offen sc1
  buffer_load_dwordx4 v[140:143], v3, s[32:35], s7 offen sc1
  buffer_load_dwordx4 v[64:67], v2, s[32:35], s62 offen sc1
  buffer_load_dwordx4 v[68:71], v2, s[32:35], s63 offen sc1
  buffer_load_dwordx4 v[72:75], v2, s[32:35], s64 offen sc1
  buffer_load_dwordx4 v[76:79], v2, s[32:35], s65 offen sc1
  buffer_load_dwordx4 v[80:83], v2, s[32:35], s66 offen sc1
  buffer_load_dwordx4 v[84:87], v2, s[32:35], s67 offen sc1
  buffer_load_dwordx4 v[88:91], v2, s[32:35], s68 offen sc1
  buffer_load_dwordx4 v[92:95], v2, s[32:35], s69 offen sc1
  buffer_load_dwordx4 v[96:99], v2, s[32:35], s70 offen sc1
  buffer_load_dwordx4 v[100:103], v2, s[32:35], s71 offen sc1
  buffer_load_dwordx4 v[104:107], v2, s[32:35], s72 offen sc1
  buffer_load_dwordx4 v[108:111], v2, s[32:35], s73 offen sc1
  buffer_load_dwordx4 v[112:115], v2, s[32:35], s74 offen sc1
  buffer_load_dwordx4 v[116:119], v2, s[32:35], s75 offen sc1
  buffer_load_dwordx4 v[120:123], v2, s[32:35], s76 offen sc1
  buffer_load_dwordx4 v[124:127], v2, s[32:35], s77 offen sc1
  buffer_load_dword v48, v30, s[32:35], 0 offen sc1
  buffer_load_dword v49, v30, s[32:35], 0 offen offset:64 sc1
  buffer_load_dword v50, v30, s[32:35], 0 offen offset:128 sc1
  buffer_load_dword v51, v30, s[32:35], 0 offen offset:192 sc1
  buffer_load_dword v52, v30, s[32:35], 0 offen offset:1024 sc1
  buffer_load_dword v53, v30, s[32:35], 0 offen offset:1088 sc1
  buffer_load_dword v54, v30, s[32:35], 0 offen offset:1152 sc1
  buffer_load_dword v55, v30, s[32:35], 0 offen offset:1216 sc1
  buffer_load_dword v56, v31, s[32:35], 0 offen sc1
  buffer_load_dword v57, v31, s[32:35], 0 offen offset:64 sc1
  buffer_load_dword v58, v31, s[32:35], 0 offen offset:128 sc1
  buffer_load_dword v59, v31, s[32:35], 0 offen offset:192 sc1
  buffer_load_dword v60, v31, s[32:35], 0 offen offset:1024 sc1
  buffer_load_dword v61, v31, s[32:35], 0 offen offset:1088 sc1
  buffer_load_dword v62, v31, s[32:35], 0 offen offset:1152 sc1
  buffer_load_dword v63, v31, s[32:35], 0 offen offset:1216 sc1
  s_waitcnt vmcnt(48)
  v_max3_i32 v24, v32, v33, v32
  v_max3_i32 v24, v34, v35, v24
  s_waitcnt vmcnt(44)
  v_max3_i32 v24, v36, v37, v24
  v_max3_i32 v24, v38, v39, v24
  s_waitcnt vmcnt(40)
  v_max3_i32 v24, v40, v41, v24
  v_max3_i32 v24, v42, v43, v24
  s_waitcnt vmcnt(36)
  v_max3_i32 v24, v44, v45, v24
  v_max3_i32 v24, v46, v47, v24
B_GEMM:
  s_waitcnt vmcnt(35)
  v_smfmac_f32_16x16x64_bf16 v[16:19], v[128:131], v[32:39], v1
  v_max3_i32 v24, v24, v128, v130
  s_waitcnt vmcnt(34)
  v_smfmac_f32_16x16x64_bf16 v[16:19], v[132:135], v[40:47], v1
  v_max3_i32 v24, v24, v132, v134
  s_waitcnt vmcnt(33)
  v_max3_i32 v24, v24, v136, v138
  s_waitcnt vmcnt(32)
  v_max3_i32 v24, v24, v140, v142
  v_cmp_eq_u32 vcc, s78, v24
  s_waitcnt vmcnt(31)
  v_smfmac_f32_16x16x64_bf16 v[16:19], v[64:67], a[0:7], v1
  s_waitcnt vmcnt(30)
  v_smfmac_f32_16x16x64_bf16 v[16:19], v[68:71], a[8:15], v1
  s_cbranch_vccnz B_EARLY
  s_waitcnt vmcnt(29)
  v_smfmac_f32_16x16x64_bf16 v[16:19], v[72:75], a[16:23], v1
  s_waitcnt vmcnt(28)
  v_smfmac_f32_16x16x64_bf16 v[16:19], v[76:79], a[24:31], v1
  s_waitcnt vmcnt(27)
  v_smfmac_f32_16x16x64_bf16 v[16:19], v[80:83], a[32:39], v1
  s_waitcnt vmcnt(26)
  v_smfmac_f32_16x16x64_bf16 v[16:19], v[84:87], a[40:47], v1
  s_waitcnt vmcnt(25)
  v_smfmac_f32_16x16x64_bf16 v[16:19], v[88:91], a[48:55], v1
  buffer_store_dword v8, v7, s[32:35], 0 offen sc1
  s_waitcnt vmcnt(25)
  v_smfmac_f32_16x16x64_bf16 v[16:19], v[92:95], a[56:63], v1
  s_waitcnt vmcnt(24)
  v_smfmac_f32_16x16x64_bf16 v[16:19], v[96:99], a[64:71], v1
  s_waitcnt vmcnt(23)
  v_smfmac_f32_16x16x64_bf16 v[16:19], v[100:103], a[72:79], v1
  s_waitcnt vmcnt(22)
  v_smfmac_f32_16x16x64_bf16 v[16:19], v[104:107], a[80:87], v1
  s_waitcnt vmcnt(21)
  v_smfmac_f32_16x16x64_bf16 v[16:19], v[108:111], a[88:95], v1
  s_waitcnt vmcnt(20)
  v_smfmac_f32_16x16x64_bf16 v[16:19], v[112:115], a[96:103], v1
  s_waitcnt vmcnt(19)
  v_smfmac_f32_16x16x64_bf16 v[16:19], v[116:119], a[104:111], v1
  s_waitcnt vmcnt(18)
  v_smfmac_f32_16x16x64_bf16 v[16:19], v[120:123], a[112:119], v1
  s_waitcnt vmcnt(17)
  v_smfmac_f32_16x16x64_bf16 v[16:19], v[124:127], a[120:127], v1
  s_waitcnt vmcnt(9)
  v_smfmac_f32_16x16x64_bf16 v[16:19], v[136:139], v[48:55], v1
  s_waitcnt vmcnt(1)
  v_smfmac_f32_16x16x64_bf16 v[16:19], v[140:143], v[56:63], v1
  s_nop 7
  v_pk_add_f32 v[16:17], v[16:17], v[18:19]
  v_cmp_u_f32 vcc, v16, v17
  v_cvt_pk_bf16_f32 v18, v16, v17
  s_nop 1
  v_mov_b32_dpp v19, v18 quad_perm:[1,0,3,2] row_mask:0xf bank_mask:0xf
  v_perm_b32 v18, v19, v18, v9
  s_cbranch_vccnz B_SLOW
B_CONT:
  buffer_store_dword v18, v144, s[32:35], 0 offen sc1
  s_add_u32 s52, s52, 1
  s_cmp_lt_u32 s52, 63
  s_cbranch_scc1 B_STEP
  s_branch L_EXIT
B_FIRST:
  s_add_u32 s54, s50, 16388
  v_lshl_add_u32 v20, v0, 7, s54
  s_mov_b32 s55, 1
  s_mov_b32 exec_hi, 0x0
  s_mov_b32 s57, 0
PL_17:
  buffer_load_dword v21, v20, s[32:35], 0 offen sc1
  s_waitcnt vmcnt(0)
  v_cmp_gt_u32 vcc, s55, v21
  s_cbranch_vccz PR_18
  s_add_u32 s57, s57, 1
  s_cmp_lt_u32 s57, 0x80000
  s_cbranch_scc1 PL_17
  s_branch L_EXIT
PR_18:
  s_mov_b64 exec, -1
  v_bfe_u32 v20, v0, 2, 3
  v_lshl_add_u32 v23, v21, 3, v20
  s_nop 1
  v_min_u32_dpp v23, v23, v23 row_ror:4 row_mask:0xf bank_mask:0xf
  s_nop 1
  v_min_u32_dpp v23, v23, v23 row_ror:8 row_mask:0xf bank_mask:0xf
  v_mov_b32 v20, v23
  s_nop 1
  v_permlane16_swap_b32 v23, v20
  v_min_u32 v23, v23, v20
  v_bfe_u32 v20, v23, 2, 1
  v_and_b32 v23, 3, v23
  v_lshlrev_b32 v23, 11, v23
  v_lshl_add_u32 v23, v20, 14, v23
  v_and_b32 v20, 3, v0
  v_lshl_add_u32 v23, v20, 7, v23
  s_and_b32 s54, s2, 3
  v_readlane_b32 s54, v23, s54
  s_add_u32 s54, s54, s50
  s_add_u32 s54, s54, 131072
  v_mov_b32 v5, s54
  s_add_u32 s54, s50, 131584
  s_cmp_eq_u32 s49, 0
  s_cselect_b32 s54, s54, 0x40000000
  s_cmp_eq_u32 s48, 39
  s_cselect_b32 s54, s54, 0x40000000
  v_add_u32 v7, s54, v23
  v_mov_b32 v20, 0x40000000
  v_cmp_lt_u32 vcc, 3, v0
  s_nop 1
  v_cndmask_b32 v7, v7, v20, vcc
  s_add_u32 s54, s50, 0
  v_lshl_add_u32 v20, v0, 7, s54
  s_mov_b32 s55, 1
  s_mov_b32 s57, 0
PL_19:
  buffer_load_dword v21, v20, s[32:35], 0 offen sc1
  s_waitcnt vmcnt(0)
  v_cmp_gt_u32 vcc, s55, v21
  s_cbranch_vccz PR_20
  s_add_u32 s57, s57, 1
  s_cmp_lt_u32 s57, 0x80000
  s_cbranch_scc1 PL_19
  s_branch L_EXIT
PR_20:
  s_mov_b32 s58, 1
  s_branch B_FDONE
B_HELP:
  s_sub_u32 s62, s49, 1
  s_cmp_ge_u32 s48, 32
  s_cbranch_scc1 HV_21
  s_mov_b32 s36, s16
  s_and_b32 s37, s17, 0xffff
  s_mov_b32 s38, 0x780000
  s_mov_b32 s39, 0x20000
  s_mul_i32 s63, s48, 384
  v_mul_u32_u24 v2, 12288, v0
  v_add_u32 v2, s63, v2
  s_and_b32 s66, s48, 3
  s_mul_i32 s66, s66, 5
  s_lshr_b32 s66, s66, 1
HA_22:
  s_mul_i32 s63, s62, 86
  s_lshr_b32 s63, s63, 8
  s_mul_i32 s64, s63, 3
  s_sub_u32 s64, s62, s64
  s_lshl_b32 s64, s64, 7
  s_add_u32 s63, s63, s66
  s_cmp_ge_u32 s63, 10
  s_cselect_b32 s67, 10, 0
  s_sub_u32 s63, s63, s67
  s_mul_i32 s63, s63, 786432
  s_add_u32 s63, s63, s64
  buffer_load_dword v3, v2, s[36:39], s63 offen
  s_waitcnt vmcnt(0)
  s_add_u32 s62, s62, 3
  s_cmp_lt_u32 s62, 30
  s_cbranch_scc1 HA_22
  s_branch HD_24
HV_21:
  s_mov_b32 s36, s22
  s_and_b32 s37, s23, 0xffff
  s_mov_b32 s38, 0x780000
  s_mov_b32 s39, 0x20000
  s_sub_u32 s63, s48, 32
  s_mul_i32 s63, s63, 245760
  v_lshl_add_u32 v2, v0, 7, s63
  s_add_u32 s62, s62, 0
HB_23:
  s_lshl_b32 s63, s62, 13
  buffer_load_dword v3, v2, s[36:39], s63 offen
  s_waitcnt vmcnt(0)
  s_add_u32 s62, s62, 3
  s_cmp_lt_u32 s62, 30
  s_cbranch_scc1 HB_23
HD_24:
  s_waitcnt vmcnt(0)
  v_min_u32 v20, 47, v0
  v_max_u32 v20, 40, v20
  v_lshlrev_b32 v20, 2, v20
  s_mov_b32 s57, 0
WI_25:
  global_load_dword v21, v20, s[28:29] sc1
  s_add_u32 s57, s57, 1
  s_cmp_gt_u32 s57, 0x20000
  s_cbranch_scc1 L_EXIT
  s_waitcnt vmcnt(0)
  s_and_b32 s53, s24, 7
  s_add_u32 s53, s53, 40
  v_readlane_b32 s53, v21, s53
  s_nop 1
  v_cmp_gt_u32 vcc, s53, v21
  s_bfe_u32 s53, vcc_hi, 0x80008
  s_bcnt1_i32_b32 s53, s53
  v_cmp_eq_u32 vcc, 0, v21
  s_bfe_u32 s54, vcc_hi, 0x80008
  s_cbranch_scc1 WI_27
  s_cmp_lg_u32 s53, s25
  s_cbranch_scc1 L_REDO
WI_27:
  s_cbranch_vccz WI_26
  s_sleep 2
  s_branch WI_25
WI_26:
  s_branch L_EXIT
B_EARLY:
  s_add_u32 s57, s57, 1
  s_cmp_gt_u32 s57, 0x80000
  s_cbranch_scc1 L_EXIT
  s_nop 7
  v_mov_b64 v[16:17], 0
  v_mov_b64 v[18:19], 0
  s_waitcnt vmcnt(8)
  s_branch B_LOADS
B_SLOW:
  s_cmp_lg_u32 s58, 0
  s_cbranch_scc1 B_CONT
  v_mov_b64 v[16:17], 0
  v_mov_b64 v[18:19], 0
  s_add_u32 s59, s59, 1
  s_cmp_lt_u32 s59, 3
  s_cbranch_scc1 B_LOADP
  s_mov_b32 s57, 0
VR_28:
  buffer_load_dword v32, v28, s[32:35], 0 offen sc1
  buffer_load_dword v33, v28, s[32:35], 0 offen offset:64 sc1
  buffer_load_dword v34, v28, s[32:35], 0 offen offset:128 sc1
  buffer_load_dword v35, v28, s[32:35], 0 offen offset:192 sc1
  buffer_load_dword v36, v28, s[32:35], 0 offen offset:1024 sc1
  buffer_load_dword v37, v28, s[32:35], 0 offen offset:1088 sc1
  buffer_load_dword v38, v28, s[32:35], 0 offen offset:1152 sc1
  buffer_load_dword v39, v28, s[32:35], 0 offen offset:1216 sc1
  buffer_load_dword v40, v29, s[32:35], 0 offen sc1
  buffer_load_dword v41, v29, s[32:35], 0 offen offset:64 sc1
  buffer_load_dword v42, v29, s[32:35], 0 offen offset:128 sc1
  buffer_load_dword v43, v29, s[32:35], 0 offen offset:192 sc1
  buffer_load_dword v44, v29, s[32:35], 0 offen offset:1024 sc1
  buffer_load_dword v45, v29, s[32:35], 0 offen offset:1088 sc1
  buffer_load_dword v46, v29, s[32:35], 0 offen offset:1152 sc1
  buffer_load_dword v47, v29, s[32:35], 0 offen offset:1216 sc1
  buffer_load_dword v48, v30, s[32:35], 0 offen sc1
  buffer_load_dword v49, v30, s[32:35], 0 offen offset:64 sc1
  buffer_load_dword v50, v30, s[32:35], 0 offen offset:128 sc1
  buffer_load_dword v51, v30, s[32:35], 0 offen offset:192 sc1
  buffer_load_dword v52, v30, s[32:35], 0 offen offset:1024 sc1
  buffer_load_dword v53, v30, s[32:35], 0 offen offset:1088 sc1
  buffer_load_dword v54, v30, s[32:35], 0 offen offset:1152 sc1
  buffer_load_dword v55, v30, s[32:35], 0 offen offset:1216 sc1
  buffer_load_dword v56, v31, s[32:35], 0 offen sc1
  buffer_load_dword v57, v31, s[32:35], 0 offen offset:64 sc1
  buffer_load_dword v58, v31, s[32:35], 0 offen offset:128 sc1
  buffer_load_dword v59, v31, s[32:35], 0 offen offset:192 sc1
  buffer_load_dword v60, v31, s[32:35], 0 offen offset:1024 sc1
  buffer_load_dword v61, v31, s[32:35], 0 offen offset:1088 sc1
  buffer_load_dword v62, v31, s[32:35], 0 offen offset:1152 sc1
  buffer_load_dword v63, v31, s[32:35], 0 offen offset:1216 sc1
  buffer_load_dwordx4 v[128:131], v3, s[32:35], s4 offen sc1
  buffer_load_dwordx4 v[132:135], v3, s[32:35], s5 offen sc1
  buffer_load_dwordx4 v[136:139], v3, s[32:35], s6 offen sc1
  buffer_load_dwordx4 v[140:143], v3, s[32:35], s7 offen sc1
  buffer_load_dwordx4 v[64:67], v2, s[32:35], s62 offen sc1
  buffer_load_dwordx4 v[68:71], v2, s[32:35], s63 offen sc1
  buffer_load_dwordx4 v[72:75], v2, s[32:35], s64 offen sc1
  buffer_load_dwordx4 v[76:79], v2, s[32:35], s65 offen sc1
  buffer_load_dwordx4 v[80:83], v2, s[32:35], s66 offen sc1
  buffer_load_dwordx4 v[84:87], v2, s[32:35], s67 offen sc1
  buffer_load_dwordx4 v[88:91], v2, s[32:35], s68 offen sc1
  buffer_load_dwordx4 v[92:95], v2, s[32:35], s69 offen sc1
  buffer_load_dwordx4 v[96:99], v2, s[32:35], s70 offen sc1
  buffer_load_dwordx4 v[100:103], v2, s[32:35], s71 offen sc1
  buffer_load_dwordx4 v[104:107], v2, s[32:35], s72 offen sc1
  buffer_load_dwordx4 v[108:111], v2, s[32:35], s73 offen sc1
  buffer_load_dwordx4 v[112:115], v2, s[32:35], s74 offen sc1
  buffer_load_dwordx4 v[116:119], v2, s[32:35], s75 offen sc1
  buffer_load_dwordx4 v[120:123], v2, s[32:35], s76 offen sc1
  buffer_load_dwordx4 v[124:127], v2, s[32:35], s77 offen sc1
  s_add_u32 s57, s57, 1
  s_cmp_gt_u32 s57, 0x20000
  s_cbranch_scc1 L_EXIT
  s_waitcnt vmcnt(0)
  s_mov_b64 s[60:61], 0
  v_cmp_eq_u32 vcc, s78, v32
  s_nop 0
  s_or_b64 s[60:61], s[60:61], vcc
  v_cmp_eq_u32 vcc, s78, v33
  s_nop 0
  s_or_b64 s[60:61], s[60:61], vcc
  v_cmp_eq_u32 vcc, s78, v34
  s_nop 0
  s_or_b64 s[60:61], s[60:61], vcc
  v_cmp_eq_u32 vcc, s78, v35
  s_nop 0
  s_or_b64 s[60:61], s[60:61], vcc
  v_cmp_eq_u32 vcc, s78, v36
  s_nop 0
  s_or_b64 s[60:61], s[60:61], vcc
  v_cmp_eq_u32 vcc, s78, v37
  s_nop 0
  s_or_b64 s[60:61], s[60:61], vcc
  v_cmp_eq_u32 vcc, s78, v38
  s_nop 0
  s_or_b64 s[60:61], s[60:61], vcc
  v_cmp_eq_u32 vcc, s78, v39
  s_nop 0
  s_or_b64 s[60:61], s[60:61], vcc
  v_cmp_eq_u32 vcc, s78, v40
  s_nop 0
  s_or_b64 s[60:61], s[60:61], vcc
  v_cmp_eq_u32 vcc, s78, v41
  s_nop 0
  s_or_b64 s[60:61], s[60:61], vcc
  v_cmp_eq_u32 vcc, s78, v42
  s_nop 0
  s_or_b64 s[60:61], s[60:61], vcc
  v_cmp_eq_u32 vcc, s78, v43
  s_nop 0
  s_or_b64 s[60:61], s[60:61], vcc
  v_cmp_eq_u32 vcc, s78, v44
  s_nop 0
  s_or_b64 s[60:61], s[60:61], vcc
  v_cmp_eq_u32 vcc, s78, v45
  s_nop 0
  s_or_b64 s[60:61], s[60:61], vcc
  v_cmp_eq_u32 vcc, s78, v46
  s_nop 0
  s_or_b64 s[60:61], s[60:61], vcc
  v_cmp_eq_u32 vcc, s78, v47
  s_nop 0
  s_or_b64 s[60:61], s[60:61], vcc
  v_cmp_eq_u32 vcc, s78, v48
  s_nop 0
  s_or_b64 s[60:61], s[60:61], vcc
  v_cmp_eq_u32 vcc, s78, v49
  s_nop 0
  s_or_b64 s[60:61], s[60:61], vcc
  v_cmp_eq_u32 vcc, s78, v50
  s_nop 0
  s_or_b64 s[60:61], s[60:61], vcc
  v_cmp_eq_u32 vcc, s78, v51
  s_nop 0
  s_or_b64 s[60:61], s[60:61], vcc
  v_cmp_eq_u32 vcc, s78, v52
  s_nop 0
  s_or_b64 s[60:61], s[60:61], vcc
  v_cmp_eq_u32 vcc, s78, v53
  s_nop 0
  s_or_b64 s[60:61], s[60:61], vcc
  v_cmp_eq_u32 vcc, s78, v54
  s_nop 0
  s_or_b64 s[60:61], s[60:61], vcc
  v_cmp_eq_u32 vcc, s78, v55
  s_nop 0
  s_or_b64 s[60:61], s[60:61], vcc
  v_cmp_eq_u32 vcc, s78, v56
  s_nop 0
  s_or_b64 s[60:61], s[60:61], vcc
  v_cmp_eq_u32 vcc, s78, v57
  s_nop 0
  s_or_b64 s[60:61], s[60:61], vcc
  v_cmp_eq_u32 vcc, s78, v58
  s_nop 0
  s_or_b64 s[60:61], s[60:61], vcc
  v_cmp_eq_u32 vcc, s78, v59
  s_nop 0
  s_or_b64 s[60:61], s[60:61], vcc
  v_cmp_eq_u32 vcc, s78, v60
  s_nop 0
  s_or_b64 s[60:61], s[60:61], vcc
  v_cmp_eq_u32 vcc, s78, v61
  s_nop 0
  s_or_b64 s[60:61], s[60:61], vcc
  v_cmp_eq_u32 vcc, s78, v62
  s_nop 0
  s_or_b64 s[60:61], s[60:61], vcc
  v_cmp_eq_u32 vcc, s78, v63
  s_nop 0
  s_or_b64 s[60:61], s[60:61], vcc
  v_cmp_eq_u32 vcc, s78, v64
  s_nop 0
  s_or_b64 s[60:61], s[60:61], vcc
  v_cmp_eq_u32 vcc, s78, v65
  s_nop 0
  s_or_b64 s[60:61], s[60:61], vcc
  v_cmp_eq_u32 vcc, s78, v66
  s_nop 0
  s_or_b64 s[60:61], s[60:61], vcc
  v_cmp_eq_u32 vcc, s78, v67
  s_nop 0
  s_or_b64 s[60:61], s[60:61], vcc
  v_cmp_eq_u32 vcc, s78, v68
  s_nop 0
  s_or_b64 s[60:61], s[60:61], vcc
  v_cmp_eq_u32 vcc, s78, v69
  s_nop 0
  s_or_b64 s[60:61], s[60:61], vcc
  v_cmp_eq_u32 vcc, s78, v70
  s_nop 0
  s_or_b64 s[60:61], s[60:61], vcc
  v_cmp_eq_u32 vcc, s78, v71
  s_nop 0
  s_or_b64 s[60:61], s[60:61], vcc
  v_cmp_eq_u32 vcc, s78, v72
  s_nop 0
  s_or_b64 s[60:61], s[60:61], vcc
  v_cmp_eq_u32 vcc, s78, v73
  s_nop 0
  s_or_b64 s[60:61], s[60:61], vcc
  v_cmp_eq_u32 vcc, s78, v74
  s_nop 0
  s_or_b64 s[60:61], s[60:61], vcc
  v_cmp_eq_u32 vcc, s78, v75
  s_nop 0
  s_or_b64 s[60:61], s[60:61], vcc
  v_cmp_eq_u32 vcc, s78, v76
  s_nop 0
  s_or_b64 s[60:61], s[60:61], vcc
  v_cmp_eq_u32 vcc, s78, v77
  s_nop 0
  s_or_b64 s[60:61], s[60:61], vcc
  v_cmp_eq_u32 vcc, s78, v78
  s_nop 0
  s_or_b64 s[60:61], s[60:61], vcc
  v_cmp_eq_u32 vcc, s78, v79
  s_nop 0
  s_or_b64 s[60:61], s[60:61], vcc
  v_cmp_eq_u32 vcc, s78, v80
  s_nop 0
  s_or_b64 s[60:61], s[60:61], vcc
  v_cmp_eq_u32 vcc, s78, v81
  s_nop 0
  s_or_b64 s[60:61], s[60:61], vcc
  v_cmp_eq_u32 vcc, s78, v82
  s_nop 0
  s_or_b64 s[60:61], s[60:61], vcc
  v_cmp_eq_u32 vcc, s78, v83
  s_nop 0
  s_or_b64 s[60:61], s[60:61], vcc
  v_cmp_eq_u32 vcc, s78, v84
  s_nop 0
  s_or_b64 s[60:61], s[60:61], vcc
  v_cmp_eq_u32 vcc, s78, v85
  s_nop 0
  s_or_b64 s[60:61], s[60:61], vcc
  v_cmp_eq_u32 vcc, s78, v86
  s_nop 0
  s_or_b64 s[60:61], s[60:61], vcc
  v_cmp_eq_u32 vcc, s78, v87
  s_nop 0
  s_or_b64 s[60:61], s[60:61], vcc
  v_cmp_eq_u32 vcc, s78, v88
  s_nop 0
  s_or_b64 s[60:61], s[60:61], vcc
  v_cmp_eq_u32 vcc, s78, v89
  s_nop 0
  s_or_b64 s[60:61], s[60:61], vcc
  v_cmp_eq_u32 vcc, s78, v90
  s_nop 0
  s_or_b64 s[60:61], s[60:61], vcc
  v_cmp_eq_u32 vcc, s78, v91
  s_nop 0
  s_or_b64 s[60:61], s[60:61], vcc
  v_cmp_eq_u32 vcc, s78, v92
  s_nop 0
  s_or_b64 s[60:61], s[60:61], vcc
  v_cmp_eq_u32 vcc, s78, v93
  s_nop 0
  s_or_b64 s[60:61], s[60:61], vcc
  v_cmp_eq_u32 vcc, s78, v94
  s_nop 0
  s_or_b64 s[60:61], s[60:61], vcc
  v_cmp_eq_u32 vcc, s78, v95
  s_nop 0
  s_or_b64 s[60:61], s[60:61], vcc
  v_cmp_eq_u32 vcc, s78, v96
  s_nop 0
  s_or_b64 s[60:61], s[60:61], vcc
  v_cmp_eq_u32 vcc, s78, v97
  s_nop 0
  s_or_b64 s[60:61], s[60:61], vcc
  v_cmp_eq_u32 vcc, s78, v98
  s_nop 0
  s_or_b64 s[60:61], s[60:61], vcc
  v_cmp_eq_u32 vcc, s78, v99
  s_nop 0
  s_or_b64 s[60:61], s[60:61], vcc
  v_cmp_eq_u32 vcc, s78, v100
  s_nop 0
  s_or_b64 s[60:61], s[60:61], vcc
  v_cmp_eq_u32 vcc, s78, v101
  s_nop 0
  s_or_b64 s[60:61], s[60:61], vcc
  v_cmp_eq_u32 vcc, s78, v102
  s_nop 0
  s_or_b64 s[60:61], s[60:61], vcc
  v_cmp_eq_u32 vcc, s78, v103
  s_nop 0
  s_or_b64 s[60:61], s[60:61], vcc
  v_cmp_eq_u32 vcc, s78, v104
  s_nop 0
  s_or_b64 s[60:61], s[60:61], vcc
  v_cmp_eq_u32 vcc, s78, v105
  s_nop 0
  s_or_b64 s[60:61], s[60:61], vcc
  v_cmp_eq_u32 vcc, s78, v106
  s_nop 0
  s_or_b64 s[60:61], s[60:61], vcc
  v_cmp_eq_u32 vcc, s78, v107
  s_nop 0
  s_or_b64 s[60:61], s[60:61], vcc
  v_cmp_eq_u32 vcc, s78, v108
  s_nop 0
  s_or_b64 s[60:61], s[60:61], vcc
  v_cmp_eq_u32 vcc, s78, v109
  s_nop 0
  s_or_b64 s[60:61], s[60:61], vcc
  v_cmp_eq_u32 vcc, s78, v110
  s_nop 0
  s_or_b64 s[60:61], s[60:61], vcc
  v_cmp_eq_u32 vcc, s78, v111
  s_nop 0
  s_or_b64 s[60:61], s[60:61], vcc
  v_cmp_eq_u32 vcc, s78, v112
  s_nop 0
  s_or_b64 s[60:61], s[60:61], vcc
  v_cmp_eq_u32 vcc, s78, v113
  s_nop 0
  s_or_b64 s[60:61], s[60:61], vcc
  v_cmp_eq_u32 vcc, s78, v114
  s_nop 0
  s_or_b64 s[60:61], s[60:61], vcc
  v_cmp_eq_u32 vcc, s78, v115
  s_nop 0
  s_or_b64 s[60:61], s[60:61], vcc
  v_cmp_eq_u32 vcc, s78, v116
  s_nop 0
  s_or_b64 s[60:61], s[60:61], vcc
  v_cmp_eq_u32 vcc, s78, v117
  s_nop 0
  s_or_b64 s[60:61], s[60:61], vcc
  v_cmp_eq_u32 vcc, s78, v118
  s_nop 0
  s_or_b64 s[60:61], s[60:61], vcc
  v_cmp_eq_u32 vcc, s78, v119
  s_nop 0
  s_or_b64 s[60:61], s[60:61], vcc
  v_cmp_eq_u32 vcc, s78, v120
  s_nop 0
  s_or_b64 s[60:61], s[60:61], vcc
  v_cmp_eq_u32 vcc, s78, v121
  s_nop 0
  s_or_b64 s[60:61], s[60:61], vcc
  v_cmp_eq_u32 vcc, s78, v122
  s_nop 0
  s_or_b64 s[60:61], s[60:61], vcc
  v_cmp_eq_u32 vcc, s78, v123
  s_nop 0
  s_or_b64 s[60:61], s[60:61], vcc
  v_cmp_eq_u32 vcc, s78, v124
  s_nop 0
  s_or_b64 s[60:61], s[60:61], vcc
  v_cmp_eq_u32 vcc, s78, v125
  s_nop 0
  s_or_b64 s[60:61], s[60:61], vcc
  v_cmp_eq_u32 vcc, s78, v126
  s_nop 0
  s_or_b64 s[60:61], s[60:61], vcc
  v_cmp_eq_u32 vcc, s78, v127
  s_nop 0
  s_or_b64 s[60:61], s[60:61], vcc
  v_cmp_eq_u32 vcc, s78, v128
  s_nop 0
  s_or_b64 s[60:61], s[60:61], vcc
  v_cmp_eq_u32 vcc, s78, v129
  s_nop 0
  s_or_b64 s[60:61], s[60:61], vcc
  v_cmp_eq_u32 vcc, s78, v130
  s_nop 0
  s_or_b64 s[60:61], s[60:61], vcc
  v_cmp_eq_u32 vcc, s78, v131
  s_nop 0
  s_or_b64 s[60:61], s[60:61], vcc
  v_cmp_eq_u32 vcc, s78, v132
  s_nop 0
  s_or_b64 s[60:61], s[60:61], vcc
  v_cmp_eq_u32 vcc, s78, v133
  s_nop 0
  s_or_b64 s[60:61], s[60:61], vcc
  v_cmp_eq_u32 vcc, s78, v134
  s_nop 0
  s_or_b64 s[60:61], s[60:61], vcc
  v_cmp_eq_u32 vcc, s78, v135
  s_nop 0
  s_or_b64 s[60:61], s[60:61], vcc
  v_cmp_eq_u32 vcc, s78, v136
  s_nop 0
  s_or_b64 s[60:61], s[60:61], vcc
  v_cmp_eq_u32 vcc, s78, v137
  s_nop 0
  s_or_b64 s[60:61], s[60:61], vcc
  v_cmp_eq_u32 vcc, s78, v138
  s_nop 0
  s_or_b64 s[60:61], s[60:61], vcc
  v_cmp_eq_u32 vcc, s78, v139
  s_nop 0
  s_or_b64 s[60:61], s[60:61], vcc
  v_cmp_eq_u32 vcc, s78, v140
  s_nop 0
  s_or_b64 s[60:61], s[60:61], vcc
  v_cmp_eq_u32 vcc, s78, v141
  s_nop 0
  s_or_b64 s[60:61], s[60:61], vcc
  v_cmp_eq_u32 vcc, s78, v142
  s_nop 0
  s_or_b64 s[60:61], s[60:61], vcc
  v_cmp_eq_u32 vcc, s78, v143
  s_nop 0
  s_or_b64 s[60:61], s[60:61], vcc
  s_cbranch_scc1 VR_28
  s_mov_b32 s58, 1
  v_mov_b32 v24, 0
  s_branch B_GEMM
B_END:
L_EXIT:
  s_endpgm
R_A:
  s_mov_b32 s36, s16
  s_and_b32 s37, s17, 0xffff
  s_mov_b32 s38, 0x780000
  s_mov_b32 s39, 0x20000
  s_mov_b32 s40, s18
  s_and_b32 s41, s19, 0xffff
  s_mov_b32 s42, 0x780000
  s_mov_b32 s43, 0x20000
  s_and_b32 s53, s48, 3
  s_mul_i32 s53, s53, 5
  s_lshr_b32 s62, s53, 1
  s_add_u32 s63, s62, 1
  s_cmp_eq_u32 s63, 10
  s_cselect_b32 s63, 0, s63
  s_add_u32 s64, s63, 1
  s_cmp_eq_u32 s64, 10
  s_cselect_b32 s64, 0, s64
  s_add_u32 s65, s64, 1
  s_cmp_eq_u32 s65, 10
  s_cselect_b32 s65, 0, s65
  s_add_u32 s66, s65, 1
  s_cmp_eq_u32 s66, 10
  s_cselect_b32 s66, 0, s66
  s_add_u32 s67, s66, 1
  s_cmp_eq_u32 s67, 10
  s_cselect_b32 s67, 0, s67
  s_add_u32 s68, s67, 1
  s_cmp_eq_u32 s68, 10
  s_cselect_b32 s68, 0, s68
  s_add_u32 s69, s68, 1
  s_cmp_eq_u32 s69, 10
  s_cselect_b32 s69, 0, s69
  s_add_u32 s70, s69, 1
  s_cmp_eq_u32 s70, 10
  s_cselect_b32 s70, 0, s70
  s_add_u32 s71, s70, 1
  s_cmp_eq_u32 s71, 10
  s_cselect_b32 s71, 0, s71
  v_lshlrev_b32 v11, 4, v0
  s_mul_i32 s53, s49, 21504
  v_add_u32 v3, s53, v11
  s_mul_i32 s55, s48, 384
  s_mul_i32 s53, s49, 384
  s_add_u32 s53, s53, 0
  v_add_u32 v60, s53, v0
  v_mul_u32_u24 v61, 43691, v60
  v_lshrrev_b32 v61, 20, v61
  v_mul_u32_u24 v62, 24, v61
  v_sub_u32 v60, v60, v62
  v_and_b32 v62, 2, v61
  v_lshrrev_b32 v63, 1, v61
  v_and_b32 v63, 4, v63
  v_or_b32 v62, v62, v63
  v_xor_b32 v60, v60, v62
  v_mul_u32_u24 v61, 12288, v61
  v_lshl_add_u32 v40, v60, 4, v61
  v_add_u32 v40, s55, v40
  s_mul_i32 s53, s49, 384
  s_add_u32 s53, s53, 64
  v_add_u32 v60, s53, v0
  v_mul_u32_u24 v61, 43691, v60
  v_lshrrev_b32 v61, 20, v61
  v_mul_u32_u24 v62, 24, v61
  v_sub_u32 v60, v60, v62
  v_and_b32 v62, 2, v61
  v_lshrrev_b32 v63, 1, v61
  v_and_b32 v63, 4, v63
  v_or_b32 v62, v62, v63
  v_xor_b32 v60, v60, v62
  v_mul_u32_u24 v61, 12288, v61
  v_lshl_add_u32 v41, v60, 4, v61
  v_add_u32 v41, s55, v41
  s_mul_i32 s53, s49, 384
  s_add_u32 s53, s53, 128
  v_add_u32 v60, s53, v0
  v_mul_u32_u24 v61, 43691, v60
  v_lshrrev_b32 v61, 20, v61
  v_mul_u32_u24 v62, 24, v61
  v_sub_u32 v60, v60, v62
  v_and_b32 v62, 2, v61
  v_lshrrev_b32 v63, 1, v61
  v_and_b32 v63, 4, v63
  v_or_b32 v62, v62, v63
  v_xor_b32 v60, v60, v62
  v_mul_u32_u24 v61, 12288, v61
  v_lshl_add_u32 v42, v60, 4, v61
  v_add_u32 v42, s55, v42
  s_mul_i32 s53, s49, 384
  s_add_u32 s53, s53, 192
  v_add_u32 v60, s53, v0
  v_mul_u32_u24 v61, 43691, v60
  v_lshrrev_b32 v61, 20, v61
  v_mul_u32_u24 v62, 24, v61
  v_sub_u32 v60, v60, v62
  v_and_b32 v62, 2, v61
  v_lshrrev_b32 v63, 1, v61
  v_and_b32 v63, 4, v63
  v_or_b32 v62, v62, v63
  v_xor_b32 v60, v60, v62
  v_mul_u32_u24 v61, 12288, v61
  v_lshl_add_u32 v43, v60, 4, v61
  v_add_u32 v43, s55, v43
  s_mul_i32 s53, s49, 384
  s_add_u32 s53, s53, 256
  v_add_u32 v60, s53, v0
  v_mul_u32_u24 v61, 43691, v60
  v_lshrrev_b32 v61, 20, v61
  v_mul_u32_u24 v62, 24, v61
  v_sub_u32 v60, v60, v62
  v_and_b32 v62, 2, v61
  v_lshrrev_b32 v63, 1, v61
  v_and_b32 v63, 4, v63
  v_or_b32 v62, v62, v63
  v_xor_b32 v60, v60, v62
  v_mul_u32_u24 v61, 12288, v61
  v_lshl_add_u32 v44, v60, 4, v61
  v_add_u32 v44, s55, v44
  s_mul_i32 s53, s49, 384
  s_add_u32 s53, s53, 320
  v_add_u32 v60, s53, v0
  v_mul_u32_u24 v61, 43691, v60
  v_lshrrev_b32 v61, 20, v61
  v_mul_u32_u24 v62, 24, v61
  v_sub_u32 v60, v60, v62
  v_and_b32 v62, 2, v61
  v_lshrrev_b32 v63, 1, v61
  v_and_b32 v63, 4, v63
  v_or_b32 v62, v62, v63
  v_xor_b32 v60, v60, v62
  v_mul_u32_u24 v61, 12288, v61
  v_lshl_add_u32 v45, v60, 4, v61
  v_add_u32 v45, s55, v45
  s_mul_i32 s55, s49, 3
  s_add_u32 s55, s55, 0
  v_lshrrev_b32 v60, 4, v0
  v_bfe_u32 v61, v0, 2, 2
  v_lshl_add_u32 v62, v60, 3, v61
  v_and_b32 v60, 1, v60
  v_lshrrev_b32 v61, 1, v61
  v_lshl_add_u32 v60, v60, 1, v61
  v_xor_b32 v60, s55, v60
  v_mul_u32_u24 v62, 384, v62
  v_lshl_add_u32 v62, v60, 5, v62
  v_and_b32 v60, 3, v0
  v_lshl_add_u32 v46, v60, 3, v62
  s_mul_i32 s55, s49, 3
  s_add_u32 s55, s55, 1
  v_lshrrev_b32 v60, 4, v0
  v_bfe_u32 v61, v0, 2, 2
  v_lshl_add_u32 v62, v60, 3, v61
  v_and_b32 v60, 1, v60
  v_lshrrev_b32 v61, 1, v61
  v_lshl_add_u32 v60, v60, 1, v61
  v_xor_b32 v60, s55, v60
  v_mul_u32_u24 v62, 384, v62
  v_lshl_add_u32 v62, v60, 5, v62
  v_and_b32 v60, 3, v0
  v_lshl_add_u32 v47, v60, 3, v62
  s_mul_i32 s55, s49, 3
  s_add_u32 s55, s55, 2
  v_lshrrev_b32 v60, 4, v0
  v_bfe_u32 v61, v0, 2, 2
  v_lshl_add_u32 v62, v60, 3, v61
  v_and_b32 v60, 1, v60
  v_lshrrev_b32 v61, 1, v61
  v_lshl_add_u32 v60, v60, 1, v61
  v_xor_b32 v60, s55, v60
  v_mul_u32_u24 v62, 384, v62
  v_lshl_add_u32 v62, v60, 5, v62
  v_and_b32 v60, 3, v0
  v_lshl_add_u32 v48, v60, 3, v62
  s_getpc_b64 s[60:61]
PC_29:
  s_lshl_b32 s53, s49, 6
  v_add_u32 v100, s53, v0
  v_lshlrev_b32 v100, 7, v100
  v_min_u32 v100, R_V-A_LD-4, v100
  v_add_u32 v100, A_LD-PC_29, v100
  v_mov_b32 v101, s61
  v_add_co_u32 v100, vcc, s60, v100
  s_nop 1
  v_addc_co_u32 v101, vcc, 0, v101, vcc
  s_mul_i32 s54, s62, 786432
  s_mul_i32 s53, s49, 6144
  s_add_u32 m0, s53, 0
  s_nop 0
  buffer_load_dwordx4 v40, s[40:43], s54 offen  lds
  s_add_u32 m0, m0, 1024
  s_nop 0
  buffer_load_dwordx4 v41, s[40:43], s54 offen  lds
  s_add_u32 m0, m0, 1024
  s_nop 0
  buffer_load_dwordx4 v42, s[40:43], s54 offen  lds
  s_add_u32 m0, m0, 1024
  s_nop 0
  buffer_load_dwordx4 v43, s[40:43], s54 offen  lds
  s_add_u32 m0, m0, 1024
  s_nop 0
  buffer_load_dwordx4 v44, s[40:43], s54 offen  lds
  s_add_u32 m0, m0, 1024
  s_nop 0
  buffer_load_dwordx4 v45, s[40:43], s54 offen  lds
  s_mul_i32 s54, s62, 786432
  s_mul_i32 s53, s49, 6144
  s_add_u32 m0, s53, 24576
  s_nop 0
  buffer_load_dwordx4 v40, s[36:39], s54 offen  lds
  s_add_u32 m0, m0, 1024
  s_nop 0
  buffer_load_dwordx4 v41, s[36:39], s54 offen  lds
  s_add_u32 m0, m0, 1024
  s_nop 0
  buffer_load_dwordx4 v42, s[36:39], s54 offen  lds
  s_add_u32 m0, m0, 1024
  s_nop 0
  buffer_load_dwordx4 v43, s[36:39], s54 offen  lds
  s_add_u32 m0, m0, 1024
  s_nop 0
  buffer_load_dwordx4 v44, s[36:39], s54 offen  lds
  s_add_u32 m0, m0, 1024
  s_nop 0
  buffer_load_dwordx4 v45, s[36:39], s54 offen  lds
  s_mul_i32 s54, s63, 786432
  s_mul_i32 s53, s49, 6144
  s_add_u32 m0, s53, 49152
  s_nop 0
  buffer_load_dwordx4 v40, s[40:43], s54 offen  lds
  s_add_u32 m0, m0, 1024
  s_nop 0
  buffer_load_dwordx4 v41, s[40:43], s54 offen  lds
  s_add_u32 m0, m0, 1024
  s_nop 0
  buffer_load_dwordx4 v42, s[40:43], s54 offen  lds
  s_add_u32 m0, m0, 1024
  s_nop 0
  buffer_load_dwordx4 v43, s[40:43], s54 offen  lds
  s_add_u32 m0, m0, 1024
  s_nop 0
  buffer_load_dwordx4 v44, s[40:43], s54 offen  lds
  s_add_u32 m0, m0, 1024
  s_nop 0
  buffer_load_dwordx4 v45, s[40:43], s54 offen  lds
  s_mul_i32 s54, s63, 786432
  s_mul_i32 s53, s49, 6144
  s_add_u32 m0, s53, 73728
  s_nop 0
  buffer_load_dwordx4 v40, s[36:39], s54 offen  lds
  s_add_u32 m0, m0, 1024
  s_nop 0
  buffer_load_dwordx4 v41, s[36:39], s54 offen  lds
  s_add_u32 m0, m0, 1024
  s_nop 0
  buffer_load_dwordx4 v42, s[36:39], s54 offen  lds
  s_add_u32 m0, m0, 1024
  s_nop 0
  buffer_load_dwordx4 v43, s[36:39], s54 offen  lds
  s_add_u32 m0, m0, 1024
  s_nop 0
  buffer_load_dwordx4 v44, s[36:39], s54 offen  lds
  s_add_u32 m0, m0, 1024
  s_nop 0
  buffer_load_dwordx4 v45, s[36:39], s54 offen  lds
  s_mul_i32 s54, s64, 786432
  s_mul_i32 s53, s49, 6144
  s_add_u32 m0, s53, 98304
  s_nop 0
  buffer_load_dwordx4 v40, s[40:43], s54 offen  lds
  s_add_u32 m0, m0, 1024
  s_nop 0
  buffer_load_dwordx4 v41, s[40:43], s54 offen  lds
  s_add_u32 m0, m0, 1024
  s_nop 0
  buffer_load_dwordx4 v42, s[40:43], s54 offen  lds
  s_add_u32 m0, m0, 1024
  s_nop 0
  buffer_load_dwordx4 v43, s[40:43], s54 offen  lds
  s_add_u32 m0, m0, 1024
  s_nop 0
  buffer_load_dwordx4 v44, s[40:43], s54 offen  lds
  s_add_u32 m0, m0, 1024
  s_nop 0
  buffer_load_dwordx4 v45, s[40:43], s54 offen  lds
  s_mul_i32 s54, s64, 786432
  s_mul_i32 s53, s49, 6144
  s_add_u32 m0, s53, 122880
  s_nop 0
  buffer_load_dwordx4 v40, s[36:39], s54 offen  lds
  s_add_u32 m0, m0, 1024
  s_nop 0
  buffer_load_dwordx4 v41, s[36:39], s54 offen  lds
  s_add_u32 m0, m0, 1024
  s_nop 0
  buffer_load_dwordx4 v42, s[36:39], s54 offen  lds
  s_add_u32 m0, m0, 1024
  s_nop 0
  buffer_load_dwordx4 v43, s[36:39], s54 offen  lds
  s_add_u32 m0, m0, 1024
  s_nop 0
  buffer_load_dwordx4 v44, s[36:39], s54 offen  lds
  s_add_u32 m0, m0, 1024
  s_nop 0
  buffer_load_dwordx4 v45, s[36:39], s54 offen  lds
  s_waitcnt vmcnt(30)
  s_barrier
  v_add_u32 v49, 0x0, v46
  v_add_u32 v50, 0x0, v47
  v_add_u32 v51, 0x0, v48
  ds_read_b64_tr_b16 v[112:113], v49 offset:0
  ds_read_b64_tr_b16 v[114:115], v49 offset:1536
  ds_read_b64_tr_b16 v[116:117], v49 offset:12288
  ds_read_b64_tr_b16 v[118:119], v49 offset:13824
  ds_read_b64_tr_b16 v[128:129], v50 offset:0
  ds_read_b64_tr_b16 v[130:131], v50 offset:1536
  ds_read_b64_tr_b16 v[132:133], v50 offset:12288
  ds_read_b64_tr_b16 v[134:135], v50 offset:13824
  ds_read_b64_tr_b16 v[144:145], v51 offset:0
  ds_read_b64_tr_b16 v[146:147], v51 offset:1536
  ds_read_b64_tr_b16 v[148:149], v51 offset:12288
  ds_read_b64_tr_b16 v[150:151], v51 offset:13824
  s_waitcnt lgkmcnt(0)
  s_barrier
  s_mul_i32 s54, s65, 786432
  s_mul_i32 s53, s49, 6144
  s_add_u32 m0, s53, 0
  s_nop 0
  buffer_load_dwordx4 v40, s[40:43], s54 offen  lds
  s_add_u32 m0, m0, 1024
  s_nop 0
  buffer_load_dwordx4 v41, s[40:43], s54 offen  lds
  s_add_u32 m0, m0, 1024
  s_nop 0
  buffer_load_dwordx4 v42, s[40:43], s54 offen  lds
  s_add_u32 m0, m0, 1024
  s_nop 0
  buffer_load_dwordx4 v43, s[40:43], s54 offen  lds
  s_add_u32 m0, m0, 1024
  s_nop 0
  buffer_load_dwordx4 v44, s[40:43], s54 offen  lds
  s_add_u32 m0, m0, 1024
  s_nop 0
  buffer_load_dwordx4 v45, s[40:43], s54 offen  lds
  s_waitcnt vmcnt(30)
  s_barrier
  v_add_u32 v49, 0x6000, v46
  v_add_u32 v50, 0x6000, v47
  v_add_u32 v51, 0x6000, v48
  ds_read_b64_tr_b16 v[104:105], v49 offset:0
  ds_read_b64_tr_b16 v[106:107], v49 offset:1536
  ds_read_b64_tr_b16 v[108:109], v49 offset:12288
  ds_read_b64_tr_b16 v[110:111], v49 offset:13824
  ds_read_b64_tr_b16 v[120:121], v50 offset:0
  ds_read_b64_tr_b16 v[122:123], v50 offset:1536
  ds_read_b64_tr_b16 v[124:125], v50 offset:12288
  ds_read_b64_tr_b16 v[126:127], v50 offset:13824
  ds_read_b64_tr_b16 v[136:137], v51 offset:0
  ds_read_b64_tr_b16 v[138:139], v51 offset:1536
  ds_read_b64_tr_b16 v[140:141], v51 offset:12288
  ds_read_b64_tr_b16 v[142:143], v51 offset:13824
  s_waitcnt lgkmcnt(0)
  s_barrier
  s_mul_i32 s54, s65, 786432
  s_mul_i32 s53, s49, 6144
  s_add_u32 m0, s53, 24576
  s_nop 0
  buffer_load_dwordx4 v40, s[36:39], s54 offen  lds
  s_add_u32 m0, m0, 1024
  s_nop 0
  buffer_load_dwordx4 v41, s[36:39], s54 offen  lds
  s_add_u32 m0, m0, 1024
  s_nop 0
  buffer_load_dwordx4 v42, s[36:39], s54 offen  lds
  s_add_u32 m0, m0, 1024
  s_nop 0
  buffer_load_dwordx4 v43, s[36:39], s54 offen  lds
  s_add_u32 m0, m0, 1024
  s_nop 0
  buffer_load_dwordx4 v44, s[36:39], s54 offen  lds
  s_add_u32 m0, m0, 1024
  s_nop 0
  buffer_load_dwordx4 v45, s[36:39], s54 offen  lds
  s_waitcnt vmcnt(30)
  s_barrier
  v_add_u32 v49, 0xc000, v46
  v_add_u32 v50, 0xc000, v47
  v_add_u32 v51, 0xc000, v48
  ds_read_b64_tr_b16 v[160:161], v49 offset:0
  ds_read_b64_tr_b16 v[162:163], v49 offset:1536
  ds_read_b64_tr_b16 v[164:165], v49 offset:12288
  ds_read_b64_tr_b16 v[166:167], v49 offset:13824
  ds_read_b64_tr_b16 v[176:177], v50 offset:0
  ds_read_b64_tr_b16 v[178:179], v50 offset:1536
  ds_read_b64_tr_b16 v[180:181], v50 offset:12288
  ds_read_b64_tr_b16 v[182:183], v50 offset:13824
  ds_read_b64_tr_b16 v[16:17], v51 offset:0
  ds_read_b64_tr_b16 v[18:19], v51 offset:1536
  ds_read_b64_tr_b16 v[20:21], v51 offset:12288
  ds_read_b64_tr_b16 v[22:23], v51 offset:13824
  s_waitcnt lgkmcnt(0)
  s_barrier
  s_mul_i32 s54, s66, 786432
  s_mul_i32 s53, s49, 6144
  s_add_u32 m0, s53, 49152
  s_nop 0
  buffer_load_dwordx4 v40, s[40:43], s54 offen  lds
  s_add_u32 m0, m0, 1024
  s_nop 0
  buffer_load_dwordx4 v41, s[40:43], s54 offen  lds
  s_add_u32 m0, m0, 1024
  s_nop 0
  buffer_load_dwordx4 v42, s[40:43], s54 offen  lds
  s_add_u32 m0, m0, 1024
  s_nop 0
  buffer_load_dwordx4 v43, s[40:43], s54 offen  lds
  s_add_u32 m0, m0, 1024
  s_nop 0
  buffer_load_dwordx4 v44, s[40:43], s54 offen  lds
  s_add_u32 m0, m0, 1024
  s_nop 0
  buffer_load_dwordx4 v45, s[40:43], s54 offen  lds
  s_waitcnt vmcnt(30)
  s_barrier
  v_add_u32 v49, 0x12000, v46
  v_add_u32 v50, 0x12000, v47
  v_add_u32 v51, 0x12000, v48
  ds_read_b64_tr_b16 v[152:153], v49 offset:0
  ds_read_b64_tr_b16 v[154:155], v49 offset:1536
  ds_read_b64_tr_b16 v[156:157], v49 offset:12288
  ds_read_b64_tr_b16 v[158:159], v49 offset:13824
  ds_read_b64_tr_b16 v[168:169], v50 offset:0
  ds_read_b64_tr_b16 v[170:171], v50 offset:1536
  ds_read_b64_tr_b16 v[172:173], v50 offset:12288
  ds_read_b64_tr_b16 v[174:175], v50 offset:13824
  ds_read_b64_tr_b16 v[184:185], v51 offset:0
  ds_read_b64_tr_b16 v[186:187], v51 offset:1536
  ds_read_b64_tr_b16 v[188:189], v51 offset:12288
  ds_read_b64_tr_b16 v[190:191], v51 offset:13824
  s_waitcnt lgkmcnt(0)
  s_barrier
  s_mul_i32 s54, s66, 786432
  s_mul_i32 s53, s49, 6144
  s_add_u32 m0, s53, 73728
  s_nop 0
  buffer_load_dwordx4 v40, s[36:39], s54 offen  lds
  s_add_u32 m0, m0, 1024
  s_nop 0
  buffer_load_dwordx4 v41, s[36:39], s54 offen  lds
  s_add_u32 m0, m0, 1024
  s_nop 0
  buffer_load_dwordx4 v42, s[36:39], s54 offen  lds
  s_add_u32 m0, m0, 1024
  s_nop 0
  buffer_load_dwordx4 v43, s[36:39], s54 offen  lds
  s_add_u32 m0, m0, 1024
  s_nop 0
  buffer_load_dwordx4 v44, s[36:39], s54 offen  lds
  s_add_u32 m0, m0, 1024
  s_nop 0
  buffer_load_dwordx4 v45, s[36:39], s54 offen  lds
  s_waitcnt vmcnt(30)
  s_barrier
  v_add_u32 v49, 0x18000, v46
  v_add_u32 v50, 0x18000, v47
  v_add_u32 v51, 0x18000, v48
  ds_read_b64_tr_b16 v[200:201], v49 offset:0
  ds_read_b64_tr_b16 v[202:203], v49 offset:1536
  ds_read_b64_tr_b16 v[204:205], v49 offset:12288
  ds_read_b64_tr_b16 v[206:207], v49 offset:13824
  ds_read_b64_tr_b16 v[216:217], v50 offset:0
  ds_read_b64_tr_b16 v[218:219], v50 offset:1536
  ds_read_b64_tr_b16 v[220:221], v50 offset:12288
  ds_read_b64_tr_b16 v[222:223], v50 offset:13824
  ds_read_b64_tr_b16 v[24:25], v51 offset:0
  ds_read_b64_tr_b16 v[26:27], v51 offset:1536
  ds_read_b64_tr_b16 v[28:29], v51 offset:12288
  ds_read_b64_tr_b16 v[30:31], v51 offset:13824
  s_waitcnt lgkmcnt(0)
  s_barrier
  s_mul_i32 s54, s67, 786432
  s_mul_i32 s53, s49, 6144
  s_add_u32 m0, s53, 98304
  s_nop 0
  buffer_load_dwordx4 v40, s[40:43], s54 offen  lds
  s_add_u32 m0, m0, 1024
  s_nop 0
  buffer_load_dwordx4 v41, s[40:43], s54 offen  lds
  s_add_u32 m0, m0, 1024
  s_nop 0
  buffer_load_dwordx4 v42, s[40:43], s54 offen  lds
  s_add_u32 m0, m0, 1024
  s_nop 0
  buffer_load_dwordx4 v43, s[40:43], s54 offen  lds
  s_add_u32 m0, m0, 1024
  s_nop 0
  buffer_load_dwordx4 v44, s[40:43], s54 offen  lds
  s_add_u32 m0, m0, 1024
  s_nop 0
  buffer_load_dwordx4 v45, s[40:43], s54 offen  lds
  s_waitcnt vmcnt(30)
  s_barrier
  v_add_u32 v49, 0x1e000, v46
  v_add_u32 v50, 0x1e000, v47
  v_add_u32 v51, 0x1e000, v48
  ds_read_b64_tr_b16 v[192:193], v49 offset:0
  ds_read_b64_tr_b16 v[194:195], v49 offset:1536
  ds_read_b64_tr_b16 v[196:197], v49 offset:12288
  ds_read_b64_tr_b16 v[198:199], v49 offset:13824
  ds_read_b64_tr_b16 v[208:209], v50 offset:0
  ds_read_b64_tr_b16 v[210:211], v50 offset:1536
  ds_read_b64_tr_b16 v[212:213], v50 offset:12288
  ds_read_b64_tr_b16 v[214:215], v50 offset:13824
  ds_read_b64_tr_b16 v[224:225], v51 offset:0
  ds_read_b64_tr_b16 v[226:227], v51 offset:1536
  ds_read_b64_tr_b16 v[228:229], v51 offset:12288
  ds_read_b64_tr_b16 v[230:231], v51 offset:13824
  s_waitcnt lgkmcnt(0)
  s_barrier
  s_mul_i32 s54, s67, 786432
  s_mul_i32 s53, s49, 6144
  s_add_u32 m0, s53, 122880
  s_nop 0
  buffer_load_dwordx4 v40, s[36:39], s54 offen  lds
  s_add_u32 m0, m0, 1024
  s_nop 0
  buffer_load_dwordx4 v41, s[36:39], s54 offen  lds
  s_add_u32 m0, m0, 1024
  s_nop 0
  buffer_load_dwordx4 v42, s[36:39], s54 offen  lds
  s_add_u32 m0, m0, 1024
  s_nop 0
  buffer_load_dwordx4 v43, s[36:39], s54 offen  lds
  s_add_u32 m0, m0, 1024
  s_nop 0
  buffer_load_dwordx4 v44, s[36:39], s54 offen  lds
  s_add_u32 m0, m0, 1024
  s_nop 0
  buffer_load_dwordx4 v45, s[36:39], s54 offen  lds
  s_waitcnt vmcnt(30)
  s_barrier
  v_add_u32 v49, 0x0, v46
  v_add_u32 v50, 0x0, v47
  v_add_u32 v51, 0x0, v48
  ds_read_b64_tr_b16 v[240:241], v49 offset:0
  ds_read_b64_tr_b16 v[242:243], v49 offset:1536
  ds_read_b64_tr_b16 v[244:245], v49 offset:12288
  ds_read_b64_tr_b16 v[246:247], v49 offset:13824
  ds_read_b64_tr_b16 a[0:1], v50 offset:0
  ds_read_b64_tr_b16 a[2:3], v50 offset:1536
  ds_read_b64_tr_b16 a[4:5], v50 offset:12288
  ds_read_b64_tr_b16 a[6:7], v50 offset:13824
  ds_read_b64_tr_b16 v[32:33], v51 offset:0
  ds_read_b64_tr_b16 v[34:35], v51 offset:1536
  ds_read_b64_tr_b16 v[36:37], v51 offset:12288
  ds_read_b64_tr_b16 v[38:39], v51 offset:13824
  s_waitcnt lgkmcnt(0)
  s_barrier
  s_mul_i32 s54, s68, 786432
  s_mul_i32 s53, s49, 6144
  s_add_u32 m0, s53, 0
  s_nop 0
  buffer_load_dwordx4 v40, s[40:43], s54 offen  lds
  s_add_u32 m0, m0, 1024
  s_nop 0
  buffer_load_dwordx4 v41, s[40:43], s54 offen  lds
  s_add_u32 m0, m0, 1024
  s_nop 0
  buffer_load_dwordx4 v42, s[40:43], s54 offen  lds
  s_add_u32 m0, m0, 1024
  s_nop 0
  buffer_load_dwordx4 v43, s[40:43], s54 offen  lds
  s_add_u32 m0, m0, 1024
  s_nop 0
  buffer_load_dwordx4 v44, s[40:43], s54 offen  lds
  s_add_u32 m0, m0, 1024
  s_nop 0
  buffer_load_dwordx4 v45, s[40:43], s54 offen  lds
  s_waitcnt vmcnt(30)
  s_barrier
  v_add_u32 v49, 0x6000, v46
  v_add_u32 v50, 0x6000, v47
  v_add_u32 v51, 0x6000, v48
  ds_read_b64_tr_b16 v[232:233], v49 offset:0
  ds_read_b64_tr_b16 v[234:235], v49 offset:1536
  ds_read_b64_tr_b16 v[236:237], v49 offset:12288
  ds_read_b64_tr_b16 v[238:239], v49 offset:13824
  ds_read_b64_tr_b16 v[248:249], v50 offset:0
  ds_read_b64_tr_b16 v[250:251], v50 offset:1536
  ds_read_b64_tr_b16 v[252:253], v50 offset:12288
  ds_read_b64_tr_b16 v[254:255], v50 offset:13824
  ds_read_b64_tr_b16 a[8:9], v51 offset:0
  ds_read_b64_tr_b16 a[10:11], v51 offset:1536
  ds_read_b64_tr_b16 a[12:13], v51 offset:12288
  ds_read_b64_tr_b16 a[14:15], v51 offset:13824
  s_waitcnt lgkmcnt(0)
  s_barrier
  s_mul_i32 s54, s68, 786432
  s_mul_i32 s53, s49, 6144
  s_add_u32 m0, s53, 24576
  s_nop 0
  buffer_load_dwordx4 v40, s[36:39], s54 offen  lds
  s_add_u32 m0, m0, 1024
  s_nop 0
  buffer_load_dwordx4 v41, s[36:39], s54 offen  lds
  s_add_u32 m0, m0, 1024
  s_nop 0
  buffer_load_dwordx4 v42, s[36:39], s54 offen  lds
  s_add_u32 m0, m0, 1024
  s_nop 0
  buffer_load_dwordx4 v43, s[36:39], s54 offen  lds
  s_add_u32 m0, m0, 1024
  s_nop 0
  buffer_load_dwordx4 v44, s[36:39], s54 offen  lds
  s_add_u32 m0, m0, 1024
  s_nop 0
  buffer_load_dwordx4 v45, s[36:39], s54 offen  lds
  s_waitcnt vmcnt(30)
  s_barrier
  v_add_u32 v49, 0xc000, v46
  v_add_u32 v50, 0xc000, v47
  v_add_u32 v51, 0xc000, v48
  ds_read_b64_tr_b16 a[24:25], v49 offset:0
  ds_read_b64_tr_b16 a[26:27], v49 offset:1536
  ds_read_b64_tr_b16 a[28:29], v49 offset:12288
  ds_read_b64_tr_b16 a[30:31], v49 offset:13824
  ds_read_b64_tr_b16 a[40:41], v50 offset:0
  ds_read_b64_tr_b16 a[42:43], v50 offset:1536
  ds_read_b64_tr_b16 a[44:45], v50 offset:12288
  ds_read_b64_tr_b16 a[46:47], v50 offset:13824
  ds_read_b64_tr_b16 v[52:53], v51 offset:0
  ds_read_b64_tr_b16 v[54:55], v51 offset:1536
  ds_read_b64_tr_b16 v[56:57], v51 offset:12288
  ds_read_b64_tr_b16 v[58:59], v51 offset:13824
  s_waitcnt lgkmcnt(0)
  s_barrier
  s_mul_i32 s54, s69, 786432
  s_mul_i32 s53, s49, 6144
  s_add_u32 m0, s53, 49152
  s_nop 0
  buffer_load_dwordx4 v40, s[40:43], s54 offen  lds
  s_add_u32 m0, m0, 1024
  s_nop 0
  buffer_load_dwordx4 v41, s[40:43], s54 offen  lds
  s_add_u32 m0, m0, 1024
  s_nop 0
  buffer_load_dwordx4 v42, s[40:43], s54 offen  lds
  s_add_u32 m0, m0, 1024
  s_nop 0
  buffer_load_dwordx4 v43, s[40:43], s54 offen  lds
  s_add_u32 m0, m0, 1024
  s_nop 0
  buffer_load_dwordx4 v44, s[40:43], s54 offen  lds
  s_add_u32 m0, m0, 1024
  s_nop 0
  buffer_load_dwordx4 v45, s[40:43], s54 offen  lds
  s_waitcnt vmcnt(30)
  s_barrier
  v_add_u32 v49, 0x12000, v46
  v_add_u32 v50, 0x12000, v47
  v_add_u32 v51, 0x12000, v48
  ds_read_b64_tr_b16 a[16:17], v49 offset:0
  ds_read_b64_tr_b16 a[18:19], v49 offset:1536
  ds_read_b64_tr_b16 a[20:21], v49 offset:12288
  ds_read_b64_tr_b16 a[22:23], v49 offset:13824
  ds_read_b64_tr_b16 a[32:33], v50 offset:0
  ds_read_b64_tr_b16 a[34:35], v50 offset:1536
  ds_read_b64_tr_b16 a[36:37], v50 offset:12288
  ds_read_b64_tr_b16 a[38:39], v50 offset:13824
  ds_read_b64_tr_b16 a[48:49], v51 offset:0
  ds_read_b64_tr_b16 a[50:51], v51 offset:1536
  ds_read_b64_tr_b16 a[52:53], v51 offset:12288
  ds_read_b64_tr_b16 a[54:55], v51 offset:13824
  s_waitcnt lgkmcnt(0)
  s_barrier
  s_mul_i32 s54, s69, 786432
  s_mul_i32 s53, s49, 6144
  s_add_u32 m0, s53, 73728
  s_nop 0
  buffer_load_dwordx4 v40, s[36:39], s54 offen  lds
  s_add_u32 m0, m0, 1024
  s_nop 0
  buffer_load_dwordx4 v41, s[36:39], s54 offen  lds
  s_add_u32 m0, m0, 1024
  s_nop 0
  buffer_load_dwordx4 v42, s[36:39], s54 offen  lds
  s_add_u32 m0, m0, 1024
  s_nop 0
  buffer_load_dwordx4 v43, s[36:39], s54 offen  lds
  s_add_u32 m0, m0, 1024
  s_nop 0
  buffer_load_dwordx4 v44, s[36:39], s54 offen  lds
  s_add_u32 m0, m0, 1024
  s_nop 0
  buffer_load_dwordx4 v45, s[36:39], s54 offen  lds
  s_waitcnt vmcnt(30)
  s_barrier
  v_add_u32 v49, 0x18000, v46
  v_add_u32 v50, 0x18000, v47
  v_add_u32 v51, 0x18000, v48
  ds_read_b64_tr_b16 a[64:65], v49 offset:0
  ds_read_b64_tr_b16 a[66:67], v49 offset:1536
  ds_read_b64_tr_b16 a[68:69], v49 offset:12288
  ds_read_b64_tr_b16 a[70:71], v49 offset:13824
  ds_read_b64_tr_b16 a[80:81], v50 offset:0
  ds_read_b64_tr_b16 a[82:83], v50 offset:1536
  ds_read_b64_tr_b16 a[84:85], v50 offset:12288
  ds_read_b64_tr_b16 a[86:87], v50 offset:13824
  ds_read_b64_tr_b16 v[60:61], v51 offset:0
  ds_read_b64_tr_b16 v[62:63], v51 offset:1536
  ds_read_b64_tr_b16 v[64:65], v51 offset:12288
  ds_read_b64_tr_b16 v[66:67], v51 offset:13824
  s_waitcnt lgkmcnt(0)
  s_barrier
  s_mul_i32 s54, s70, 786432
  s_mul_i32 s53, s49, 6144
  s_add_u32 m0, s53, 98304
  s_nop 0
  buffer_load_dwordx4 v40, s[40:43], s54 offen  lds
  s_add_u32 m0, m0, 1024
  s_nop 0
  buffer_load_dwordx4 v41, s[40:43], s54 offen  lds
  s_add_u32 m0, m0, 1024
  s_nop 0
  buffer_load_dwordx4 v42, s[40:43], s54 offen  lds
  s_add_u32 m0, m0, 1024
  s_nop 0
  buffer_load_dwordx4 v43, s[40:43], s54 offen  lds
  s_add_u32 m0, m0, 1024
  s_nop 0
  buffer_load_dwordx4 v44, s[40:43], s54 offen  lds
  s_add_u32 m0, m0, 1024
  s_nop 0
  buffer_load_dwordx4 v45, s[40:43], s54 offen  lds
  s_waitcnt vmcnt(30)
  s_barrier
  v_add_u32 v49, 0x1e000, v46
  v_add_u32 v50, 0x1e000, v47
  v_add_u32 v51, 0x1e000, v48
  ds_read_b64_tr_b16 a[56:57], v49 offset:0
  ds_read_b64_tr_b16 a[58:59], v49 offset:1536
  ds_read_b64_tr_b16 a[60:61], v49 offset:12288
  ds_read_b64_tr_b16 a[62:63], v49 offset:13824
  ds_read_b64_tr_b16 a[72:73], v50 offset:0
  ds_read_b64_tr_b16 a[74:75], v50 offset:1536
  ds_read_b64_tr_b16 a[76:77], v50 offset:12288
  ds_read_b64_tr_b16 a[78:79], v50 offset:13824
  ds_read_b64_tr_b16 a[88:89], v51 offset:0
  ds_read_b64_tr_b16 a[90:91], v51 offset:1536
  ds_read_b64_tr_b16 a[92:93], v51 offset:12288
  ds_read_b64_tr_b16 a[94:95], v51 offset:13824
  s_waitcnt lgkmcnt(0)
  s_barrier
  s_mul_i32 s54, s70, 786432
  s_mul_i32 s53, s49, 6144
  s_add_u32 m0, s53, 122880
  s_nop 0
  buffer_load_dwordx4 v40, s[36:39], s54 offen  lds
  s_add_u32 m0, m0, 1024
  s_nop 0
  buffer_load_dwordx4 v41, s[36:39], s54 offen  lds
  s_add_u32 m0, m0, 1024
  s_nop 0
  buffer_load_dwordx4 v42, s[36:39], s54 offen  lds
  s_add_u32 m0, m0, 1024
  s_nop 0
  buffer_load_dwordx4 v43, s[36:39], s54 offen  lds
  s_add_u32 m0, m0, 1024
  s_nop 0
  buffer_load_dwordx4 v44, s[36:39], s54 offen  lds
  s_add_u32 m0, m0, 1024
  s_nop 0
  buffer_load_dwordx4 v45, s[36:39], s54 offen  lds
  s_waitcnt vmcnt(30)
  s_barrier
  v_add_u32 v49, 0x0, v46
  v_add_u32 v50, 0x0, v47
  v_add_u32 v51, 0x0, v48
  ds_read_b64_tr_b16 a[104:105], v49 offset:0
  ds_read_b64_tr_b16 a[106:107], v49 offset:1536
  ds_read_b64_tr_b16 a[108:109], v49 offset:12288
  ds_read_b64_tr_b16 a[110:111], v49 offset:13824
  ds_read_b64_tr_b16 a[120:121], v50 offset:0
  ds_read_b64_tr_b16 a[122:123], v50 offset:1536
  ds_read_b64_tr_b16 a[124:125], v50 offset:12288
  ds_read_b64_tr_b16 a[126:127], v50 offset:13824
  ds_read_b64_tr_b16 v[68:69], v51 offset:0
  ds_read_b64_tr_b16 v[70:71], v51 offset:1536
  ds_read_b64_tr_b16 v[72:73], v51 offset:12288
  ds_read_b64_tr_b16 v[74:75], v51 offset:13824
  s_waitcnt lgkmcnt(0)
  s_barrier
  s_mul_i32 s54, s71, 786432
  s_mul_i32 s53, s49, 6144
  s_add_u32 m0, s53, 0
  s_nop 0
  buffer_load_dwordx4 v40, s[40:43], s54 offen  lds
  s_add_u32 m0, m0, 1024
  s_nop 0
  buffer_load_dwordx4 v41, s[40:43], s54 offen  lds
  s_add_u32 m0, m0, 1024
  s_nop 0
  buffer_load_dwordx4 v42, s[40:43], s54 offen  lds
  s_add_u32 m0, m0, 1024
  s_nop 0
  buffer_load_dwordx4 v43, s[40:43], s54 offen  lds
  s_add_u32 m0, m0, 1024
  s_nop 0
  buffer_load_dwordx4 v44, s[40:43], s54 offen  lds
  s_add_u32 m0, m0, 1024
  s_nop 0
  buffer_load_dwordx4 v45, s[40:43], s54 offen  lds
  s_waitcnt vmcnt(30)
  s_barrier
  v_add_u32 v49, 0x6000, v46
  v_add_u32 v50, 0x6000, v47
  v_add_u32 v51, 0x6000, v48
  ds_read_b64_tr_b16 a[96:97], v49 offset:0
  ds_read_b64_tr_b16 a[98:99], v49 offset:1536
  ds_read_b64_tr_b16 a[100:101], v49 offset:12288
  ds_read_b64_tr_b16 a[102:103], v49 offset:13824
  ds_read_b64_tr_b16 a[112:113], v50 offset:0
  ds_read_b64_tr_b16 a[114:115], v50 offset:1536
  ds_read_b64_tr_b16 a[116:117], v50 offset:12288
  ds_read_b64_tr_b16 a[118:119], v50 offset:13824
  ds_read_b64_tr_b16 a[128:129], v51 offset:0
  ds_read_b64_tr_b16 a[130:131], v51 offset:1536
  ds_read_b64_tr_b16 a[132:133], v51 offset:12288
  ds_read_b64_tr_b16 a[134:135], v51 offset:13824
  s_waitcnt lgkmcnt(0)
  s_barrier
  s_mul_i32 s54, s71, 786432
  s_mul_i32 s53, s49, 6144
  s_add_u32 m0, s53, 24576
  s_nop 0
  buffer_load_dwordx4 v40, s[36:39], s54 offen  lds
  s_add_u32 m0, m0, 1024
  s_nop 0
  buffer_load_dwordx4 v41, s[36:39], s54 offen  lds
  s_add_u32 m0, m0, 1024
  s_nop 0
  buffer_load_dwordx4 v42, s[36:39], s54 offen  lds
  s_add_u32 m0, m0, 1024
  s_nop 0
  buffer_load_dwordx4 v43, s[36:39], s54 offen  lds
  s_add_u32 m0, m0, 1024
  s_nop 0
  buffer_load_dwordx4 v44, s[36:39], s54 offen  lds
  s_add_u32 m0, m0, 1024
  s_nop 0
  buffer_load_dwordx4 v45, s[36:39], s54 offen  lds
  global_load_dword v102, v[100:101], off
  s_waitcnt vmcnt(31)
  s_barrier
  v_add_u32 v49, 0xc000, v46
  v_add_u32 v50, 0xc000, v47
  v_add_u32 v51, 0xc000, v48
  ds_read_b64_tr_b16 a[144:145], v49 offset:0
  ds_read_b64_tr_b16 a[146:147], v49 offset:1536
  ds_read_b64_tr_b16 a[148:149], v49 offset:12288
  ds_read_b64_tr_b16 a[150:151], v49 offset:13824
  ds_read_b64_tr_b16 a[160:161], v50 offset:0
  ds_read_b64_tr_b16 a[162:163], v50 offset:1536
  ds_read_b64_tr_b16 a[164:165], v50 offset:12288
  ds_read_b64_tr_b16 a[166:167], v50 offset:13824
  ds_read_b64_tr_b16 v[76:77], v51 offset:0
  ds_read_b64_tr_b16 v[78:79], v51 offset:1536
  ds_read_b64_tr_b16 v[80:81], v51 offset:12288
  ds_read_b64_tr_b16 v[82:83], v51 offset:13824
  s_waitcnt lgkmcnt(0)
  s_waitcnt vmcnt(25)
  s_barrier
  v_add_u32 v49, 0x12000, v46
  v_add_u32 v50, 0x12000, v47
  v_add_u32 v51, 0x12000, v48
  ds_read_b64_tr_b16 a[136:137], v49 offset:0
  ds_read_b64_tr_b16 a[138:139], v49 offset:1536
  ds_read_b64_tr_b16 a[140:141], v49 offset:12288
  ds_read_b64_tr_b16 a[142:143], v49 offset:13824
  ds_read_b64_tr_b16 a[152:153], v50 offset:0
  ds_read_b64_tr_b16 a[154:155], v50 offset:1536
  ds_read_b64_tr_b16 a[156:157], v50 offset:12288
  ds_read_b64_tr_b16 a[158:159], v50 offset:13824
  ds_read_b64_tr_b16 a[168:169], v51 offset:0
  ds_read_b64_tr_b16 a[170:171], v51 offset:1536
  ds_read_b64_tr_b16 a[172:173], v51 offset:12288
  ds_read_b64_tr_b16 a[174:175], v51 offset:13824
  s_waitcnt lgkmcnt(0)
  s_waitcnt vmcnt(19)
  s_barrier
  v_add_u32 v49, 0x18000, v46
  v_add_u32 v50, 0x18000, v47
  v_add_u32 v51, 0x18000, v48
  ds_read_b64_tr_b16 a[184:185], v49 offset:0
  ds_read_b64_tr_b16 a[186:187], v49 offset:1536
  ds_read_b64_tr_b16 a[188:189], v49 offset:12288
  ds_read_b64_tr_b16 a[190:191], v49 offset:13824
  ds_read_b64_tr_b16 a[200:201], v50 offset:0
  ds_read_b64_tr_b16 a[202:203], v50 offset:1536
  ds_read_b64_tr_b16 a[204:205], v50 offset:12288
  ds_read_b64_tr_b16 a[206:207], v50 offset:13824
  ds_read_b64_tr_b16 v[84:85], v51 offset:0
  ds_read_b64_tr_b16 v[86:87], v51 offset:1536
  ds_read_b64_tr_b16 v[88:89], v51 offset:12288
  ds_read_b64_tr_b16 v[90:91], v51 offset:13824
  s_waitcnt lgkmcnt(0)
  s_waitcnt vmcnt(13)
  s_barrier
  v_add_u32 v49, 0x1e000, v46
  v_add_u32 v50, 0x1e000, v47
  v_add_u32 v51, 0x1e000, v48
  ds_read_b64_tr_b16 a[176:177], v49 offset:0
  ds_read_b64_tr_b16 a[178:179], v49 offset:1536
  ds_read_b64_tr_b16 a[180:181], v49 offset:12288
  ds_read_b64_tr_b16 a[182:183], v49 offset:13824
  ds_read_b64_tr_b16 a[192:193], v50 offset:0
  ds_read_b64_tr_b16 a[194:195], v50 offset:1536
  ds_read_b64_tr_b16 a[196:197], v50 offset:12288
  ds_read_b64_tr_b16 a[198:199], v50 offset:13824
  ds_read_b64_tr_b16 a[208:209], v51 offset:0
  ds_read_b64_tr_b16 a[210:211], v51 offset:1536
  ds_read_b64_tr_b16 a[212:213], v51 offset:12288
  ds_read_b64_tr_b16 a[214:215], v51 offset:13824
  s_waitcnt lgkmcnt(0)
  s_waitcnt vmcnt(7)
  s_barrier
  v_add_u32 v49, 0x0, v46
  v_add_u32 v50, 0x0, v47
  v_add_u32 v51, 0x0, v48
  ds_read_b64_tr_b16 a[224:225], v49 offset:0
  ds_read_b64_tr_b16 a[226:227], v49 offset:1536
  ds_read_b64_tr_b16 a[228:229], v49 offset:12288
  ds_read_b64_tr_b16 a[230:231], v49 offset:13824
  ds_read_b64_tr_b16 a[240:241], v50 offset:0
  ds_read_b64_tr_b16 a[242:243], v50 offset:1536
  ds_read_b64_tr_b16 a[244:245], v50 offset:12288
  ds_read_b64_tr_b16 a[246:247], v50 offset:13824
  ds_read_b64_tr_b16 v[92:93], v51 offset:0
  ds_read_b64_tr_b16 v[94:95], v51 offset:1536
  ds_read_b64_tr_b16 v[96:97], v51 offset:12288
  ds_read_b64_tr_b16 v[98:99], v51 offset:13824
  s_waitcnt lgkmcnt(0)
  s_waitcnt vmcnt(1)
  s_barrier
  v_add_u32 v49, 0x6000, v46
  v_add_u32 v50, 0x6000, v47
  v_add_u32 v51, 0x6000, v48
  ds_read_b64_tr_b16 a[216:217], v49 offset:0
  ds_read_b64_tr_b16 a[218:219], v49 offset:1536
  ds_read_b64_tr_b16 a[220:221], v49 offset:12288
  ds_read_b64_tr_b16 a[222:223], v49 offset:13824
  ds_read_b64_tr_b16 a[232:233], v50 offset:0
  ds_read_b64_tr_b16 a[234:235], v50 offset:1536
  ds_read_b64_tr_b16 a[236:237], v50 offset:12288
  ds_read_b64_tr_b16 a[238:239], v50 offset:13824
  ds_read_b64_tr_b16 a[248:249], v51 offset:0
  ds_read_b64_tr_b16 a[250:251], v51 offset:1536
  ds_read_b64_tr_b16 a[252:253], v51 offset:12288
  ds_read_b64_tr_b16 a[254:255], v51 offset:13824
  s_waitcnt lgkmcnt(0)
  s_barrier
A_LD:
  ds_write_b128 v3, v[16:19] offset:0
  ds_write_b128 v3, v[20:23] offset:1024
  ds_write_b128 v3, v[24:27] offset:2048
  ds_write_b128 v3, v[28:31] offset:3072
  ds_write_b128 v3, v[32:35] offset:4096
  ds_write_b128 v3, v[36:39] offset:5120
  ds_write_b128 v3, v[52:55] offset:6144
  ds_write_b128 v3, v[56:59] offset:7168
  ds_write_b128 v3, v[60:63] offset:8192
  ds_write_b128 v3, v[64:67] offset:9216
  ds_write_b128 v3, v[68:71] offset:10240
  ds_write_b128 v3, v[72:75] offset:11264
  ds_write_b128 v3, v[76:79] offset:12288
  ds_write_b128 v3, v[80:83] offset:13312
  ds_write_b128 v3, v[84:87] offset:14336
  ds_write_b128 v3, v[88:91] offset:15360
  ds_write_b128 v3, v[92:95] offset:16384
  ds_write_b128 v3, v[96:99] offset:17408
  s_waitcnt lgkmcnt(0)
  s_lshr_b32 s53, s62, 3
  s_lshl_b32 s53, s53, 13
  s_lshl_b32 s62, s62, 10
  s_add_u32 s62, s62, s53
  s_and_b32 s53, s2, 0
  s_lshl_b32 s53, s53, 15
  s_add_u32 s62, s62, s53
  s_lshr_b32 s53, s63, 3
  s_lshl_b32 s53, s53, 13
  s_lshl_b32 s63, s63, 10
  s_add_u32 s63, s63, s53
  s_and_b32 s53, s2, 0
  s_lshl_b32 s53, s53, 15
  s_add_u32 s63, s63, s53
  s_lshr_b32 s53, s64, 3
  s_lshl_b32 s53, s53, 13
  s_lshl_b32 s64, s64, 10
  s_add_u32 s64, s64, s53
  s_and_b32 s53, s2, 0
  s_lshl_b32 s53, s53, 15
  s_add_u32 s64, s64, s53
  s_lshr_b32 s53, s65, 3
  s_lshl_b32 s53, s53, 13
  s_lshl_b32 s65, s65, 10
  s_add_u32 s65, s65, s53
  s_and_b32 s53, s2, 0
  s_lshl_b32 s53, s53, 15
  s_add_u32 s65, s65, s53
  s_lshr_b32 s53, s66, 3
  s_lshl_b32 s53, s53, 13
  s_lshl_b32 s66, s66, 10
  s_add_u32 s66, s66, s53
  s_and_b32 s53, s2, 0
  s_lshl_b32 s53, s53, 15
  s_add_u32 s66, s66, s53
  s_lshr_b32 s53, s67, 3
  s_lshl_b32 s53, s53, 13
  s_lshl_b32 s67, s67, 10
  s_add_u32 s67, s67, s53
  s_and_b32 s53, s2, 0
  s_lshl_b32 s53, s53, 15
  s_add_u32 s67, s67, s53
  s_lshr_b32 s53, s68, 3
  s_lshl_b32 s53, s53, 13
  s_lshl_b32 s68, s68, 10
  s_add_u32 s68, s68, s53
  s_and_b32 s53, s2, 0
  s_lshl_b32 s53, s53, 15
  s_add_u32 s68, s68, s53
  s_lshr_b32 s53, s69, 3
  s_lshl_b32 s53, s53, 13
  s_lshl_b32 s69, s69, 10
  s_add_u32 s69, s69, s53
  s_and_b32 s53, s2, 0
  s_lshl_b32 s53, s53, 15
  s_add_u32 s69, s69, s53
  s_lshr_b32 s53, s70, 3
  s_lshl_b32 s53, s53, 13
  s_lshl_b32 s70, s70, 10
  s_add_u32 s70, s70, s53
  s_and_b32 s53, s2, 0
  s_lshl_b32 s53, s53, 15
  s_add_u32 s70, s70, s53
  s_lshr_b32 s53, s71, 3
  s_lshl_b32 s53, s53, 13
  s_lshl_b32 s71, s71, 10
  s_add_u32 s71, s71, s53
  s_and_b32 s53, s2, 0
  s_lshl_b32 s53, s53, 15
  s_add_u32 s71, s71, s53
  v_min_u32 v96, 47, v0
  v_max_u32 v96, 31, v96
  v_lshlrev_b32 v96, 2, v96
  s_mov_b32 s57, 0
WI_30:
  global_load_dword v97, v96, s[28:29] sc1
  s_add_u32 s57, s57, 1
  s_cmp_gt_u32 s57, 0x20000
  s_cbranch_scc1 L_EXIT
  s_waitcnt vmcnt(0)
  s_and_b32 s53, s24, 7
  s_add_u32 s53, s53, 40
  v_readlane_b32 s53, v97, s53
  s_nop 1
  v_cmp_gt_u32 vcc, s53, v97
  s_bfe_u32 s53, vcc_hi, 0x80008
  s_bcnt1_i32_b32 s53, s53
  v_cmp_eq_u32 vcc, 0, v97
  s_bfe_u32 s54, vcc_hi, 0x80008
  s_cbranch_scc1 WI_32
  s_cmp_lg_u32 s53, s25
  s_cbranch_scc1 L_REDO
WI_32:
  s_cbranch_vccz WI_31
  s_sleep 8
  s_branch WI_30
WI_31:
  v_readfirstlane_b32 s53, v97
  s_and_b32 s53, s53, 1
  s_lshl_b32 s50, s53, 13
  s_xor_b32 s51, s50, 0x2000
  s_add_u32 s54, s50, 16384
  v_lshl_add_u32 v96, v0, 7, s54
  s_mov_b32 s55, 1
  s_mov_b32 exec_hi, 0xff
  s_mov_b32 s57, 0
PL_33:
  buffer_load_dword v97, v96, s[32:35], 0 offen sc1
  s_waitcnt vmcnt(0)
  v_cmp_gt_u32 vcc, s55, v97
  s_cbranch_vccz PR_34
  s_add_u32 s57, s57, 1
  s_cmp_lt_u32 s57, 0x80000
  s_cbranch_scc1 PL_33
  s_branch L_EXIT
PR_34:
  s_mov_b64 exec, -1
  v_and_b32 v96, 2, v0
  v_cmp_eq_u32 vcc, 0, v96
  v_mov_b32 v1, 0xeeee
  v_mov_b32 v96, 0x4444
  v_cndmask_b32 v1, v1, v96, vcc
  v_mov_b32 v4, 0x40000000
  v_lshrrev_b32 v40, 4, v0
  v_and_b32 v41, 15, v0
  v_and_b32 v42, 7, v0
  v_bfe_u32 v43, v0, 3, 1
  s_mul_i32 s54, s49, 1408
  s_add_u32 s54, s54, 86016
  v_mul_u32_u24 v44, 176, v42
  v_add_u32 v44, s54, v44
  v_lshl_add_u32 v45, v43, 6, v44
  v_lshl_add_u32 v5, v40, 4, v45
  v_lshl_add_u32 v45, v43, 3, v44
  v_lshl_add_u32 v45, v40, 4, v45
  v_add_u32 v45, 96, v45
  v_lshlrev_b32 v46, 3, v0
  v_add_u32 v46, 91648, v46
  v_cmp_gt_u32 vcc, 32, v0
  s_nop 1
  v_cndmask_b32 v6, v45, v46, vcc
  v_lshlrev_b32 v44, 1, v40
  v_sub_u32 v44, v41, v44
  v_mov_b32 v45, 0x3f80
  v_mov_b32 v46, 0x3f800000
  v_cmp_eq_u32 vcc, 0, v44
  s_nop 1
  v_cndmask_b32 v12, 0, v45, vcc
  v_cmp_eq_u32 vcc, 1, v44
  s_nop 1
  v_cndmask_b32 v12, v12, v46, vcc
  v_cmp_eq_u32 vcc, 8, v44
  s_nop 1
  v_cndmask_b32 v13, 0, v45, vcc
  v_cmp_eq_u32 vcc, 9, v44
  s_nop 1
  v_cndmask_b32 v13, v13, v46, vcc
  v_lshrrev_b32 v40, 5, v0
  v_and_b32 v41, 31, v0
  v_bfe_u32 v42, v0, 3, 1
  v_bfe_u32 v43, v0, 2, 1
  v_and_b32 v44, 3, v0
  v_and_b32 v45, 1, v0
  v_lshlrev_b32 v45, 6, v45
  v_lshl_add_u32 v45, v42, 5, v45
  v_bfe_u32 v46, v0, 1, 1
  v_lshl_add_u32 v45, v46, 4, v45
  v_lshl_add_u32 v45, v43, 3, v45
  v_lshlrev_b32 v46, 3, v44
  v_add_u32 v46, 128, v46
  v_cmp_gt_u32 vcc, 16, v41
  s_nop 1
  v_cndmask_b32 v45, v46, v45, vcc
  s_mul_i32 s54, s49, 352
  s_add_u32 s54, s54, 86016
  v_mul_u32_u24 v46, 176, v40
  v_add3_u32 v7, v45, v46, s54
  s_and_b32 s54, s48, 15
  s_lshl_b32 s54, s54, 9
  s_lshr_b32 s55, s48, 4
  s_lshl_b32 s55, s55, 14
  s_add_u32 s54, s54, s55
  s_lshl_b32 s55, s49, 7
  s_add_u32 s54, s54, s55
  v_lshlrev_b32 v45, 6, v42
  v_lshl_add_u32 v45, v43, 5, v45
  v_lshl_add_u32 v45, v40, 4, v45
  v_lshl_add_u32 v45, v44, 2, v45
  v_add_u32 v45, s54, v45
  v_add_u32 v48, s54, v11
  s_lshr_b32 s54, s48, 1
  s_lshl_b32 s54, s54, 8
  s_and_b32 s55, s48, 1
  s_lshl_b32 s55, s55, 3
  s_add_u32 s54, s54, s55
  s_lshl_b32 s55, s49, 6
  s_add_u32 s54, s54, s55
  s_add_u32 s54, s54, 32768
  v_and_b32 v46, 1, v0
  v_lshlrev_b32 v46, 5, v46
  v_lshl_add_u32 v46, v40, 4, v46
  v_bfe_u32 v47, v0, 1, 1
  v_lshl_add_u32 v46, v47, 2, v46
  v_add_u32 v46, s54, v46
  v_cndmask_b32 v45, v46, v45, vcc
  v_mov_b32 v46, 0x40000000
  v_mov_b32 v47, 0xff800000
  v_cmp_lt_u32 vcc, 19, v41
  s_nop 1
  v_cndmask_b32 v8, v45, v46, vcc
  v_cndmask_b32 v9, 0, v47, vcc
  s_and_b32 s54, s54, 0xfffffff0
  s_sub_u32 s54, s54, 128
  v_add_u32 v45, s54, v11
  v_cmp_gt_u32 vcc, 8, v0
  s_nop 1
  v_cndmask_b32 v45, v45, v48, vcc
  v_cmp_gt_u32 vcc, 12, v0
  s_nop 1
  v_cndmask_b32 v102, v46, v45, vcc
  s_lshl_b32 s56, s48, 7
  s_add_u32 s56, s56, s50
  v_mov_b32 v10, 0x40000000
  s_add_u32 s54, s56, 32768
  s_xor_b32 s54, s54, 0x2000
  s_cmp_eq_u32 s49, 0
  s_cselect_b32 s54, s54, 0x40000000
  v_mov_b32 v15, 0x40000000
  s_nop 0
  v_writelane_b32 v15, s54, 0
  s_add_u32 s54, s56, 49152
  s_xor_b32 s54, s54, 0x2000
  v_mov_b32 v100, s54
  s_mov_b32 s72, 0x3dd53b95
  s_mov_b32 s73, 0x7f817f81
  s_mov_b32 s77, 0x44101164
  s_mov_b32 s76, 0
  s_lshl_b32 s78, s48, 14
  s_lshr_b32 s54, s49, 1
  s_lshl_b32 s54, s54, 13
  s_add_u32 s78, s78, s54
  s_lshr_b32 s79, s48, 1
  s_lshl_b32 s79, s79, 13
  s_and_b32 s85, s48, 1
  s_lshl_b32 s85, s85, 2
  s_add_u32 s85, s85, s49
  s_lshl_b32 s85, s85, 10
  s_sub_u32 s85, s85, 128
  s_mov_b32 s52, 0
  s_mul_i32 s55, s49, 21504
  s_add_u32 m0, s55, 18432
  s_mov_b32 s74, 1
  s_cmp_ge_u32 s76, s74
  s_cbranch_scc1 WPD_35
  s_mov_b32 s57, 0
  s_mov_b32 exec_lo, 0x1
  s_mov_b32 exec_hi, 0
WPL_36:
  buffer_load_dword v97, v100, s[32:35], 0 offen sc1
  s_add_u32 s57, s57, 1
  s_cmp_gt_u32 s57, 0x80000
  s_cbranch_scc1 L_EXIT
  s_waitcnt vmcnt(0)
  v_cmp_gt_u32 vcc, s74, v97
  s_cbranch_vccnz WPL_36
  s_mov_b32 s76, s74
  s_add_u32 s53, s74, 2
  s_min_u32 s53, s53, 64
  v_cmp_gt_u32 vcc, s53, v97
  s_nop 0
  s_cmp_eq_u64 vcc, 0
  s_cselect_b32 s76, s53, s76
  s_add_u32 s53, s74, 6
  s_min_u32 s53, s53, 64
  v_cmp_gt_u32 vcc, s53, v97
  s_nop 0
  s_cmp_eq_u64 vcc, 0
  s_cselect_b32 s76, s53, s76
  s_add_u32 s53, s74, 16
  s_min_u32 s53, s53, 64
  v_cmp_gt_u32 vcc, s53, v97
  s_nop 0
  s_cmp_eq_u64 vcc, 0
  s_cselect_b32 s76, s53, s76
  s_mov_b64 exec, -1
WPD_35:
  s_mul_i32 s82, s52, 0x80000
  s_add_u32 s82, s82, 0x180000
  s_add_u32 s82, s82, s78
  s_lshr_b32 s53, s82, 7
  s_and_b32 s53, s53, 0x2000
  s_xor_b32 s53, s53, s51
  s_lshl_b32 s82, s82, 1
  s_or_b32 s82, s82, s53
  s_and_b32 s55, s49, 1
  s_lshl_b32 s55, s55, 12
  s_add_u32 s82, s82, s55
  buffer_load_dwordx4 v11, s[32:35], s82 offen offset:0 sc1 lds
  buffer_load_dwordx4 v11, s[32:35], s82 offen offset:1024 sc1 lds
  buffer_load_dwordx4 v11, s[32:35], s82 offen offset:2048 sc1 lds
  s_add_u32 s54, s52, 1
  s_and_b32 s54, s54, 31
  s_mul_i32 s54, s54, 0x8000
  s_add_u32 s54, s54, 0x200000
  s_lshr_b32 s53, s54, 7
  s_and_b32 s53, s53, 0x2000
  s_xor_b32 s53, s53, s50
  s_lshl_b32 s54, s54, 1
  s_or_b32 s54, s54, s53
  v_mov_b32 v96, s73
  v_mov_b32 v97, s73
  v_mov_b32 v98, s73
  v_mov_b32 v99, s73
  buffer_store_dwordx4 v[96:99], v102, s[32:35], s54 offen sc1
  v_mov_b32 v103, 0
A_STEP:
  s_add_u32 s74, s52, 1
  s_min_u32 s56, s74, 63
  s_mul_i32 s82, s56, 0x80000
  s_add_u32 s82, s82, 0x180000
  s_add_u32 s82, s82, s78
  s_lshr_b32 s53, s82, 7
  s_and_b32 s53, s53, 0x2000
  s_xor_b32 s53, s53, s51
  s_lshl_b32 s82, s82, 1
  s_or_b32 s82, s82, s53
  s_and_b32 s55, s49, 1
  s_lshl_b32 s55, s55, 12
  s_add_u32 s82, s82, s55
  s_add_u32 s83, s56, 1
  v_readfirstlane_b32 s54, v103
  s_cmp_lt_u32 s54, s83
  s_cselect_b32 s82, 0x40000000, s82
  s_add_u32 s55, s83, 2
  s_min_u32 s55, s55, 64
  s_cmp_ge_u32 s54, s55
  s_cbranch_scc1 A_NOKP
  buffer_load_dword v103, v100, s[32:35], 0 offen sc1
A_NOKP:
  s_add_u32 s84, s52, 2
  s_and_b32 s84, s84, 31
  s_mul_i32 s84, s84, 0x8000
  s_add_u32 s84, s84, 0x200000
  s_lshr_b32 s53, s84, 7
  s_and_b32 s53, s53, 0x2000
  s_xor_b32 s53, s53, s50
  s_lshl_b32 s84, s84, 1
  s_or_b32 s84, s84, s53
  s_cmp_lt_u32 s52, 61
  s_cselect_b32 s84, s84, 0x40000000
  s_add_u32 s75, s52, 0
  s_and_b32 s75, s75, 31
  s_mul_i32 s75, s75, 0x8000
  s_add_u32 s75, s75, 0x200000
  s_lshr_b32 s53, s75, 7
  s_and_b32 s53, s53, 0x2000
  s_xor_b32 s53, s53, s50
  s_lshl_b32 s75, s75, 1
  s_or_b32 s75, s75, s53
  s_add_u32 s54, s52, 0
  s_and_b32 s54, s54, 31
  s_mul_i32 s54, s54, 0x4000
  s_add_u32 s54, s54, 0x100000
  s_lshr_b32 s53, s54, 7
  s_and_b32 s53, s53, 0x2000
  s_xor_b32 s53, s53, s50
  s_lshl_b32 s54, s54, 1
  s_or_b32 s54, s54, s53
  v_add_u32 v2, s54, v11
  v_mov_b64 v[16:17], 0
  v_mov_b64 v[18:19], 0
  v_mov_b64 v[20:21], 0
  v_mov_b64 v[22:23], 0
  v_mov_b64 v[24:25], 0
  v_mov_b64 v[26:27], 0
  v_mov_b64 v[28:29], 0
  v_mov_b64 v[30:31], 0
  v_mov_b64 v[32:33], 0
  v_mov_b64 v[34:35], 0
  v_mov_b64 v[36:37], 0
  v_mov_b64 v[38:39], 0
  ds_read_b128 v[80:83], v3 offset:0
  ds_read_b128 v[84:87], v3 offset:1024
  ds_read_b128 v[88:91], v3 offset:2048
  ds_read_b128 v[92:95], v3 offset:3072
  s_mov_b32 s59, 0
  s_mov_b32 s57, 0
  s_mov_b32 s58, 0
  s_waitcnt lgkmcnt(0)
  v_mov_b32 v101, v10
  v_mov_b32 v14, s74
  s_cmp_lg_u32 s49, 0
  s_cbranch_scc1 A_GO
  s_cmp_eq_u32 s52, 0
  s_cbranch_scc1 A_GO
  s_mov_b64 exec, 1
  s_mov_b32 s57, 0
  buffer_load_dword v96, v4, s[32:35], 0 offen sc1
  buffer_load_dword v97, v4, s[32:35], 0 offen sc1
  buffer_load_dword v98, v4, s[32:35], 0 offen sc1
PL_37:
  buffer_load_dword v99, v4, s[32:35], 0 offen sc1
  s_waitcnt vmcnt(3)
  v_cmp_gt_u32 vcc, s74, v96
  s_cbranch_vccz PR_38
  buffer_load_dword v96, v4, s[32:35], 0 offen sc1
  s_waitcnt vmcnt(3)
  v_cmp_gt_u32 vcc, s74, v97
  s_cbranch_vccz PR_38
  buffer_load_dword v97, v4, s[32:35], 0 offen sc1
  s_waitcnt vmcnt(3)
  v_cmp_gt_u32 vcc, s74, v98
  s_cbranch_vccz PR_38
  buffer_load_dword v98, v4, s[32:35], 0 offen sc1
  s_waitcnt vmcnt(3)
  v_cmp_gt_u32 vcc, s74, v99
  s_cbranch_vccz PR_38
  s_add_u32 s57, s57, 1
  s_cmp_lt_u32 s57, 0x80000
  s_cbranch_scc1 PL_37
  s_branch L_EXIT
PR_38:
  s_mov_b64 exec, -1
A_GO:
  s_barrier
  buffer_load_dwordx4 v[40:43], v2, s[32:35], s62 offen
  s_barrier
  buffer_load_dwordx4 v[44:47], v2, s[32:35], s63 offen
  s_barrier
  buffer_load_dwordx4 v[48:51], v2, s[32:35], s64 offen
  s_barrier
  buffer_load_dwordx4 v[52:55], v2, s[32:35], s65 offen
  s_barrier
  buffer_load_dwordx4 v[56:59], v2, s[32:35], s66 offen
  s_barrier
  buffer_load_dwordx4 v[60:63], v2, s[32:35], s67 offen
  s_barrier
  buffer_load_dwordx4 v[64:67], v2, s[32:35], s68 offen
  s_barrier
  buffer_load_dwordx4 v[68:71], v2, s[32:35], s69 offen
  s_barrier
  buffer_load_dwordx4 v[72:75], v2, s[32:35], s70 offen
  s_barrier
  buffer_load_dwordx4 v[76:79], v2, s[32:35], s71 offen
A_GEMM:
  s_waitcnt vmcnt(9)
  v_smfmac_f32_16x16x64_bf16 v[16:19], v[40:43], v[104:111], v1
  v_smfmac_f32_16x16x64_bf16 v[20:23], v[40:43], v[112:119], v1
  v_smfmac_f32_16x16x64_bf16 v[24:27], v[40:43], v[120:127], v1
  v_smfmac_f32_16x16x64_bf16 v[28:31], v[40:43], v[128:135], v1
  v_smfmac_f32_16x16x64_bf16 v[32:35], v[40:43], v[136:143], v1
  v_smfmac_f32_16x16x64_bf16 v[36:39], v[40:43], v[144:151], v1
  s_waitcnt vmcnt(8)
  v_smfmac_f32_16x16x64_bf16 v[16:19], v[44:47], v[152:159], v1
  v_smfmac_f32_16x16x64_bf16 v[20:23], v[44:47], v[160:167], v1
  v_smfmac_f32_16x16x64_bf16 v[24:27], v[44:47], v[168:175], v1
  v_smfmac_f32_16x16x64_bf16 v[28:31], v[44:47], v[176:183], v1
  v_smfmac_f32_16x16x64_bf16 v[32:35], v[44:47], v[184:191], v1
  v_smfmac_f32_16x16x64_bf16 v[36:39], v[44:47], v[80:87], v1
  s_waitcnt vmcnt(7)
  v_smfmac_f32_16x16x64_bf16 v[16:19], v[48:51], v[192:199], v1
  ds_read_b128 v[80:83], v3 offset:4096
  v_max3_i32 v96, v40, v44, v48
  v_smfmac_f32_16x16x64_bf16 v[20:23], v[48:51], v[200:207], v1
  ds_read_b128 v[84:87], v3 offset:5120
  v_cmp_eq_u32 vcc, s73, v96
  v_smfmac_f32_16x16x64_bf16 v[24:27], v[48:51], v[208:215], v1
  v_smfmac_f32_16x16x64_bf16 v[28:31], v[48:51], v[216:223], v1
  v_smfmac_f32_16x16x64_bf16 v[32:35], v[48:51], v[224:231], v1
  s_cbranch_vccnz A_RETRY
  v_smfmac_f32_16x16x64_bf16 v[36:39], v[48:51], v[88:95], v1
  s_waitcnt vmcnt(6)
  v_smfmac_f32_16x16x64_bf16 v[16:19], v[52:55], v[232:239], v1
  ds_read_b128 v[88:91], v3 offset:6144
  v_smfmac_f32_16x16x64_bf16 v[20:23], v[52:55], v[240:247], v1
  ds_read_b128 v[92:95], v3 offset:7168
  v_smfmac_f32_16x16x64_bf16 v[24:27], v[52:55], v[248:255], v1
  s_waitcnt lgkmcnt(2)
  v_smfmac_f32_16x16x64_bf16 v[28:31], v[52:55], a[0:7], v1
  v_smfmac_f32_16x16x64_bf16 v[32:35], v[52:55], a[8:15], v1
  v_smfmac_f32_16x16x64_bf16 v[36:39], v[52:55], v[80:87], v1
  s_waitcnt vmcnt(5)
  v_smfmac_f32_16x16x64_bf16 v[16:19], v[56:59], a[16:23], v1
  ds_read_b128 v[80:83], v3 offset:8192
  v_smfmac_f32_16x16x64_bf16 v[20:23], v[56:59], a[24:31], v1
  ds_read_b128 v[84:87], v3 offset:9216
  v_smfmac_f32_16x16x64_bf16 v[24:27], v[56:59], a[32:39], v1
  s_waitcnt lgkmcnt(2)
  v_smfmac_f32_16x16x64_bf16 v[28:31], v[56:59], a[40:47], v1
  v_smfmac_f32_16x16x64_bf16 v[32:35], v[56:59], a[48:55], v1
  v_smfmac_f32_16x16x64_bf16 v[36:39], v[56:59], v[88:95], v1
  s_waitcnt vmcnt(4)
  v_smfmac_f32_16x16x64_bf16 v[16:19], v[60:63], a[56:63], v1
  ds_read_b128 v[88:91], v3 offset:10240
  v_max3_i32 v96, v52, v56, v60
  v_smfmac_f32_16x16x64_bf16 v[20:23], v[60:63], a[64:71], v1
  ds_read_b128 v[92:95], v3 offset:11264
  v_smfmac_f32_16x16x64_bf16 v[24:27], v[60:63], a[72:79], v1
  s_waitcnt lgkmcnt(2)
  v_smfmac_f32_16x16x64_bf16 v[28:31], v[60:63], a[80:87], v1
  v_smfmac_f32_16x16x64_bf16 v[32:35], v[60:63], a[88:95], v1
  v_smfmac_f32_16x16x64_bf16 v[36:39], v[60:63], v[80:87], v1
  s_waitcnt vmcnt(3)
  v_smfmac_f32_16x16x64_bf16 v[16:19], v[64:67], a[96:103], v1
  ds_read_b128 v[80:83], v3 offset:12288
  v_smfmac_f32_16x16x64_bf16 v[20:23], v[64:67], a[104:111], v1
  ds_read_b128 v[84:87], v3 offset:13312
  v_smfmac_f32_16x16x64_bf16 v[24:27], v[64:67], a[112:119], v1
  s_waitcnt lgkmcnt(2)
  v_smfmac_f32_16x16x64_bf16 v[28:31], v[64:67], a[120:127], v1
  v_smfmac_f32_16x16x64_bf16 v[32:35], v[64:67], a[128:135], v1
  v_smfmac_f32_16x16x64_bf16 v[36:39], v[64:67], v[88:95], v1
  s_waitcnt vmcnt(2)
  v_smfmac_f32_16x16x64_bf16 v[16:19], v[68:71], a[136:143], v1
  ds_read_b128 v[88:91], v3 offset:14336
  v_max3_i32 v96, v96, v64, v68
  v_smfmac_f32_16x16x64_bf16 v[20:23], v[68:71], a[144:151], v1
  ds_read_b128 v[92:95], v3 offset:15360
  v_smfmac_f32_16x16x64_bf16 v[24:27], v[68:71], a[152:159], v1
  s_waitcnt lgkmcnt(2)
  v_smfmac_f32_16x16x64_bf16 v[28:31], v[68:71], a[160:167], v1
  v_smfmac_f32_16x16x64_bf16 v[32:35], v[68:71], a[168:175], v1
  v_smfmac_f32_16x16x64_bf16 v[36:39], v[68:71], v[80:87], v1
  s_waitcnt vmcnt(1)
  v_smfmac_f32_16x16x64_bf16 v[16:19], v[72:75], a[176:183], v1
  ds_read_b128 v[80:83], v3 offset:16384
  s_waitcnt vmcnt(0)
  v_max3_i32 v96, v96, v72, v76
  v_smfmac_f32_16x16x64_bf16 v[20:23], v[72:75], a[184:191], v1
  ds_read_b128 v[84:87], v3 offset:17408
  v_cmp_eq_u32 vcc, s73, v96
  v_smfmac_f32_16x16x64_bf16 v[16:19], v[76:79], a[216:223], v1
  v_smfmac_f32_16x16x64_bf16 v[20:23], v[76:79], a[224:231], v1
  v_smfmac_f32_16x16x64_bf16 v[24:27], v[72:75], a[192:199], v1
  s_cbranch_vccnz A_RETRY
  ds_read_b128 v[40:43], v3 offset:18432
  v_smfmac_f32_16x16x64_bf16 v[28:31], v[72:75], a[200:207], v1
  ds_read_b128 v[44:47], v3 offset:19456
  v_add_f32 v16, v16, v18
  v_smfmac_f32_16x16x64_bf16 v[24:27], v[76:79], a[232:239], v1
  ds_read_b128 v[48:51], v3 offset:20480
  v_add_f32 v17, v17, v19
  v_smfmac_f32_16x16x64_bf16 v[28:31], v[76:79], a[240:247], v1
  s_waitcnt lgkmcnt(3)
  v_cvt_pk_bf16_f32 v52, v16, v17
  v_smfmac_f32_16x16x64_bf16 v[32:35], v[72:75], a[208:215], v1
  v_add_f32 v20, v20, v22
  v_smfmac_f32_16x16x64_bf16 v[36:39], v[72:75], v[88:95], v1
  v_add_f32 v21, v21, v23
  v_smfmac_f32_16x16x64_bf16 v[32:35], v[76:79], a[248:255], v1
  s_waitcnt lgkmcnt(0)
  v_cvt_pk_bf16_f32 v53, v20, v21
  v_smfmac_f32_16x16x64_bf16 v[36:39], v[76:79], v[80:87], v1
  buffer_load_dwordx4 v11, s[32:35], s82 offen offset:0 sc1 lds
  v_add_f32 v24, v24, v26
  v_mfma_f32_16x16x16_bf16 v[60:63], v[52:53], v[12:13], 0
  v_add_f32 v25, v25, v27
  v_cvt_pk_bf16_f32 v54, v24, v25
  v_add_f32 v28, v28, v30
  v_add_f32 v29, v29, v31
  v_cvt_pk_bf16_f32 v55, v28, v29
  v_add_f32 v32, v32, v34
  v_add_f32 v33, v33, v35
  v_mfma_f32_16x16x16_bf16 v[64:67], v[54:55], v[12:13], 0
  buffer_load_dwordx4 v11, s[32:35], s82 offen offset:1024 sc1 lds
  v_cvt_pk_bf16_f32 v56, v32, v33
  v_add_f32 v36, v36, v38
  v_add_f32 v37, v37, v39
  v_cvt_pk_bf16_f32 v57, v36, v37
  v_cvt_pk_bf16_f32 v72, v60, v61
  v_cvt_pk_bf16_f32 v73, v62, v63
  v_mfma_f32_16x16x16_bf16 v[68:71], v[56:57], v[12:13], 0
  buffer_load_dwordx4 v11, s[32:35], s82 offen offset:2048 sc1 lds
  v_cvt_pk_bf16_f32 v74, v64, v65
  v_cvt_pk_bf16_f32 v75, v66, v67
  s_nop 1
  v_mfma_f32_16x16x32_bf16 v[16:19], v[72:75], v[72:75], 0
  v_mfma_f32_16x16x32_bf16 v[24:27], v[44:47], v[72:75], 0
  v_cvt_pk_bf16_f32 v76, v68, v69
  v_cvt_pk_bf16_f32 v77, v70, v71
  v_mfma_f32_16x16x32_bf16 v[20:23], v[40:43], v[72:75], 0
  s_nop 0
  v_mfma_f32_16x16x16_bf16 v[16:19], v[76:77], v[76:77], v[16:19]
  v_mfma_f32_16x16x16_bf16 v[24:27], v[50:51], v[76:77], v[24:27]
  v_mfma_f32_16x16x16_bf16 v[20:23], v[48:49], v[76:77], v[20:23]
  s_nop 0
  v_mov_b32_dpp v16, v18 row_shr:8 row_mask:0xf bank_mask:0xc
  v_mov_b32_dpp v17, v19 row_shr:8 row_mask:0xf bank_mask:0xc
  ds_write_b64 v6, v[16:17]
  s_nop 3
  v_mov_b32_dpp v20, v24 row_shr:8 row_mask:0xf bank_mask:0xc
  v_mov_b32_dpp v21, v25 row_shr:8 row_mask:0xf bank_mask:0xc
  ds_write_b64 v5, v[20:21] offset:0
  v_mov_b32_dpp v22, v26 row_shr:8 row_mask:0xf bank_mask:0xc
  v_mov_b32_dpp v23, v27 row_shr:8 row_mask:0xf bank_mask:0xc
  ds_write_b64 v5, v[22:23] offset:8
  buffer_store_dword v14, v101, s[32:35], 0 offen sc1
  v_mfma_f32_32x32x16_bf16 v[80:95], v[104:107], v[104:107], 0
  v_mfma_f32_32x32x64_f8f6f4 v[24:39], v[104:111], v[104:111], 0
  s_waitcnt lgkmcnt(0)
  s_barrier
  ds_read_b64 v[52:53], v7 offset:0
  ds_read_b64 v[54:55], v7 offset:1408
  ds_read_b64 v[56:57], v7 offset:2816
  ds_read_b64 v[58:59], v7 offset:4224
  v_mfma_f32_32x32x64_f8f6f4 v[80:95], v[104:111], v[104:111], 0
  s_waitcnt lgkmcnt(2)
  v_add_f32 v52, v52, v54
  v_add_f32 v53, v53, v55
  s_waitcnt lgkmcnt(0)
  v_add_f32 v56, v56, v58
  v_add_f32 v57, v57, v59
  v_add_f32 v52, v52, v56
  v_add_f32 v53, v53, v57
  v_fma_f32 v60, v52, s72, v9
  v_fma_f32 v61, v53, s72, v9
  v_exp_f32 v62, v60
  v_exp_f32 v63, v61
  s_nop 0
  v_add_f32 v64, v62, v63
  v_cmp_nle_f32 s[60:61], abs(v52), s77
  s_nop 0
  v_add_f32_dpp v64, v64, v64 row_ror:8 row_mask:0xf bank_mask:0xf
  v_cmp_nle_f32 vcc, abs(v53), s77
  s_nop 0
  v_add_f32_dpp v64, v64, v64 row_ror:4 row_mask:0xf bank_mask:0xf
  s_nop 0
  s_nop 0
  v_add_f32_dpp v64, v64, v64 row_ror:2 row_mask:0xf bank_mask:0xf
  s_or_b64 vcc, vcc, s[60:61]
  s_nop 0
  v_add_f32_dpp v64, v64, v64 row_ror:1 row_mask:0xf bank_mask:0xf
  v_mov_b32 v65, v64
  s_nop 1
  v_permlane16_swap_b32 v64, v65
  v_add_f32 v64, v64, v65
A_FIN:
  v_rcp_f32 v64, v64
  s_cbranch_vccnz A_SLOW
  v_mul_f32 v66, v62, v64
  v_mul_f32 v67, v63, v64
  v_cvt_pk_bf16_f32 v66, v66, v67
  buffer_store_dword v66, v8, s[32:35], s75 offen sc1
  s_and_b32 s54, s52, 15
  s_mul_i32 s54, s54, 0x20000
  s_add_u32 s54, s54, 0x6400000
  s_add_u32 s54, s54, s79
  s_lshr_b32 s53, s54, 7
  s_and_b32 s53, s53, 0x2000
  s_xor_b32 s53, s53, s50
  s_lshl_b32 s54, s54, 1
  s_or_b32 s54, s54, s53
  s_add_u32 s54, s54, s85
  s_mov_b32 exec_lo, 0xff00ff00
  s_mov_b32 exec_hi, 0xff00ff00
  buffer_store_dwordx4 v[72:75], v11, s[32:35], s54 offen offset:128 sc1
  buffer_store_dwordx4 v[76:79], v11, s[32:35], s54 offen sc1
  s_mov_b64 exec, -1
  s_cmp_eq_u32 s59, 0
  s_cbranch_scc1 A_NOSAFE
  buffer_store_dword v14, v10, s[32:35], 0 offen sc1
A_NOSAFE:
  v_mov_b32 v96, s73
  v_mov_b32 v97, s73
  v_mov_b32 v98, s73
  v_mov_b32 v99, s73
  buffer_store_dwordx4 v[96:99], v102, s[32:35], s84 offen sc1
  s_cmp_ge_u32 s52, 61
  s_cbranch_scc1 A_LATE
A_LDONE:
  buffer_store_dword v14, v15, s[32:35], 0 offen sc1
  s_cmp_eq_u32 s52, 0
  s_cbranch_scc1 A_FIRST
A_FDONE:
  s_cmp_eq_u32 s82, 0x40000000
  s_cbranch_scc1 A_KLATE
A_KDONE:
  s_add_u32 s52, s52, 1
  s_cmp_lt_u32 s52, 64
  s_cbranch_scc1 A_STEP
  s_branch L_EXIT
A_LATE:
  s_cmp_lg_u32 s52, 61
  s_cbranch_scc1 A_LATE2
  buffer_store_dword v14, v15, s[32:35], 0 offen sc1
A_LATE2:
  v_add_u32 v14, 1, v14
  s_waitcnt vmcnt(0)
  s_barrier
  s_branch A_LDONE
A_SLOW:
  s_cmp_lg_u32 s58, 0
  s_cbranch_scc1 A_TRUEMAX
  v_lshrrev_b32 v66, 3, v0
  v_mul_u32_u24 v66, 176, v66
  v_and_b32 v67, 7, v0
  v_lshl_add_u32 v66, v67, 2, v66
  v_add_u32 v66, 86144, v66
  ds_read_b32 v68, v66 offset:0
  ds_read_b32 v69, v66 offset:1408
  ds_read_b32 v70, v66 offset:2816
  ds_read_b32 v71, v66 offset:4224
  s_waitcnt lgkmcnt(0)
  v_add_f32 v68, v68, v69
  v_add_f32 v70, v70, v71
  v_add_f32 v68, v68, v70
  v_cmp_u_f32 vcc, v68, v68
  s_nop 1
  s_and_b32 s53, vcc_lo, 0xff
  s_cbranch_scc0 A_TRUEMAX
  s_and_b32 s53, vcc_lo, 0xff00
  s_cbranch_scc0 A_TRUEMAX
  s_and_b32 s53, vcc_lo, 0xff0000
  s_cbranch_scc0 A_TRUEMAX
  s_and_b32 s53, vcc_lo, 0xff000000
  s_cbranch_scc0 A_TRUEMAX
  s_and_b32 s53, vcc_hi, 0xff
  s_cbranch_scc0 A_TRUEMAX
  s_and_b32 s53, vcc_hi, 0xff00
  s_cbranch_scc0 A_TRUEMAX
  s_and_b32 s53, vcc_hi, 0xff0000
  s_cbranch_scc0 A_TRUEMAX
  s_and_b32 s53, vcc_hi, 0xff000000
  s_cbranch_scc0 A_TRUEMAX
  s_barrier
  s_mov_b32 s56, s82
  s_mul_i32 s82, s52, 0x80000
  s_add_u32 s82, s82, 0x180000
  s_add_u32 s82, s82, s78
  s_lshr_b32 s53, s82, 7
  s_and_b32 s53, s53, 0x2000
  s_xor_b32 s53, s53, s51
  s_lshl_b32 s82, s82, 1
  s_or_b32 s82, s82, s53
  s_and_b32 s55, s49, 1
  s_lshl_b32 s55, s55, 12
  s_add_u32 s82, s82, s55
  buffer_load_dwordx4 v11, s[32:35], s82 offen offset:0 sc1 lds
  buffer_load_dwordx4 v11, s[32:35], s82 offen offset:1024 sc1 lds
  buffer_load_dwordx4 v11, s[32:35], s82 offen offset:2048 sc1 lds
  s_mov_b32 s82, s56
  s_mov_b32 s57, 0
VR_39:
  buffer_load_dwordx4 v[40:43], v2, s[32:35], s62 offen sc1
  buffer_load_dwordx4 v[44:47], v2, s[32:35], s63 offen sc1
  buffer_load_dwordx4 v[48:51], v2, s[32:35], s64 offen sc1
  buffer_load_dwordx4 v[52:55], v2, s[32:35], s65 offen sc1
  buffer_load_dwordx4 v[56:59], v2, s[32:35], s66 offen sc1
  buffer_load_dwordx4 v[60:63], v2, s[32:35], s67 offen sc1
  buffer_load_dwordx4 v[64:67], v2, s[32:35], s68 offen sc1
  buffer_load_dwordx4 v[68:71], v2, s[32:35], s69 offen sc1
  buffer_load_dwordx4 v[72:75], v2, s[32:35], s70 offen sc1
  buffer_load_dwordx4 v[76:79], v2, s[32:35], s71 offen sc1
  s_add_u32 s57, s57, 1
  s_cmp_gt_u32 s57, 0x20000
  s_cbranch_scc1 L_EXIT
  s_waitcnt vmcnt(0)
  s_mov_b64 s[60:61], 0
  v_cmp_eq_u32 vcc, s73, v40
  s_nop 0
  s_or_b64 s[60:61], s[60:61], vcc
  v_cmp_eq_u32 vcc, s73, v41
  s_nop 0
  s_or_b64 s[60:61], s[60:61], vcc
  v_cmp_eq_u32 vcc, s73, v42
  s_nop 0
  s_or_b64 s[60:61], s[60:61], vcc
  v_cmp_eq_u32 vcc, s73, v43
  s_nop 0
  s_or_b64 s[60:61], s[60:61], vcc
  v_cmp_eq_u32 vcc, s73, v44
  s_nop 0
  s_or_b64 s[60:61], s[60:61], vcc
  v_cmp_eq_u32 vcc, s73, v45
  s_nop 0
  s_or_b64 s[60:61], s[60:61], vcc
  v_cmp_eq_u32 vcc, s73, v46
  s_nop 0
  s_or_b64 s[60:61], s[60:61], vcc
  v_cmp_eq_u32 vcc, s73, v47
  s_nop 0
  s_or_b64 s[60:61], s[60:61], vcc
  v_cmp_eq_u32 vcc, s73, v48
  s_nop 0
  s_or_b64 s[60:61], s[60:61], vcc
  v_cmp_eq_u32 vcc, s73, v49
  s_nop 0
  s_or_b64 s[60:61], s[60:61], vcc
  v_cmp_eq_u32 vcc, s73, v50
  s_nop 0
  s_or_b64 s[60:61], s[60:61], vcc
  v_cmp_eq_u32 vcc, s73, v51
  s_nop 0
  s_or_b64 s[60:61], s[60:61], vcc
  v_cmp_eq_u32 vcc, s73, v52
  s_nop 0
  s_or_b64 s[60:61], s[60:61], vcc
  v_cmp_eq_u32 vcc, s73, v53
  s_nop 0
  s_or_b64 s[60:61], s[60:61], vcc
  v_cmp_eq_u32 vcc, s73, v54
  s_nop 0
  s_or_b64 s[60:61], s[60:61], vcc
  v_cmp_eq_u32 vcc, s73, v55
  s_nop 0
  s_or_b64 s[60:61], s[60:61], vcc
  v_cmp_eq_u32 vcc, s73, v56
  s_nop 0
  s_or_b64 s[60:61], s[60:61], vcc
  v_cmp_eq_u32 vcc, s73, v57
  s_nop 0
  s_or_b64 s[60:61], s[60:61], vcc
  v_cmp_eq_u32 vcc, s73, v58
  s_nop 0
  s_or_b64 s[60:61], s[60:61], vcc
  v_cmp_eq_u32 vcc, s73, v59
  s_nop 0
  s_or_b64 s[60:61], s[60:61], vcc
  v_cmp_eq_u32 vcc, s73, v60
  s_nop 0
  s_or_b64 s[60:61], s[60:61], vcc
  v_cmp_eq_u32 vcc, s73, v61
  s_nop 0
  s_or_b64 s[60:61], s[60:61], vcc
  v_cmp_eq_u32 vcc, s73, v62
  s_nop 0
  s_or_b64 s[60:61], s[60:61], vcc
  v_cmp_eq_u32 vcc, s73, v63
  s_nop 0
  s_or_b64 s[60:61], s[60:61], vcc
  v_cmp_eq_u32 vcc, s73, v64
  s_nop 0
  s_or_b64 s[60:61], s[60:61], vcc
  v_cmp_eq_u32 vcc, s73, v65
  s_nop 0
  s_or_b64 s[60:61], s[60:61], vcc
  v_cmp_eq_u32 vcc, s73, v66
  s_nop 0
  s_or_b64 s[60:61], s[60:61], vcc
  v_cmp_eq_u32 vcc, s73, v67
  s_nop 0
  s_or_b64 s[60:61], s[60:61], vcc
  v_cmp_eq_u32 vcc, s73, v68
  s_nop 0
  s_or_b64 s[60:61], s[60:61], vcc
  v_cmp_eq_u32 vcc, s73, v69
  s_nop 0
  s_or_b64 s[60:61], s[60:61], vcc
  v_cmp_eq_u32 vcc, s73, v70
  s_nop 0
  s_or_b64 s[60:61], s[60:61], vcc
  v_cmp_eq_u32 vcc, s73, v71
  s_nop 0
  s_or_b64 s[60:61], s[60:61], vcc
  v_cmp_eq_u32 vcc, s73, v72
  s_nop 0
  s_or_b64 s[60:61], s[60:61], vcc
  v_cmp_eq_u32 vcc, s73, v73
  s_nop 0
  s_or_b64 s[60:61], s[60:61], vcc
  v_cmp_eq_u32 vcc, s73, v74
  s_nop 0
  s_or_b64 s[60:61], s[60:61], vcc
  v_cmp_eq_u32 vcc, s73, v75
  s_nop 0
  s_or_b64 s[60:61], s[60:61], vcc
  v_cmp_eq_u32 vcc, s73, v76
  s_nop 0
  s_or_b64 s[60:61], s[60:61], vcc
  v_cmp_eq_u32 vcc, s73, v77
  s_nop 0
  s_or_b64 s[60:61], s[60:61], vcc
  v_cmp_eq_u32 vcc, s73, v78
  s_nop 0
  s_or_b64 s[60:61], s[60:61], vcc
  v_cmp_eq_u32 vcc, s73, v79
  s_nop 0
  s_or_b64 s[60:61], s[60:61], vcc
  s_cbranch_scc1 VR_39
  s_mov_b32 s58, 1
  v_mov_b64 v[16:17], 0
  v_mov_b64 v[18:19], 0
  v_mov_b64 v[20:21], 0
  v_mov_b64 v[22:23], 0
  v_mov_b64 v[24:25], 0
  v_mov_b64 v[26:27], 0
  v_mov_b64 v[28:29], 0
  v_mov_b64 v[30:31], 0
  v_mov_b64 v[32:33], 0
  v_mov_b64 v[34:35], 0
  v_mov_b64 v[36:37], 0
  v_mov_b64 v[38:39], 0
  ds_read_b128 v[80:83], v3 offset:0
  ds_read_b128 v[84:87], v3 offset:1024
  ds_read_b128 v[88:91], v3 offset:2048
  ds_read_b128 v[92:95], v3 offset:3072
  s_waitcnt lgkmcnt(0)
  s_branch A_GEMM
A_RETRY:
  v_mov_b32 v101, 0x40000000
  s_mov_b32 s59, 1
  s_waitcnt lgkmcnt(0)
  s_nop 7
  v_mov_b64 v[16:17], 0
  v_mov_b64 v[18:19], 0
  v_mov_b64 v[20:21], 0
  v_mov_b64 v[22:23], 0
  v_mov_b64 v[24:25], 0
  v_mov_b64 v[26:27], 0
  v_mov_b64 v[28:29], 0
  v_mov_b64 v[30:31], 0
  v_mov_b64 v[32:33], 0
  v_mov_b64 v[34:35], 0
  v_mov_b64 v[36:37], 0
  v_mov_b64 v[38:39], 0
  ds_read_b128 v[80:83], v3 offset:0
  ds_read_b128 v[84:87], v3 offset:1024
  ds_read_b128 v[88:91], v3 offset:2048
  ds_read_b128 v[92:95], v3 offset:3072
  s_call_b64 s[86:87], A_FIX
  s_waitcnt lgkmcnt(0)
  s_branch A_GEMM
A_FIX:
FX_40:
  s_waitcnt vmcnt(0)
  v_cmp_eq_u32 s[4:5], s73, v40
  v_cmp_eq_u32 s[6:7], s73, v44
  v_cmp_eq_u32 s[8:9], s73, v48
  v_cmp_eq_u32 s[10:11], s73, v52
  v_cmp_eq_u32 s[12:13], s73, v56
  v_cmp_eq_u32 s[14:15], s73, v60
  v_cmp_eq_u32 s[16:17], s73, v64
  v_cmp_eq_u32 s[18:19], s73, v68
  v_cmp_eq_u32 s[20:21], s73, v72
  v_cmp_eq_u32 s[22:23], s73, v76
  s_add_u32 s57, s57, 1
  s_cmp_gt_u32 s57, 0x80000
  s_cbranch_scc1 L_EXIT
  s_cmp_lg_u64 s[4:5], 0
  s_cbranch_scc1 A_FIX_S0
  s_cmp_lg_u64 s[6:7], 0
  s_cbranch_scc1 A_FIX_S1
  s_cmp_lg_u64 s[8:9], 0
  s_cbranch_scc1 A_FIX_S2
  s_cmp_lg_u64 s[10:11], 0
  s_cbranch_scc1 A_FIX_S3
  s_cmp_lg_u64 s[12:13], 0
  s_cbranch_scc1 A_FIX_S4
  s_cmp_lg_u64 s[14:15], 0
  s_cbranch_scc1 A_FIX_S5
  s_cmp_lg_u64 s[16:17], 0
  s_cbranch_scc1 A_FIX_S6
  s_cmp_lg_u64 s[18:19], 0
  s_cbranch_scc1 A_FIX_S7
  s_cmp_lg_u64 s[20:21], 0
  s_cbranch_scc1 A_FIX_S8
  s_cmp_lg_u64 s[22:23], 0
  s_cbranch_scc1 A_FIX_S9
  s_setpc_b64 s[86:87]
A_FIX_S0:
  buffer_load_dwordx4 v[40:43], v2, s[32:35], s62 offen sc1
  s_add_u32 s57, s57, 1
  s_cmp_gt_u32 s57, 0x80000
  s_cbranch_scc1 L_EXIT
  s_waitcnt vmcnt(0)
  v_cmp_eq_u32 vcc, s73, v40
  s_cbranch_vccnz A_FIX_S0
  s_mov_b32 s53, 0
  s_branch A_FIX_R1
A_FIX_S1:
  buffer_load_dwordx4 v[44:47], v2, s[32:35], s63 offen sc1
  s_add_u32 s57, s57, 1
  s_cmp_gt_u32 s57, 0x80000
  s_cbranch_scc1 L_EXIT
  s_waitcnt vmcnt(0)
  v_cmp_eq_u32 vcc, s73, v44
  s_cbranch_vccnz A_FIX_S1
  s_mov_b32 s53, 0
  s_branch A_FIX_R2
A_FIX_S2:
  buffer_load_dwordx4 v[48:51], v2, s[32:35], s64 offen sc1
  s_add_u32 s57, s57, 1
  s_cmp_gt_u32 s57, 0x80000
  s_cbranch_scc1 L_EXIT
  s_waitcnt vmcnt(0)
  v_cmp_eq_u32 vcc, s73, v48
  s_cbranch_vccnz A_FIX_S2
  s_mov_b32 s53, 0
  s_branch A_FIX_R3
A_FIX_S3:
  buffer_load_dwordx4 v[52:55], v2, s[32:35], s65 offen sc1
  s_add_u32 s57, s57, 1
  s_cmp_gt_u32 s57, 0x80000
  s_cbranch_scc1 L_EXIT
  s_waitcnt vmcnt(0)
  v_cmp_eq_u32 vcc, s73, v52
  s_cbranch_vccnz A_FIX_S3
  s_mov_b32 s53, 0
  s_branch A_FIX_R4
A_FIX_S4:
  buffer_load_dwordx4 v[56:59], v2, s[32:35], s66 offen sc1
  s_add_u32 s57, s57, 1
  s_cmp_gt_u32 s57, 0x80000
  s_cbranch_scc1 L_EXIT
  s_waitcnt vmcnt(0)
  v_cmp_eq_u32 vcc, s73, v56
  s_cbranch_vccnz A_FIX_S4
  s_mov_b32 s53, 0
  s_branch A_FIX_R5
A_FIX_S5:
  buffer_load_dwordx4 v[60:63], v2, s[32:35], s67 offen sc1
  s_add_u32 s57, s57, 1
  s_cmp_gt_u32 s57, 0x80000
  s_cbranch_scc1 L_EXIT
  s_waitcnt vmcnt(0)
  v_cmp_eq_u32 vcc, s73, v60
  s_cbranch_vccnz A_FIX_S5
  s_mov_b32 s53, 0
  s_branch A_FIX_R6
A_FIX_S6:
  buffer_load_dwordx4 v[64:67], v2, s[32:35], s68 offen sc1
  s_add_u32 s57, s57, 1
  s_cmp_gt_u32 s57, 0x80000
  s_cbranch_scc1 L_EXIT
  s_waitcnt vmcnt(0)
  v_cmp_eq_u32 vcc, s73, v64
  s_cbranch_vccnz A_FIX_S6
  s_mov_b32 s53, 0
  s_branch A_FIX_R7
A_FIX_S7:
  buffer_load_dwordx4 v[68:71], v2, s[32:35], s69 offen sc1
  s_add_u32 s57, s57, 1
  s_cmp_gt_u32 s57, 0x80000
  s_cbranch_scc1 L_EXIT
  s_waitcnt vmcnt(0)
  v_cmp_eq_u32 vcc, s73, v68
  s_cbranch_vccnz A_FIX_S7
  s_mov_b32 s53, 0
  s_branch A_FIX_R8
A_FIX_S8:
  buffer_load_dwordx4 v[72:75], v2, s[32:35], s70 offen sc1
  s_add_u32 s57, s57, 1
  s_cmp_gt_u32 s57, 0x80000
  s_cbranch_scc1 L_EXIT
  s_waitcnt vmcnt(0)
  v_cmp_eq_u32 vcc, s73, v72
  s_cbranch_vccnz A_FIX_S8
  s_mov_b32 s53, 0
  s_branch A_FIX_R9
A_FIX_S9:
  buffer_load_dwordx4 v[76:79], v2, s[32:35], s71 offen sc1
  s_add_u32 s57, s57, 1
  s_cmp_gt_u32 s57, 0x80000
  s_cbranch_scc1 L_EXIT
  s_waitcnt vmcnt(0)
  v_cmp_eq_u32 vcc, s73, v76
  s_cbranch_vccnz A_FIX_S9
  s_mov_b32 s53, 0
  s_branch A_FIX_R10
A_FIX_R1:
  s_cmp_lg_u64 s[6:7], 0
  s_cbranch_scc1 A_FIX_L1
A_FIX_R2:
  s_cmp_lg_u64 s[8:9], 0
  s_cbranch_scc1 A_FIX_L2
A_FIX_R3:
  s_cmp_lg_u64 s[10:11], 0
  s_cbranch_scc1 A_FIX_L3
A_FIX_R4:
  s_cmp_lg_u64 s[12:13], 0
  s_cbranch_scc1 A_FIX_L4
A_FIX_R5:
  s_cmp_lg_u64 s[14:15], 0
  s_cbranch_scc1 A_FIX_L5
A_FIX_R6:
  s_cmp_lg_u64 s[16:17], 0
  s_cbranch_scc1 A_FIX_L6
A_FIX_R7:
  s_cmp_lg_u64 s[18:19], 0
  s_cbranch_scc1 A_FIX_L7
A_FIX_R8:
  s_cmp_lg_u64 s[20:21], 0
  s_cbranch_scc1 A_FIX_L8
A_FIX_R9:
  s_cmp_lg_u64 s[22:23], 0
  s_cbranch_scc1 A_FIX_L9
A_FIX_R10:
  s_cmp_lg_u32 s53, 0
  s_cbranch_scc1 FX_40
  s_setpc_b64 s[86:87]
A_FIX_L1:
  buffer_load_dwordx4 v[44:47], v2, s[32:35], s63 offen sc1
  s_mov_b32 s53, 1
  s_branch A_FIX_R2
A_FIX_L2:
  buffer_load_dwordx4 v[48:51], v2, s[32:35], s64 offen sc1
  s_mov_b32 s53, 1
  s_branch A_FIX_R3
A_FIX_L3:
  buffer_load_dwordx4 v[52:55], v2, s[32:35], s65 offen sc1
  s_mov_b32 s53, 1
  s_branch A_FIX_R4
A_FIX_L4:
  buffer_load_dwordx4 v[56:59], v2, s[32:35], s66 offen sc1
  s_mov_b32 s53, 1
  s_branch A_FIX_R5
A_FIX_L5:
  buffer_load_dwordx4 v[60:63], v2, s[32:35], s67 offen sc1
  s_mov_b32 s53, 1
  s_branch A_FIX_R6
A_FIX_L6:
  buffer_load_dwordx4 v[64:67], v2, s[32:35], s68 offen sc1
  s_mov_b32 s53, 1
  s_branch A_FIX_R7
A_FIX_L7:
  buffer_load_dwordx4 v[68:71], v2, s[32:35], s69 offen sc1
  s_mov_b32 s53, 1
  s_branch A_FIX_R8
A_FIX_L8:
  buffer_load_dwordx4 v[72:75], v2, s[32:35], s70 offen sc1
  s_mov_b32 s53, 1
  s_branch A_FIX_R9
A_FIX_L9:
  buffer_load_dwordx4 v[76:79], v2, s[32:35], s71 offen sc1
  s_mov_b32 s53, 1
  s_branch A_FIX_R10
A_FIRST:
  s_waitcnt vmcnt(0)
  s_barrier
  s_lshl_b32 s54, s48, 7
  s_add_u32 s54, s54, s50
  s_add_u32 s54, s54, 0
  s_cmp_eq_u32 s49, 0
  s_cselect_b32 s54, s54, 0x40000000
  v_mov_b32 v96, 0x40000000
  s_nop 0
  v_writelane_b32 v96, s54, 0
  v_mov_b32 v97, 1
  buffer_store_dword v97, v96, s[32:35], 0 offen sc1
  s_add_u32 s54, s50, 16388
  v_lshl_add_u32 v96, v0, 7, s54
  s_mov_b32 s55, 1
  s_mov_b32 exec_hi, 0x0
  s_mov_b32 s57, 0
PL_42:
  buffer_load_dword v97, v96, s[32:35], 0 offen sc1
  s_waitcnt vmcnt(0)
  v_cmp_gt_u32 vcc, s55, v97
  s_cbranch_vccz PR_43
  s_add_u32 s57, s57, 1
  s_cmp_lt_u32 s57, 0x80000
  s_cbranch_scc1 PL_42
  s_branch L_EXIT
PR_43:
  s_mov_b64 exec, -1
  v_bfe_u32 v96, v0, 2, 3
  v_lshl_add_u32 v99, v97, 3, v96
  s_nop 1
  v_min_u32_dpp v99, v99, v99 row_ror:4 row_mask:0xf bank_mask:0xf
  s_nop 1
  v_min_u32_dpp v99, v99, v99 row_ror:8 row_mask:0xf bank_mask:0xf
  v_mov_b32 v96, v99
  s_nop 1
  v_permlane16_swap_b32 v99, v96
  v_min_u32 v99, v99, v96
  v_bfe_u32 v96, v99, 2, 1
  v_and_b32 v99, 3, v99
  v_lshlrev_b32 v99, 11, v99
  v_lshl_add_u32 v99, v96, 14, v99
  v_and_b32 v96, 3, v0
  v_lshl_add_u32 v99, v96, 7, v99
  s_and_b32 s54, s2, 3
  v_readlane_b32 s54, v99, s54
  s_add_u32 s54, s54, s50
  s_add_u32 s54, s54, 131584
  v_mov_b32 v4, s54
  s_add_u32 s54, s50, 131072
  s_cmp_eq_u32 s49, 0
  s_cselect_b32 s54, s54, 0x40000000
  s_cmp_eq_u32 s48, 0
  s_cselect_b32 s54, s54, 0x40000000
  v_add_u32 v10, s54, v99
  v_mov_b32 v96, 0x40000000
  v_cmp_lt_u32 vcc, 3, v0
  s_nop 1
  v_cndmask_b32 v10, v10, v96, vcc
  s_branch A_FDONE
A_KLATE:
  s_cmp_ge_u32 s76, s83
  s_cbranch_scc1 WPD_44
  s_mov_b32 s57, 0
  s_mov_b32 exec_lo, 0x1
  s_mov_b32 exec_hi, 0
WPL_45:
  buffer_load_dword v97, v100, s[32:35], 0 offen sc1
  s_add_u32 s57, s57, 1
  s_cmp_gt_u32 s57, 0x80000
  s_cbranch_scc1 L_EXIT
  s_waitcnt vmcnt(0)
  v_cmp_gt_u32 vcc, s83, v97
  s_cbranch_vccnz WPL_45
  s_mov_b32 s76, s83
  s_add_u32 s53, s83, 2
  s_min_u32 s53, s53, 64
  v_cmp_gt_u32 vcc, s53, v97
  s_nop 0
  s_cmp_eq_u64 vcc, 0
  s_cselect_b32 s76, s53, s76
  s_add_u32 s53, s83, 6
  s_min_u32 s53, s53, 64
  v_cmp_gt_u32 vcc, s53, v97
  s_nop 0
  s_cmp_eq_u64 vcc, 0
  s_cselect_b32 s76, s53, s76
  s_add_u32 s53, s83, 16
  s_min_u32 s53, s53, 64
  v_cmp_gt_u32 vcc, s53, v97
  s_nop 0
  s_cmp_eq_u64 vcc, 0
  s_cselect_b32 s76, s53, s76
  s_mov_b64 exec, -1
WPD_44:
  s_sub_u32 s56, s83, 1
  s_mul_i32 s82, s56, 0x80000
  s_add_u32 s82, s82, 0x180000
  s_add_u32 s82, s82, s78
  s_lshr_b32 s53, s82, 7
  s_and_b32 s53, s53, 0x2000
  s_xor_b32 s53, s53, s51
  s_lshl_b32 s82, s82, 1
  s_or_b32 s82, s82, s53
  s_and_b32 s55, s49, 1
  s_lshl_b32 s55, s55, 12
  s_add_u32 s82, s82, s55
  buffer_load_dwordx4 v11, s[32:35], s82 offen offset:0 sc1 lds
  buffer_load_dwordx4 v11, s[32:35], s82 offen offset:1024 sc1 lds
  buffer_load_dwordx4 v11, s[32:35], s82 offen offset:2048 sc1 lds
  s_branch A_KDONE
A_TRUEMAX:
  v_max_f32 v64, v60, v61
  s_nop 1
  v_max_f32_dpp v64, v64, v64 row_ror:8 row_mask:0xf bank_mask:0xf
  s_nop 1
  v_max_f32_dpp v64, v64, v64 row_ror:4 row_mask:0xf bank_mask:0xf
  s_nop 1
  v_max_f32_dpp v64, v64, v64 row_ror:2 row_mask:0xf bank_mask:0xf
  s_nop 1
  v_max_f32_dpp v64, v64, v64 row_ror:1 row_mask:0xf bank_mask:0xf
  v_mov_b32 v65, v64
  s_nop 1
  v_permlane16_swap_b32 v64, v65
  v_max_f32 v64, v64, v65
  v_sub_f32 v62, v60, v64
  v_sub_f32 v63, v61, v64
  v_exp_f32 v62, v62
  v_exp_f32 v63, v63
  s_nop 0
  v_add_f32 v64, v62, v63
  s_nop 1
  v_add_f32_dpp v64, v64, v64 row_ror:8 row_mask:0xf bank_mask:0xf
  s_nop 1
  v_add_f32_dpp v64, v64, v64 row_ror:4 row_mask:0xf bank_mask:0xf
  s_nop 1
  v_add_f32_dpp v64, v64, v64 row_ror:2 row_mask:0xf bank_mask:0xf
  s_nop 1
  v_add_f32_dpp v64, v64, v64 row_ror:1 row_mask:0xf bank_mask:0xf
  v_mov_b32 v65, v64
  s_nop 1
  v_permlane16_swap_b32 v64, v65
  v_add_f32 v64, v64, v65
  s_mov_b64 vcc, 0
  s_branch A_FIN
R_V:
  s_mov_b32 s36, s20
  s_and_b32 s37, s21, 0xffff
  s_mov_b32 s38, 0x780000
  s_mov_b32 s39, 0x20000
  s_mov_b32 s40, s22
  s_and_b32 s41, s23, 0xffff
  s_mov_b32 s42, 0x780000
  s_mov_b32 s43, 0x20000
  s_and_b32 s53, s48, 3
  s_mul_i32 s53, s53, 5
  s_lshr_b32 s62, s53, 1
  s_add_u32 s63, s62, 1
  s_cmp_eq_u32 s63, 10
  s_cselect_b32 s63, 0, s63
  s_add_u32 s64, s63, 1
  s_cmp_eq_u32 s64, 10
  s_cselect_b32 s64, 0, s64
  s_add_u32 s65, s64, 1
  s_cmp_eq_u32 s65, 10
  s_cselect_b32 s65, 0, s65
  s_add_u32 s66, s65, 1
  s_cmp_eq_u32 s66, 10
  s_cselect_b32 s66, 0, s66
  s_add_u32 s67, s66, 1
  s_cmp_eq_u32 s67, 10
  s_cselect_b32 s67, 0, s67
  s_add_u32 s68, s67, 1
  s_cmp_eq_u32 s68, 10
  s_cselect_b32 s68, 0, s68
  s_add_u32 s69, s68, 1
  s_cmp_eq_u32 s69, 10
  s_cselect_b32 s69, 0, s69
  s_add_u32 s70, s69, 1
  s_cmp_eq_u32 s70, 10
  s_cselect_b32 s70, 0, s70
  s_add_u32 s71, s70, 1
  s_cmp_eq_u32 s71, 10
  s_cselect_b32 s71, 0, s71
  s_bfe_u32 s76, s48, 0x10003
  s_mul_i32 s76, s76, 640
  s_sub_u32 s77, 640, s76
  v_lshlrev_b32 v11, 4, v0
  s_mul_i32 s53, s49, 18432
  v_add_u32 v3, s53, v11
  s_mul_i32 s55, s48, 384
  s_mul_i32 s53, s49, 384
  s_add_u32 s53, s53, 0
  v_add_u32 v60, s53, v0
  v_mul_u32_u24 v61, 43691, v60
  v_lshrrev_b32 v61, 20, v61
  v_mul_u32_u24 v62, 24, v61
  v_sub_u32 v60, v60, v62
  v_and_b32 v62, 2, v61
  v_lshrrev_b32 v63, 1, v61
  v_and_b32 v63, 4, v63
  v_or_b32 v62, v62, v63
  v_xor_b32 v60, v60, v62
  v_mul_u32_u24 v61, 12288, v61
  v_lshl_add_u32 v40, v60, 4, v61
  v_add_u32 v40, s55, v40
  s_mul_i32 s53, s49, 384
  s_add_u32 s53, s53, 64
  v_add_u32 v60, s53, v0
  v_mul_u32_u24 v61, 43691, v60
  v_lshrrev_b32 v61, 20, v61
  v_mul_u32_u24 v62, 24, v61
  v_sub_u32 v60, v60, v62
  v_and_b32 v62, 2, v61
  v_lshrrev_b32 v63, 1, v61
  v_and_b32 v63, 4, v63
  v_or_b32 v62, v62, v63
  v_xor_b32 v60, v60, v62
  v_mul_u32_u24 v61, 12288, v61
  v_lshl_add_u32 v41, v60, 4, v61
  v_add_u32 v41, s55, v41
  s_mul_i32 s53, s49, 384
  s_add_u32 s53, s53, 128
  v_add_u32 v60, s53, v0
  v_mul_u32_u24 v61, 43691, v60
  v_lshrrev_b32 v61, 20, v61
  v_mul_u32_u24 v62, 24, v61
  v_sub_u32 v60, v60, v62
  v_and_b32 v62, 2, v61
  v_lshrrev_b32 v63, 1, v61
  v_and_b32 v63, 4, v63
  v_or_b32 v62, v62, v63
  v_xor_b32 v60, v60, v62
  v_mul_u32_u24 v61, 12288, v61
  v_lshl_add_u32 v42, v60, 4, v61
  v_add_u32 v42, s55, v42
  s_mul_i32 s53, s49, 384
  s_add_u32 s53, s53, 192
  v_add_u32 v60, s53, v0
  v_mul_u32_u24 v61, 43691, v60
  v_lshrrev_b32 v61, 20, v61
  v_mul_u32_u24 v62, 24, v61
  v_sub_u32 v60, v60, v62
  v_and_b32 v62, 2, v61
  v_lshrrev_b32 v63, 1, v61
  v_and_b32 v63, 4, v63
  v_or_b32 v62, v62, v63
  v_xor_b32 v60, v60, v62
  v_mul_u32_u24 v61, 12288, v61
  v_lshl_add_u32 v43, v60, 4, v61
  v_add_u32 v43, s55, v43
  s_mul_i32 s53, s49, 384
  s_add_u32 s53, s53, 256
  v_add_u32 v60, s53, v0
  v_mul_u32_u24 v61, 43691, v60
  v_lshrrev_b32 v61, 20, v61
  v_mul_u32_u24 v62, 24, v61
  v_sub_u32 v60, v60, v62
  v_and_b32 v62, 2, v61
  v_lshrrev_b32 v63, 1, v61
  v_and_b32 v63, 4, v63
  v_or_b32 v62, v62, v63
  v_xor_b32 v60, v60, v62
  v_mul_u32_u24 v61, 12288, v61
  v_lshl_add_u32 v44, v60, 4, v61
  v_add_u32 v44, s55, v44
  s_mul_i32 s53, s49, 384
  s_add_u32 s53, s53, 320
  v_add_u32 v60, s53, v0
  v_mul_u32_u24 v61, 43691, v60
  v_lshrrev_b32 v61, 20, v61
  v_mul_u32_u24 v62, 24, v61
  v_sub_u32 v60, v60, v62
  v_and_b32 v62, 2, v61
  v_lshrrev_b32 v63, 1, v61
  v_and_b32 v63, 4, v63
  v_or_b32 v62, v62, v63
  v_xor_b32 v60, v60, v62
  v_mul_u32_u24 v61, 12288, v61
  v_lshl_add_u32 v45, v60, 4, v61
  v_add_u32 v45, s55, v45
  s_add_u32 s55, s49, 0
  v_lshrrev_b32 v60, 4, v0
  v_bfe_u32 v61, v0, 2, 2
  v_lshl_add_u32 v62, v60, 3, v61
  v_and_b32 v60, 1, v60
  v_lshrrev_b32 v61, 1, v61
  v_lshl_add_u32 v60, v60, 1, v61
  v_xor_b32 v60, s55, v60
  v_mul_u32_u24 v62, 384, v62
  v_lshl_add_u32 v62, v60, 5, v62
  v_and_b32 v60, 3, v0
  v_lshl_add_u32 v46, v60, 3, v62
  s_add_u32 s55, s49, 4
  v_lshrrev_b32 v60, 4, v0
  v_bfe_u32 v61, v0, 2, 2
  v_lshl_add_u32 v62, v60, 3, v61
  v_and_b32 v60, 1, v60
  v_lshrrev_b32 v61, 1, v61
  v_lshl_add_u32 v60, v60, 1, v61
  v_xor_b32 v60, s55, v60
  v_mul_u32_u24 v62, 384, v62
  v_lshl_add_u32 v62, v60, 5, v62
  v_and_b32 v60, 3, v0
  v_lshl_add_u32 v47, v60, 3, v62
  s_add_u32 s55, s49, 8
  v_lshrrev_b32 v60, 4, v0
  v_bfe_u32 v61, v0, 2, 2
  v_lshl_add_u32 v62, v60, 3, v61
  v_and_b32 v60, 1, v60
  v_lshrrev_b32 v61, 1, v61
  v_lshl_add_u32 v60, v60, 1, v61
  v_xor_b32 v60, s55, v60
  v_mul_u32_u24 v62, 384, v62
  v_lshl_add_u32 v62, v60, 5, v62
  v_and_b32 v60, 3, v0
  v_lshl_add_u32 v48, v60, 3, v62
  s_mul_i32 s55, s48, 245760
  s_mul_i32 s53, s49, 320
  s_add_u32 s53, s53, 0
  v_add_u32 v60, s53, v0
  v_mul_u32_u24 v61, 26215, v60
  v_lshrrev_b32 v61, 20, v61
  v_mul_u32_u24 v62, 40, v61
  v_sub_u32 v60, v60, v62
  v_and_b32 v62, 2, v61
  v_lshrrev_b32 v63, 1, v61
  v_and_b32 v63, 4, v63
  v_or_b32 v62, v62, v63
  v_xor_b32 v60, v60, v62
  v_mul_u32_u24 v61, 1280, v61
  v_lshl_add_u32 v1, v60, 4, v61
  v_add_u32 v1, s55, v1
  s_mul_i32 s53, s49, 320
  s_add_u32 s53, s53, 64
  v_add_u32 v60, s53, v0
  v_mul_u32_u24 v61, 26215, v60
  v_lshrrev_b32 v61, 20, v61
  v_mul_u32_u24 v62, 40, v61
  v_sub_u32 v60, v60, v62
  v_and_b32 v62, 2, v61
  v_lshrrev_b32 v63, 1, v61
  v_and_b32 v63, 4, v63
  v_or_b32 v62, v62, v63
  v_xor_b32 v60, v60, v62
  v_mul_u32_u24 v61, 1280, v61
  v_lshl_add_u32 v2, v60, 4, v61
  v_add_u32 v2, s55, v2
  s_mul_i32 s53, s49, 320
  s_add_u32 s53, s53, 128
  v_add_u32 v60, s53, v0
  v_mul_u32_u24 v61, 26215, v60
  v_lshrrev_b32 v61, 20, v61
  v_mul_u32_u24 v62, 40, v61
  v_sub_u32 v60, v60, v62
  v_and_b32 v62, 2, v61
  v_lshrrev_b32 v63, 1, v61
  v_and_b32 v63, 4, v63
  v_or_b32 v62, v62, v63
  v_xor_b32 v60, v60, v62
  v_mul_u32_u24 v61, 1280, v61
  v_lshl_add_u32 v3, v60, 4, v61
  v_add_u32 v3, s55, v3
  s_mul_i32 s53, s49, 320
  s_add_u32 s53, s53, 192
  v_add_u32 v60, s53, v0
  v_mul_u32_u24 v61, 26215, v60
  v_lshrrev_b32 v61, 20, v61
  v_mul_u32_u24 v62, 40, v61
  v_sub_u32 v60, v60, v62
  v_and_b32 v62, 2, v61
  v_lshrrev_b32 v63, 1, v61
  v_and_b32 v63, 4, v63
  v_or_b32 v62, v62, v63
  v_xor_b32 v60, v60, v62
  v_mul_u32_u24 v61, 1280, v61
  v_lshl_add_u32 v4, v60, 4, v61
  v_add_u32 v4, s55, v4
  s_mul_i32 s53, s49, 320
  s_add_u32 s53, s53, 256
  v_add_u32 v60, s53, v0
  v_mul_u32_u24 v61, 26215, v60
  v_lshrrev_b32 v61, 20, v61
  v_mul_u32_u24 v62, 40, v61
  v_sub_u32 v60, v60, v62
  v_and_b32 v62, 2, v61
  v_lshrrev_b32 v63, 1, v61
  v_and_b32 v63, 4, v63
  v_or_b32 v62, v62, v63
  v_xor_b32 v60, v60, v62
  v_mul_u32_u24 v61, 1280, v61
  v_lshl_add_u32 v5, v60, 4, v61
  v_add_u32 v5, s55, v5
  s_mul_i32 s55, s49, 5
  s_add_u32 s55, s55, 0
  v_lshrrev_b32 v60, 4, v0
  v_bfe_u32 v61, v0, 2, 2
  v_lshl_add_u32 v62, v60, 3, v61
  v_and_b32 v60, 1, v60
  v_lshrrev_b32 v61, 1, v61
  v_lshl_add_u32 v60, v60, 1, v61
  v_xor_b32 v60, s55, v60
  v_mul_u32_u24 v62, 640, v62
  v_lshl_add_u32 v62, v60, 5, v62
  v_and_b32 v60, 3, v0
  v_lshl_add_u32 v6, v60, 3, v62
  s_mul_i32 s55, s49, 5
  s_add_u32 s55, s55, 1
  v_lshrrev_b32 v60, 4, v0
  v_bfe_u32 v61, v0, 2, 2
  v_lshl_add_u32 v62, v60, 3, v61
  v_and_b32 v60, 1, v60
  v_lshrrev_b32 v61, 1, v61
  v_lshl_add_u32 v60, v60, 1, v61
  v_xor_b32 v60, s55, v60
  v_mul_u32_u24 v62, 640, v62
  v_lshl_add_u32 v62, v60, 5, v62
  v_and_b32 v60, 3, v0
  v_lshl_add_u32 v7, v60, 3, v62
  s_mul_i32 s55, s49, 5
  s_add_u32 s55, s55, 2
  v_lshrrev_b32 v60, 4, v0
  v_bfe_u32 v61, v0, 2, 2
  v_lshl_add_u32 v62, v60, 3, v61
  v_and_b32 v60, 1, v60
  v_lshrrev_b32 v61, 1, v61
  v_lshl_add_u32 v60, v60, 1, v61
  v_xor_b32 v60, s55, v60
  v_mul_u32_u24 v62, 640, v62
  v_lshl_add_u32 v62, v60, 5, v62
  v_and_b32 v60, 3, v0
  v_lshl_add_u32 v8, v60, 3, v62
  s_mul_i32 s55, s49, 5
  s_add_u32 s55, s55, 3
  v_lshrrev_b32 v60, 4, v0
  v_bfe_u32 v61, v0, 2, 2
  v_lshl_add_u32 v62, v60, 3, v61
  v_and_b32 v60, 1, v60
  v_lshrrev_b32 v61, 1, v61
  v_lshl_add_u32 v60, v60, 1, v61
  v_xor_b32 v60, s55, v60
  v_mul_u32_u24 v62, 640, v62
  v_lshl_add_u32 v62, v60, 5, v62
  v_and_b32 v60, 3, v0
  v_lshl_add_u32 v9, v60, 3, v62
  s_mul_i32 s55, s49, 5
  s_add_u32 s55, s55, 4
  v_lshrrev_b32 v60, 4, v0
  v_bfe_u32 v61, v0, 2, 2
  v_lshl_add_u32 v62, v60, 3, v61
  v_and_b32 v60, 1, v60
  v_lshrrev_b32 v61, 1, v61
  v_lshl_add_u32 v60, v60, 1, v61
  v_xor_b32 v60, s55, v60
  v_mul_u32_u24 v62, 640, v62
  v_lshl_add_u32 v62, v60, 5, v62
  v_and_b32 v60, 3, v0
  v_lshl_add_u32 v10, v60, 3, v62
  s_getpc_b64 s[60:61]
PC_46:
  s_lshl_b32 s53, s49, 6
  v_add_u32 v100, s53, v0
  v_lshlrev_b32 v100, 7, v100
  v_min_u32 v100, V_END-V_LD-4, v100
  v_add_u32 v100, V_LD-PC_46, v100
  v_mov_b32 v101, s61
  v_add_co_u32 v100, vcc, s60, v100
  s_nop 1
  v_addc_co_u32 v101, vcc, 0, v101, vcc
  s_mul_i32 s54, s62, 786432
  s_mul_i32 s53, s49, 6144
  s_add_u32 m0, s53, 0
  s_nop 0
  buffer_load_dwordx4 v40, s[36:39], s54 offen  lds
  s_add_u32 m0, m0, 1024
  s_nop 0
  buffer_load_dwordx4 v41, s[36:39], s54 offen  lds
  s_add_u32 m0, m0, 1024
  s_nop 0
  buffer_load_dwordx4 v42, s[36:39], s54 offen  lds
  s_add_u32 m0, m0, 1024
  s_nop 0
  buffer_load_dwordx4 v43, s[36:39], s54 offen  lds
  s_add_u32 m0, m0, 1024
  s_nop 0
  buffer_load_dwordx4 v44, s[36:39], s54 offen  lds
  s_add_u32 m0, m0, 1024
  s_nop 0
  buffer_load_dwordx4 v45, s[36:39], s54 offen  lds
  s_mul_i32 s54, s63, 786432
  s_mul_i32 s53, s49, 6144
  s_add_u32 m0, s53, 24576
  s_nop 0
  buffer_load_dwordx4 v40, s[36:39], s54 offen  lds
  s_add_u32 m0, m0, 1024
  s_nop 0
  buffer_load_dwordx4 v41, s[36:39], s54 offen  lds
  s_add_u32 m0, m0, 1024
  s_nop 0
  buffer_load_dwordx4 v42, s[36:39], s54 offen  lds
  s_add_u32 m0, m0, 1024
  s_nop 0
  buffer_load_dwordx4 v43, s[36:39], s54 offen  lds
  s_add_u32 m0, m0, 1024
  s_nop 0
  buffer_load_dwordx4 v44, s[36:39], s54 offen  lds
  s_add_u32 m0, m0, 1024
  s_nop 0
  buffer_load_dwordx4 v45, s[36:39], s54 offen  lds
  s_mul_i32 s54, s64, 786432
  s_mul_i32 s53, s49, 6144
  s_add_u32 m0, s53, 49152
  s_nop 0
  buffer_load_dwordx4 v40, s[36:39], s54 offen  lds
  s_add_u32 m0, m0, 1024
  s_nop 0
  buffer_load_dwordx4 v41, s[36:39], s54 offen  lds
  s_add_u32 m0, m0, 1024
  s_nop 0
  buffer_load_dwordx4 v42, s[36:39], s54 offen  lds
  s_add_u32 m0, m0, 1024
  s_nop 0
  buffer_load_dwordx4 v43, s[36:39], s54 offen  lds
  s_add_u32 m0, m0, 1024
  s_nop 0
  buffer_load_dwordx4 v44, s[36:39], s54 offen  lds
  s_add_u32 m0, m0, 1024
  s_nop 0
  buffer_load_dwordx4 v45, s[36:39], s54 offen  lds
  s_mul_i32 s54, s65, 786432
  s_mul_i32 s53, s49, 6144
  s_add_u32 m0, s53, 73728
  s_nop 0
  buffer_load_dwordx4 v40, s[36:39], s54 offen  lds
  s_add_u32 m0, m0, 1024
  s_nop 0
  buffer_load_dwordx4 v41, s[36:39], s54 offen  lds
  s_add_u32 m0, m0, 1024
  s_nop 0
  buffer_load_dwordx4 v42, s[36:39], s54 offen  lds
  s_add_u32 m0, m0, 1024
  s_nop 0
  buffer_load_dwordx4 v43, s[36:39], s54 offen  lds
  s_add_u32 m0, m0, 1024
  s_nop 0
  buffer_load_dwordx4 v44, s[36:39], s54 offen  lds
  s_add_u32 m0, m0, 1024
  s_nop 0
  buffer_load_dwordx4 v45, s[36:39], s54 offen  lds
  s_add_u32 s54, s76, 0
  s_mul_i32 s53, s49, 5120
  s_add_u32 m0, s53, 98304
  s_nop 0
  buffer_load_dwordx4 v1, s[40:43], s54 offen  lds
  s_add_u32 m0, m0, 1024
  s_nop 0
  buffer_load_dwordx4 v2, s[40:43], s54 offen  lds
  s_add_u32 m0, m0, 1024
  s_nop 0
  buffer_load_dwordx4 v3, s[40:43], s54 offen  lds
  s_add_u32 m0, m0, 1024
  s_nop 0
  buffer_load_dwordx4 v4, s[40:43], s54 offen  lds
  s_add_u32 m0, m0, 1024
  s_nop 0
  buffer_load_dwordx4 v5, s[40:43], s54 offen  lds
  s_mul_i32 s54, s66, 786432
  s_mul_i32 s53, s49, 6144
  s_add_u32 m0, s53, 122880
  s_nop 0
  buffer_load_dwordx4 v40, s[36:39], s54 offen  lds
  s_add_u32 m0, m0, 1024
  s_nop 0
  buffer_load_dwordx4 v41, s[36:39], s54 offen  lds
  s_add_u32 m0, m0, 1024
  s_nop 0
  buffer_load_dwordx4 v42, s[36:39], s54 offen  lds
  s_add_u32 m0, m0, 1024
  s_nop 0
  buffer_load_dwordx4 v43, s[36:39], s54 offen  lds
  s_add_u32 m0, m0, 1024
  s_nop 0
  buffer_load_dwordx4 v44, s[36:39], s54 offen  lds
  s_add_u32 m0, m0, 1024
  s_nop 0
  buffer_load_dwordx4 v45, s[36:39], s54 offen  lds
  s_waitcnt vmcnt(29)
  s_barrier
  v_add_u32 v49, 0x0, v46
  v_add_u32 v50, 0x0, v47
  v_add_u32 v51, 0x0, v48
  ds_read_b64_tr_b16 v[104:105], v49 offset:0
  ds_read_b64_tr_b16 v[106:107], v49 offset:1536
  ds_read_b64_tr_b16 v[108:109], v49 offset:12288
  ds_read_b64_tr_b16 v[110:111], v49 offset:13824
  ds_read_b64_tr_b16 v[112:113], v50 offset:0
  ds_read_b64_tr_b16 v[114:115], v50 offset:1536
  ds_read_b64_tr_b16 v[116:117], v50 offset:12288
  ds_read_b64_tr_b16 v[118:119], v50 offset:13824
  ds_read_b64_tr_b16 v[120:121], v51 offset:0
  ds_read_b64_tr_b16 v[122:123], v51 offset:1536
  ds_read_b64_tr_b16 v[124:125], v51 offset:12288
  ds_read_b64_tr_b16 v[126:127], v51 offset:13824
  s_waitcnt lgkmcnt(0)
  s_barrier
  s_add_u32 s54, s77, 0
  s_mul_i32 s53, s49, 5120
  s_add_u32 m0, s53, 0
  s_nop 0
  buffer_load_dwordx4 v1, s[40:43], s54 offen  lds
  s_add_u32 m0, m0, 1024
  s_nop 0
  buffer_load_dwordx4 v2, s[40:43], s54 offen  lds
  s_add_u32 m0, m0, 1024
  s_nop 0
  buffer_load_dwordx4 v3, s[40:43], s54 offen  lds
  s_add_u32 m0, m0, 1024
  s_nop 0
  buffer_load_dwordx4 v4, s[40:43], s54 offen  lds
  s_add_u32 m0, m0, 1024
  s_nop 0
  buffer_load_dwordx4 v5, s[40:43], s54 offen  lds
  s_waitcnt vmcnt(28)
  s_barrier
  v_add_u32 v49, 0x6000, v46
  v_add_u32 v50, 0x6000, v47
  v_add_u32 v51, 0x6000, v48
  ds_read_b64_tr_b16 v[128:129], v49 offset:0
  ds_read_b64_tr_b16 v[130:131], v49 offset:1536
  ds_read_b64_tr_b16 v[132:133], v49 offset:12288
  ds_read_b64_tr_b16 v[134:135], v49 offset:13824
  ds_read_b64_tr_b16 v[136:137], v50 offset:0
  ds_read_b64_tr_b16 v[138:139], v50 offset:1536
  ds_read_b64_tr_b16 v[140:141], v50 offset:12288
  ds_read_b64_tr_b16 v[142:143], v50 offset:13824
  ds_read_b64_tr_b16 v[16:17], v51 offset:0
  ds_read_b64_tr_b16 v[18:19], v51 offset:1536
  ds_read_b64_tr_b16 v[20:21], v51 offset:12288
  ds_read_b64_tr_b16 v[22:23], v51 offset:13824
  s_waitcnt lgkmcnt(0)
  s_barrier
  s_mul_i32 s54, s67, 786432
  s_mul_i32 s53, s49, 6144
  s_add_u32 m0, s53, 24576
  s_nop 0
  buffer_load_dwordx4 v40, s[36:39], s54 offen  lds
  s_add_u32 m0, m0, 1024
  s_nop 0
  buffer_load_dwordx4 v41, s[36:39], s54 offen  lds
  s_add_u32 m0, m0, 1024
  s_nop 0
  buffer_load_dwordx4 v42, s[36:39], s54 offen  lds
  s_add_u32 m0, m0, 1024
  s_nop 0
  buffer_load_dwordx4 v43, s[36:39], s54 offen  lds
  s_add_u32 m0, m0, 1024
  s_nop 0
  buffer_load_dwordx4 v44, s[36:39], s54 offen  lds
  s_add_u32 m0, m0, 1024
  s_nop 0
  buffer_load_dwordx4 v45, s[36:39], s54 offen  lds
  s_waitcnt vmcnt(28)
  s_barrier
  v_add_u32 v49, 0xc000, v46
  v_add_u32 v50, 0xc000, v47
  v_add_u32 v51, 0xc000, v48
  ds_read_b64_tr_b16 v[144:145], v49 offset:0
  ds_read_b64_tr_b16 v[146:147], v49 offset:1536
  ds_read_b64_tr_b16 v[148:149], v49 offset:12288
  ds_read_b64_tr_b16 v[150:151], v49 offset:13824
  ds_read_b64_tr_b16 v[152:153], v50 offset:0
  ds_read_b64_tr_b16 v[154:155], v50 offset:1536
  ds_read_b64_tr_b16 v[156:157], v50 offset:12288
  ds_read_b64_tr_b16 v[158:159], v50 offset:13824
  ds_read_b64_tr_b16 v[24:25], v51 offset:0
  ds_read_b64_tr_b16 v[26:27], v51 offset:1536
  ds_read_b64_tr_b16 v[28:29], v51 offset:12288
  ds_read_b64_tr_b16 v[30:31], v51 offset:13824
  s_waitcnt lgkmcnt(0)
  s_barrier
  s_add_u32 s54, s76, 40960
  s_mul_i32 s53, s49, 5120
  s_add_u32 m0, s53, 49152
  s_nop 0
  buffer_load_dwordx4 v1, s[40:43], s54 offen  lds
  s_add_u32 m0, m0, 1024
  s_nop 0
  buffer_load_dwordx4 v2, s[40:43], s54 offen  lds
  s_add_u32 m0, m0, 1024
  s_nop 0
  buffer_load_dwordx4 v3, s[40:43], s54 offen  lds
  s_add_u32 m0, m0, 1024
  s_nop 0
  buffer_load_dwordx4 v4, s[40:43], s54 offen  lds
  s_add_u32 m0, m0, 1024
  s_nop 0
  buffer_load_dwordx4 v5, s[40:43], s54 offen  lds
  s_waitcnt vmcnt(27)
  s_barrier
  v_add_u32 v49, 0x12000, v46
  v_add_u32 v50, 0x12000, v47
  v_add_u32 v51, 0x12000, v48
  ds_read_b64_tr_b16 v[160:161], v49 offset:0
  ds_read_b64_tr_b16 v[162:163], v49 offset:1536
  ds_read_b64_tr_b16 v[164:165], v49 offset:12288
  ds_read_b64_tr_b16 v[166:167], v49 offset:13824
  ds_read_b64_tr_b16 v[168:169], v50 offset:0
  ds_read_b64_tr_b16 v[170:171], v50 offset:1536
  ds_read_b64_tr_b16 v[172:173], v50 offset:12288
  ds_read_b64_tr_b16 v[174:175], v50 offset:13824
  ds_read_b64_tr_b16 v[32:33], v51 offset:0
  ds_read_b64_tr_b16 v[34:35], v51 offset:1536
  ds_read_b64_tr_b16 v[36:37], v51 offset:12288
  ds_read_b64_tr_b16 v[38:39], v51 offset:13824
  s_waitcnt lgkmcnt(0)
  s_barrier
  s_mul_i32 s54, s68, 786432
  s_mul_i32 s53, s49, 6144
  s_add_u32 m0, s53, 73728
  s_nop 0
  buffer_load_dwordx4 v40, s[36:39], s54 offen  lds
  s_add_u32 m0, m0, 1024
  s_nop 0
  buffer_load_dwordx4 v41, s[36:39], s54 offen  lds
  s_add_u32 m0, m0, 1024
  s_nop 0
  buffer_load_dwordx4 v42, s[36:39], s54 offen  lds
  s_add_u32 m0, m0, 1024
  s_nop 0
  buffer_load_dwordx4 v43, s[36:39], s54 offen  lds
  s_add_u32 m0, m0, 1024
  s_nop 0
  buffer_load_dwordx4 v44, s[36:39], s54 offen  lds
  s_add_u32 m0, m0, 1024
  s_nop 0
  buffer_load_dwordx4 v45, s[36:39], s54 offen  lds
  s_waitcnt vmcnt(28)
  s_barrier
  v_add_u32 v11, 0x18000, v6
  v_add_u32 v12, 0x18000, v7
  v_add_u32 v13, 0x18000, v8
  v_add_u32 v14, 0x18000, v9
  v_add_u32 v15, 0x18000, v10
  ds_read_b64_tr_b16 a[16:17], v11 offset:0
  ds_read_b64_tr_b16 a[18:19], v11 offset:2560
  ds_read_b64_tr_b16 a[40:41], v12 offset:0
  ds_read_b64_tr_b16 a[42:43], v12 offset:2560
  ds_read_b64_tr_b16 a[64:65], v13 offset:0
  ds_read_b64_tr_b16 a[66:67], v13 offset:2560
  ds_read_b64_tr_b16 a[88:89], v14 offset:0
  ds_read_b64_tr_b16 a[90:91], v14 offset:2560
  ds_read_b64_tr_b16 a[112:113], v15 offset:0
  ds_read_b64_tr_b16 a[114:115], v15 offset:2560
  s_waitcnt lgkmcnt(0)
  s_barrier
  s_add_u32 s54, s77, 40960
  s_mul_i32 s53, s49, 5120
  s_add_u32 m0, s53, 98304
  s_nop 0
  buffer_load_dwordx4 v1, s[40:43], s54 offen  lds
  s_add_u32 m0, m0, 1024
  s_nop 0
  buffer_load_dwordx4 v2, s[40:43], s54 offen  lds
  s_add_u32 m0, m0, 1024
  s_nop 0
  buffer_load_dwordx4 v3, s[40:43], s54 offen  lds
  s_add_u32 m0, m0, 1024
  s_nop 0
  buffer_load_dwordx4 v4, s[40:43], s54 offen  lds
  s_add_u32 m0, m0, 1024
  s_nop 0
  buffer_load_dwordx4 v5, s[40:43], s54 offen  lds
  s_waitcnt vmcnt(27)
  s_barrier
  v_add_u32 v49, 0x1e000, v46
  v_add_u32 v50, 0x1e000, v47
  v_add_u32 v51, 0x1e000, v48
  ds_read_b64_tr_b16 v[176:177], v49 offset:0
  ds_read_b64_tr_b16 v[178:179], v49 offset:1536
  ds_read_b64_tr_b16 v[180:181], v49 offset:12288
  ds_read_b64_tr_b16 v[182:183], v49 offset:13824
  ds_read_b64_tr_b16 v[184:185], v50 offset:0
  ds_read_b64_tr_b16 v[186:187], v50 offset:1536
  ds_read_b64_tr_b16 v[188:189], v50 offset:12288
  ds_read_b64_tr_b16 v[190:191], v50 offset:13824
  ds_read_b64_tr_b16 v[52:53], v51 offset:0
  ds_read_b64_tr_b16 v[54:55], v51 offset:1536
  ds_read_b64_tr_b16 v[56:57], v51 offset:12288
  ds_read_b64_tr_b16 v[58:59], v51 offset:13824
  s_waitcnt lgkmcnt(0)
  s_barrier
  s_mul_i32 s54, s69, 786432
  s_mul_i32 s53, s49, 6144
  s_add_u32 m0, s53, 122880
  s_nop 0
  buffer_load_dwordx4 v40, s[36:39], s54 offen  lds
  s_add_u32 m0, m0, 1024
  s_nop 0
  buffer_load_dwordx4 v41, s[36:39], s54 offen  lds
  s_add_u32 m0, m0, 1024
  s_nop 0
  buffer_load_dwordx4 v42, s[36:39], s54 offen  lds
  s_add_u32 m0, m0, 1024
  s_nop 0
  buffer_load_dwordx4 v43, s[36:39], s54 offen  lds
  s_add_u32 m0, m0, 1024
  s_nop 0
  buffer_load_dwordx4 v44, s[36:39], s54 offen  lds
  s_add_u32 m0, m0, 1024
  s_nop 0
  buffer_load_dwordx4 v45, s[36:39], s54 offen  lds
  s_waitcnt vmcnt(28)
  s_barrier
  v_add_u32 v11, 0x0, v6
  v_add_u32 v12, 0x0, v7
  v_add_u32 v13, 0x0, v8
  v_add_u32 v14, 0x0, v9
  v_add_u32 v15, 0x0, v10
  ds_read_b64_tr_b16 a[136:137], v11 offset:0
  ds_read_b64_tr_b16 a[138:139], v11 offset:2560
  ds_read_b64_tr_b16 a[160:161], v12 offset:0
  ds_read_b64_tr_b16 a[162:163], v12 offset:2560
  ds_read_b64_tr_b16 a[184:185], v13 offset:0
  ds_read_b64_tr_b16 a[186:187], v13 offset:2560
  ds_read_b64_tr_b16 a[208:209], v14 offset:0
  ds_read_b64_tr_b16 a[210:211], v14 offset:2560
  ds_read_b64_tr_b16 a[232:233], v15 offset:0
  ds_read_b64_tr_b16 a[234:235], v15 offset:2560
  s_waitcnt lgkmcnt(0)
  s_barrier
  s_add_u32 s54, s76, 81920
  s_mul_i32 s53, s49, 5120
  s_add_u32 m0, s53, 0
  s_nop 0
  buffer_load_dwordx4 v1, s[40:43], s54 offen  lds
  s_add_u32 m0, m0, 1024
  s_nop 0
  buffer_load_dwordx4 v2, s[40:43], s54 offen  lds
  s_add_u32 m0, m0, 1024
  s_nop 0
  buffer_load_dwordx4 v3, s[40:43], s54 offen  lds
  s_add_u32 m0, m0, 1024
  s_nop 0
  buffer_load_dwordx4 v4, s[40:43], s54 offen  lds
  s_add_u32 m0, m0, 1024
  s_nop 0
  buffer_load_dwordx4 v5, s[40:43], s54 offen  lds
  s_waitcnt vmcnt(27)
  s_barrier
  v_add_u32 v49, 0x6000, v46
  v_add_u32 v50, 0x6000, v47
  v_add_u32 v51, 0x6000, v48
  ds_read_b64_tr_b16 v[192:193], v49 offset:0
  ds_read_b64_tr_b16 v[194:195], v49 offset:1536
  ds_read_b64_tr_b16 v[196:197], v49 offset:12288
  ds_read_b64_tr_b16 v[198:199], v49 offset:13824
  ds_read_b64_tr_b16 v[200:201], v50 offset:0
  ds_read_b64_tr_b16 v[202:203], v50 offset:1536
  ds_read_b64_tr_b16 v[204:205], v50 offset:12288
  ds_read_b64_tr_b16 v[206:207], v50 offset:13824
  ds_read_b64_tr_b16 v[60:61], v51 offset:0
  ds_read_b64_tr_b16 v[62:63], v51 offset:1536
  ds_read_b64_tr_b16 v[64:65], v51 offset:12288
  ds_read_b64_tr_b16 v[66:67], v51 offset:13824
  s_waitcnt lgkmcnt(0)
  s_barrier
  s_mul_i32 s54, s70, 786432
  s_mul_i32 s53, s49, 6144
  s_add_u32 m0, s53, 24576
  s_nop 0
  buffer_load_dwordx4 v40, s[36:39], s54 offen  lds
  s_add_u32 m0, m0, 1024
  s_nop 0
  buffer_load_dwordx4 v41, s[36:39], s54 offen  lds
  s_add_u32 m0, m0, 1024
  s_nop 0
  buffer_load_dwordx4 v42, s[36:39], s54 offen  lds
  s_add_u32 m0, m0, 1024
  s_nop 0
  buffer_load_dwordx4 v43, s[36:39], s54 offen  lds
  s_add_u32 m0, m0, 1024
  s_nop 0
  buffer_load_dwordx4 v44, s[36:39], s54 offen  lds
  s_add_u32 m0, m0, 1024
  s_nop 0
  buffer_load_dwordx4 v45, s[36:39], s54 offen  lds
  s_waitcnt vmcnt(28)
  s_barrier
  v_add_u32 v11, 0xc000, v6
  v_add_u32 v12, 0xc000, v7
  v_add_u32 v13, 0xc000, v8
  v_add_u32 v14, 0xc000, v9
  v_add_u32 v15, 0xc000, v10
  ds_read_b64_tr_b16 a[20:21], v11 offset:0
  ds_read_b64_tr_b16 a[22:23], v11 offset:2560
  ds_read_b64_tr_b16 a[44:45], v12 offset:0
  ds_read_b64_tr_b16 a[46:47], v12 offset:2560
  ds_read_b64_tr_b16 a[68:69], v13 offset:0
  ds_read_b64_tr_b16 a[70:71], v13 offset:2560
  ds_read_b64_tr_b16 a[92:93], v14 offset:0
  ds_read_b64_tr_b16 a[94:95], v14 offset:2560
  ds_read_b64_tr_b16 a[116:117], v15 offset:0
  ds_read_b64_tr_b16 a[118:119], v15 offset:2560
  s_waitcnt lgkmcnt(0)
  s_barrier
  s_add_u32 s54, s77, 81920
  s_mul_i32 s53, s49, 5120
  s_add_u32 m0, s53, 49152
  s_nop 0
  buffer_load_dwordx4 v1, s[40:43], s54 offen  lds
  s_add_u32 m0, m0, 1024
  s_nop 0
  buffer_load_dwordx4 v2, s[40:43], s54 offen  lds
  s_add_u32 m0, m0, 1024
  s_nop 0
  buffer_load_dwordx4 v3, s[40:43], s54 offen  lds
  s_add_u32 m0, m0, 1024
  s_nop 0
  buffer_load_dwordx4 v4, s[40:43], s54 offen  lds
  s_add_u32 m0, m0, 1024
  s_nop 0
  buffer_load_dwordx4 v5, s[40:43], s54 offen  lds
  s_waitcnt vmcnt(27)
  s_barrier
  v_add_u32 v49, 0x12000, v46
  v_add_u32 v50, 0x12000, v47
  v_add_u32 v51, 0x12000, v48
  ds_read_b64_tr_b16 v[208:209], v49 offset:0
  ds_read_b64_tr_b16 v[210:211], v49 offset:1536
  ds_read_b64_tr_b16 v[212:213], v49 offset:12288
  ds_read_b64_tr_b16 v[214:215], v49 offset:13824
  ds_read_b64_tr_b16 v[216:217], v50 offset:0
  ds_read_b64_tr_b16 v[218:219], v50 offset:1536
  ds_read_b64_tr_b16 v[220:221], v50 offset:12288
  ds_read_b64_tr_b16 v[222:223], v50 offset:13824
  ds_read_b64_tr_b16 v[68:69], v51 offset:0
  ds_read_b64_tr_b16 v[70:71], v51 offset:1536
  ds_read_b64_tr_b16 v[72:73], v51 offset:12288
  ds_read_b64_tr_b16 v[74:75], v51 offset:13824
  s_waitcnt lgkmcnt(0)
  s_barrier
  s_mul_i32 s54, s71, 786432
  s_mul_i32 s53, s49, 6144
  s_add_u32 m0, s53, 73728
  s_nop 0
  buffer_load_dwordx4 v40, s[36:39], s54 offen  lds
  s_add_u32 m0, m0, 1024
  s_nop 0
  buffer_load_dwordx4 v41, s[36:39], s54 offen  lds
  s_add_u32 m0, m0, 1024
  s_nop 0
  buffer_load_dwordx4 v42, s[36:39], s54 offen  lds
  s_add_u32 m0, m0, 1024
  s_nop 0
  buffer_load_dwordx4 v43, s[36:39], s54 offen  lds
  s_add_u32 m0, m0, 1024
  s_nop 0
  buffer_load_dwordx4 v44, s[36:39], s54 offen  lds
  s_add_u32 m0, m0, 1024
  s_nop 0
  buffer_load_dwordx4 v45, s[36:39], s54 offen  lds
  s_waitcnt vmcnt(28)
  s_barrier
  v_add_u32 v11, 0x18000, v6
  v_add_u32 v12, 0x18000, v7
  v_add_u32 v13, 0x18000, v8
  v_add_u32 v14, 0x18000, v9
  v_add_u32 v15, 0x18000, v10
  ds_read_b64_tr_b16 a[140:141], v11 offset:0
  ds_read_b64_tr_b16 a[142:143], v11 offset:2560
  ds_read_b64_tr_b16 a[164:165], v12 offset:0
  ds_read_b64_tr_b16 a[166:167], v12 offset:2560
  ds_read_b64_tr_b16 a[188:189], v13 offset:0
  ds_read_b64_tr_b16 a[190:191], v13 offset:2560
  ds_read_b64_tr_b16 a[212:213], v14 offset:0
  ds_read_b64_tr_b16 a[214:215], v14 offset:2560
  ds_read_b64_tr_b16 a[236:237], v15 offset:0
  ds_read_b64_tr_b16 a[238:239], v15 offset:2560
  s_waitcnt lgkmcnt(0)
  s_barrier
  s_add_u32 s54, s76, 122880
  s_mul_i32 s53, s49, 5120
  s_add_u32 m0, s53, 98304
  s_nop 0
  buffer_load_dwordx4 v1, s[40:43], s54 offen  lds
  s_add_u32 m0, m0, 1024
  s_nop 0
  buffer_load_dwordx4 v2, s[40:43], s54 offen  lds
  s_add_u32 m0, m0, 1024
  s_nop 0
  buffer_load_dwordx4 v3, s[40:43], s54 offen  lds
  s_add_u32 m0, m0, 1024
  s_nop 0
  buffer_load_dwordx4 v4, s[40:43], s54 offen  lds
  s_add_u32 m0, m0, 1024
  s_nop 0
  buffer_load_dwordx4 v5, s[40:43], s54 offen  lds
  s_waitcnt vmcnt(27)
  s_barrier
  v_add_u32 v49, 0x1e000, v46
  v_add_u32 v50, 0x1e000, v47
  v_add_u32 v51, 0x1e000, v48
  ds_read_b64_tr_b16 v[224:225], v49 offset:0
  ds_read_b64_tr_b16 v[226:227], v49 offset:1536
  ds_read_b64_tr_b16 v[228:229], v49 offset:12288
  ds_read_b64_tr_b16 v[230:231], v49 offset:13824
  ds_read_b64_tr_b16 v[232:233], v50 offset:0
  ds_read_b64_tr_b16 v[234:235], v50 offset:1536
  ds_read_b64_tr_b16 v[236:237], v50 offset:12288
  ds_read_b64_tr_b16 v[238:239], v50 offset:13824
  ds_read_b64_tr_b16 v[76:77], v51 offset:0
  ds_read_b64_tr_b16 v[78:79], v51 offset:1536
  ds_read_b64_tr_b16 v[80:81], v51 offset:12288
  ds_read_b64_tr_b16 v[82:83], v51 offset:13824
  s_waitcnt lgkmcnt(0)
  s_barrier
  s_add_u32 s54, s77, 122880
  s_mul_i32 s53, s49, 5120
  s_add_u32 m0, s53, 122880
  s_nop 0
  buffer_load_dwordx4 v1, s[40:43], s54 offen  lds
  s_add_u32 m0, m0, 1024
  s_nop 0
  buffer_load_dwordx4 v2, s[40:43], s54 offen  lds
  s_add_u32 m0, m0, 1024
  s_nop 0
  buffer_load_dwordx4 v3, s[40:43], s54 offen  lds
  s_add_u32 m0, m0, 1024
  s_nop 0
  buffer_load_dwordx4 v4, s[40:43], s54 offen  lds
  s_add_u32 m0, m0, 1024
  s_nop 0
  buffer_load_dwordx4 v5, s[40:43], s54 offen  lds
  s_waitcnt vmcnt(27)
  s_barrier
  v_add_u32 v11, 0x0, v6
  v_add_u32 v12, 0x0, v7
  v_add_u32 v13, 0x0, v8
  v_add_u32 v14, 0x0, v9
  v_add_u32 v15, 0x0, v10
  ds_read_b64_tr_b16 a[24:25], v11 offset:0
  ds_read_b64_tr_b16 a[26:27], v11 offset:2560
  ds_read_b64_tr_b16 a[48:49], v12 offset:0
  ds_read_b64_tr_b16 a[50:51], v12 offset:2560
  ds_read_b64_tr_b16 a[72:73], v13 offset:0
  ds_read_b64_tr_b16 a[74:75], v13 offset:2560
  ds_read_b64_tr_b16 a[96:97], v14 offset:0
  ds_read_b64_tr_b16 a[98:99], v14 offset:2560
  ds_read_b64_tr_b16 a[120:121], v15 offset:0
  ds_read_b64_tr_b16 a[122:123], v15 offset:2560
  s_waitcnt lgkmcnt(0)
  s_barrier
  s_add_u32 s54, s76, 163840
  s_mul_i32 s53, s49, 5120
  s_add_u32 m0, s53, 0
  s_nop 0
  buffer_load_dwordx4 v1, s[40:43], s54 offen  lds
  s_add_u32 m0, m0, 1024
  s_nop 0
  buffer_load_dwordx4 v2, s[40:43], s54 offen  lds
  s_add_u32 m0, m0, 1024
  s_nop 0
  buffer_load_dwordx4 v3, s[40:43], s54 offen  lds
  s_add_u32 m0, m0, 1024
  s_nop 0
  buffer_load_dwordx4 v4, s[40:43], s54 offen  lds
  s_add_u32 m0, m0, 1024
  s_nop 0
  buffer_load_dwordx4 v5, s[40:43], s54 offen  lds
  s_waitcnt vmcnt(26)
  s_barrier
  v_add_u32 v49, 0x6000, v46
  v_add_u32 v50, 0x6000, v47
  v_add_u32 v51, 0x6000, v48
  ds_read_b64_tr_b16 v[240:241], v49 offset:0
  ds_read_b64_tr_b16 v[242:243], v49 offset:1536
  ds_read_b64_tr_b16 v[244:245], v49 offset:12288
  ds_read_b64_tr_b16 v[246:247], v49 offset:13824
  ds_read_b64_tr_b16 v[248:249], v50 offset:0
  ds_read_b64_tr_b16 v[250:251], v50 offset:1536
  ds_read_b64_tr_b16 v[252:253], v50 offset:12288
  ds_read_b64_tr_b16 v[254:255], v50 offset:13824
  ds_read_b64_tr_b16 v[84:85], v51 offset:0
  ds_read_b64_tr_b16 v[86:87], v51 offset:1536
  ds_read_b64_tr_b16 v[88:89], v51 offset:12288
  ds_read_b64_tr_b16 v[90:91], v51 offset:13824
  s_waitcnt lgkmcnt(0)
  s_barrier
  s_add_u32 s54, s77, 163840
  s_mul_i32 s53, s49, 5120
  s_add_u32 m0, s53, 24576
  s_nop 0
  buffer_load_dwordx4 v1, s[40:43], s54 offen  lds
  s_add_u32 m0, m0, 1024
  s_nop 0
  buffer_load_dwordx4 v2, s[40:43], s54 offen  lds
  s_add_u32 m0, m0, 1024
  s_nop 0
  buffer_load_dwordx4 v3, s[40:43], s54 offen  lds
  s_add_u32 m0, m0, 1024
  s_nop 0
  buffer_load_dwordx4 v4, s[40:43], s54 offen  lds
  s_add_u32 m0, m0, 1024
  s_nop 0
  buffer_load_dwordx4 v5, s[40:43], s54 offen  lds
  s_waitcnt vmcnt(26)
  s_barrier
  v_add_u32 v11, 0xc000, v6
  v_add_u32 v12, 0xc000, v7
  v_add_u32 v13, 0xc000, v8
  v_add_u32 v14, 0xc000, v9
  v_add_u32 v15, 0xc000, v10
  ds_read_b64_tr_b16 a[144:145], v11 offset:0
  ds_read_b64_tr_b16 a[146:147], v11 offset:2560
  ds_read_b64_tr_b16 a[168:169], v12 offset:0
  ds_read_b64_tr_b16 a[170:171], v12 offset:2560
  ds_read_b64_tr_b16 a[192:193], v13 offset:0
  ds_read_b64_tr_b16 a[194:195], v13 offset:2560
  ds_read_b64_tr_b16 a[216:217], v14 offset:0
  ds_read_b64_tr_b16 a[218:219], v14 offset:2560
  ds_read_b64_tr_b16 a[240:241], v15 offset:0
  ds_read_b64_tr_b16 a[242:243], v15 offset:2560
  s_waitcnt lgkmcnt(0)
  s_barrier
  s_add_u32 s54, s76, 204800
  s_mul_i32 s53, s49, 5120
  s_add_u32 m0, s53, 49152
  s_nop 0
  buffer_load_dwordx4 v1, s[40:43], s54 offen  lds
  s_add_u32 m0, m0, 1024
  s_nop 0
  buffer_load_dwordx4 v2, s[40:43], s54 offen  lds
  s_add_u32 m0, m0, 1024
  s_nop 0
  buffer_load_dwordx4 v3, s[40:43], s54 offen  lds
  s_add_u32 m0, m0, 1024
  s_nop 0
  buffer_load_dwordx4 v4, s[40:43], s54 offen  lds
  s_add_u32 m0, m0, 1024
  s_nop 0
  buffer_load_dwordx4 v5, s[40:43], s54 offen  lds
  s_waitcnt vmcnt(25)
  s_barrier
  v_add_u32 v49, 0x12000, v46
  v_add_u32 v50, 0x12000, v47
  v_add_u32 v51, 0x12000, v48
  ds_read_b64_tr_b16 a[0:1], v49 offset:0
  ds_read_b64_tr_b16 a[2:3], v49 offset:1536
  ds_read_b64_tr_b16 a[4:5], v49 offset:12288
  ds_read_b64_tr_b16 a[6:7], v49 offset:13824
  ds_read_b64_tr_b16 a[8:9], v50 offset:0
  ds_read_b64_tr_b16 a[10:11], v50 offset:1536
  ds_read_b64_tr_b16 a[12:13], v50 offset:12288
  ds_read_b64_tr_b16 a[14:15], v50 offset:13824
  ds_read_b64_tr_b16 v[92:93], v51 offset:0
  ds_read_b64_tr_b16 v[94:95], v51 offset:1536
  ds_read_b64_tr_b16 v[96:97], v51 offset:12288
  ds_read_b64_tr_b16 v[98:99], v51 offset:13824
  s_waitcnt lgkmcnt(0)
  s_barrier
  s_add_u32 s54, s77, 204800
  s_mul_i32 s53, s49, 5120
  s_add_u32 m0, s53, 73728
  s_nop 0
  buffer_load_dwordx4 v1, s[40:43], s54 offen  lds
  s_add_u32 m0, m0, 1024
  s_nop 0
  buffer_load_dwordx4 v2, s[40:43], s54 offen  lds
  s_add_u32 m0, m0, 1024
  s_nop 0
  buffer_load_dwordx4 v3, s[40:43], s54 offen  lds
  s_add_u32 m0, m0, 1024
  s_nop 0
  buffer_load_dwordx4 v4, s[40:43], s54 offen  lds
  s_add_u32 m0, m0, 1024
  s_nop 0
  buffer_load_dwordx4 v5, s[40:43], s54 offen  lds
  global_load_dword v102, v[100:101], off
  s_waitcnt vmcnt(26)
  s_barrier
  v_add_u32 v11, 0x18000, v6
  v_add_u32 v12, 0x18000, v7
  v_add_u32 v13, 0x18000, v8
  v_add_u32 v14, 0x18000, v9
  v_add_u32 v15, 0x18000, v10
  ds_read_b64_tr_b16 a[28:29], v11 offset:0
  ds_read_b64_tr_b16 a[30:31], v11 offset:2560
  ds_read_b64_tr_b16 a[52:53], v12 offset:0
  ds_read_b64_tr_b16 a[54:55], v12 offset:2560
  ds_read_b64_tr_b16 a[76:77], v13 offset:0
  ds_read_b64_tr_b16 a[78:79], v13 offset:2560
  ds_read_b64_tr_b16 a[100:101], v14 offset:0
  ds_read_b64_tr_b16 a[102:103], v14 offset:2560
  ds_read_b64_tr_b16 a[124:125], v15 offset:0
  ds_read_b64_tr_b16 a[126:127], v15 offset:2560
  s_waitcnt lgkmcnt(0)
  s_waitcnt vmcnt(21)
  s_barrier
  v_add_u32 v11, 0x1e000, v6
  v_add_u32 v12, 0x1e000, v7
  v_add_u32 v13, 0x1e000, v8
  v_add_u32 v14, 0x1e000, v9
  v_add_u32 v15, 0x1e000, v10
  ds_read_b64_tr_b16 a[148:149], v11 offset:0
  ds_read_b64_tr_b16 a[150:151], v11 offset:2560
  ds_read_b64_tr_b16 a[172:173], v12 offset:0
  ds_read_b64_tr_b16 a[174:175], v12 offset:2560
  ds_read_b64_tr_b16 a[196:197], v13 offset:0
  ds_read_b64_tr_b16 a[198:199], v13 offset:2560
  ds_read_b64_tr_b16 a[220:221], v14 offset:0
  ds_read_b64_tr_b16 a[222:223], v14 offset:2560
  ds_read_b64_tr_b16 a[244:245], v15 offset:0
  ds_read_b64_tr_b16 a[246:247], v15 offset:2560
  s_waitcnt lgkmcnt(0)
  s_waitcnt vmcnt(16)
  s_barrier
  v_add_u32 v11, 0x0, v6
  v_add_u32 v12, 0x0, v7
  v_add_u32 v13, 0x0, v8
  v_add_u32 v14, 0x0, v9
  v_add_u32 v15, 0x0, v10
  ds_read_b64_tr_b16 a[32:33], v11 offset:0
  ds_read_b64_tr_b16 a[34:35], v11 offset:2560
  ds_read_b64_tr_b16 a[56:57], v12 offset:0
  ds_read_b64_tr_b16 a[58:59], v12 offset:2560
  ds_read_b64_tr_b16 a[80:81], v13 offset:0
  ds_read_b64_tr_b16 a[82:83], v13 offset:2560
  ds_read_b64_tr_b16 a[104:105], v14 offset:0
  ds_read_b64_tr_b16 a[106:107], v14 offset:2560
  ds_read_b64_tr_b16 a[128:129], v15 offset:0
  ds_read_b64_tr_b16 a[130:131], v15 offset:2560
  s_waitcnt lgkmcnt(0)
  s_waitcnt vmcnt(11)
  s_barrier
  v_add_u32 v11, 0x6000, v6
  v_add_u32 v12, 0x6000, v7
  v_add_u32 v13, 0x6000, v8
  v_add_u32 v14, 0x6000, v9
  v_add_u32 v15, 0x6000, v10
  ds_read_b64_tr_b16 a[152:153], v11 offset:0
  ds_read_b64_tr_b16 a[154:155], v11 offset:2560
  ds_read_b64_tr_b16 a[176:177], v12 offset:0
  ds_read_b64_tr_b16 a[178:179], v12 offset:2560
  ds_read_b64_tr_b16 a[200:201], v13 offset:0
  ds_read_b64_tr_b16 a[202:203], v13 offset:2560
  ds_read_b64_tr_b16 a[224:225], v14 offset:0
  ds_read_b64_tr_b16 a[226:227], v14 offset:2560
  ds_read_b64_tr_b16 a[248:249], v15 offset:0
  ds_read_b64_tr_b16 a[250:251], v15 offset:2560
  s_waitcnt lgkmcnt(0)
  s_waitcnt vmcnt(6)
  s_barrier
  v_add_u32 v11, 0xc000, v6
  v_add_u32 v12, 0xc000, v7
  v_add_u32 v13, 0xc000, v8
  v_add_u32 v14, 0xc000, v9
  v_add_u32 v15, 0xc000, v10
  ds_read_b64_tr_b16 a[36:37], v11 offset:0
  ds_read_b64_tr_b16 a[38:39], v11 offset:2560
  ds_read_b64_tr_b16 a[60:61], v12 offset:0
  ds_read_b64_tr_b16 a[62:63], v12 offset:2560
  ds_read_b64_tr_b16 a[84:85], v13 offset:0
  ds_read_b64_tr_b16 a[86:87], v13 offset:2560
  ds_read_b64_tr_b16 a[108:109], v14 offset:0
  ds_read_b64_tr_b16 a[110:111], v14 offset:2560
  ds_read_b64_tr_b16 a[132:133], v15 offset:0
  ds_read_b64_tr_b16 a[134:135], v15 offset:2560
  s_waitcnt lgkmcnt(0)
  s_waitcnt vmcnt(1)
  s_barrier
  v_add_u32 v11, 0x12000, v6
  v_add_u32 v12, 0x12000, v7
  v_add_u32 v13, 0x12000, v8
  v_add_u32 v14, 0x12000, v9
  v_add_u32 v15, 0x12000, v10
  ds_read_b64_tr_b16 a[156:157], v11 offset:0
  ds_read_b64_tr_b16 a[158:159], v11 offset:2560
  ds_read_b64_tr_b16 a[180:181], v12 offset:0
  ds_read_b64_tr_b16 a[182:183], v12 offset:2560
  ds_read_b64_tr_b16 a[204:205], v13 offset:0
  ds_read_b64_tr_b16 a[206:207], v13 offset:2560
  ds_read_b64_tr_b16 a[228:229], v14 offset:0
  ds_read_b64_tr_b16 a[230:231], v14 offset:2560
  ds_read_b64_tr_b16 a[252:253], v15 offset:0
  ds_read_b64_tr_b16 a[254:255], v15 offset:2560
  s_waitcnt lgkmcnt(0)
  s_barrier
V_LD:
  v_lshlrev_b32 v11, 4, v0
  s_mul_i32 s53, s49, 18432
  v_add_u32 v3, s53, v11
  ds_write_b128 v3, v[16:19] offset:0
  ds_write_b128 v3, v[20:23] offset:1024
  ds_write_b128 v3, v[24:27] offset:2048
  ds_write_b128 v3, v[28:31] offset:3072
  ds_write_b128 v3, v[32:35] offset:4096
  ds_write_b128 v3, v[36:39] offset:5120
  ds_write_b128 v3, v[52:55] offset:6144
  ds_write_b128 v3, v[56:59] offset:7168
  ds_write_b128 v3, v[60:63] offset:8192
  ds_write_b128 v3, v[64:67] offset:9216
  ds_write_b128 v3, v[68:71] offset:10240
  ds_write_b128 v3, v[72:75] offset:11264
  ds_write_b128 v3, v[76:79] offset:12288
  ds_write_b128 v3, v[80:83] offset:13312
  ds_write_b128 v3, v[84:87] offset:14336
  ds_write_b128 v3, v[88:91] offset:15360
  ds_write_b128 v3, v[92:95] offset:16384
  ds_write_b128 v3, v[96:99] offset:17408
  s_waitcnt lgkmcnt(0)
  s_lshr_b32 s53, s62, 3
  s_lshl_b32 s53, s53, 13
  s_lshl_b32 s62, s62, 10
  s_add_u32 s62, s62, s53
  s_and_b32 s53, s2, 0
  s_lshl_b32 s53, s53, 15
  s_add_u32 s62, s62, s53
  s_lshr_b32 s53, s63, 3
  s_lshl_b32 s53, s53, 13
  s_lshl_b32 s63, s63, 10
  s_add_u32 s63, s63, s53
  s_and_b32 s53, s2, 0
  s_lshl_b32 s53, s53, 15
  s_add_u32 s63, s63, s53
  s_lshr_b32 s53, s64, 3
  s_lshl_b32 s53, s53, 13
  s_lshl_b32 s64, s64, 10
  s_add_u32 s64, s64, s53
  s_and_b32 s53, s2, 0
  s_lshl_b32 s53, s53, 15
  s_add_u32 s64, s64, s53
  s_lshr_b32 s53, s65, 3
  s_lshl_b32 s53, s53, 13
  s_lshl_b32 s65, s65, 10
  s_add_u32 s65, s65, s53
  s_and_b32 s53, s2, 0
  s_lshl_b32 s53, s53, 15
  s_add_u32 s65, s65, s53
  s_lshr_b32 s53, s66, 3
  s_lshl_b32 s53, s53, 13
  s_lshl_b32 s66, s66, 10
  s_add_u32 s66, s66, s53
  s_and_b32 s53, s2, 0
  s_lshl_b32 s53, s53, 15
  s_add_u32 s66, s66, s53
  s_lshr_b32 s53, s67, 3
  s_lshl_b32 s53, s53, 13
  s_lshl_b32 s67, s67, 10
  s_add_u32 s67, s67, s53
  s_and_b32 s53, s2, 0
  s_lshl_b32 s53, s53, 15
  s_add_u32 s67, s67, s53
  s_lshr_b32 s53, s68, 3
  s_lshl_b32 s53, s53, 13
  s_lshl_b32 s68, s68, 10
  s_add_u32 s68, s68, s53
  s_and_b32 s53, s2, 0
  s_lshl_b32 s53, s53, 15
  s_add_u32 s68, s68, s53
  s_lshr_b32 s53, s69, 3
  s_lshl_b32 s53, s53, 13
  s_lshl_b32 s69, s69, 10
  s_add_u32 s69, s69, s53
  s_and_b32 s53, s2, 0
  s_lshl_b32 s53, s53, 15
  s_add_u32 s69, s69, s53
  s_lshr_b32 s53, s70, 3
  s_lshl_b32 s53, s53, 13
  s_lshl_b32 s70, s70, 10
  s_add_u32 s70, s70, s53
  s_and_b32 s53, s2, 0
  s_lshl_b32 s53, s53, 15
  s_add_u32 s70, s70, s53
  s_lshr_b32 s53, s71, 3
  s_lshl_b32 s53, s53, 13
  s_lshl_b32 s71, s71, 10
  s_add_u32 s71, s71, s53
  s_and_b32 s53, s2, 0
  s_lshl_b32 s53, s53, 15
  s_add_u32 s71, s71, s53
  v_min_u32 v96, 47, v0
  v_max_u32 v96, 31, v96
  v_lshlrev_b32 v96, 2, v96
  s_mov_b32 s57, 0
WI_47:
  global_load_dword v97, v96, s[28:29] sc1
  s_add_u32 s57, s57, 1
  s_cmp_gt_u32 s57, 0x20000
  s_cbranch_scc1 L_EXIT
  s_waitcnt vmcnt(0)
  s_and_b32 s53, s24, 7
  s_add_u32 s53, s53, 40
  v_readlane_b32 s53, v97, s53
  s_nop 1
  v_cmp_gt_u32 vcc, s53, v97
  s_bfe_u32 s53, vcc_hi, 0x80008
  s_bcnt1_i32_b32 s53, s53
  v_cmp_eq_u32 vcc, 0, v97
  s_bfe_u32 s54, vcc_hi, 0x80008
  s_cbranch_scc1 WI_49
  s_cmp_lg_u32 s53, s25
  s_cbranch_scc1 L_REDO
WI_49:
  s_cbranch_vccz WI_48
  s_sleep 8
  s_branch WI_47
WI_48:
  v_readfirstlane_b32 s53, v97
  s_and_b32 s53, s53, 1
  s_lshl_b32 s50, s53, 13
  s_xor_b32 s51, s50, 0x2000
  s_add_u32 s54, s50, 16384
  v_lshl_add_u32 v96, v0, 7, s54
  s_mov_b32 s55, 1
  s_mov_b32 exec_hi, 0xff
  s_mov_b32 s57, 0
PL_50:
  buffer_load_dword v97, v96, s[32:35], 0 offen sc1
  s_waitcnt vmcnt(0)
  v_cmp_gt_u32 vcc, s55, v97
  s_cbranch_vccz PR_51
  s_add_u32 s57, s57, 1
  s_cmp_lt_u32 s57, 0x80000
  s_cbranch_scc1 PL_50
  s_branch L_EXIT
PR_51:
  s_mov_b64 exec, -1
  v_and_b32 v96, 2, v0
  v_cmp_eq_u32 vcc, 0, v96
  v_mov_b32 v1, 0xeeee
  v_mov_b32 v96, 0x4444
  v_cndmask_b32 v1, v1, v96, vcc
  v_mov_b32 v4, 0x40000000
  v_bfe_u32 v40, v0, 3, 1
  v_lshlrev_b32 v40, 9, v40
  v_bfe_u32 v41, v0, 2, 1
  v_lshl_add_u32 v40, v41, 6, v40
  v_and_b32 v41, 1, v0
  v_lshl_add_u32 v40, v41, 5, v40
  v_lshrrev_b32 v41, 4, v0
  v_lshl_add_u32 v40, v41, 3, v40
  v_bfe_u32 v41, v0, 1, 1
  v_lshl_add_u32 v40, v41, 2, v40
  s_lshl_b32 s54, s49, 7
  s_add_u32 s54, s54, 73728
  v_add_u32 v5, s54, v40
  v_lshlrev_b32 v40, 3, v0
  v_add_u32 v6, 73728, v40
  s_lshl_b32 s54, s48, 8
  v_lshl_add_u32 v8, v0, 2, s54
  s_mul_i32 s36, s49, 81920
  s_add_u32 s36, s36, 0
  s_lshl_b32 s54, s76, 9
  s_add_u32 s36, s36, s54
  s_mul_i32 s37, s49, 81920
  s_add_u32 s37, s37, 16384
  s_lshl_b32 s54, s76, 9
  s_add_u32 s37, s37, s54
  s_mul_i32 s38, s49, 81920
  s_add_u32 s38, s38, 32768
  s_lshl_b32 s54, s76, 9
  s_add_u32 s38, s38, s54
  s_mul_i32 s39, s49, 81920
  s_add_u32 s39, s39, 49152
  s_lshl_b32 s54, s76, 9
  s_add_u32 s39, s39, s54
  s_mul_i32 s40, s49, 81920
  s_add_u32 s40, s40, 65536
  s_lshl_b32 s54, s76, 9
  s_add_u32 s40, s40, s54
  s_mul_i32 s41, s49, 81920
  s_add_u32 s41, s41, 0
  s_lshl_b32 s54, s77, 9
  s_add_u32 s41, s41, s54
  s_mul_i32 s42, s49, 81920
  s_add_u32 s42, s42, 16384
  s_lshl_b32 s54, s77, 9
  s_add_u32 s42, s42, s54
  s_mul_i32 s43, s49, 81920
  s_add_u32 s43, s43, 32768
  s_lshl_b32 s54, s77, 9
  s_add_u32 s43, s43, s54
  s_mul_i32 s44, s49, 81920
  s_add_u32 s44, s44, 49152
  s_lshl_b32 s54, s77, 9
  s_add_u32 s44, s44, s54
  s_mul_i32 s45, s49, 81920
  s_add_u32 s45, s45, 65536
  s_lshl_b32 s54, s77, 9
  s_add_u32 s45, s45, s54
  s_lshl_b32 s56, s48, 7
  s_add_u32 s56, s56, s50
  s_lshl_b32 s54, s49, 2
  s_add_u32 s54, s54, s56
  s_add_u32 s54, s54, 36864
  v_mov_b32 v15, 0x40000000
  s_nop 0
  v_writelane_b32 v15, s54, 0
  s_add_u32 s54, s50, 114688
  v_lshl_add_u32 v10, v0, 7, s54
  v_and_b32 v40, 4, v0
  v_lshlrev_b32 v40, 11, v40
  v_xor_b32 v10, v40, v10
  s_or_b32 s54, s48, s49
  s_cselect_b32 s54, 0, 8
  v_mov_b32 v40, 0x40000000
  v_cmp_gt_u32 vcc, s54, v0
  s_nop 1
  v_cndmask_b32 v10, v40, v10, vcc
  s_mov_b32 s72, 0x7f817f81
  s_mov_b32 s52, 0
V_STEP:
  s_add_u32 s73, s52, 1
  s_and_b32 s54, s52, 15
  s_mul_i32 s54, s54, 0x80000
  s_add_u32 s54, s54, 0xc00000
  s_lshr_b32 s53, s54, 7
  s_and_b32 s53, s53, 0x2000
  s_xor_b32 s53, s53, s50
  s_lshl_b32 s54, s54, 1
  s_or_b32 s54, s54, s53
  v_add_u32 v7, s54, v8
  s_add_u32 s54, s52, 0
  s_and_b32 s54, s54, 31
  s_mul_i32 s54, s54, 0x4000
  s_add_u32 s54, s54, 0x100000
  s_lshr_b32 s53, s54, 7
  s_and_b32 s53, s53, 0x2000
  s_xor_b32 s53, s53, s50
  s_lshl_b32 s54, s54, 1
  s_or_b32 s54, s54, s53
  v_add_u32 v2, s54, v11
  v_mov_b64 v[16:17], 0
  v_mov_b64 v[18:19], 0
  v_mov_b64 v[20:21], 0
  v_mov_b64 v[22:23], 0
  v_mov_b64 v[24:25], 0
  v_mov_b64 v[26:27], 0
  ds_read_b128 v[80:83], v3 offset:0
  ds_read_b128 v[84:87], v3 offset:1024
  ds_read_b128 v[88:91], v3 offset:2048
  ds_read_b128 v[92:95], v3 offset:3072
  s_mov_b32 s59, 0
  s_mov_b32 s57, 0
  s_mov_b32 s58, 0
  s_waitcnt lgkmcnt(0)
  v_mov_b32 v14, s52
  s_cmp_lg_u32 s49, 0
  s_cbranch_scc1 V_GO
  s_cmp_eq_u32 s52, 0
  s_cbranch_scc1 V_GO
  s_mov_b64 exec, 1
  s_mov_b32 s57, 0
  buffer_load_dword v96, v4, s[32:35], 0 offen sc1
  buffer_load_dword v97, v4, s[32:35], 0 offen sc1
  buffer_load_dword v98, v4, s[32:35], 0 offen sc1
PL_52:
  buffer_load_dword v99, v4, s[32:35], 0 offen sc1
  s_waitcnt vmcnt(3)
  v_cmp_gt_u32 vcc, s73, v96
  s_cbranch_vccz PR_53
  buffer_load_dword v96, v4, s[32:35], 0 offen sc1
  s_waitcnt vmcnt(3)
  v_cmp_gt_u32 vcc, s73, v97
  s_cbranch_vccz PR_53
  buffer_load_dword v97, v4, s[32:35], 0 offen sc1
  s_waitcnt vmcnt(3)
  v_cmp_gt_u32 vcc, s73, v98
  s_cbranch_vccz PR_53
  buffer_load_dword v98, v4, s[32:35], 0 offen sc1
  s_waitcnt vmcnt(3)
  v_cmp_gt_u32 vcc, s73, v99
  s_cbranch_vccz PR_53
  s_add_u32 s57, s57, 1
  s_cmp_lt_u32 s57, 0x80000
  s_cbranch_scc1 PL_52
  s_branch L_EXIT
PR_53:
  s_mov_b64 exec, -1
V_GO:
  s_barrier
  buffer_load_dwordx4 v[40:43], v2, s[32:35], s62 offen
  s_barrier
  buffer_load_dwordx4 v[44:47], v2, s[32:35], s63 offen
  s_barrier
  buffer_load_dwordx4 v[48:51], v2, s[32:35], s64 offen
  s_barrier
  buffer_load_dwordx4 v[52:55], v2, s[32:35], s65 offen
  s_barrier
  buffer_load_dwordx4 v[56:59], v2, s[32:35], s66 offen
  s_barrier
  buffer_load_dwordx4 v[60:63], v2, s[32:35], s67 offen
  s_barrier
  buffer_load_dwordx4 v[64:67], v2, s[32:35], s68 offen
  s_barrier
  buffer_load_dwordx4 v[68:71], v2, s[32:35], s69 offen
  s_barrier
  buffer_load_dwordx4 v[72:75], v2, s[32:35], s70 offen
  s_barrier
  buffer_load_dwordx4 v[76:79], v2, s[32:35], s71 offen
V_GEMM:
  s_waitcnt vmcnt(9)
  v_smfmac_f32_16x16x64_bf16 v[16:19], v[40:43], v[104:111], v1
  v_smfmac_f32_16x16x64_bf16 v[20:23], v[40:43], v[112:119], v1
  v_smfmac_f32_16x16x64_bf16 v[24:27], v[40:43], v[120:127], v1
  s_waitcnt vmcnt(8)
  v_smfmac_f32_16x16x64_bf16 v[16:19], v[44:47], v[128:135], v1
  v_smfmac_f32_16x16x64_bf16 v[20:23], v[44:47], v[136:143], v1
  v_smfmac_f32_16x16x64_bf16 v[24:27], v[44:47], v[80:87], v1
  ds_read_b128 v[80:83], v3 offset:4096
  ds_read_b128 v[84:87], v3 offset:5120
  s_waitcnt vmcnt(7)
  v_smfmac_f32_16x16x64_bf16 v[16:19], v[48:51], v[144:151], v1
  v_smfmac_f32_16x16x64_bf16 v[20:23], v[48:51], v[152:159], v1
  v_smfmac_f32_16x16x64_bf16 v[24:27], v[48:51], v[88:95], v1
  ds_read_b128 v[88:91], v3 offset:6144
  ds_read_b128 v[92:95], v3 offset:7168
  s_waitcnt vmcnt(6)
  v_smfmac_f32_16x16x64_bf16 v[16:19], v[52:55], v[160:167], v1
  v_max3_i32 v96, v40, v44, v48
  v_smfmac_f32_16x16x64_bf16 v[20:23], v[52:55], v[168:175], v1
  s_waitcnt lgkmcnt(2)
  v_smfmac_f32_16x16x64_bf16 v[24:27], v[52:55], v[80:87], v1
  ds_read_b128 v[80:83], v3 offset:8192
  ds_read_b128 v[84:87], v3 offset:9216
  s_waitcnt vmcnt(5)
  v_smfmac_f32_16x16x64_bf16 v[16:19], v[56:59], v[176:183], v1
  v_max3_i32 v96, v96, v52, v56
  v_smfmac_f32_16x16x64_bf16 v[20:23], v[56:59], v[184:191], v1
  s_waitcnt lgkmcnt(2)
  v_cmp_eq_u32 vcc, s72, v96
  v_smfmac_f32_16x16x64_bf16 v[24:27], v[56:59], v[88:95], v1
  ds_read_b128 v[88:91], v3 offset:10240
  ds_read_b128 v[92:95], v3 offset:11264
  s_waitcnt vmcnt(4)
  v_smfmac_f32_16x16x64_bf16 v[16:19], v[60:63], v[192:199], v1
  s_cbranch_vccnz V_RETRY
  v_smfmac_f32_16x16x64_bf16 v[20:23], v[60:63], v[200:207], v1
  s_waitcnt lgkmcnt(2)
  v_smfmac_f32_16x16x64_bf16 v[24:27], v[60:63], v[80:87], v1
  ds_read_b128 v[80:83], v3 offset:12288
  ds_read_b128 v[84:87], v3 offset:13312
  s_waitcnt vmcnt(3)
  v_smfmac_f32_16x16x64_bf16 v[16:19], v[64:67], v[208:215], v1
  v_max3_i32 v96, v96, v60, v64
  v_smfmac_f32_16x16x64_bf16 v[20:23], v[64:67], v[216:223], v1
  s_waitcnt lgkmcnt(2)
  v_smfmac_f32_16x16x64_bf16 v[24:27], v[64:67], v[88:95], v1
  ds_read_b128 v[88:91], v3 offset:14336
  ds_read_b128 v[92:95], v3 offset:15360
  s_waitcnt vmcnt(2)
  v_smfmac_f32_16x16x64_bf16 v[16:19], v[68:71], v[224:231], v1
  v_smfmac_f32_16x16x64_bf16 v[20:23], v[68:71], v[232:239], v1
  s_waitcnt lgkmcnt(2)
  v_smfmac_f32_16x16x64_bf16 v[24:27], v[68:71], v[80:87], v1
  ds_read_b128 v[80:83], v3 offset:16384
  ds_read_b128 v[84:87], v3 offset:17408
  s_waitcnt vmcnt(1)
  v_smfmac_f32_16x16x64_bf16 v[16:19], v[72:75], v[240:247], v1
  v_max3_i32 v96, v96, v68, v72
  v_smfmac_f32_16x16x64_bf16 v[20:23], v[72:75], v[248:255], v1
  s_waitcnt lgkmcnt(2)
  v_smfmac_f32_16x16x64_bf16 v[24:27], v[72:75], v[88:95], v1
  s_waitcnt vmcnt(0)
  v_smfmac_f32_16x16x64_bf16 v[16:19], v[76:79], a[0:7], v1
  v_max_i32 v96, v96, v76
  v_smfmac_f32_16x16x64_bf16 v[20:23], v[76:79], a[8:15], v1
  s_waitcnt lgkmcnt(0)
  v_cmp_eq_u32 vcc, s72, v96
  v_smfmac_f32_16x16x64_bf16 v[24:27], v[76:79], v[80:87], v1
  s_nop 1
  v_add_f32 v16, v16, v18
  v_add_f32 v17, v17, v19
  v_cvt_pk_bf16_f32 v16, v16, v17
  s_cbranch_vccnz V_RETRY
  ds_write_b32 v5, v16 offset:0
  v_add_f32 v20, v20, v22
  v_add_f32 v21, v21, v23
  v_cvt_pk_bf16_f32 v20, v20, v21
  ds_write_b32 v5, v20 offset:1024
  v_add_f32 v24, v24, v26
  v_add_f32 v25, v25, v27
  v_cvt_pk_bf16_f32 v24, v24, v25
  ds_write_b32 v5, v24 offset:2048
  v_mov_b64 v[40:41], 0
  v_mov_b64 v[42:43], 0
  v_mov_b64 v[44:45], 0
  v_mov_b64 v[46:47], 0
  v_mov_b64 v[48:49], 0
  v_mov_b64 v[50:51], 0
  v_mov_b64 v[52:53], 0
  v_mov_b64 v[54:55], 0
  v_mov_b64 v[56:57], 0
  v_mov_b64 v[58:59], 0
  v_mov_b64 v[60:61], 0
  v_mfma_f32_32x32x64_f8f6f4 v[80:95], v[104:111], v[104:111], 0
  s_waitcnt lgkmcnt(0)
  s_barrier
  ds_read_b64_tr_b16 v[28:29], v6 offset:0
  ds_read_b64_tr_b16 v[30:31], v6 offset:512
  ds_read_b64_tr_b16 v[32:33], v6 offset:1024
  ds_read_b64_tr_b16 v[34:35], v6 offset:1536
  ds_read_b64_tr_b16 v[36:37], v6 offset:2048
  ds_read_b64_tr_b16 v[38:39], v6 offset:2560
  v_mov_b64 v[62:63], 0
  v_mov_b64 v[64:65], 0
  v_mov_b64 v[66:67], 0
  v_mov_b64 v[68:69], 0
  v_mov_b64 v[70:71], 0
  v_mov_b64 v[72:73], 0
  v_mov_b64 v[74:75], 0
  v_mov_b64 v[76:77], 0
  v_mov_b64 v[78:79], 0
  s_waitcnt lgkmcnt(4)
  v_smfmac_f32_16x16x64_bf16 v[40:43], v[28:31], a[16:23], v1
  s_waitcnt lgkmcnt(2)
  v_smfmac_f32_16x16x64_bf16 v[40:43], v[32:35], a[24:31], v1
  s_waitcnt lgkmcnt(0)
  v_smfmac_f32_16x16x64_bf16 v[40:43], v[36:39], a[32:39], v1
  v_add_f32 v96, v28, v32
  v_smfmac_f32_16x16x64_bf16 v[44:47], v[28:31], a[40:47], v1
  v_cmp_u_f32 vcc, v96, v36
  v_smfmac_f32_16x16x64_bf16 v[44:47], v[32:35], a[48:55], v1
  v_smfmac_f32_16x16x64_bf16 v[44:47], v[36:39], a[56:63], v1
  v_add_f32 v40, v40, v42
  v_smfmac_f32_16x16x64_bf16 v[48:51], v[28:31], a[64:71], v1
  s_cbranch_vccnz V_SLOW
V_CONT:
  v_add_f32 v41, v41, v43
  v_smfmac_f32_16x16x64_bf16 v[48:51], v[32:35], a[72:79], v1
  v_cvt_pk_bf16_f32 v40, v40, v41
  v_smfmac_f32_16x16x64_bf16 v[48:51], v[36:39], a[80:87], v1
  buffer_store_dword v40, v7, s[32:35], s36 offen sc1
  v_add_f32 v44, v44, v46
  v_smfmac_f32_16x16x64_bf16 v[52:55], v[28:31], a[88:95], v1
  v_add_f32 v45, v45, v47
  v_smfmac_f32_16x16x64_bf16 v[52:55], v[32:35], a[96:103], v1
  v_cvt_pk_bf16_f32 v44, v44, v45
  v_smfmac_f32_16x16x64_bf16 v[52:55], v[36:39], a[104:111], v1
  buffer_store_dword v44, v7, s[32:35], s37 offen sc1
  v_add_f32 v48, v48, v50
  v_smfmac_f32_16x16x64_bf16 v[56:59], v[28:31], a[112:119], v1
  v_add_f32 v49, v49, v51
  v_smfmac_f32_16x16x64_bf16 v[56:59], v[32:35], a[120:127], v1
  v_cvt_pk_bf16_f32 v48, v48, v49
  v_smfmac_f32_16x16x64_bf16 v[56:59], v[36:39], a[128:135], v1
  buffer_store_dword v48, v7, s[32:35], s38 offen sc1
  v_add_f32 v52, v52, v54
  v_smfmac_f32_16x16x64_bf16 v[60:63], v[28:31], a[136:143], v1
  v_add_f32 v53, v53, v55
  v_smfmac_f32_16x16x64_bf16 v[60:63], v[32:35], a[144:151], v1
  v_cvt_pk_bf16_f32 v52, v52, v53
  v_smfmac_f32_16x16x64_bf16 v[60:63], v[36:39], a[152:159], v1
  buffer_store_dword v52, v7, s[32:35], s39 offen sc1
  v_add_f32 v56, v56, v58
  v_smfmac_f32_16x16x64_bf16 v[64:67], v[28:31], a[160:167], v1
  v_add_f32 v57, v57, v59
  v_smfmac_f32_16x16x64_bf16 v[64:67], v[32:35], a[168:175], v1
  v_cvt_pk_bf16_f32 v56, v56, v57
  v_smfmac_f32_16x16x64_bf16 v[64:67], v[36:39], a[176:183], v1
  buffer_store_dword v56, v7, s[32:35], s40 offen sc1
  v_add_f32 v60, v60, v62
  v_smfmac_f32_16x16x64_bf16 v[68:71], v[28:31], a[184:191], v1
  v_add_f32 v61, v61, v63
  v_smfmac_f32_16x16x64_bf16 v[68:71], v[32:35], a[192:199], v1
  v_cvt_pk_bf16_f32 v60, v60, v61
  v_smfmac_f32_16x16x64_bf16 v[68:71], v[36:39], a[200:207], v1
  buffer_store_dword v60, v7, s[32:35], s41 offen sc1
  v_add_f32 v64, v64, v66
  v_smfmac_f32_16x16x64_bf16 v[72:75], v[28:31], a[208:215], v1
  v_add_f32 v65, v65, v67
  v_smfmac_f32_16x16x64_bf16 v[72:75], v[32:35], a[216:223], v1
  v_cvt_pk_bf16_f32 v64, v64, v65
  v_smfmac_f32_16x16x64_bf16 v[72:75], v[36:39], a[224:231], v1
  buffer_store_dword v64, v7, s[32:35], s42 offen sc1
  v_add_f32 v68, v68, v70
  v_smfmac_f32_16x16x64_bf16 v[76:79], v[28:31], a[232:239], v1
  v_add_f32 v69, v69, v71
  v_smfmac_f32_16x16x64_bf16 v[76:79], v[32:35], a[240:247], v1
  v_cvt_pk_bf16_f32 v68, v68, v69
  v_smfmac_f32_16x16x64_bf16 v[76:79], v[36:39], a[248:255], v1
  buffer_store_dword v68, v7, s[32:35], s43 offen sc1
  v_add_f32 v72, v72, v74
  v_add_f32 v73, v73, v75
  v_cvt_pk_bf16_f32 v72, v72, v73
  buffer_store_dword v72, v7, s[32:35], s44 offen sc1
  s_nop 2
  v_add_f32 v76, v76, v78
  v_add_f32 v77, v77, v79
  v_cvt_pk_bf16_f32 v76, v76, v77
  buffer_store_dword v76, v7, s[32:35], s45 offen sc1
  buffer_store_dword v14, v10, s[32:35], 0 offen sc1
  s_cmp_eq_u32 s52, 0
  s_cbranch_scc1 V_FIRST
V_FDONE:
  s_add_u32 s52, s52, 1
  s_cmp_lt_u32 s52, 64
  s_cbranch_scc1 V_STEP
  v_mov_b32 v14, 63
  buffer_store_dword v14, v10, s[32:35], 0 offen sc1
  s_waitcnt vmcnt(0)
  v_mov_b32 v96, s52
  buffer_store_dword v96, v15, s[32:35], 0 offen sc1
  s_branch L_EXIT
V_FIX:
FX_54:
  s_waitcnt vmcnt(0)
  v_cmp_eq_u32 s[4:5], s72, v40
  v_cmp_eq_u32 s[6:7], s72, v44
  v_cmp_eq_u32 s[8:9], s72, v48
  v_cmp_eq_u32 s[10:11], s72, v52
  v_cmp_eq_u32 s[12:13], s72, v56
  v_cmp_eq_u32 s[14:15], s72, v60
  v_cmp_eq_u32 s[16:17], s72, v64
  v_cmp_eq_u32 s[18:19], s72, v68
  v_cmp_eq_u32 s[20:21], s72, v72
  v_cmp_eq_u32 s[22:23], s72, v76
  s_add_u32 s57, s57, 1
  s_cmp_gt_u32 s57, 0x80000
  s_cbranch_scc1 L_EXIT
  s_cmp_lg_u64 s[4:5], 0
  s_cbranch_scc1 V_FIX_S0
  s_cmp_lg_u64 s[6:7], 0
  s_cbranch_scc1 V_FIX_S1
  s_cmp_lg_u64 s[8:9], 0
  s_cbranch_scc1 V_FIX_S2
  s_cmp_lg_u64 s[10:11], 0
  s_cbranch_scc1 V_FIX_S3
  s_cmp_lg_u64 s[12:13], 0
  s_cbranch_scc1 V_FIX_S4
  s_cmp_lg_u64 s[14:15], 0
  s_cbranch_scc1 V_FIX_S5
  s_cmp_lg_u64 s[16:17], 0
  s_cbranch_scc1 V_FIX_S6
  s_cmp_lg_u64 s[18:19], 0
  s_cbranch_scc1 V_FIX_S7
  s_cmp_lg_u64 s[20:21], 0
  s_cbranch_scc1 V_FIX_S8
  s_cmp_lg_u64 s[22:23], 0
  s_cbranch_scc1 V_FIX_S9
  s_setpc_b64 s[86:87]
V_FIX_S0:
  buffer_load_dwordx4 v[40:43], v2, s[32:35], s62 offen sc1
  s_add_u32 s57, s57, 1
  s_cmp_gt_u32 s57, 0x80000
  s_cbranch_scc1 L_EXIT
  s_waitcnt vmcnt(0)
  v_cmp_eq_u32 vcc, s72, v40
  s_cbranch_vccnz V_FIX_S0
  s_mov_b32 s53, 0
  s_branch V_FIX_R1
V_FIX_S1:
  buffer_load_dwordx4 v[44:47], v2, s[32:35], s63 offen sc1
  s_add_u32 s57, s57, 1
  s_cmp_gt_u32 s57, 0x80000
  s_cbranch_scc1 L_EXIT
  s_waitcnt vmcnt(0)
  v_cmp_eq_u32 vcc, s72, v44
  s_cbranch_vccnz V_FIX_S1
  s_mov_b32 s53, 0
  s_branch V_FIX_R2
V_FIX_S2:
  buffer_load_dwordx4 v[48:51], v2, s[32:35], s64 offen sc1
  s_add_u32 s57, s57, 1
  s_cmp_gt_u32 s57, 0x80000
  s_cbranch_scc1 L_EXIT
  s_waitcnt vmcnt(0)
  v_cmp_eq_u32 vcc, s72, v48
  s_cbranch_vccnz V_FIX_S2
  s_mov_b32 s53, 0
  s_branch V_FIX_R3
V_FIX_S3:
  buffer_load_dwordx4 v[52:55], v2, s[32:35], s65 offen sc1
  s_add_u32 s57, s57, 1
  s_cmp_gt_u32 s57, 0x80000
  s_cbranch_scc1 L_EXIT
  s_waitcnt vmcnt(0)
  v_cmp_eq_u32 vcc, s72, v52
  s_cbranch_vccnz V_FIX_S3
  s_mov_b32 s53, 0
  s_branch V_FIX_R4
V_FIX_S4:
  buffer_load_dwordx4 v[56:59], v2, s[32:35], s66 offen sc1
  s_add_u32 s57, s57, 1
  s_cmp_gt_u32 s57, 0x80000
  s_cbranch_scc1 L_EXIT
  s_waitcnt vmcnt(0)
  v_cmp_eq_u32 vcc, s72, v56
  s_cbranch_vccnz V_FIX_S4
  s_mov_b32 s53, 0
  s_branch V_FIX_R5
V_FIX_S5:
  buffer_load_dwordx4 v[60:63], v2, s[32:35], s67 offen sc1
  s_add_u32 s57, s57, 1
  s_cmp_gt_u32 s57, 0x80000
  s_cbranch_scc1 L_EXIT
  s_waitcnt vmcnt(0)
  v_cmp_eq_u32 vcc, s72, v60
  s_cbranch_vccnz V_FIX_S5
  s_mov_b32 s53, 0
  s_branch V_FIX_R6
V_FIX_S6:
  buffer_load_dwordx4 v[64:67], v2, s[32:35], s68 offen sc1
  s_add_u32 s57, s57, 1
  s_cmp_gt_u32 s57, 0x80000
  s_cbranch_scc1 L_EXIT
  s_waitcnt vmcnt(0)
  v_cmp_eq_u32 vcc, s72, v64
  s_cbranch_vccnz V_FIX_S6
  s_mov_b32 s53, 0
  s_branch V_FIX_R7
V_FIX_S7:
  buffer_load_dwordx4 v[68:71], v2, s[32:35], s69 offen sc1
  s_add_u32 s57, s57, 1
  s_cmp_gt_u32 s57, 0x80000
  s_cbranch_scc1 L_EXIT
  s_waitcnt vmcnt(0)
  v_cmp_eq_u32 vcc, s72, v68
  s_cbranch_vccnz V_FIX_S7
  s_mov_b32 s53, 0
  s_branch V_FIX_R8
V_FIX_S8:
  buffer_load_dwordx4 v[72:75], v2, s[32:35], s70 offen sc1
  s_add_u32 s57, s57, 1
  s_cmp_gt_u32 s57, 0x80000
  s_cbranch_scc1 L_EXIT
  s_waitcnt vmcnt(0)
  v_cmp_eq_u32 vcc, s72, v72
  s_cbranch_vccnz V_FIX_S8
  s_mov_b32 s53, 0
  s_branch V_FIX_R9
V_FIX_S9:
  buffer_load_dwordx4 v[76:79], v2, s[32:35], s71 offen sc1
  s_add_u32 s57, s57, 1
  s_cmp_gt_u32 s57, 0x80000
  s_cbranch_scc1 L_EXIT
  s_waitcnt vmcnt(0)
  v_cmp_eq_u32 vcc, s72, v76
  s_cbranch_vccnz V_FIX_S9
  s_mov_b32 s53, 0
  s_branch V_FIX_R10
V_FIX_R1:
  s_cmp_lg_u64 s[6:7], 0
  s_cbranch_scc1 V_FIX_L1
V_FIX_R2:
  s_cmp_lg_u64 s[8:9], 0
  s_cbranch_scc1 V_FIX_L2
V_FIX_R3:
  s_cmp_lg_u64 s[10:11], 0
  s_cbranch_scc1 V_FIX_L3
V_FIX_R4:
  s_cmp_lg_u64 s[12:13], 0
  s_cbranch_scc1 V_FIX_L4
V_FIX_R5:
  s_cmp_lg_u64 s[14:15], 0
  s_cbranch_scc1 V_FIX_L5
V_FIX_R6:
  s_cmp_lg_u64 s[16:17], 0
  s_cbranch_scc1 V_FIX_L6
V_FIX_R7:
  s_cmp_lg_u64 s[18:19], 0
  s_cbranch_scc1 V_FIX_L7
V_FIX_R8:
  s_cmp_lg_u64 s[20:21], 0
  s_cbranch_scc1 V_FIX_L8
V_FIX_R9:
  s_cmp_lg_u64 s[22:23], 0
  s_cbranch_scc1 V_FIX_L9
V_FIX_R10:
  s_cmp_lg_u32 s53, 0
  s_cbranch_scc1 FX_54
  s_setpc_b64 s[86:87]
V_FIX_L1:
  buffer_load_dwordx4 v[44:47], v2, s[32:35], s63 offen sc1
  s_mov_b32 s53, 1
  s_branch V_FIX_R2
V_FIX_L2:
  buffer_load_dwordx4 v[48:51], v2, s[32:35], s64 offen sc1
  s_mov_b32 s53, 1
  s_branch V_FIX_R3
V_FIX_L3:
  buffer_load_dwordx4 v[52:55], v2, s[32:35], s65 offen sc1
  s_mov_b32 s53, 1
  s_branch V_FIX_R4
V_FIX_L4:
  buffer_load_dwordx4 v[56:59], v2, s[32:35], s66 offen sc1
  s_mov_b32 s53, 1
  s_branch V_FIX_R5
V_FIX_L5:
  buffer_load_dwordx4 v[60:63], v2, s[32:35], s67 offen sc1
  s_mov_b32 s53, 1
  s_branch V_FIX_R6
V_FIX_L6:
  buffer_load_dwordx4 v[64:67], v2, s[32:35], s68 offen sc1
  s_mov_b32 s53, 1
  s_branch V_FIX_R7
V_FIX_L7:
  buffer_load_dwordx4 v[68:71], v2, s[32:35], s69 offen sc1
  s_mov_b32 s53, 1
  s_branch V_FIX_R8
V_FIX_L8:
  buffer_load_dwordx4 v[72:75], v2, s[32:35], s70 offen sc1
  s_mov_b32 s53, 1
  s_branch V_FIX_R9
V_FIX_L9:
  buffer_load_dwordx4 v[76:79], v2, s[32:35], s71 offen sc1
  s_mov_b32 s53, 1
  s_branch V_FIX_R10
V_RETRY:
  s_call_b64 s[86:87], V_FIX
  s_waitcnt lgkmcnt(0)
  v_mov_b64 v[16:17], 0
  v_mov_b64 v[18:19], 0
  v_mov_b64 v[20:21], 0
  v_mov_b64 v[22:23], 0
  v_mov_b64 v[24:25], 0
  v_mov_b64 v[26:27], 0
  ds_read_b128 v[80:83], v3 offset:0
  ds_read_b128 v[84:87], v3 offset:1024
  ds_read_b128 v[88:91], v3 offset:2048
  ds_read_b128 v[92:95], v3 offset:3072
  s_waitcnt lgkmcnt(0)
  s_branch V_GEMM
V_FIRST:
  s_waitcnt vmcnt(0)
  s_barrier
  s_lshl_b32 s54, s48, 7
  s_add_u32 s54, s54, s50
  s_add_u32 s54, s54, 4096
  s_cmp_eq_u32 s49, 0
  s_cselect_b32 s54, s54, 0x40000000
  v_mov_b32 v96, 0x40000000
  s_nop 0
  v_writelane_b32 v96, s54, 0
  v_mov_b32 v97, 1
  buffer_store_dword v97, v96, s[32:35], 0 offen sc1
  s_add_u32 s54, s50, 16388
  v_lshl_add_u32 v96, v0, 7, s54
  s_mov_b32 s55, 1
  s_mov_b32 exec_hi, 0x0
  s_mov_b32 s57, 0
PL_56:
  buffer_load_dword v97, v96, s[32:35], 0 offen sc1
  s_waitcnt vmcnt(0)
  v_cmp_gt_u32 vcc, s55, v97
  s_cbranch_vccz PR_57
  s_add_u32 s57, s57, 1
  s_cmp_lt_u32 s57, 0x80000
  s_cbranch_scc1 PL_56
  s_branch L_EXIT
PR_57:
  s_mov_b64 exec, -1
  v_bfe_u32 v96, v0, 2, 3
  v_lshl_add_u32 v99, v97, 3, v96
  s_nop 1
  v_min_u32_dpp v99, v99, v99 row_ror:4 row_mask:0xf bank_mask:0xf
  s_nop 1
  v_min_u32_dpp v99, v99, v99 row_ror:8 row_mask:0xf bank_mask:0xf
  v_mov_b32 v96, v99
  s_nop 1
  v_permlane16_swap_b32 v99, v96
  v_min_u32 v99, v99, v96
  v_bfe_u32 v96, v99, 2, 1
  v_and_b32 v99, 3, v99
  v_lshlrev_b32 v99, 11, v99
  v_lshl_add_u32 v99, v96, 14, v99
  v_and_b32 v96, 3, v0
  v_lshl_add_u32 v99, v96, 7, v99
  s_and_b32 s54, s2, 3
  v_readlane_b32 s54, v99, s54
  s_add_u32 s54, s54, s50
  s_add_u32 s54, s54, 131584
  v_mov_b32 v4, s54
  s_branch V_FDONE
V_SLOW:
  s_cmp_lg_u32 s58, 0
  s_cbranch_scc1 V_CONT
  s_nop 7
  s_nop 3
  s_barrier
  s_mov_b32 s57, 0
VR_58:
  buffer_load_dwordx4 v[40:43], v2, s[32:35], s62 offen sc1
  buffer_load_dwordx4 v[44:47], v2, s[32:35], s63 offen sc1
  buffer_load_dwordx4 v[48:51], v2, s[32:35], s64 offen sc1
  buffer_load_dwordx4 v[52:55], v2, s[32:35], s65 offen sc1
  buffer_load_dwordx4 v[56:59], v2, s[32:35], s66 offen sc1
  buffer_load_dwordx4 v[60:63], v2, s[32:35], s67 offen sc1
  buffer_load_dwordx4 v[64:67], v2, s[32:35], s68 offen sc1
  buffer_load_dwordx4 v[68:71], v2, s[32:35], s69 offen sc1
  buffer_load_dwordx4 v[72:75], v2, s[32:35], s70 offen sc1
  buffer_load_dwordx4 v[76:79], v2, s[32:35], s71 offen sc1
  s_add_u32 s57, s57, 1
  s_cmp_gt_u32 s57, 0x20000
  s_cbranch_scc1 L_EXIT
  s_waitcnt vmcnt(0)
  s_mov_b64 s[60:61], 0
  v_cmp_eq_u32 vcc, s72, v40
  s_nop 0
  s_or_b64 s[60:61], s[60:61], vcc
  v_cmp_eq_u32 vcc, s72, v41
  s_nop 0
  s_or_b64 s[60:61], s[60:61], vcc
  v_cmp_eq_u32 vcc, s72, v42
  s_nop 0
  s_or_b64 s[60:61], s[60:61], vcc
  v_cmp_eq_u32 vcc, s72, v43
  s_nop 0
  s_or_b64 s[60:61], s[60:61], vcc
  v_cmp_eq_u32 vcc, s72, v44
  s_nop 0
  s_or_b64 s[60:61], s[60:61], vcc
  v_cmp_eq_u32 vcc, s72, v45
  s_nop 0
  s_or_b64 s[60:61], s[60:61], vcc
  v_cmp_eq_u32 vcc, s72, v46
  s_nop 0
  s_or_b64 s[60:61], s[60:61], vcc
  v_cmp_eq_u32 vcc, s72, v47
  s_nop 0
  s_or_b64 s[60:61], s[60:61], vcc
  v_cmp_eq_u32 vcc, s72, v48
  s_nop 0
  s_or_b64 s[60:61], s[60:61], vcc
  v_cmp_eq_u32 vcc, s72, v49
  s_nop 0
  s_or_b64 s[60:61], s[60:61], vcc
  v_cmp_eq_u32 vcc, s72, v50
  s_nop 0
  s_or_b64 s[60:61], s[60:61], vcc
  v_cmp_eq_u32 vcc, s72, v51
  s_nop 0
  s_or_b64 s[60:61], s[60:61], vcc
  v_cmp_eq_u32 vcc, s72, v52
  s_nop 0
  s_or_b64 s[60:61], s[60:61], vcc
  v_cmp_eq_u32 vcc, s72, v53
  s_nop 0
  s_or_b64 s[60:61], s[60:61], vcc
  v_cmp_eq_u32 vcc, s72, v54
  s_nop 0
  s_or_b64 s[60:61], s[60:61], vcc
  v_cmp_eq_u32 vcc, s72, v55
  s_nop 0
  s_or_b64 s[60:61], s[60:61], vcc
  v_cmp_eq_u32 vcc, s72, v56
  s_nop 0
  s_or_b64 s[60:61], s[60:61], vcc
  v_cmp_eq_u32 vcc, s72, v57
  s_nop 0
  s_or_b64 s[60:61], s[60:61], vcc
  v_cmp_eq_u32 vcc, s72, v58
  s_nop 0
  s_or_b64 s[60:61], s[60:61], vcc
  v_cmp_eq_u32 vcc, s72, v59
  s_nop 0
  s_or_b64 s[60:61], s[60:61], vcc
  v_cmp_eq_u32 vcc, s72, v60
  s_nop 0
  s_or_b64 s[60:61], s[60:61], vcc
  v_cmp_eq_u32 vcc, s72, v61
  s_nop 0
  s_or_b64 s[60:61], s[60:61], vcc
  v_cmp_eq_u32 vcc, s72, v62
  s_nop 0
  s_or_b64 s[60:61], s[60:61], vcc
  v_cmp_eq_u32 vcc, s72, v63
  s_nop 0
  s_or_b64 s[60:61], s[60:61], vcc
  v_cmp_eq_u32 vcc, s72, v64
  s_nop 0
  s_or_b64 s[60:61], s[60:61], vcc
  v_cmp_eq_u32 vcc, s72, v65
  s_nop 0
  s_or_b64 s[60:61], s[60:61], vcc
  v_cmp_eq_u32 vcc, s72, v66
  s_nop 0
  s_or_b64 s[60:61], s[60:61], vcc
  v_cmp_eq_u32 vcc, s72, v67
  s_nop 0
  s_or_b64 s[60:61], s[60:61], vcc
  v_cmp_eq_u32 vcc, s72, v68
  s_nop 0
  s_or_b64 s[60:61], s[60:61], vcc
  v_cmp_eq_u32 vcc, s72, v69
  s_nop 0
  s_or_b64 s[60:61], s[60:61], vcc
  v_cmp_eq_u32 vcc, s72, v70
  s_nop 0
  s_or_b64 s[60:61], s[60:61], vcc
  v_cmp_eq_u32 vcc, s72, v71
  s_nop 0
  s_or_b64 s[60:61], s[60:61], vcc
  v_cmp_eq_u32 vcc, s72, v72
  s_nop 0
  s_or_b64 s[60:61], s[60:61], vcc
  v_cmp_eq_u32 vcc, s72, v73
  s_nop 0
  s_or_b64 s[60:61], s[60:61], vcc
  v_cmp_eq_u32 vcc, s72, v74
  s_nop 0
  s_or_b64 s[60:61], s[60:61], vcc
  v_cmp_eq_u32 vcc, s72, v75
  s_nop 0
  s_or_b64 s[60:61], s[60:61], vcc
  v_cmp_eq_u32 vcc, s72, v76
  s_nop 0
  s_or_b64 s[60:61], s[60:61], vcc
  v_cmp_eq_u32 vcc, s72, v77
  s_nop 0
  s_or_b64 s[60:61], s[60:61], vcc
  v_cmp_eq_u32 vcc, s72, v78
  s_nop 0
  s_or_b64 s[60:61], s[60:61], vcc
  v_cmp_eq_u32 vcc, s72, v79
  s_nop 0
  s_or_b64 s[60:61], s[60:61], vcc
  s_cbranch_scc1 VR_58
  s_mov_b32 s58, 1
  v_mov_b64 v[16:17], 0
  v_mov_b64 v[18:19], 0
  v_mov_b64 v[20:21], 0
  v_mov_b64 v[22:23], 0
  v_mov_b64 v[24:25], 0
  v_mov_b64 v[26:27], 0
  ds_read_b128 v[80:83], v3 offset:0
  ds_read_b128 v[84:87], v3 offset:1024
  ds_read_b128 v[88:91], v3 offset:2048
  ds_read_b128 v[92:95], v3 offset:3072
  s_waitcnt lgkmcnt(0)
  s_branch V_GEMM
V_END:
R_VC:
  s_mov_b32 s36, s20
  s_and_b32 s37, s21, 0xffff
  s_mov_b32 s38, 0x780000
  s_mov_b32 s39, 0x20000
  s_mov_b32 s72, 0x2200000
  s_mov_b32 s73, 53248
  s_mov_b32 s80, 0
  s_branch KV_GO
R_KC:
  s_mov_b32 s36, s18
  s_and_b32 s37, s19, 0xffff
  s_mov_b32 s38, 0x780000
  s_mov_b32 s39, 0x20000
  s_mov_b32 s72, 0x180000
  s_mov_b32 s73, 49152
  s_mov_b32 s80, 1
KV_GO:
  s_mov_b32 s44, s12
  s_and_b32 s45, s13, 0xffff
  s_mov_b32 s46, 0x280000
  s_mov_b32 s47, 0x20000
  v_lshrrev_b32 v72, 3, v0
  s_lshl_b32 s53, s49, 3
  v_add_u32 v72, s53, v72
  v_bfe_u32 v73, v72, 1, 3
  v_and_b32 v74, 7, v0
  v_xor_b32 v73, v73, v74
  v_mul_u32_u24 v72, 1280, v72
  v_lshl_add_u32 v1, v73, 4, v72
  v_and_b32 v72, 15, v0
  v_lshrrev_b32 v73, 1, v72
  v_lshrrev_b32 v74, 4, v0
  v_xor_b32 v73, v73, v74
  v_lshlrev_b32 v72, 7, v72
  v_lshl_add_u32 v2, v73, 4, v72
  v_xor_b32 v3, 64, v2
  s_mov_b32 s76, 0
  s_lshl_b32 s77, s49, 10
  s_add_u32 m0, s77, 0
  s_nop 0
  buffer_load_dwordx4 v1, s[44:47], s76 offen offset:0 lds
  s_add_u32 m0, s77, 3968
  s_nop 0
  buffer_load_dwordx4 v1, s[44:47], s76 offen offset:128 lds
  s_add_u32 m0, s77, 7936
  s_nop 0
  buffer_load_dwordx4 v1, s[44:47], s76 offen offset:256 lds
  s_add_u32 m0, s77, 11904
  s_nop 0
  buffer_load_dwordx4 v1, s[44:47], s76 offen offset:384 lds
  s_add_u32 m0, s77, 15872
  s_nop 0
  buffer_load_dwordx4 v1, s[44:47], s76 offen offset:512 lds
  s_add_u32 m0, s77, 19840
  s_nop 0
  buffer_load_dwordx4 v1, s[44:47], s76 offen offset:640 lds
  s_add_u32 m0, s77, 23808
  s_nop 0
  buffer_load_dwordx4 v1, s[44:47], s76 offen offset:768 lds
  s_add_u32 m0, s77, 27776
  s_nop 0
  buffer_load_dwordx4 v1, s[44:47], s76 offen offset:896 lds
  s_add_u32 m0, s77, 31744
  s_nop 0
  buffer_load_dwordx4 v1, s[44:47], s76 offen offset:1024 lds
  s_add_u32 m0, s77, 35712
  s_nop 0
  buffer_load_dwordx4 v1, s[44:47], s76 offen offset:1152 lds
  s_add_u32 s76, s76, 40960
  s_add_u32 s77, s77, 40960
  s_cmp_ge_u32 s77, 122880
  s_cselect_b32 s53, 122880, 0
  s_sub_u32 s77, s77, s53
  s_add_u32 m0, s77, 0
  s_nop 0
  buffer_load_dwordx4 v1, s[44:47], s76 offen offset:0 lds
  s_add_u32 m0, s77, 3968
  s_nop 0
  buffer_load_dwordx4 v1, s[44:47], s76 offen offset:128 lds
  s_add_u32 m0, s77, 7936
  s_nop 0
  buffer_load_dwordx4 v1, s[44:47], s76 offen offset:256 lds
  s_add_u32 m0, s77, 11904
  s_nop 0
  buffer_load_dwordx4 v1, s[44:47], s76 offen offset:384 lds
  s_add_u32 m0, s77, 15872
  s_nop 0
  buffer_load_dwordx4 v1, s[44:47], s76 offen offset:512 lds
  s_add_u32 m0, s77, 19840
  s_nop 0
  buffer_load_dwordx4 v1, s[44:47], s76 offen offset:640 lds
  s_add_u32 m0, s77, 23808
  s_nop 0
  buffer_load_dwordx4 v1, s[44:47], s76 offen offset:768 lds
  s_add_u32 m0, s77, 27776
  s_nop 0
  buffer_load_dwordx4 v1, s[44:47], s76 offen offset:896 lds
  s_add_u32 m0, s77, 31744
  s_nop 0
  buffer_load_dwordx4 v1, s[44:47], s76 offen offset:1024 lds
  s_add_u32 m0, s77, 35712
  s_nop 0
  buffer_load_dwordx4 v1, s[44:47], s76 offen offset:1152 lds
  s_mov_b32 s62, 0
  s_mov_b32 s63, 1
  s_mov_b32 s64, 2
  s_mov_b32 s65, 3
  s_mov_b32 s66, 4
  s_mov_b32 s67, 5
  s_mov_b32 s68, 6
  s_mov_b32 s69, 7
  s_mov_b32 s70, 8
  s_mov_b32 s71, 9
  s_mul_i32 s55, s48, 384
  s_mul_i32 s53, s49, 384
  s_add_u32 s53, s53, 0
  v_add_u32 v60, s53, v0
  v_mul_u32_u24 v61, 43691, v60
  v_lshrrev_b32 v61, 20, v61
  v_mul_u32_u24 v62, 24, v61
  v_sub_u32 v60, v60, v62
  v_and_b32 v62, 2, v61
  v_lshrrev_b32 v63, 1, v61
  v_and_b32 v63, 4, v63
  v_or_b32 v62, v62, v63
  v_xor_b32 v60, v60, v62
  v_mul_u32_u24 v61, 12288, v61
  v_lshl_add_u32 v40, v60, 4, v61
  v_add_u32 v40, s55, v40
  s_mul_i32 s53, s49, 384
  s_add_u32 s53, s53, 64
  v_add_u32 v60, s53, v0
  v_mul_u32_u24 v61, 43691, v60
  v_lshrrev_b32 v61, 20, v61
  v_mul_u32_u24 v62, 24, v61
  v_sub_u32 v60, v60, v62
  v_and_b32 v62, 2, v61
  v_lshrrev_b32 v63, 1, v61
  v_and_b32 v63, 4, v63
  v_or_b32 v62, v62, v63
  v_xor_b32 v60, v60, v62
  v_mul_u32_u24 v61, 12288, v61
  v_lshl_add_u32 v41, v60, 4, v61
  v_add_u32 v41, s55, v41
  s_mul_i32 s53, s49, 384
  s_add_u32 s53, s53, 128
  v_add_u32 v60, s53, v0
  v_mul_u32_u24 v61, 43691, v60
  v_lshrrev_b32 v61, 20, v61
  v_mul_u32_u24 v62, 24, v61
  v_sub_u32 v60, v60, v62
  v_and_b32 v62, 2, v61
  v_lshrrev_b32 v63, 1, v61
  v_and_b32 v63, 4, v63
  v_or_b32 v62, v62, v63
  v_xor_b32 v60, v60, v62
  v_mul_u32_u24 v61, 12288, v61
  v_lshl_add_u32 v42, v60, 4, v61
  v_add_u32 v42, s55, v42
  s_mul_i32 s53, s49, 384
  s_add_u32 s53, s53, 192
  v_add_u32 v60, s53, v0
  v_mul_u32_u24 v61, 43691, v60
  v_lshrrev_b32 v61, 20, v61
  v_mul_u32_u24 v62, 24, v61
  v_sub_u32 v60, v60, v62
  v_and_b32 v62, 2, v61
  v_lshrrev_b32 v63, 1, v61
  v_and_b32 v63, 4, v63
  v_or_b32 v62, v62, v63
  v_xor_b32 v60, v60, v62
  v_mul_u32_u24 v61, 12288, v61
  v_lshl_add_u32 v43, v60, 4, v61
  v_add_u32 v43, s55, v43
  s_mul_i32 s53, s49, 384
  s_add_u32 s53, s53, 256
  v_add_u32 v60, s53, v0
  v_mul_u32_u24 v61, 43691, v60
  v_lshrrev_b32 v61, 20, v61
  v_mul_u32_u24 v62, 24, v61
  v_sub_u32 v60, v60, v62
  v_and_b32 v62, 2, v61
  v_lshrrev_b32 v63, 1, v61
  v_and_b32 v63, 4, v63
  v_or_b32 v62, v62, v63
  v_xor_b32 v60, v60, v62
  v_mul_u32_u24 v61, 12288, v61
  v_lshl_add_u32 v44, v60, 4, v61
  v_add_u32 v44, s55, v44
  s_mul_i32 s53, s49, 384
  s_add_u32 s53, s53, 320
  v_add_u32 v60, s53, v0
  v_mul_u32_u24 v61, 43691, v60
  v_lshrrev_b32 v61, 20, v61
  v_mul_u32_u24 v62, 24, v61
  v_sub_u32 v60, v60, v62
  v_and_b32 v62, 2, v61
  v_lshrrev_b32 v63, 1, v61
  v_and_b32 v63, 4, v63
  v_or_b32 v62, v62, v63
  v_xor_b32 v60, v60, v62
  v_mul_u32_u24 v61, 12288, v61
  v_lshl_add_u32 v45, v60, 4, v61
  v_add_u32 v45, s55, v45
  s_mul_i32 s55, s49, 3
  s_add_u32 s55, s55, 0
  v_lshrrev_b32 v60, 4, v0
  v_bfe_u32 v61, v0, 2, 2
  v_lshl_add_u32 v62, v60, 3, v61
  v_and_b32 v60, 1, v60
  v_lshrrev_b32 v61, 1, v61
  v_lshl_add_u32 v60, v60, 1, v61
  v_xor_b32 v60, s55, v60
  v_mul_u32_u24 v62, 384, v62
  v_lshl_add_u32 v62, v60, 5, v62
  v_and_b32 v60, 3, v0
  v_lshl_add_u32 v46, v60, 3, v62
  s_mul_i32 s55, s49, 3
  s_add_u32 s55, s55, 1
  v_lshrrev_b32 v60, 4, v0
  v_bfe_u32 v61, v0, 2, 2
  v_lshl_add_u32 v62, v60, 3, v61
  v_and_b32 v60, 1, v60
  v_lshrrev_b32 v61, 1, v61
  v_lshl_add_u32 v60, v60, 1, v61
  v_xor_b32 v60, s55, v60
  v_mul_u32_u24 v62, 384, v62
  v_lshl_add_u32 v62, v60, 5, v62
  v_and_b32 v60, 3, v0
  v_lshl_add_u32 v47, v60, 3, v62
  s_mul_i32 s55, s49, 3
  s_add_u32 s55, s55, 2
  v_lshrrev_b32 v60, 4, v0
  v_bfe_u32 v61, v0, 2, 2
  v_lshl_add_u32 v62, v60, 3, v61
  v_and_b32 v60, 1, v60
  v_lshrrev_b32 v61, 1, v61
  v_lshl_add_u32 v60, v60, 1, v61
  v_xor_b32 v60, s55, v60
  v_mul_u32_u24 v62, 384, v62
  v_lshl_add_u32 v62, v60, 5, v62
  v_and_b32 v60, 3, v0
  v_lshl_add_u32 v48, v60, 3, v62
  s_mul_i32 s54, s62, 786432
  s_mul_i32 s53, s49, 6144
  s_add_u32 m0, s53, 81920
  s_nop 0
  buffer_load_dwordx4 v40, s[36:39], s54 offen  lds
  s_add_u32 m0, m0, 1024
  s_nop 0
  buffer_load_dwordx4 v41, s[36:39], s54 offen  lds
  s_add_u32 m0, m0, 1024
  s_nop 0
  buffer_load_dwordx4 v42, s[36:39], s54 offen  lds
  s_add_u32 m0, m0, 1024
  s_nop 0
  buffer_load_dwordx4 v43, s[36:39], s54 offen  lds
  s_add_u32 m0, m0, 1024
  s_nop 0
  buffer_load_dwordx4 v44, s[36:39], s54 offen  lds
  s_add_u32 m0, m0, 1024
  s_nop 0
  buffer_load_dwordx4 v45, s[36:39], s54 offen  lds
  s_mul_i32 s54, s63, 786432
  s_mul_i32 s53, s49, 6144
  s_add_u32 m0, s53, 106496
  s_nop 0
  buffer_load_dwordx4 v40, s[36:39], s54 offen  lds
  s_add_u32 m0, m0, 1024
  s_nop 0
  buffer_load_dwordx4 v41, s[36:39], s54 offen  lds
  s_add_u32 m0, m0, 1024
  s_nop 0
  buffer_load_dwordx4 v42, s[36:39], s54 offen  lds
  s_add_u32 m0, m0, 1024
  s_nop 0
  buffer_load_dwordx4 v43, s[36:39], s54 offen  lds
  s_add_u32 m0, m0, 1024
  s_nop 0
  buffer_load_dwordx4 v44, s[36:39], s54 offen  lds
  s_add_u32 m0, m0, 1024
  s_nop 0
  buffer_load_dwordx4 v45, s[36:39], s54 offen  lds
  s_mul_i32 s54, s64, 786432
  s_mul_i32 s53, s49, 6144
  s_add_u32 m0, s53, 131072
  s_nop 0
  buffer_load_dwordx4 v40, s[36:39], s54 offen  lds
  s_add_u32 m0, m0, 1024
  s_nop 0
  buffer_load_dwordx4 v41, s[36:39], s54 offen  lds
  s_add_u32 m0, m0, 1024
  s_nop 0
  buffer_load_dwordx4 v42, s[36:39], s54 offen  lds
  s_add_u32 m0, m0, 1024
  s_nop 0
  buffer_load_dwordx4 v43, s[36:39], s54 offen  lds
  s_add_u32 m0, m0, 1024
  s_nop 0
  buffer_load_dwordx4 v44, s[36:39], s54 offen  lds
  s_add_u32 m0, m0, 1024
  s_nop 0
  buffer_load_dwordx4 v45, s[36:39], s54 offen  lds
  s_waitcnt vmcnt(12)
  s_barrier
  v_add_u32 v49, 0x14000, v46
  v_add_u32 v50, 0x14000, v47
  v_add_u32 v51, 0x14000, v48
  ds_read_b64_tr_b16 a[16:17], v49 offset:0
  ds_read_b64_tr_b16 a[18:19], v49 offset:1536
  ds_read_b64_tr_b16 a[20:21], v49 offset:12288
  ds_read_b64_tr_b16 a[22:23], v49 offset:13824
  ds_read_b64_tr_b16 a[24:25], v50 offset:0
  ds_read_b64_tr_b16 a[26:27], v50 offset:1536
  ds_read_b64_tr_b16 a[28:29], v50 offset:12288
  ds_read_b64_tr_b16 a[30:31], v50 offset:13824
  ds_read_b64_tr_b16 a[32:33], v51 offset:0
  ds_read_b64_tr_b16 a[34:35], v51 offset:1536
  ds_read_b64_tr_b16 a[36:37], v51 offset:12288
  ds_read_b64_tr_b16 a[38:39], v51 offset:13824
  s_waitcnt lgkmcnt(0)
  s_barrier
  s_mul_i32 s54, s65, 786432
  s_mul_i32 s53, s49, 6144
  s_add_u32 m0, s53, 81920
  s_nop 0
  buffer_load_dwordx4 v40, s[36:39], s54 offen  lds
  s_add_u32 m0, m0, 1024
  s_nop 0
  buffer_load_dwordx4 v41, s[36:39], s54 offen  lds
  s_add_u32 m0, m0, 1024
  s_nop 0
  buffer_load_dwordx4 v42, s[36:39], s54 offen  lds
  s_add_u32 m0, m0, 1024
  s_nop 0
  buffer_load_dwordx4 v43, s[36:39], s54 offen  lds
  s_add_u32 m0, m0, 1024
  s_nop 0
  buffer_load_dwordx4 v44, s[36:39], s54 offen  lds
  s_add_u32 m0, m0, 1024
  s_nop 0
  buffer_load_dwordx4 v45, s[36:39], s54 offen  lds
  s_waitcnt vmcnt(12)
  s_barrier
  v_add_u32 v49, 0x1a000, v46
  v_add_u32 v50, 0x1a000, v47
  v_add_u32 v51, 0x1a000, v48
  ds_read_b64_tr_b16 a[40:41], v49 offset:0
  ds_read_b64_tr_b16 a[42:43], v49 offset:1536
  ds_read_b64_tr_b16 a[44:45], v49 offset:12288
  ds_read_b64_tr_b16 a[46:47], v49 offset:13824
  ds_read_b64_tr_b16 a[48:49], v50 offset:0
  ds_read_b64_tr_b16 a[50:51], v50 offset:1536
  ds_read_b64_tr_b16 a[52:53], v50 offset:12288
  ds_read_b64_tr_b16 a[54:55], v50 offset:13824
  ds_read_b64_tr_b16 a[56:57], v51 offset:0
  ds_read_b64_tr_b16 a[58:59], v51 offset:1536
  ds_read_b64_tr_b16 a[60:61], v51 offset:12288
  ds_read_b64_tr_b16 a[62:63], v51 offset:13824
  s_waitcnt lgkmcnt(0)
  s_barrier
  s_mul_i32 s54, s66, 786432
  s_mul_i32 s53, s49, 6144
  s_add_u32 m0, s53, 106496
  s_nop 0
  buffer_load_dwordx4 v40, s[36:39], s54 offen  lds
  s_add_u32 m0, m0, 1024
  s_nop 0
  buffer_load_dwordx4 v41, s[36:39], s54 offen  lds
  s_add_u32 m0, m0, 1024
  s_nop 0
  buffer_load_dwordx4 v42, s[36:39], s54 offen  lds
  s_add_u32 m0, m0, 1024
  s_nop 0
  buffer_load_dwordx4 v43, s[36:39], s54 offen  lds
  s_add_u32 m0, m0, 1024
  s_nop 0
  buffer_load_dwordx4 v44, s[36:39], s54 offen  lds
  s_add_u32 m0, m0, 1024
  s_nop 0
  buffer_load_dwordx4 v45, s[36:39], s54 offen  lds
  s_waitcnt vmcnt(12)
  s_barrier
  v_add_u32 v49, 0x20000, v46
  v_add_u32 v50, 0x20000, v47
  v_add_u32 v51, 0x20000, v48
  ds_read_b64_tr_b16 a[64:65], v49 offset:0
  ds_read_b64_tr_b16 a[66:67], v49 offset:1536
  ds_read_b64_tr_b16 a[68:69], v49 offset:12288
  ds_read_b64_tr_b16 a[70:71], v49 offset:13824
  ds_read_b64_tr_b16 a[72:73], v50 offset:0
  ds_read_b64_tr_b16 a[74:75], v50 offset:1536
  ds_read_b64_tr_b16 a[76:77], v50 offset:12288
  ds_read_b64_tr_b16 a[78:79], v50 offset:13824
  ds_read_b64_tr_b16 a[80:81], v51 offset:0
  ds_read_b64_tr_b16 a[82:83], v51 offset:1536
  ds_read_b64_tr_b16 a[84:85], v51 offset:12288
  ds_read_b64_tr_b16 a[86:87], v51 offset:13824
  s_waitcnt lgkmcnt(0)
  s_barrier
  s_mul_i32 s54, s67, 786432
  s_mul_i32 s53, s49, 6144
  s_add_u32 m0, s53, 131072
  s_nop 0
  buffer_load_dwordx4 v40, s[36:39], s54 offen  lds
  s_add_u32 m0, m0, 1024
  s_nop 0
  buffer_load_dwordx4 v41, s[36:39], s54 offen  lds
  s_add_u32 m0, m0, 1024
  s_nop 0
  buffer_load_dwordx4 v42, s[36:39], s54 offen  lds
  s_add_u32 m0, m0, 1024
  s_nop 0
  buffer_load_dwordx4 v43, s[36:39], s54 offen  lds
  s_add_u32 m0, m0, 1024
  s_nop 0
  buffer_load_dwordx4 v44, s[36:39], s54 offen  lds
  s_add_u32 m0, m0, 1024
  s_nop 0
  buffer_load_dwordx4 v45, s[36:39], s54 offen  lds
  s_waitcnt vmcnt(12)
  s_barrier
  v_add_u32 v49, 0x14000, v46
  v_add_u32 v50, 0x14000, v47
  v_add_u32 v51, 0x14000, v48
  ds_read_b64_tr_b16 a[88:89], v49 offset:0
  ds_read_b64_tr_b16 a[90:91], v49 offset:1536
  ds_read_b64_tr_b16 a[92:93], v49 offset:12288
  ds_read_b64_tr_b16 a[94:95], v49 offset:13824
  ds_read_b64_tr_b16 a[96:97], v50 offset:0
  ds_read_b64_tr_b16 a[98:99], v50 offset:1536
  ds_read_b64_tr_b16 a[100:101], v50 offset:12288
  ds_read_b64_tr_b16 a[102:103], v50 offset:13824
  ds_read_b64_tr_b16 a[104:105], v51 offset:0
  ds_read_b64_tr_b16 a[106:107], v51 offset:1536
  ds_read_b64_tr_b16 a[108:109], v51 offset:12288
  ds_read_b64_tr_b16 a[110:111], v51 offset:13824
  s_waitcnt lgkmcnt(0)
  s_barrier
  s_mul_i32 s54, s68, 786432
  s_mul_i32 s53, s49, 6144
  s_add_u32 m0, s53, 81920
  s_nop 0
  buffer_load_dwordx4 v40, s[36:39], s54 offen  lds
  s_add_u32 m0, m0, 1024
  s_nop 0
  buffer_load_dwordx4 v41, s[36:39], s54 offen  lds
  s_add_u32 m0, m0, 1024
  s_nop 0
  buffer_load_dwordx4 v42, s[36:39], s54 offen  lds
  s_add_u32 m0, m0, 1024
  s_nop 0
  buffer_load_dwordx4 v43, s[36:39], s54 offen  lds
  s_add_u32 m0, m0, 1024
  s_nop 0
  buffer_load_dwordx4 v44, s[36:39], s54 offen  lds
  s_add_u32 m0, m0, 1024
  s_nop 0
  buffer_load_dwordx4 v45, s[36:39], s54 offen  lds
  s_waitcnt vmcnt(12)
  s_barrier
  v_add_u32 v49, 0x1a000, v46
  v_add_u32 v50, 0x1a000, v47
  v_add_u32 v51, 0x1a000, v48
  ds_read_b64_tr_b16 a[112:113], v49 offset:0
  ds_read_b64_tr_b16 a[114:115], v49 offset:1536
  ds_read_b64_tr_b16 a[116:117], v49 offset:12288
  ds_read_b64_tr_b16 a[118:119], v49 offset:13824
  ds_read_b64_tr_b16 a[120:121], v50 offset:0
  ds_read_b64_tr_b16 a[122:123], v50 offset:1536
  ds_read_b64_tr_b16 a[124:125], v50 offset:12288
  ds_read_b64_tr_b16 a[126:127], v50 offset:13824
  ds_read_b64_tr_b16 a[128:129], v51 offset:0
  ds_read_b64_tr_b16 a[130:131], v51 offset:1536
  ds_read_b64_tr_b16 a[132:133], v51 offset:12288
  ds_read_b64_tr_b16 a[134:135], v51 offset:13824
  s_waitcnt lgkmcnt(0)
  s_barrier
  s_mul_i32 s54, s69, 786432
  s_mul_i32 s53, s49, 6144
  s_add_u32 m0, s53, 106496
  s_nop 0
  buffer_load_dwordx4 v40, s[36:39], s54 offen  lds
  s_add_u32 m0, m0, 1024
  s_nop 0
  buffer_load_dwordx4 v41, s[36:39], s54 offen  lds
  s_add_u32 m0, m0, 1024
  s_nop 0
  buffer_load_dwordx4 v42, s[36:39], s54 offen  lds
  s_add_u32 m0, m0, 1024
  s_nop 0
  buffer_load_dwordx4 v43, s[36:39], s54 offen  lds
  s_add_u32 m0, m0, 1024
  s_nop 0
  buffer_load_dwordx4 v44, s[36:39], s54 offen  lds
  s_add_u32 m0, m0, 1024
  s_nop 0
  buffer_load_dwordx4 v45, s[36:39], s54 offen  lds
  s_waitcnt vmcnt(12)
  s_barrier
  v_add_u32 v49, 0x20000, v46
  v_add_u32 v50, 0x20000, v47
  v_add_u32 v51, 0x20000, v48
  ds_read_b64_tr_b16 a[136:137], v49 offset:0
  ds_read_b64_tr_b16 a[138:139], v49 offset:1536
  ds_read_b64_tr_b16 a[140:141], v49 offset:12288
  ds_read_b64_tr_b16 a[142:143], v49 offset:13824
  ds_read_b64_tr_b16 a[144:145], v50 offset:0
  ds_read_b64_tr_b16 a[146:147], v50 offset:1536
  ds_read_b64_tr_b16 a[148:149], v50 offset:12288
  ds_read_b64_tr_b16 a[150:151], v50 offset:13824
  ds_read_b64_tr_b16 a[152:153], v51 offset:0
  ds_read_b64_tr_b16 a[154:155], v51 offset:1536
  ds_read_b64_tr_b16 a[156:157], v51 offset:12288
  ds_read_b64_tr_b16 a[158:159], v51 offset:13824
  s_waitcnt lgkmcnt(0)
  s_barrier
  s_mul_i32 s54, s70, 786432
  s_mul_i32 s53, s49, 6144
  s_add_u32 m0, s53, 131072
  s_nop 0
  buffer_load_dwordx4 v40, s[36:39], s54 offen  lds
  s_add_u32 m0, m0, 1024
  s_nop 0
  buffer_load_dwordx4 v41, s[36:39], s54 offen  lds
  s_add_u32 m0, m0, 1024
  s_nop 0
  buffer_load_dwordx4 v42, s[36:39], s54 offen  lds
  s_add_u32 m0, m0, 1024
  s_nop 0
  buffer_load_dwordx4 v43, s[36:39], s54 offen  lds
  s_add_u32 m0, m0, 1024
  s_nop 0
  buffer_load_dwordx4 v44, s[36:39], s54 offen  lds
  s_add_u32 m0, m0, 1024
  s_nop 0
  buffer_load_dwordx4 v45, s[36:39], s54 offen  lds
  s_waitcnt vmcnt(12)
  s_barrier
  v_add_u32 v49, 0x14000, v46
  v_add_u32 v50, 0x14000, v47
  v_add_u32 v51, 0x14000, v48
  ds_read_b64_tr_b16 a[160:161], v49 offset:0
  ds_read_b64_tr_b16 a[162:163], v49 offset:1536
  ds_read_b64_tr_b16 a[164:165], v49 offset:12288
  ds_read_b64_tr_b16 a[166:167], v49 offset:13824
  ds_read_b64_tr_b16 a[168:169], v50 offset:0
  ds_read_b64_tr_b16 a[170:171], v50 offset:1536
  ds_read_b64_tr_b16 a[172:173], v50 offset:12288
  ds_read_b64_tr_b16 a[174:175], v50 offset:13824
  ds_read_b64_tr_b16 a[176:177], v51 offset:0
  ds_read_b64_tr_b16 a[178:179], v51 offset:1536
  ds_read_b64_tr_b16 a[180:181], v51 offset:12288
  ds_read_b64_tr_b16 a[182:183], v51 offset:13824
  s_waitcnt lgkmcnt(0)
  s_barrier
  s_mul_i32 s54, s71, 786432
  s_mul_i32 s53, s49, 6144
  s_add_u32 m0, s53, 81920
  s_nop 0
  buffer_load_dwordx4 v40, s[36:39], s54 offen  lds
  s_add_u32 m0, m0, 1024
  s_nop 0
  buffer_load_dwordx4 v41, s[36:39], s54 offen  lds
  s_add_u32 m0, m0, 1024
  s_nop 0
  buffer_load_dwordx4 v42, s[36:39], s54 offen  lds
  s_add_u32 m0, m0, 1024
  s_nop 0
  buffer_load_dwordx4 v43, s[36:39], s54 offen  lds
  s_add_u32 m0, m0, 1024
  s_nop 0
  buffer_load_dwordx4 v44, s[36:39], s54 offen  lds
  s_add_u32 m0, m0, 1024
  s_nop 0
  buffer_load_dwordx4 v45, s[36:39], s54 offen  lds
  s_waitcnt vmcnt(12)
  s_barrier
  v_add_u32 v49, 0x1a000, v46
  v_add_u32 v50, 0x1a000, v47
  v_add_u32 v51, 0x1a000, v48
  ds_read_b64_tr_b16 a[184:185], v49 offset:0
  ds_read_b64_tr_b16 a[186:187], v49 offset:1536
  ds_read_b64_tr_b16 a[188:189], v49 offset:12288
  ds_read_b64_tr_b16 a[190:191], v49 offset:13824
  ds_read_b64_tr_b16 a[192:193], v50 offset:0
  ds_read_b64_tr_b16 a[194:195], v50 offset:1536
  ds_read_b64_tr_b16 a[196:197], v50 offset:12288
  ds_read_b64_tr_b16 a[198:199], v50 offset:13824
  ds_read_b64_tr_b16 a[200:201], v51 offset:0
  ds_read_b64_tr_b16 a[202:203], v51 offset:1536
  ds_read_b64_tr_b16 a[204:205], v51 offset:12288
  ds_read_b64_tr_b16 a[206:207], v51 offset:13824
  s_waitcnt lgkmcnt(0)
  s_waitcnt vmcnt(6)
  s_barrier
  v_add_u32 v49, 0x20000, v46
  v_add_u32 v50, 0x20000, v47
  v_add_u32 v51, 0x20000, v48
  ds_read_b64_tr_b16 a[208:209], v49 offset:0
  ds_read_b64_tr_b16 a[210:211], v49 offset:1536
  ds_read_b64_tr_b16 a[212:213], v49 offset:12288
  ds_read_b64_tr_b16 a[214:215], v49 offset:13824
  ds_read_b64_tr_b16 a[216:217], v50 offset:0
  ds_read_b64_tr_b16 a[218:219], v50 offset:1536
  ds_read_b64_tr_b16 a[220:221], v50 offset:12288
  ds_read_b64_tr_b16 a[222:223], v50 offset:13824
  ds_read_b64_tr_b16 a[224:225], v51 offset:0
  ds_read_b64_tr_b16 a[226:227], v51 offset:1536
  ds_read_b64_tr_b16 a[228:229], v51 offset:12288
  ds_read_b64_tr_b16 a[230:231], v51 offset:13824
  s_waitcnt lgkmcnt(0)
  s_waitcnt vmcnt(0)
  s_barrier
  v_add_u32 v49, 0x14000, v46
  v_add_u32 v50, 0x14000, v47
  v_add_u32 v51, 0x14000, v48
  ds_read_b64_tr_b16 a[232:233], v49 offset:0
  ds_read_b64_tr_b16 a[234:235], v49 offset:1536
  ds_read_b64_tr_b16 a[236:237], v49 offset:12288
  ds_read_b64_tr_b16 a[238:239], v49 offset:13824
  ds_read_b64_tr_b16 a[240:241], v50 offset:0
  ds_read_b64_tr_b16 a[242:243], v50 offset:1536
  ds_read_b64_tr_b16 a[244:245], v50 offset:12288
  ds_read_b64_tr_b16 a[246:247], v50 offset:13824
  ds_read_b64_tr_b16 a[248:249], v51 offset:0
  ds_read_b64_tr_b16 a[250:251], v51 offset:1536
  ds_read_b64_tr_b16 a[252:253], v51 offset:12288
  ds_read_b64_tr_b16 a[254:255], v51 offset:13824
  s_waitcnt lgkmcnt(0)
  s_barrier
  v_min_u32 v72, 47, v0
  v_max_u32 v72, 31, v72
  v_lshlrev_b32 v72, 2, v72
  s_mov_b32 s57, 0
WI_59:
  global_load_dword v73, v72, s[28:29] sc1
  s_add_u32 s57, s57, 1
  s_cmp_gt_u32 s57, 0x20000
  s_cbranch_scc1 L_EXIT
  s_waitcnt vmcnt(0)
  s_and_b32 s53, s24, 7
  s_add_u32 s53, s53, 40
  v_readlane_b32 s53, v73, s53
  s_nop 1
  v_cmp_gt_u32 vcc, s53, v73
  s_bfe_u32 s53, vcc_hi, 0x80008
  s_bcnt1_i32_b32 s53, s53
  v_cmp_eq_u32 vcc, 0, v73
  s_bfe_u32 s54, vcc_hi, 0x80008
  s_cbranch_scc1 WI_61
  s_cmp_lg_u32 s53, s25
  s_cbranch_scc1 L_REDO
WI_61:
  s_cbranch_vccz WI_60
  s_sleep 8
  s_branch WI_59
WI_60:
  v_readfirstlane_b32 s53, v73
  s_and_b32 s53, s53, 1
  s_lshl_b32 s50, s53, 13
  s_xor_b32 s51, s50, 0x2000
  v_lshlrev_b32 v6, 4, v0
  s_lshl_b32 s74, s48, 14
  s_lshr_b32 s54, s49, 1
  s_lshl_b32 s54, s54, 13
  s_add_u32 s74, s74, s54
  s_and_b32 s75, s49, 1
  s_lshl_b32 s75, s75, 12
  s_add_u32 s74, s74, s72
  s_cmp_eq_u32 s80, 1
  s_cselect_b32 s82, s51, s51
  s_lshl_b32 s54, s48, 7
  s_add_u32 s54, s54, s51
  s_add_u32 s54, s54, s73
  s_cmp_eq_u32 s49, 0
  s_cselect_b32 s54, s54, 0x40000000
  v_mov_b32 v7, 0x40000000
  s_nop 0
  v_writelane_b32 v7, s54, 0
  s_mov_b32 s52, 0
  s_mov_b32 s78, 0
  s_mov_b32 s79, 0x40000000
  v_mov_b32 v4, v2
  v_mov_b32 v5, v3
  ds_read_b128 v[40:43], v4 offset:0
  ds_read_b128 v[44:47], v5 offset:0
  ds_read_b128 v[48:51], v4 offset:4096
KV_SEG:
  ds_read_b128 v[52:55], v5 offset:4096
  s_waitcnt lgkmcnt(3)
  v_mfma_f32_16x16x32_bf16 v[16:19], a[16:19], v[40:43], 0
  buffer_store_dwordx4 v[56:59], v6, s[32:35], s79 offen sc1
  v_mfma_f32_16x16x32_bf16 v[20:23], a[24:27], v[40:43], 0
  v_mfma_f32_16x16x32_bf16 v[24:27], a[32:35], v[40:43], 0
  ds_read_b128 v[40:43], v4 offset:8192
  s_waitcnt lgkmcnt(3)
  v_mfma_f32_16x16x32_bf16 v[16:19], a[20:23], v[44:47], v[16:19]
  v_cvt_pk_bf16_f32 v60, v28, v29
  v_mfma_f32_16x16x32_bf16 v[20:23], a[28:31], v[44:47], v[20:23]
  v_cvt_pk_bf16_f32 v61, v30, v31
  v_mfma_f32_16x16x32_bf16 v[24:27], a[36:39], v[44:47], v[24:27]
  v_cvt_pk_bf16_f32 v62, v32, v33
  ds_read_b128 v[44:47], v5 offset:8192
  s_waitcnt lgkmcnt(3)
  v_mfma_f32_16x16x32_bf16 v[16:19], a[40:43], v[48:51], v[16:19]
  v_cvt_pk_bf16_f32 v63, v34, v35
  v_mfma_f32_16x16x32_bf16 v[20:23], a[48:51], v[48:51], v[20:23]
  v_cvt_pk_bf16_f32 v66, v36, v37
  v_mfma_f32_16x16x32_bf16 v[24:27], a[56:59], v[48:51], v[24:27]
  v_cvt_pk_bf16_f32 v67, v38, v39
  ds_read_b128 v[48:51], v4 offset:12288
  s_waitcnt lgkmcnt(3)
  v_mfma_f32_16x16x32_bf16 v[16:19], a[44:47], v[52:55], v[16:19]
  buffer_store_dwordx4 v[60:63], v6, s[32:35], s79 offen offset:1024 sc1
  v_mfma_f32_16x16x32_bf16 v[20:23], a[52:55], v[52:55], v[20:23]
  v_mfma_f32_16x16x32_bf16 v[24:27], a[60:63], v[52:55], v[24:27]
  ds_read_b128 v[52:55], v5 offset:12288
  s_waitcnt lgkmcnt(3)
  v_mfma_f32_16x16x32_bf16 v[16:19], a[64:67], v[40:43], v[16:19]
  v_mfma_f32_16x16x32_bf16 v[20:23], a[72:75], v[40:43], v[20:23]
  v_mfma_f32_16x16x32_bf16 v[24:27], a[80:83], v[40:43], v[24:27]
  ds_read_b128 v[40:43], v4 offset:16384
  s_waitcnt lgkmcnt(3)
  v_mfma_f32_16x16x32_bf16 v[16:19], a[68:71], v[44:47], v[16:19]
  buffer_store_dwordx4 v[64:67], v6, s[32:35], s79 offen offset:2048 sc1
  v_mfma_f32_16x16x32_bf16 v[20:23], a[76:79], v[44:47], v[20:23]
  v_mfma_f32_16x16x32_bf16 v[24:27], a[84:87], v[44:47], v[24:27]
  ds_read_b128 v[44:47], v5 offset:16384
  s_waitcnt lgkmcnt(3)
  v_mfma_f32_16x16x32_bf16 v[16:19], a[88:91], v[48:51], v[16:19]
  v_mov_b32 v8, s52
  v_mfma_f32_16x16x32_bf16 v[20:23], a[96:99], v[48:51], v[20:23]
  s_add_u32 s76, s76, 40960
  v_mfma_f32_16x16x32_bf16 v[24:27], a[104:107], v[48:51], v[24:27]
  s_add_u32 s77, s77, 40960
  ds_read_b128 v[48:51], v4 offset:20480
  s_waitcnt lgkmcnt(3)
  v_mfma_f32_16x16x32_bf16 v[16:19], a[92:95], v[52:55], v[16:19]
  s_cmp_ge_u32 s77, 122880
  v_mfma_f32_16x16x32_bf16 v[20:23], a[100:103], v[52:55], v[20:23]
  s_cselect_b32 s53, 122880, 0
  v_mfma_f32_16x16x32_bf16 v[24:27], a[108:111], v[52:55], v[24:27]
  s_sub_u32 s77, s77, s53
  ds_read_b128 v[52:55], v5 offset:20480
  s_waitcnt lgkmcnt(3)
  v_mfma_f32_16x16x32_bf16 v[16:19], a[112:115], v[40:43], v[16:19]
  s_mul_i32 s79, s52, 0x80000
  v_mfma_f32_16x16x32_bf16 v[20:23], a[120:123], v[40:43], v[20:23]
  s_add_u32 s79, s79, 0x0
  v_mfma_f32_16x16x32_bf16 v[24:27], a[128:131], v[40:43], v[24:27]
  s_add_u32 s79, s79, s74
  ds_read_b128 v[40:43], v4 offset:24576
  s_waitcnt lgkmcnt(3)
  v_mfma_f32_16x16x32_bf16 v[16:19], a[116:119], v[44:47], v[16:19]
  s_lshr_b32 s53, s79, 7
  v_mfma_f32_16x16x32_bf16 v[20:23], a[124:127], v[44:47], v[20:23]
  s_and_b32 s53, s53, 0x2000
  v_mfma_f32_16x16x32_bf16 v[24:27], a[132:135], v[44:47], v[24:27]
  s_xor_b32 s53, s53, s82
  ds_read_b128 v[44:47], v5 offset:24576
  s_waitcnt lgkmcnt(3)
  v_mfma_f32_16x16x32_bf16 v[16:19], a[136:139], v[48:51], v[16:19]
  s_lshl_b32 s79, s79, 1
  v_mfma_f32_16x16x32_bf16 v[20:23], a[144:147], v[48:51], v[20:23]
  s_or_b32 s79, s79, s53
  v_mfma_f32_16x16x32_bf16 v[24:27], a[152:155], v[48:51], v[24:27]
  s_add_u32 s79, s79, s75
  ds_read_b128 v[48:51], v4 offset:28672
  s_waitcnt lgkmcnt(3)
  v_mfma_f32_16x16x32_bf16 v[16:19], a[140:143], v[52:55], v[16:19]
  s_add_u32 s78, s78, 40960
  v_mfma_f32_16x16x32_bf16 v[20:23], a[148:151], v[52:55], v[20:23]
  s_cmp_ge_u32 s78, 122880
  v_mfma_f32_16x16x32_bf16 v[24:27], a[156:159], v[52:55], v[24:27]
  s_cselect_b32 s53, 122880, 0
  ds_read_b128 v[52:55], v5 offset:28672
  s_waitcnt lgkmcnt(3)
  v_mfma_f32_16x16x32_bf16 v[16:19], a[160:163], v[40:43], v[16:19]
  s_sub_u32 s78, s78, s53
  v_mfma_f32_16x16x32_bf16 v[20:23], a[168:171], v[40:43], v[20:23]
  v_mfma_f32_16x16x32_bf16 v[24:27], a[176:179], v[40:43], v[24:27]
  ds_read_b128 v[40:43], v4 offset:32768
  s_waitcnt lgkmcnt(3)
  v_mfma_f32_16x16x32_bf16 v[16:19], a[164:167], v[44:47], v[16:19]
  v_mfma_f32_16x16x32_bf16 v[20:23], a[172:175], v[44:47], v[20:23]
  v_mfma_f32_16x16x32_bf16 v[24:27], a[180:183], v[44:47], v[24:27]
  ds_read_b128 v[44:47], v5 offset:32768
  s_waitcnt lgkmcnt(3)
  v_mfma_f32_16x16x32_bf16 v[16:19], a[184:187], v[48:51], v[16:19]
  v_mfma_f32_16x16x32_bf16 v[20:23], a[192:195], v[48:51], v[20:23]
  v_mfma_f32_16x16x32_bf16 v[24:27], a[200:203], v[48:51], v[24:27]
  ds_read_b128 v[48:51], v4 offset:36864
  s_waitcnt lgkmcnt(3)
  v_mfma_f32_16x16x32_bf16 v[16:19], a[188:191], v[52:55], v[16:19]
  v_mfma_f32_16x16x32_bf16 v[20:23], a[196:199], v[52:55], v[20:23]
  v_mfma_f32_16x16x32_bf16 v[24:27], a[204:207], v[52:55], v[24:27]
  ds_read_b128 v[52:55], v5 offset:36864
  s_waitcnt lgkmcnt(3)
  v_mfma_f32_16x16x32_bf16 v[16:19], a[208:211], v[40:43], v[16:19]
  v_mfma_f32_16x16x32_bf16 v[20:23], a[216:219], v[40:43], v[20:23]
  v_mfma_f32_16x16x32_bf16 v[24:27], a[224:227], v[40:43], v[24:27]
  ds_read_b128 v[40:43], v4 offset:2048
  s_waitcnt lgkmcnt(3)
  v_mfma_f32_16x16x32_bf16 v[16:19], a[212:215], v[44:47], v[16:19]
  v_mfma_f32_16x16x32_bf16 v[20:23], a[220:223], v[44:47], v[20:23]
  v_mfma_f32_16x16x32_bf16 v[24:27], a[228:231], v[44:47], v[24:27]
  ds_read_b128 v[44:47], v5 offset:2048
  s_waitcnt lgkmcnt(3)
  v_mfma_f32_16x16x32_bf16 v[16:19], a[232:235], v[48:51], v[16:19]
  s_waitcnt vmcnt(0)
  s_barrier
  buffer_store_dword v8, v7, s[32:35], 0 offen sc1
  v_mfma_f32_16x16x32_bf16 v[20:23], a[240:243], v[48:51], v[20:23]
  v_mfma_f32_16x16x32_bf16 v[24:27], a[248:251], v[48:51], v[24:27]
  ds_read_b128 v[48:51], v4 offset:6144
  s_waitcnt lgkmcnt(3)
  v_mfma_f32_16x16x32_bf16 v[16:19], a[236:239], v[52:55], v[16:19]
  v_mfma_f32_16x16x32_bf16 v[20:23], a[244:247], v[52:55], v[20:23]
  v_mfma_f32_16x16x32_bf16 v[24:27], a[252:255], v[52:55], v[24:27]
  ds_read_b128 v[52:55], v5 offset:6144
  s_waitcnt lgkmcnt(3)
  v_mfma_f32_16x16x32_bf16 v[28:31], a[16:19], v[40:43], 0
  v_mfma_f32_16x16x32_bf16 v[32:35], a[24:27], v[40:43], 0
  v_mfma_f32_16x16x32_bf16 v[36:39], a[32:35], v[40:43], 0
  ds_read_b128 v[40:43], v4 offset:10240
  s_waitcnt lgkmcnt(3)
  v_mfma_f32_16x16x32_bf16 v[28:31], a[20:23], v[44:47], v[28:31]
  v_cvt_pk_bf16_f32 v56, v16, v17
  v_mfma_f32_16x16x32_bf16 v[32:35], a[28:31], v[44:47], v[32:35]
  v_cvt_pk_bf16_f32 v57, v18, v19
  v_mfma_f32_16x16x32_bf16 v[36:39], a[36:39], v[44:47], v[36:39]
  v_cvt_pk_bf16_f32 v58, v20, v21
  ds_read_b128 v[44:47], v5 offset:10240
  s_waitcnt lgkmcnt(3)
  v_mfma_f32_16x16x32_bf16 v[28:31], a[40:43], v[48:51], v[28:31]
  v_cvt_pk_bf16_f32 v59, v22, v23
  v_mfma_f32_16x16x32_bf16 v[32:35], a[48:51], v[48:51], v[32:35]
  v_cvt_pk_bf16_f32 v64, v24, v25
  v_mfma_f32_16x16x32_bf16 v[36:39], a[56:59], v[48:51], v[36:39]
  v_cvt_pk_bf16_f32 v65, v26, v27
  ds_read_b128 v[48:51], v4 offset:14336
  s_waitcnt lgkmcnt(3)
  v_mfma_f32_16x16x32_bf16 v[28:31], a[44:47], v[52:55], v[28:31]
  s_add_u32 m0, s77, 0
  v_mfma_f32_16x16x32_bf16 v[32:35], a[52:55], v[52:55], v[32:35]
  buffer_load_dwordx4 v1, s[44:47], s76 offen offset:0 lds
  v_mfma_f32_16x16x32_bf16 v[36:39], a[60:63], v[52:55], v[36:39]
  ds_read_b128 v[52:55], v5 offset:14336
  s_waitcnt lgkmcnt(3)
  v_mfma_f32_16x16x32_bf16 v[28:31], a[64:67], v[40:43], v[28:31]
  v_mfma_f32_16x16x32_bf16 v[32:35], a[72:75], v[40:43], v[32:35]
  s_add_u32 m0, s77, 3968
  v_mfma_f32_16x16x32_bf16 v[36:39], a[80:83], v[40:43], v[36:39]
  buffer_load_dwordx4 v1, s[44:47], s76 offen offset:128 lds
  ds_read_b128 v[40:43], v4 offset:18432
  s_waitcnt lgkmcnt(3)
  v_mfma_f32_16x16x32_bf16 v[28:31], a[68:71], v[44:47], v[28:31]
  v_mfma_f32_16x16x32_bf16 v[32:35], a[76:79], v[44:47], v[32:35]
  v_mfma_f32_16x16x32_bf16 v[36:39], a[84:87], v[44:47], v[36:39]
  s_add_u32 m0, s77, 7936
  ds_read_b128 v[44:47], v5 offset:18432
  s_waitcnt lgkmcnt(3)
  v_mfma_f32_16x16x32_bf16 v[28:31], a[88:91], v[48:51], v[28:31]
  buffer_load_dwordx4 v1, s[44:47], s76 offen offset:256 lds
  v_mfma_f32_16x16x32_bf16 v[32:35], a[96:99], v[48:51], v[32:35]
  v_mfma_f32_16x16x32_bf16 v[36:39], a[104:107], v[48:51], v[36:39]
  ds_read_b128 v[48:51], v4 offset:22528
  s_waitcnt lgkmcnt(3)
  v_mfma_f32_16x16x32_bf16 v[28:31], a[92:95], v[52:55], v[28:31]
  s_add_u32 m0, s77, 11904
  v_mfma_f32_16x16x32_bf16 v[32:35], a[100:103], v[52:55], v[32:35]
  buffer_load_dwordx4 v1, s[44:47], s76 offen offset:384 lds
  v_mfma_f32_16x16x32_bf16 v[36:39], a[108:111], v[52:55], v[36:39]
  ds_read_b128 v[52:55], v5 offset:22528
  s_waitcnt lgkmcnt(3)
  v_mfma_f32_16x16x32_bf16 v[28:31], a[112:115], v[40:43], v[28:31]
  v_mfma_f32_16x16x32_bf16 v[32:35], a[120:123], v[40:43], v[32:35]
  s_add_u32 m0, s77, 15872
  v_mfma_f32_16x16x32_bf16 v[36:39], a[128:131], v[40:43], v[36:39]
  buffer_load_dwordx4 v1, s[44:47], s76 offen offset:512 lds
  ds_read_b128 v[40:43], v4 offset:26624
  s_waitcnt lgkmcnt(3)
  v_mfma_f32_16x16x32_bf16 v[28:31], a[116:119], v[44:47], v[28:31]
  v_mfma_f32_16x16x32_bf16 v[32:35], a[124:127], v[44:47], v[32:35]
  v_mfma_f32_16x16x32_bf16 v[36:39], a[132:135], v[44:47], v[36:39]
  s_add_u32 m0, s77, 19840
  ds_read_b128 v[44:47], v5 offset:26624
  s_waitcnt lgkmcnt(3)
  v_mfma_f32_16x16x32_bf16 v[28:31], a[136:139], v[48:51], v[28:31]
  buffer_load_dwordx4 v1, s[44:47], s76 offen offset:640 lds
  v_mfma_f32_16x16x32_bf16 v[32:35], a[144:147], v[48:51], v[32:35]
  v_mfma_f32_16x16x32_bf16 v[36:39], a[152:155], v[48:51], v[36:39]
  ds_read_b128 v[48:51], v4 offset:30720
  s_waitcnt lgkmcnt(3)
  v_mfma_f32_16x16x32_bf16 v[28:31], a[140:143], v[52:55], v[28:31]
  s_add_u32 m0, s77, 23808
  v_mfma_f32_16x16x32_bf16 v[32:35], a[148:151], v[52:55], v[32:35]
  buffer_load_dwordx4 v1, s[44:47], s76 offen offset:768 lds
  v_mfma_f32_16x16x32_bf16 v[36:39], a[156:159], v[52:55], v[36:39]
  ds_read_b128 v[52:55], v5 offset:30720
  s_waitcnt lgkmcnt(3)
  v_mfma_f32_16x16x32_bf16 v[28:31], a[160:163], v[40:43], v[28:31]
  v_mfma_f32_16x16x32_bf16 v[32:35], a[168:171], v[40:43], v[32:35]
  s_add_u32 m0, s77, 27776
  v_mfma_f32_16x16x32_bf16 v[36:39], a[176:179], v[40:43], v[36:39]
  buffer_load_dwordx4 v1, s[44:47], s76 offen offset:896 lds
  ds_read_b128 v[40:43], v4 offset:34816
  s_waitcnt lgkmcnt(3)
  v_mfma_f32_16x16x32_bf16 v[28:31], a[164:167], v[44:47], v[28:31]
  v_mfma_f32_16x16x32_bf16 v[32:35], a[172:175], v[44:47], v[32:35]
  v_mfma_f32_16x16x32_bf16 v[36:39], a[180:183], v[44:47], v[36:39]
  s_add_u32 m0, s77, 31744
  ds_read_b128 v[44:47], v5 offset:34816
  s_waitcnt lgkmcnt(3)
  v_mfma_f32_16x16x32_bf16 v[28:31], a[184:187], v[48:51], v[28:31]
  buffer_load_dwordx4 v1, s[44:47], s76 offen offset:1024 lds
  v_mfma_f32_16x16x32_bf16 v[32:35], a[192:195], v[48:51], v[32:35]
  v_mfma_f32_16x16x32_bf16 v[36:39], a[200:203], v[48:51], v[36:39]
  ds_read_b128 v[48:51], v4 offset:38912
  s_waitcnt lgkmcnt(3)
  v_mfma_f32_16x16x32_bf16 v[28:31], a[188:191], v[52:55], v[28:31]
  s_add_u32 m0, s77, 35712
  v_mfma_f32_16x16x32_bf16 v[32:35], a[196:199], v[52:55], v[32:35]
  buffer_load_dwordx4 v1, s[44:47], s76 offen offset:1152 lds
  v_mfma_f32_16x16x32_bf16 v[36:39], a[204:207], v[52:55], v[36:39]
  ds_read_b128 v[52:55], v5 offset:38912
  s_waitcnt lgkmcnt(3)
  v_mfma_f32_16x16x32_bf16 v[28:31], a[208:211], v[40:43], v[28:31]
  v_add_u32 v4, s78, v2
  v_mfma_f32_16x16x32_bf16 v[32:35], a[216:219], v[40:43], v[32:35]
  v_add_u32 v5, s78, v3
  v_mfma_f32_16x16x32_bf16 v[36:39], a[224:227], v[40:43], v[36:39]
  ds_read_b128 v[40:43], v4 offset:0
  s_waitcnt lgkmcnt(3)
  v_mfma_f32_16x16x32_bf16 v[28:31], a[212:215], v[44:47], v[28:31]
  v_mfma_f32_16x16x32_bf16 v[32:35], a[220:223], v[44:47], v[32:35]
  v_mfma_f32_16x16x32_bf16 v[36:39], a[228:231], v[44:47], v[36:39]
  ds_read_b128 v[44:47], v5 offset:0
  s_waitcnt lgkmcnt(3)
  v_mfma_f32_16x16x32_bf16 v[28:31], a[232:235], v[48:51], v[28:31]
  v_mfma_f32_16x16x32_bf16 v[32:35], a[240:243], v[48:51], v[32:35]
  v_mfma_f32_16x16x32_bf16 v[36:39], a[248:251], v[48:51], v[36:39]
  ds_read_b128 v[48:51], v4 offset:4096
  s_waitcnt lgkmcnt(3)
  v_mfma_f32_16x16x32_bf16 v[28:31], a[236:239], v[52:55], v[28:31]
  v_mfma_f32_16x16x32_bf16 v[32:35], a[244:247], v[52:55], v[32:35]
  v_mfma_f32_16x16x32_bf16 v[36:39], a[252:255], v[52:55], v[36:39]
  s_add_u32 s52, s52, 1
  s_sub_u32 s53, s52, 2
  s_cmp_lt_u32 s53, 62
  s_cbranch_scc1 KV_SEG
  s_nop 7
  v_cvt_pk_bf16_f32 v60, v28, v29
  v_cvt_pk_bf16_f32 v61, v30, v31
  v_cvt_pk_bf16_f32 v62, v32, v33
  v_cvt_pk_bf16_f32 v63, v34, v35
  v_cvt_pk_bf16_f32 v66, v36, v37
  v_cvt_pk_bf16_f32 v67, v38, v39
  buffer_store_dwordx4 v[56:59], v6, s[32:35], s79 offen sc1
  buffer_store_dwordx4 v[60:63], v6, s[32:35], s79 offen offset:1024 sc1
  buffer_store_dwordx4 v[64:67], v6, s[32:35], s79 offen offset:2048 sc1
  v_mov_b32 v8, s52
  s_waitcnt lgkmcnt(0)
  s_waitcnt vmcnt(0)
  s_barrier
  buffer_store_dword v8, v7, s[32:35], 0 offen sc1
  s_cmp_lt_u32 s52, 64
  s_cbranch_scc1 KV_SEG
  s_branch R_PA
R_PA:
  s_getpc_b64 s[60:61]
PA_PC:
  s_lshl_b32 s53, s49, 6
  v_add_u32 v40, s53, v0
  v_lshlrev_b32 v40, 7, v40
  v_min_u32 v40, PA_END-PA_PC-4, v40
  v_mov_b32 v41, s61
  v_add_co_u32 v40, vcc, s60, v40
  s_nop 1
  v_addc_co_u32 v41, vcc, 0, v41, vcc
  global_load_dword a255, v[40:41], off
  s_lshl_b32 s62, s80, 5
  s_add_u32 s62, s62, s48
  s_and_b32 s63, s62, 7
  s_lshr_b32 s64, s62, 3
  s_lshl_b32 s71, s63, 2
  s_add_u32 s71, s71, s49
  s_mov_b32 s44, s4
  s_and_b32 s45, s5, 0xffff
  s_mov_b32 s46, 0x280000
  s_mov_b32 s47, 0x20000
  s_mov_b32 s36, s6
  s_and_b32 s37, s7, 0xffff
  s_mov_b32 s38, 0x258000
  s_mov_b32 s39, 0x20000
  s_mov_b32 s40, s8
  s_and_b32 s41, s9, 0xffff
  s_mov_b32 s42, 0x6400
  s_mov_b32 s43, 0x20000
  s_mul_i32 s65, s64, 327680
  s_lshl_b32 s66, s49, 10
  s_add_u32 m0, s66, 0
  s_nop 0
  buffer_load_dwordx4 v1, s[44:47], s65 offen offset:0 lds
  s_add_u32 m0, s66, 3968
  s_nop 0
  buffer_load_dwordx4 v1, s[44:47], s65 offen offset:128 lds
  s_add_u32 m0, s66, 7936
  s_nop 0
  buffer_load_dwordx4 v1, s[44:47], s65 offen offset:256 lds
  s_add_u32 m0, s66, 11904
  s_nop 0
  buffer_load_dwordx4 v1, s[44:47], s65 offen offset:384 lds
  s_add_u32 m0, s66, 15872
  s_nop 0
  buffer_load_dwordx4 v1, s[44:47], s65 offen offset:512 lds
  s_add_u32 m0, s66, 19840
  s_nop 0
  buffer_load_dwordx4 v1, s[44:47], s65 offen offset:640 lds
  s_add_u32 m0, s66, 23808
  s_nop 0
  buffer_load_dwordx4 v1, s[44:47], s65 offen offset:768 lds
  s_add_u32 m0, s66, 27776
  s_nop 0
  buffer_load_dwordx4 v1, s[44:47], s65 offen offset:896 lds
  s_add_u32 m0, s66, 31744
  s_nop 0
  buffer_load_dwordx4 v1, s[44:47], s65 offen offset:1024 lds
  s_add_u32 m0, s66, 35712
  s_nop 0
  buffer_load_dwordx4 v1, s[44:47], s65 offen offset:1152 lds
  v_lshrrev_b32 v40, 4, v0
  v_and_b32 v41, 15, v0
  s_mul_i32 s54, s71, 800
  v_mov_b32 v46, 0x40000000
  v_lshlrev_b32 v42, 1, v41
  v_lshrrev_b32 v43, 2, v41
  v_lshl_add_u32 v43, v43, 1, 32
  v_and_b32 v44, 3, v41
  v_cmp_eq_u32 vcc, 0, v44
  s_nop 1
  v_cndmask_b32 v43, v46, v43, vcc
  v_mul_u32_u24 v44, 160, v40
  v_add_u32 v45, v44, v42
  buffer_load_ushort v88, v45, s[40:43], s54 offen offset:0
  buffer_load_ushort v89, v45, s[40:43], s54 offen offset:40
  buffer_load_ushort v90, v45, s[40:43], s54 offen offset:80
  buffer_load_ushort v91, v45, s[40:43], s54 offen offset:120
  v_cmp_eq_u32 vcc, 1, v40
  s_nop 1
  v_cndmask_b32 v45, v46, v42, vcc
  buffer_load_ushort v84, v45, s[40:43], s54 offen offset:640
  buffer_load_ushort v85, v45, s[40:43], s54 offen offset:680
  buffer_load_ushort v86, v45, s[40:43], s54 offen offset:720
  buffer_load_ushort v87, v45, s[40:43], s54 offen offset:760
  v_cmp_eq_u32 vcc, 0, v40
  s_nop 1
  v_cndmask_b32 v45, v46, v42, vcc
  buffer_load_ushort v92, v45, s[40:43], s54 offen offset:640
  buffer_load_ushort v93, v45, s[40:43], s54 offen offset:680
  buffer_load_ushort v94, v45, s[40:43], s54 offen offset:720
  buffer_load_ushort v95, v45, s[40:43], s54 offen offset:760
  v_add_u32 v45, v44, v43
  buffer_load_ushort v100, v45, s[40:43], s54 offen offset:0
  buffer_load_ushort v101, v45, s[40:43], s54 offen offset:40
  buffer_load_ushort v102, v45, s[40:43], s54 offen offset:80
  buffer_load_ushort v103, v45, s[40:43], s54 offen offset:120
  v_cmp_eq_u32 vcc, 1, v40
  s_nop 1
  v_cndmask_b32 v45, v46, v43, vcc
  buffer_load_ushort v96, v45, s[40:43], s54 offen offset:640
  buffer_load_ushort v97, v45, s[40:43], s54 offen offset:680
  buffer_load_ushort v98, v45, s[40:43], s54 offen offset:720
  buffer_load_ushort v99, v45, s[40:43], s54 offen offset:760
  v_cmp_eq_u32 vcc, 0, v40
  s_nop 1
  v_cndmask_b32 v45, v46, v43, vcc
  buffer_load_ushort v104, v45, s[40:43], s54 offen offset:640
  buffer_load_ushort v105, v45, s[40:43], s54 offen offset:680
  buffer_load_ushort v106, v45, s[40:43], s54 offen offset:720
  buffer_load_ushort v107, v45, s[40:43], s54 offen offset:760
  v_lshrrev_b32 v44, 5, v0
  s_lshl_b32 s53, s49, 3
  s_add_u32 s53, s53, 0
  v_add_u32 v44, s53, v44
  v_and_b32 v45, 3, v44
  v_bfe_u32 v47, v44, 3, 1
  v_lshl_add_u32 v45, v47, 2, v45
  v_lshlrev_b32 v45, 1, v45
  v_sub_u32 v45, v0, v45
  v_and_b32 v45, 31, v45
  v_min_u32 v45, 29, v45
  v_mul_u32_u24 v47, 26, v45
  v_lshrrev_b32 v47, 8, v47
  v_mul_u32_u24 v47, 1120, v47
  v_lshl_add_u32 v45, v45, 4, v47
  v_mul_u32_u24 v44, 3840, v44
  s_mul_i32 s53, s63, 160
  v_add3_u32 v112, v44, v45, s53
  v_lshrrev_b32 v44, 5, v0
  s_lshl_b32 s53, s49, 3
  s_add_u32 s53, s53, 2
  v_add_u32 v44, s53, v44
  v_and_b32 v45, 3, v44
  v_bfe_u32 v47, v44, 3, 1
  v_lshl_add_u32 v45, v47, 2, v45
  v_lshlrev_b32 v45, 1, v45
  v_sub_u32 v45, v0, v45
  v_and_b32 v45, 31, v45
  v_min_u32 v45, 29, v45
  v_mul_u32_u24 v47, 26, v45
  v_lshrrev_b32 v47, 8, v47
  v_mul_u32_u24 v47, 1120, v47
  v_lshl_add_u32 v45, v45, 4, v47
  v_mul_u32_u24 v44, 3840, v44
  s_mul_i32 s53, s63, 160
  v_add3_u32 v113, v44, v45, s53
  v_lshrrev_b32 v44, 5, v0
  s_lshl_b32 s53, s49, 3
  s_add_u32 s53, s53, 4
  v_add_u32 v44, s53, v44
  v_and_b32 v45, 3, v44
  v_bfe_u32 v47, v44, 3, 1
  v_lshl_add_u32 v45, v47, 2, v45
  v_lshlrev_b32 v45, 1, v45
  v_sub_u32 v45, v0, v45
  v_and_b32 v45, 31, v45
  v_min_u32 v45, 29, v45
  v_mul_u32_u24 v47, 26, v45
  v_lshrrev_b32 v47, 8, v47
  v_mul_u32_u24 v47, 1120, v47
  v_lshl_add_u32 v45, v45, 4, v47
  v_mul_u32_u24 v44, 3840, v44
  s_mul_i32 s53, s63, 160
  v_add3_u32 v114, v44, v45, s53
  v_lshrrev_b32 v44, 5, v0
  s_lshl_b32 s53, s49, 3
  s_add_u32 s53, s53, 6
  v_add_u32 v44, s53, v44
  v_and_b32 v45, 3, v44
  v_bfe_u32 v47, v44, 3, 1
  v_lshl_add_u32 v45, v47, 2, v45
  v_lshlrev_b32 v45, 1, v45
  v_sub_u32 v45, v0, v45
  v_and_b32 v45, 31, v45
  v_min_u32 v45, 29, v45
  v_mul_u32_u24 v47, 26, v45
  v_lshrrev_b32 v47, 8, v47
  v_mul_u32_u24 v47, 1120, v47
  v_lshl_add_u32 v45, v45, 4, v47
  v_mul_u32_u24 v44, 3840, v44
  s_mul_i32 s53, s63, 160
  v_add3_u32 v115, v44, v45, s53
  v_bfe_u32 v44, v0, 2, 2
  v_and_b32 v45, 1, v40
  v_lshl_add_u32 v45, v45, 2, v44
  v_lshl_add_u32 v44, v40, 3, v44
  v_lshlrev_b32 v44, 9, v44
  s_mul_i32 s53, s49, 40
  v_lshl_add_u32 v45, v45, 5, s53
  v_and_b32 v47, 3, v0
  v_lshl_add_u32 v46, v47, 3, v45
  v_add_u32 v46, 0, v46
  v_and_b32 v46, 511, v46
  v_add_u32 v116, v44, v46
  v_lshl_add_u32 v46, v47, 3, v45
  v_add_u32 v46, 160, v46
  v_and_b32 v46, 511, v46
  v_add_u32 v117, v44, v46
  v_lshl_add_u32 v46, v47, 3, v45
  v_add_u32 v46, 320, v46
  v_and_b32 v46, 511, v46
  v_add_u32 v118, v44, v46
  v_min_u32 v46, 2, v47
  v_mul_u32_u24 v46, 160, v46
  v_add3_u32 v46, v46, v45, 32
  v_and_b32 v46, 511, v46
  v_add_u32 v119, v44, v46
  s_waitcnt vmcnt(0)
  v_lshl_or_b32 v56, v85, 16, v84
  v_lshl_or_b32 v57, v87, 16, v86
  v_lshl_or_b32 v58, v89, 16, v88
  v_lshl_or_b32 v59, v91, 16, v90
  v_lshl_or_b32 v60, v93, 16, v92
  v_lshl_or_b32 v61, v95, 16, v94
  v_lshl_or_b32 v62, v97, 16, v96
  v_lshl_or_b32 v63, v99, 16, v98
  v_lshl_or_b32 v64, v101, 16, v100
  v_lshl_or_b32 v65, v103, 16, v102
  v_lshl_or_b32 v66, v105, 16, v104
  v_lshl_or_b32 v67, v107, 16, v106
  s_mov_b32 s54, 0
  s_mul_i32 s53, s49, 4096
  s_add_u32 m0, s53, 40960
  s_nop 0
  buffer_load_dwordx4 v112, s[36:39], s54 offen  lds
  s_add_u32 m0, m0, 1024
  s_nop 0
  buffer_load_dwordx4 v113, s[36:39], s54 offen  lds
  s_add_u32 m0, m0, 1024
  s_nop 0
  buffer_load_dwordx4 v114, s[36:39], s54 offen  lds
  s_add_u32 m0, m0, 1024
  s_nop 0
  buffer_load_dwordx4 v115, s[36:39], s54 offen  lds
  s_mov_b32 s54, 122880
  s_mul_i32 s53, s49, 4096
  s_add_u32 m0, s53, 57344
  s_nop 0
  buffer_load_dwordx4 v112, s[36:39], s54 offen  lds
  s_add_u32 m0, m0, 1024
  s_nop 0
  buffer_load_dwordx4 v113, s[36:39], s54 offen  lds
  s_add_u32 m0, m0, 1024
  s_nop 0
  buffer_load_dwordx4 v114, s[36:39], s54 offen  lds
  s_add_u32 m0, m0, 1024
  s_nop 0
  buffer_load_dwordx4 v115, s[36:39], s54 offen  lds
  s_mov_b32 s54, 245760
  s_mul_i32 s53, s49, 4096
  s_add_u32 m0, s53, 73728
  s_nop 0
  buffer_load_dwordx4 v112, s[36:39], s54 offen  lds
  s_add_u32 m0, m0, 1024
  s_nop 0
  buffer_load_dwordx4 v113, s[36:39], s54 offen  lds
  s_add_u32 m0, m0, 1024
  s_nop 0
  buffer_load_dwordx4 v114, s[36:39], s54 offen  lds
  s_add_u32 m0, m0, 1024
  s_nop 0
  buffer_load_dwordx4 v115, s[36:39], s54 offen  lds
  s_mov_b32 s54, 368640
  s_mul_i32 s53, s49, 4096
  s_add_u32 m0, s53, 90112
  s_nop 0
  buffer_load_dwordx4 v112, s[36:39], s54 offen  lds
  s_add_u32 m0, m0, 1024
  s_nop 0
  buffer_load_dwordx4 v113, s[36:39], s54 offen  lds
  s_add_u32 m0, m0, 1024
  s_nop 0
  buffer_load_dwordx4 v114, s[36:39], s54 offen  lds
  s_add_u32 m0, m0, 1024
  s_nop 0
  buffer_load_dwordx4 v115, s[36:39], s54 offen  lds
  s_mov_b32 s54, 491520
  s_mul_i32 s53, s49, 4096
  s_add_u32 m0, s53, 106496
  s_nop 0
  buffer_load_dwordx4 v112, s[36:39], s54 offen  lds
  s_add_u32 m0, m0, 1024
  s_nop 0
  buffer_load_dwordx4 v113, s[36:39], s54 offen  lds
  s_add_u32 m0, m0, 1024
  s_nop 0
  buffer_load_dwordx4 v114, s[36:39], s54 offen  lds
  s_add_u32 m0, m0, 1024
  s_nop 0
  buffer_load_dwordx4 v115, s[36:39], s54 offen  lds
  s_mov_b32 s54, 614400
  s_mul_i32 s53, s49, 4096
  s_add_u32 m0, s53, 122880
  s_nop 0
  buffer_load_dwordx4 v112, s[36:39], s54 offen  lds
  s_add_u32 m0, m0, 1024
  s_nop 0
  buffer_load_dwordx4 v113, s[36:39], s54 offen  lds
  s_add_u32 m0, m0, 1024
  s_nop 0
  buffer_load_dwordx4 v114, s[36:39], s54 offen  lds
  s_add_u32 m0, m0, 1024
  s_nop 0
  buffer_load_dwordx4 v115, s[36:39], s54 offen  lds
  s_mov_b32 s54, 737280
  s_mul_i32 s53, s49, 4096
  s_add_u32 m0, s53, 139264
  s_nop 0
  buffer_load_dwordx4 v112, s[36:39], s54 offen  lds
  s_add_u32 m0, m0, 1024
  s_nop 0
  buffer_load_dwordx4 v113, s[36:39], s54 offen  lds
  s_add_u32 m0, m0, 1024
  s_nop 0
  buffer_load_dwordx4 v114, s[36:39], s54 offen  lds
  s_add_u32 m0, m0, 1024
  s_nop 0
  buffer_load_dwordx4 v115, s[36:39], s54 offen  lds
  s_waitcnt vmcnt(24)
  s_barrier
  v_add_u32 v120, 0xa000, v116
  v_add_u32 v121, 0xa000, v117
  v_add_u32 v122, 0xa000, v118
  v_add_u32 v123, 0xa000, v119
  ds_read_b64_tr_b16 v[192:193], v120 offset:0
  ds_read_b64_tr_b16 v[194:195], v120 offset:2048
  ds_read_b64_tr_b16 v[196:197], v121 offset:0
  ds_read_b64_tr_b16 v[198:199], v121 offset:2048
  ds_read_b64_tr_b16 v[200:201], v122 offset:0
  ds_read_b64_tr_b16 v[202:203], v122 offset:2048
  ds_read_b64_tr_b16 v[204:205], v123 offset:0
  ds_read_b64_tr_b16 v[206:207], v123 offset:2048
  s_waitcnt lgkmcnt(0)
  s_barrier
  s_mov_b32 s54, 860160
  s_mul_i32 s53, s49, 4096
  s_add_u32 m0, s53, 40960
  s_nop 0
  buffer_load_dwordx4 v112, s[36:39], s54 offen  lds
  s_add_u32 m0, m0, 1024
  s_nop 0
  buffer_load_dwordx4 v113, s[36:39], s54 offen  lds
  s_add_u32 m0, m0, 1024
  s_nop 0
  buffer_load_dwordx4 v114, s[36:39], s54 offen  lds
  s_add_u32 m0, m0, 1024
  s_nop 0
  buffer_load_dwordx4 v115, s[36:39], s54 offen  lds
  s_waitcnt vmcnt(24)
  s_barrier
  v_add_u32 v120, 0xe000, v116
  v_add_u32 v121, 0xe000, v117
  v_add_u32 v122, 0xe000, v118
  v_add_u32 v123, 0xe000, v119
  ds_read_b64_tr_b16 v[208:209], v120 offset:0
  ds_read_b64_tr_b16 v[210:211], v120 offset:2048
  ds_read_b64_tr_b16 v[212:213], v121 offset:0
  ds_read_b64_tr_b16 v[214:215], v121 offset:2048
  ds_read_b64_tr_b16 v[216:217], v122 offset:0
  ds_read_b64_tr_b16 v[218:219], v122 offset:2048
  ds_read_b64_tr_b16 v[220:221], v123 offset:0
  ds_read_b64_tr_b16 v[222:223], v123 offset:2048
  s_waitcnt lgkmcnt(0)
  s_barrier
  s_mov_b32 s54, 983040
  s_mul_i32 s53, s49, 4096
  s_add_u32 m0, s53, 57344
  s_nop 0
  buffer_load_dwordx4 v112, s[36:39], s54 offen  lds
  s_add_u32 m0, m0, 1024
  s_nop 0
  buffer_load_dwordx4 v113, s[36:39], s54 offen  lds
  s_add_u32 m0, m0, 1024
  s_nop 0
  buffer_load_dwordx4 v114, s[36:39], s54 offen  lds
  s_add_u32 m0, m0, 1024
  s_nop 0
  buffer_load_dwordx4 v115, s[36:39], s54 offen  lds
  s_waitcnt vmcnt(24)
  s_barrier
  v_add_u32 v120, 0x12000, v116
  v_add_u32 v121, 0x12000, v117
  v_add_u32 v122, 0x12000, v118
  v_add_u32 v123, 0x12000, v119
  ds_read_b64_tr_b16 v[224:225], v120 offset:0
  ds_read_b64_tr_b16 v[226:227], v120 offset:2048
  ds_read_b64_tr_b16 v[228:229], v121 offset:0
  ds_read_b64_tr_b16 v[230:231], v121 offset:2048
  ds_read_b64_tr_b16 v[232:233], v122 offset:0
  ds_read_b64_tr_b16 v[234:235], v122 offset:2048
  ds_read_b64_tr_b16 v[236:237], v123 offset:0
  ds_read_b64_tr_b16 v[238:239], v123 offset:2048
  s_waitcnt lgkmcnt(0)
  s_barrier
  s_mov_b32 s54, 1105920
  s_mul_i32 s53, s49, 4096
  s_add_u32 m0, s53, 73728
  s_nop 0
  buffer_load_dwordx4 v112, s[36:39], s54 offen  lds
  s_add_u32 m0, m0, 1024
  s_nop 0
  buffer_load_dwordx4 v113, s[36:39], s54 offen  lds
  s_add_u32 m0, m0, 1024
  s_nop 0
  buffer_load_dwordx4 v114, s[36:39], s54 offen  lds
  s_add_u32 m0, m0, 1024
  s_nop 0
  buffer_load_dwordx4 v115, s[36:39], s54 offen  lds
  s_waitcnt vmcnt(24)
  s_barrier
  v_add_u32 v120, 0x16000, v116
  v_add_u32 v121, 0x16000, v117
  v_add_u32 v122, 0x16000, v118
  v_add_u32 v123, 0x16000, v119
  ds_read_b64_tr_b16 v[240:241], v120 offset:0
  ds_read_b64_tr_b16 v[242:243], v120 offset:2048
  ds_read_b64_tr_b16 v[244:245], v121 offset:0
  ds_read_b64_tr_b16 v[246:247], v121 offset:2048
  ds_read_b64_tr_b16 v[248:249], v122 offset:0
  ds_read_b64_tr_b16 v[250:251], v122 offset:2048
  ds_read_b64_tr_b16 v[252:253], v123 offset:0
  ds_read_b64_tr_b16 v[254:255], v123 offset:2048
  s_waitcnt lgkmcnt(0)
  s_barrier
  s_mov_b32 s54, 1228800
  s_mul_i32 s53, s49, 4096
  s_add_u32 m0, s53, 90112
  s_nop 0
  buffer_load_dwordx4 v112, s[36:39], s54 offen  lds
  s_add_u32 m0, m0, 1024
  s_nop 0
  buffer_load_dwordx4 v113, s[36:39], s54 offen  lds
  s_add_u32 m0, m0, 1024
  s_nop 0
  buffer_load_dwordx4 v114, s[36:39], s54 offen  lds
  s_add_u32 m0, m0, 1024
  s_nop 0
  buffer_load_dwordx4 v115, s[36:39], s54 offen  lds
  s_waitcnt vmcnt(24)
  s_barrier
  v_add_u32 v120, 0x1a000, v116
  v_add_u32 v121, 0x1a000, v117
  v_add_u32 v122, 0x1a000, v118
  v_add_u32 v123, 0x1a000, v119
  ds_read_b64_tr_b16 a[0:1], v120 offset:0
  ds_read_b64_tr_b16 a[2:3], v120 offset:2048
  ds_read_b64_tr_b16 a[4:5], v121 offset:0
  ds_read_b64_tr_b16 a[6:7], v121 offset:2048
  ds_read_b64_tr_b16 a[8:9], v122 offset:0
  ds_read_b64_tr_b16 a[10:11], v122 offset:2048
  ds_read_b64_tr_b16 a[12:13], v123 offset:0
  ds_read_b64_tr_b16 a[14:15], v123 offset:2048
  s_waitcnt lgkmcnt(0)
  s_barrier
  s_mov_b32 s54, 1351680
  s_mul_i32 s53, s49, 4096
  s_add_u32 m0, s53, 106496
  s_nop 0
  buffer_load_dwordx4 v112, s[36:39], s54 offen  lds
  s_add_u32 m0, m0, 1024
  s_nop 0
  buffer_load_dwordx4 v113, s[36:39], s54 offen  lds
  s_add_u32 m0, m0, 1024
  s_nop 0
  buffer_load_dwordx4 v114, s[36:39], s54 offen  lds
  s_add_u32 m0, m0, 1024
  s_nop 0
  buffer_load_dwordx4 v115, s[36:39], s54 offen  lds
  s_waitcnt vmcnt(24)
  s_barrier
  v_add_u32 v120, 0x1e000, v116
  v_add_u32 v121, 0x1e000, v117
  v_add_u32 v122, 0x1e000, v118
  v_add_u32 v123, 0x1e000, v119
  ds_read_b64_tr_b16 a[16:17], v120 offset:0
  ds_read_b64_tr_b16 a[18:19], v120 offset:2048
  ds_read_b64_tr_b16 a[20:21], v121 offset:0
  ds_read_b64_tr_b16 a[22:23], v121 offset:2048
  ds_read_b64_tr_b16 a[24:25], v122 offset:0
  ds_read_b64_tr_b16 a[26:27], v122 offset:2048
  ds_read_b64_tr_b16 a[28:29], v123 offset:0
  ds_read_b64_tr_b16 a[30:31], v123 offset:2048
  s_waitcnt lgkmcnt(0)
  s_barrier
  s_mov_b32 s54, 1474560
  s_mul_i32 s53, s49, 4096
  s_add_u32 m0, s53, 122880
  s_nop 0
  buffer_load_dwordx4 v112, s[36:39], s54 offen  lds
  s_add_u32 m0, m0, 1024
  s_nop 0
  buffer_load_dwordx4 v113, s[36:39], s54 offen  lds
  s_add_u32 m0, m0, 1024
  s_nop 0
  buffer_load_dwordx4 v114, s[36:39], s54 offen  lds
  s_add_u32 m0, m0, 1024
  s_nop 0
  buffer_load_dwordx4 v115, s[36:39], s54 offen  lds
  s_waitcnt vmcnt(24)
  s_barrier
  v_add_u32 v120, 0x22000, v116
  v_add_u32 v121, 0x22000, v117
  v_add_u32 v122, 0x22000, v118
  v_add_u32 v123, 0x22000, v119
  ds_read_b64_tr_b16 a[32:33], v120 offset:0
  ds_read_b64_tr_b16 a[34:35], v120 offset:2048
  ds_read_b64_tr_b16 a[36:37], v121 offset:0
  ds_read_b64_tr_b16 a[38:39], v121 offset:2048
  ds_read_b64_tr_b16 a[40:41], v122 offset:0
  ds_read_b64_tr_b16 a[42:43], v122 offset:2048
  ds_read_b64_tr_b16 a[44:45], v123 offset:0
  ds_read_b64_tr_b16 a[46:47], v123 offset:2048
  s_waitcnt lgkmcnt(0)
  s_barrier
  s_mov_b32 s54, 1597440
  s_mul_i32 s53, s49, 4096
  s_add_u32 m0, s53, 139264
  s_nop 0
  buffer_load_dwordx4 v112, s[36:39], s54 offen  lds
  s_add_u32 m0, m0, 1024
  s_nop 0
  buffer_load_dwordx4 v113, s[36:39], s54 offen  lds
  s_add_u32 m0, m0, 1024
  s_nop 0
  buffer_load_dwordx4 v114, s[36:39], s54 offen  lds
  s_add_u32 m0, m0, 1024
  s_nop 0
  buffer_load_dwordx4 v115, s[36:39], s54 offen  lds
  s_waitcnt vmcnt(24)
  s_barrier
  v_add_u32 v120, 0xa000, v116
  v_add_u32 v121, 0xa000, v117
  v_add_u32 v122, 0xa000, v118
  v_add_u32 v123, 0xa000, v119
  ds_read_b64_tr_b16 a[48:49], v120 offset:0
  ds_read_b64_tr_b16 a[50:51], v120 offset:2048
  ds_read_b64_tr_b16 a[52:53], v121 offset:0
  ds_read_b64_tr_b16 a[54:55], v121 offset:2048
  ds_read_b64_tr_b16 a[56:57], v122 offset:0
  ds_read_b64_tr_b16 a[58:59], v122 offset:2048
  ds_read_b64_tr_b16 a[60:61], v123 offset:0
  ds_read_b64_tr_b16 a[62:63], v123 offset:2048
  s_waitcnt lgkmcnt(0)
  s_barrier
  s_mov_b32 s54, 1720320
  s_mul_i32 s53, s49, 4096
  s_add_u32 m0, s53, 40960
  s_nop 0
  buffer_load_dwordx4 v112, s[36:39], s54 offen  lds
  s_add_u32 m0, m0, 1024
  s_nop 0
  buffer_load_dwordx4 v113, s[36:39], s54 offen  lds
  s_add_u32 m0, m0, 1024
  s_nop 0
  buffer_load_dwordx4 v114, s[36:39], s54 offen  lds
  s_add_u32 m0, m0, 1024
  s_nop 0
  buffer_load_dwordx4 v115, s[36:39], s54 offen  lds
  s_waitcnt vmcnt(24)
  s_barrier
  v_add_u32 v120, 0xe000, v116
  v_add_u32 v121, 0xe000, v117
  v_add_u32 v122, 0xe000, v118
  v_add_u32 v123, 0xe000, v119
  ds_read_b64_tr_b16 a[64:65], v120 offset:0
  ds_read_b64_tr_b16 a[66:67], v120 offset:2048
  ds_read_b64_tr_b16 a[68:69], v121 offset:0
  ds_read_b64_tr_b16 a[70:71], v121 offset:2048
  ds_read_b64_tr_b16 a[72:73], v122 offset:0
  ds_read_b64_tr_b16 a[74:75], v122 offset:2048
  ds_read_b64_tr_b16 a[76:77], v123 offset:0
  ds_read_b64_tr_b16 a[78:79], v123 offset:2048
  s_waitcnt lgkmcnt(0)
  s_barrier
  s_mov_b32 s54, 1843200
  s_mul_i32 s53, s49, 4096
  s_add_u32 m0, s53, 57344
  s_nop 0
  buffer_load_dwordx4 v112, s[36:39], s54 offen  lds
  s_add_u32 m0, m0, 1024
  s_nop 0
  buffer_load_dwordx4 v113, s[36:39], s54 offen  lds
  s_add_u32 m0, m0, 1024
  s_nop 0
  buffer_load_dwordx4 v114, s[36:39], s54 offen  lds
  s_add_u32 m0, m0, 1024
  s_nop 0
  buffer_load_dwordx4 v115, s[36:39], s54 offen  lds
  s_waitcnt vmcnt(24)
  s_barrier
  v_add_u32 v120, 0x12000, v116
  v_add_u32 v121, 0x12000, v117
  v_add_u32 v122, 0x12000, v118
  v_add_u32 v123, 0x12000, v119
  ds_read_b64_tr_b16 a[80:81], v120 offset:0
  ds_read_b64_tr_b16 a[82:83], v120 offset:2048
  ds_read_b64_tr_b16 a[84:85], v121 offset:0
  ds_read_b64_tr_b16 a[86:87], v121 offset:2048
  ds_read_b64_tr_b16 a[88:89], v122 offset:0
  ds_read_b64_tr_b16 a[90:91], v122 offset:2048
  ds_read_b64_tr_b16 a[92:93], v123 offset:0
  ds_read_b64_tr_b16 a[94:95], v123 offset:2048
  s_waitcnt lgkmcnt(0)
  s_barrier
  s_mov_b32 s54, 1966080
  s_mul_i32 s53, s49, 4096
  s_add_u32 m0, s53, 73728
  s_nop 0
  buffer_load_dwordx4 v112, s[36:39], s54 offen  lds
  s_add_u32 m0, m0, 1024
  s_nop 0
  buffer_load_dwordx4 v113, s[36:39], s54 offen  lds
  s_add_u32 m0, m0, 1024
  s_nop 0
  buffer_load_dwordx4 v114, s[36:39], s54 offen  lds
  s_add_u32 m0, m0, 1024
  s_nop 0
  buffer_load_dwordx4 v115, s[36:39], s54 offen  lds
  s_waitcnt vmcnt(24)
  s_barrier
  v_add_u32 v120, 0x16000, v116
  v_add_u32 v121, 0x16000, v117
  v_add_u32 v122, 0x16000, v118
  v_add_u32 v123, 0x16000, v119
  ds_read_b64_tr_b16 a[96:97], v120 offset:0
  ds_read_b64_tr_b16 a[98:99], v120 offset:2048
  ds_read_b64_tr_b16 a[100:101], v121 offset:0
  ds_read_b64_tr_b16 a[102:103], v121 offset:2048
  ds_read_b64_tr_b16 a[104:105], v122 offset:0
  ds_read_b64_tr_b16 a[106:107], v122 offset:2048
  ds_read_b64_tr_b16 a[108:109], v123 offset:0
  ds_read_b64_tr_b16 a[110:111], v123 offset:2048
  s_waitcnt lgkmcnt(0)
  s_barrier
  s_mov_b32 s54, 2088960
  s_mul_i32 s53, s49, 4096
  s_add_u32 m0, s53, 90112
  s_nop 0
  buffer_load_dwordx4 v112, s[36:39], s54 offen  lds
  s_add_u32 m0, m0, 1024
  s_nop 0
  buffer_load_dwordx4 v113, s[36:39], s54 offen  lds
  s_add_u32 m0, m0, 1024
  s_nop 0
  buffer_load_dwordx4 v114, s[36:39], s54 offen  lds
  s_add_u32 m0, m0, 1024
  s_nop 0
  buffer_load_dwordx4 v115, s[36:39], s54 offen  lds
  s_waitcnt vmcnt(24)
  s_barrier
  v_add_u32 v120, 0x1a000, v116
  v_add_u32 v121, 0x1a000, v117
  v_add_u32 v122, 0x1a000, v118
  v_add_u32 v123, 0x1a000, v119
  ds_read_b64_tr_b16 a[112:113], v120 offset:0
  ds_read_b64_tr_b16 a[114:115], v120 offset:2048
  ds_read_b64_tr_b16 a[116:117], v121 offset:0
  ds_read_b64_tr_b16 a[118:119], v121 offset:2048
  ds_read_b64_tr_b16 a[120:121], v122 offset:0
  ds_read_b64_tr_b16 a[122:123], v122 offset:2048
  ds_read_b64_tr_b16 a[124:125], v123 offset:0
  ds_read_b64_tr_b16 a[126:127], v123 offset:2048
  s_waitcnt lgkmcnt(0)
  s_barrier
  s_mov_b32 s54, 2211840
  s_mul_i32 s53, s49, 4096
  s_add_u32 m0, s53, 106496
  s_nop 0
  buffer_load_dwordx4 v112, s[36:39], s54 offen  lds
  s_add_u32 m0, m0, 1024
  s_nop 0
  buffer_load_dwordx4 v113, s[36:39], s54 offen  lds
  s_add_u32 m0, m0, 1024
  s_nop 0
  buffer_load_dwordx4 v114, s[36:39], s54 offen  lds
  s_add_u32 m0, m0, 1024
  s_nop 0
  buffer_load_dwordx4 v115, s[36:39], s54 offen  lds
  s_waitcnt vmcnt(24)
  s_barrier
  v_add_u32 v120, 0x1e000, v116
  v_add_u32 v121, 0x1e000, v117
  v_add_u32 v122, 0x1e000, v118
  v_add_u32 v123, 0x1e000, v119
  ds_read_b64_tr_b16 a[128:129], v120 offset:0
  ds_read_b64_tr_b16 a[130:131], v120 offset:2048
  ds_read_b64_tr_b16 a[132:133], v121 offset:0
  ds_read_b64_tr_b16 a[134:135], v121 offset:2048
  ds_read_b64_tr_b16 a[136:137], v122 offset:0
  ds_read_b64_tr_b16 a[138:139], v122 offset:2048
  ds_read_b64_tr_b16 a[140:141], v123 offset:0
  ds_read_b64_tr_b16 a[142:143], v123 offset:2048
  s_waitcnt lgkmcnt(0)
  s_barrier
  s_mov_b32 s54, 2334720
  s_mul_i32 s53, s49, 4096
  s_add_u32 m0, s53, 122880
  s_nop 0
  buffer_load_dwordx4 v112, s[36:39], s54 offen  lds
  s_add_u32 m0, m0, 1024
  s_nop 0
  buffer_load_dwordx4 v113, s[36:39], s54 offen  lds
  s_add_u32 m0, m0, 1024
  s_nop 0
  buffer_load_dwordx4 v114, s[36:39], s54 offen  lds
  s_add_u32 m0, m0, 1024
  s_nop 0
  buffer_load_dwordx4 v115, s[36:39], s54 offen  lds
  s_waitcnt vmcnt(24)
  s_barrier
  v_add_u32 v120, 0x22000, v116
  v_add_u32 v121, 0x22000, v117
  v_add_u32 v122, 0x22000, v118
  v_add_u32 v123, 0x22000, v119
  ds_read_b64_tr_b16 a[144:145], v120 offset:0
  ds_read_b64_tr_b16 a[146:147], v120 offset:2048
  ds_read_b64_tr_b16 a[148:149], v121 offset:0
  ds_read_b64_tr_b16 a[150:151], v121 offset:2048
  ds_read_b64_tr_b16 a[152:153], v122 offset:0
  ds_read_b64_tr_b16 a[154:155], v122 offset:2048
  ds_read_b64_tr_b16 a[156:157], v123 offset:0
  ds_read_b64_tr_b16 a[158:159], v123 offset:2048
  s_waitcnt lgkmcnt(0)
  s_waitcnt vmcnt(20)
  s_barrier
  v_add_u32 v120, 0xa000, v116
  v_add_u32 v121, 0xa000, v117
  v_add_u32 v122, 0xa000, v118
  v_add_u32 v123, 0xa000, v119
  ds_read_b64_tr_b16 a[160:161], v120 offset:0
  ds_read_b64_tr_b16 a[162:163], v120 offset:2048
  ds_read_b64_tr_b16 a[164:165], v121 offset:0
  ds_read_b64_tr_b16 a[166:167], v121 offset:2048
  ds_read_b64_tr_b16 a[168:169], v122 offset:0
  ds_read_b64_tr_b16 a[170:171], v122 offset:2048
  ds_read_b64_tr_b16 a[172:173], v123 offset:0
  ds_read_b64_tr_b16 a[174:175], v123 offset:2048
  s_waitcnt lgkmcnt(0)
  s_waitcnt vmcnt(16)
  s_barrier
  v_add_u32 v120, 0xe000, v116
  v_add_u32 v121, 0xe000, v117
  v_add_u32 v122, 0xe000, v118
  v_add_u32 v123, 0xe000, v119
  ds_read_b64_tr_b16 a[176:177], v120 offset:0
  ds_read_b64_tr_b16 a[178:179], v120 offset:2048
  ds_read_b64_tr_b16 a[180:181], v121 offset:0
  ds_read_b64_tr_b16 a[182:183], v121 offset:2048
  ds_read_b64_tr_b16 a[184:185], v122 offset:0
  ds_read_b64_tr_b16 a[186:187], v122 offset:2048
  ds_read_b64_tr_b16 a[188:189], v123 offset:0
  ds_read_b64_tr_b16 a[190:191], v123 offset:2048
  s_waitcnt lgkmcnt(0)
  s_waitcnt vmcnt(12)
  s_barrier
  v_add_u32 v120, 0x12000, v116
  v_add_u32 v121, 0x12000, v117
  v_add_u32 v122, 0x12000, v118
  v_add_u32 v123, 0x12000, v119
  ds_read_b64_tr_b16 a[192:193], v120 offset:0
  ds_read_b64_tr_b16 a[194:195], v120 offset:2048
  ds_read_b64_tr_b16 a[196:197], v121 offset:0
  ds_read_b64_tr_b16 a[198:199], v121 offset:2048
  ds_read_b64_tr_b16 a[200:201], v122 offset:0
  ds_read_b64_tr_b16 a[202:203], v122 offset:2048
  ds_read_b64_tr_b16 a[204:205], v123 offset:0
  ds_read_b64_tr_b16 a[206:207], v123 offset:2048
  s_waitcnt lgkmcnt(0)
  s_waitcnt vmcnt(8)
  s_barrier
  v_add_u32 v120, 0x16000, v116
  v_add_u32 v121, 0x16000, v117
  v_add_u32 v122, 0x16000, v118
  v_add_u32 v123, 0x16000, v119
  ds_read_b64_tr_b16 a[208:209], v120 offset:0
  ds_read_b64_tr_b16 a[210:211], v120 offset:2048
  ds_read_b64_tr_b16 a[212:213], v121 offset:0
  ds_read_b64_tr_b16 a[214:215], v121 offset:2048
  ds_read_b64_tr_b16 a[216:217], v122 offset:0
  ds_read_b64_tr_b16 a[218:219], v122 offset:2048
  ds_read_b64_tr_b16 a[220:221], v123 offset:0
  ds_read_b64_tr_b16 a[222:223], v123 offset:2048
  s_waitcnt lgkmcnt(0)
  s_waitcnt vmcnt(4)
  s_barrier
  v_add_u32 v120, 0x1a000, v116
  v_add_u32 v121, 0x1a000, v117
  v_add_u32 v122, 0x1a000, v118
  v_add_u32 v123, 0x1a000, v119
  ds_read_b64_tr_b16 a[224:225], v120 offset:0
  ds_read_b64_tr_b16 a[226:227], v120 offset:2048
  ds_read_b64_tr_b16 a[228:229], v121 offset:0
  ds_read_b64_tr_b16 a[230:231], v121 offset:2048
  ds_read_b64_tr_b16 a[232:233], v122 offset:0
  ds_read_b64_tr_b16 a[234:235], v122 offset:2048
  ds_read_b64_tr_b16 a[236:237], v123 offset:0
  ds_read_b64_tr_b16 a[238:239], v123 offset:2048
  s_waitcnt lgkmcnt(0)
  s_waitcnt vmcnt(0)
  s_barrier
  v_add_u32 v120, 0x1e000, v116
  v_add_u32 v121, 0x1e000, v117
  v_add_u32 v122, 0x1e000, v118
  v_add_u32 v123, 0x1e000, v119
  ds_read_b64_tr_b16 a[240:241], v120 offset:0
  ds_read_b64_tr_b16 a[242:243], v120 offset:2048
  ds_read_b64_tr_b16 a[244:245], v121 offset:0
  ds_read_b64_tr_b16 a[246:247], v121 offset:2048
  ds_read_b64_tr_b16 a[248:249], v122 offset:0
  ds_read_b64_tr_b16 a[250:251], v122 offset:2048
  ds_read_b64_tr_b16 a[252:253], v123 offset:0
  ds_read_b64_tr_b16 a[254:255], v123 offset:2048
  s_waitcnt lgkmcnt(0)
  s_barrier
  s_mul_i32 s53, s49, 5120
  s_add_u32 s53, s53, 81920
  v_mul_u32_u24 v44, 160, v41
  v_lshl_add_u32 v44, v40, 3, v44
  v_add_u32 v7, s53, v44
  v_lshrrev_b32 v44, 2, v0
  v_mul_u32_u24 v44, 160, v44
  v_lshl_add_u32 v44, v47, 3, v44
  v_add_u32 v8, s53, v44
  v_mov_b32 v12, 0x3f803f80
  v_mov_b32 v13, 0x3f803f80
  v_mov_b32 v14, 0x3f803f80
  v_mov_b32 v15, 0x3f803f80
  v_mov_b64 v[84:85], 0
  v_mov_b64 v[86:87], 0
  v_mov_b64 v[88:89], 0
  v_mov_b64 v[90:91], 0
  v_mov_b64 v[92:93], 0
  v_mov_b64 v[94:95], 0
  v_mov_b64 v[96:97], 0
  v_mov_b64 v[98:99], 0
  v_mov_b64 v[100:101], 0
  v_mov_b64 v[102:103], 0
  v_mov_b64 v[104:105], 0
  v_mov_b64 v[106:107], 0
  v_mov_b64 v[108:109], 0
  v_mov_b64 v[110:111], 0
  v_mov_b64 v[112:113], 0
  v_mov_b64 v[114:115], 0
  v_mov_b64 v[116:117], 0
  v_mov_b64 v[118:119], 0
  v_mov_b32 v131, 0
  s_mov_b32 s69, 0x3fb8aa3b
  s_mov_b32 s70, 0xbfb8aa3b
  s_lshl_b32 s54, s62, 2
  s_add_u32 s54, s54, s49
  s_mul_i32 s68, s54, 0x8000
  s_add_u32 s68, s68, 0x5100000
  s_lshr_b32 s53, s68, 7
  s_and_b32 s53, s53, 0x2000
  s_xor_b32 s53, s53, s51
  s_lshl_b32 s68, s68, 1
  s_or_b32 s68, s68, s53
  s_mov_b32 s67, 0
  s_mov_b32 s74, 0
PA_SEG:
  s_waitcnt vmcnt(0)
  s_barrier
  v_add_u32 v4, s67, v2
  v_add_u32 v5, s67, v3
  ds_read_b128 v[32:35], v4 offset:0
  ds_read_b128 v[36:39], v5 offset:0
  ds_read_b128 v[40:43], v4 offset:4096
  s_add_u32 s65, s65, 40960
  s_add_u32 s66, s66, 40960
  s_cmp_ge_u32 s66, 81920
  s_cselect_b32 s53, 81920, 0
  s_sub_u32 s66, s66, s53
  s_add_u32 s67, s67, 40960
  s_cmp_ge_u32 s67, 81920
  s_cselect_b32 s53, 81920, 0
  s_sub_u32 s67, s67, s53
  ds_read_b128 v[44:47], v5 offset:4096
  s_waitcnt lgkmcnt(3)
  v_mfma_f32_16x16x32_bf16 v[16:19], v[192:195], v[32:35], 0
  s_add_u32 m0, s66, 0
  v_mfma_f32_16x16x32_bf16 v[20:23], v[196:199], v[32:35], 0
  buffer_load_dwordx4 v1, s[44:47], s65 offen offset:0 lds
  v_mfma_f32_16x16x32_bf16 v[24:27], v[200:203], v[32:35], 0
  v_max3_f32 v168, v68, v69, v70
  v_min3_f32 v169, v68, v69, v70
  v_mfma_f32_16x16x32_bf16 v[28:31], v[204:207], v[32:35], 0
  v_max3_f32 v168, v168, v71, v72
  v_min3_f32 v169, v169, v71, v72
  ds_read_b128 v[32:35], v4 offset:8192
  s_waitcnt lgkmcnt(3)
  v_mfma_f32_16x16x32_bf16 v[16:19], v[208:211], v[36:39], v[16:19]
  v_mov_b32 v170, v168
  v_mov_b32 v171, v169
  v_mfma_f32_16x16x32_bf16 v[20:23], v[212:215], v[36:39], v[20:23]
  v_permlane16_swap_b32 v168, v170
  v_permlane16_swap_b32 v169, v171
  v_mfma_f32_16x16x32_bf16 v[24:27], v[216:219], v[36:39], v[24:27]
  v_max_f32 v168, v168, v170
  v_min_f32 v169, v169, v171
  v_mfma_f32_16x16x32_bf16 v[28:31], v[220:223], v[36:39], v[28:31]
  v_mov_b32 v170, v168
  v_mov_b32 v171, v169
  ds_read_b128 v[36:39], v5 offset:8192
  s_waitcnt lgkmcnt(3)
  v_mfma_f32_16x16x32_bf16 v[16:19], v[224:227], v[40:43], v[16:19]
  s_add_u32 m0, s66, 3968
  v_permlane32_swap_b32 v168, v170
  v_mfma_f32_16x16x32_bf16 v[20:23], v[228:231], v[40:43], v[20:23]
  buffer_load_dwordx4 v1, s[44:47], s65 offen offset:128 lds
  v_permlane32_swap_b32 v169, v171
  v_max_f32 v168, v168, v170
  v_mfma_f32_16x16x32_bf16 v[24:27], v[232:235], v[40:43], v[24:27]
  v_min_f32 v169, v169, v171
  v_mul_f32 v168, s69, v168
  v_mfma_f32_16x16x32_bf16 v[28:31], v[236:239], v[40:43], v[28:31]
  v_mul_f32 v169, s69, v169
  v_fma_f32 v120, v68, s69, -v168
  ds_read_b128 v[40:43], v4 offset:12288
  s_waitcnt lgkmcnt(3)
  v_mfma_f32_16x16x32_bf16 v[16:19], v[240:243], v[44:47], v[16:19]
  v_fma_f32 v124, -v68, s69, v169
  v_fma_f32 v121, v69, s69, -v168
  v_mfma_f32_16x16x32_bf16 v[20:23], v[244:247], v[44:47], v[20:23]
  v_fma_f32 v125, -v69, s69, v169
  v_fma_f32 v122, v70, s69, -v168
  v_fma_f32 v126, -v70, s69, v169
  v_mfma_f32_16x16x32_bf16 v[24:27], v[248:251], v[44:47], v[24:27]
  v_fma_f32 v123, v71, s69, -v168
  v_fma_f32 v127, -v71, s69, v169
  v_mfma_f32_16x16x32_bf16 v[28:31], v[252:255], v[44:47], v[28:31]
  v_fma_f32 v128, v72, s69, -v168
  v_fma_f32 v129, -v72, s69, v169
  ds_read_b128 v[44:47], v5 offset:12288
  s_waitcnt lgkmcnt(3)
  v_mfma_f32_16x16x32_bf16 v[16:19], a[0:3], v[32:35], v[16:19]
  s_add_u32 m0, s66, 7936
  v_exp_f32 v120, v120
  v_mfma_f32_16x16x32_bf16 v[20:23], a[4:7], v[32:35], v[20:23]
  buffer_load_dwordx4 v1, s[44:47], s65 offen offset:256 lds
  v_exp_f32 v121, v121
  v_exp_f32 v122, v122
  v_mfma_f32_16x16x32_bf16 v[24:27], a[8:11], v[32:35], v[24:27]
  v_exp_f32 v123, v123
  v_mfma_f32_16x16x32_bf16 v[28:31], a[12:15], v[32:35], v[28:31]
  v_exp_f32 v124, v124
  ds_read_b128 v[32:35], v4 offset:16384
  s_waitcnt lgkmcnt(3)
  v_mfma_f32_16x16x32_bf16 v[16:19], a[16:19], v[36:39], v[16:19]
  v_exp_f32 v125, v125
  v_mfma_f32_16x16x32_bf16 v[20:23], a[20:23], v[36:39], v[20:23]
  v_exp_f32 v126, v126
  v_exp_f32 v127, v127
  v_mfma_f32_16x16x32_bf16 v[24:27], a[24:27], v[36:39], v[24:27]
  v_exp_f32 v128, v128
  v_mfma_f32_16x16x32_bf16 v[28:31], a[28:31], v[36:39], v[28:31]
  v_exp_f32 v129, v129
  ds_read_b128 v[36:39], v5 offset:16384
  s_waitcnt lgkmcnt(3)
  v_mfma_f32_16x16x32_bf16 v[16:19], a[32:35], v[40:43], v[16:19]
  s_add_u32 m0, s66, 11904
  v_add_f32 v168, v120, v121
  v_add_f32 v169, v124, v125
  v_mfma_f32_16x16x32_bf16 v[20:23], a[36:39], v[40:43], v[20:23]
  buffer_load_dwordx4 v1, s[44:47], s65 offen offset:384 lds
  v_add_f32 v168, v168, v122
  v_add_f32 v169, v169, v126
  v_add_f32 v168, v168, v123
  v_mfma_f32_16x16x32_bf16 v[24:27], a[40:43], v[40:43], v[24:27]
  v_add_f32 v169, v169, v127
  v_add_f32 v168, v168, v128
  v_mfma_f32_16x16x32_bf16 v[28:31], a[44:47], v[40:43], v[28:31]
  v_add_f32 v169, v169, v129
  v_mov_b32 v170, v168
  ds_read_b128 v[40:43], v4 offset:20480
  s_waitcnt lgkmcnt(3)
  v_mfma_f32_16x16x32_bf16 v[16:19], a[48:51], v[44:47], v[16:19]
  v_mov_b32 v171, v169
  v_permlane16_swap_b32 v168, v170
  v_mfma_f32_16x16x32_bf16 v[20:23], a[52:55], v[44:47], v[20:23]
  v_permlane16_swap_b32 v169, v171
  v_add_f32 v168, v168, v170
  v_mfma_f32_16x16x32_bf16 v[24:27], a[56:59], v[44:47], v[24:27]
  v_add_f32 v169, v169, v171
  v_mov_b32 v170, v168
  v_mfma_f32_16x16x32_bf16 v[28:31], a[60:63], v[44:47], v[28:31]
  v_mov_b32 v171, v169
  v_permlane32_swap_b32 v168, v170
  ds_read_b128 v[44:47], v5 offset:20480
  s_waitcnt lgkmcnt(3)
  v_mfma_f32_16x16x32_bf16 v[16:19], a[64:67], v[32:35], v[16:19]
  s_add_u32 m0, s66, 15872
  v_permlane32_swap_b32 v169, v171
  v_mfma_f32_16x16x32_bf16 v[20:23], a[68:71], v[32:35], v[20:23]
  buffer_load_dwordx4 v1, s[44:47], s65 offen offset:512 lds
  v_add_f32 v168, v168, v170
  v_add_f32 v169, v169, v171
  v_rcp_f32 v168, v168
  v_mfma_f32_16x16x32_bf16 v[24:27], a[72:75], v[32:35], v[24:27]
  v_rcp_f32 v169, v169
  v_mfma_f32_16x16x32_bf16 v[28:31], a[76:79], v[32:35], v[28:31]
  v_mul_f32 v120, v120, v168
  v_mul_f32 v124, v124, v169
  ds_read_b128 v[32:35], v4 offset:24576
  s_waitcnt lgkmcnt(3)
  v_mfma_f32_16x16x32_bf16 v[16:19], a[80:83], v[36:39], v[16:19]
  v_mul_f32 v121, v121, v168
  v_mul_f32 v125, v125, v169
  v_mfma_f32_16x16x32_bf16 v[20:23], a[84:87], v[36:39], v[20:23]
  v_mul_f32 v122, v122, v168
  v_mul_f32 v126, v126, v169
  v_mul_f32 v123, v123, v168
  v_mfma_f32_16x16x32_bf16 v[24:27], a[88:91], v[36:39], v[24:27]
  v_mul_f32 v127, v127, v169
  v_mul_f32 v128, v128, v168
  v_mfma_f32_16x16x32_bf16 v[28:31], a[92:95], v[36:39], v[28:31]
  v_mul_f32 v129, v129, v169
  v_cvt_pk_bf16_f32 v136, v120, v121
  ds_read_b128 v[36:39], v5 offset:24576
  s_waitcnt lgkmcnt(3)
  v_mfma_f32_16x16x32_bf16 v[16:19], a[96:99], v[40:43], v[16:19]
  s_add_u32 m0, s66, 19840
  v_cvt_pk_bf16_f32 v137, v122, v123
  v_cvt_pk_bf16_f32 v138, v124, v125
  v_mfma_f32_16x16x32_bf16 v[20:23], a[100:103], v[40:43], v[20:23]
  buffer_load_dwordx4 v1, s[44:47], s65 offen offset:640 lds
  v_cvt_pk_bf16_f32 v139, v126, v127
  v_cvt_pk_bf16_f32 v141, v128, v129
  v_max3_f32 v168, v76, v77, v78
  v_mfma_f32_16x16x32_bf16 v[24:27], a[104:107], v[40:43], v[24:27]
  v_min3_f32 v169, v76, v77, v78
  v_max3_f32 v168, v168, v79, v80
  v_mfma_f32_16x16x32_bf16 v[28:31], a[108:111], v[40:43], v[28:31]
  v_min3_f32 v169, v169, v79, v80
  v_mov_b32 v170, v168
  ds_read_b128 v[40:43], v4 offset:28672
  s_waitcnt lgkmcnt(3)
  v_mfma_f32_16x16x32_bf16 v[16:19], a[112:115], v[44:47], v[16:19]
  v_mov_b32 v171, v169
  v_permlane16_swap_b32 v168, v170
  v_mfma_f32_16x16x32_bf16 v[20:23], a[116:119], v[44:47], v[20:23]
  v_permlane16_swap_b32 v169, v171
  v_max_f32 v168, v168, v170
  v_mfma_f32_16x16x32_bf16 v[24:27], a[120:123], v[44:47], v[24:27]
  v_min_f32 v169, v169, v171
  v_mov_b32 v170, v168
  v_mfma_f32_16x16x32_bf16 v[28:31], a[124:127], v[44:47], v[28:31]
  v_mov_b32 v171, v169
  v_permlane32_swap_b32 v168, v170
  ds_read_b128 v[44:47], v5 offset:28672
  s_waitcnt lgkmcnt(3)
  v_mfma_f32_16x16x32_bf16 v[16:19], a[128:131], v[32:35], v[16:19]
  s_add_u32 m0, s66, 23808
  v_permlane32_swap_b32 v169, v171
  v_mfma_f32_16x16x32_bf16 v[20:23], a[132:135], v[32:35], v[20:23]
  buffer_load_dwordx4 v1, s[44:47], s65 offen offset:768 lds
  v_max_f32 v168, v168, v170
  v_min_f32 v169, v169, v171
  v_mul_f32 v168, s69, v168
  v_mfma_f32_16x16x32_bf16 v[24:27], a[136:139], v[32:35], v[24:27]
  v_mul_f32 v169, s69, v169
  v_fma_f32 v120, v76, s69, -v168
  v_mfma_f32_16x16x32_bf16 v[28:31], a[140:143], v[32:35], v[28:31]
  v_fma_f32 v124, -v76, s69, v169
  v_fma_f32 v121, v77, s69, -v168
  ds_read_b128 v[32:35], v4 offset:32768
  s_waitcnt lgkmcnt(3)
  v_mfma_f32_16x16x32_bf16 v[16:19], a[144:147], v[36:39], v[16:19]
  v_fma_f32 v125, -v77, s69, v169
  v_fma_f32 v122, v78, s69, -v168
  v_mfma_f32_16x16x32_bf16 v[20:23], a[148:151], v[36:39], v[20:23]
  v_fma_f32 v126, -v78, s69, v169
  v_fma_f32 v123, v79, s69, -v168
  v_fma_f32 v127, -v79, s69, v169
  v_mfma_f32_16x16x32_bf16 v[24:27], a[152:155], v[36:39], v[24:27]
  v_fma_f32 v128, v80, s69, -v168
  v_fma_f32 v129, -v80, s69, v169
  v_mfma_f32_16x16x32_bf16 v[28:31], a[156:159], v[36:39], v[28:31]
  v_exp_f32 v120, v120
  ds_read_b128 v[36:39], v5 offset:32768
  s_waitcnt lgkmcnt(3)
  v_mfma_f32_16x16x32_bf16 v[16:19], a[160:163], v[40:43], v[16:19]
  s_add_u32 m0, s66, 27776
  v_exp_f32 v121, v121
  v_mfma_f32_16x16x32_bf16 v[20:23], a[164:167], v[40:43], v[20:23]
  buffer_load_dwordx4 v1, s[44:47], s65 offen offset:896 lds
  v_exp_f32 v122, v122
  v_exp_f32 v123, v123
  v_mfma_f32_16x16x32_bf16 v[24:27], a[168:171], v[40:43], v[24:27]
  v_exp_f32 v124, v124
  v_mfma_f32_16x16x32_bf16 v[28:31], a[172:175], v[40:43], v[28:31]
  v_exp_f32 v125, v125
  ds_read_b128 v[40:43], v4 offset:36864
  s_waitcnt lgkmcnt(3)
  v_mfma_f32_16x16x32_bf16 v[16:19], a[176:179], v[44:47], v[16:19]
  v_exp_f32 v126, v126
  v_mfma_f32_16x16x32_bf16 v[20:23], a[180:183], v[44:47], v[20:23]
  v_exp_f32 v127, v127
  v_exp_f32 v128, v128
  v_mfma_f32_16x16x32_bf16 v[24:27], a[184:187], v[44:47], v[24:27]
  v_exp_f32 v129, v129
  v_mfma_f32_16x16x32_bf16 v[28:31], a[188:191], v[44:47], v[28:31]
  v_add_f32 v168, v120, v121
  v_add_f32 v169, v124, v125
  ds_read_b128 v[44:47], v5 offset:36864
  s_waitcnt lgkmcnt(3)
  v_mfma_f32_16x16x32_bf16 v[16:19], a[192:195], v[32:35], v[16:19]
  s_add_u32 m0, s66, 31744
  v_add_f32 v168, v168, v122
  v_add_f32 v169, v169, v126
  v_mfma_f32_16x16x32_bf16 v[20:23], a[196:199], v[32:35], v[20:23]
  buffer_load_dwordx4 v1, s[44:47], s65 offen offset:1024 lds
  v_add_f32 v168, v168, v123
  v_add_f32 v169, v169, v127
  v_add_f32 v168, v168, v128
  v_mfma_f32_16x16x32_bf16 v[24:27], a[200:203], v[32:35], v[24:27]
  v_add_f32 v169, v169, v129
  v_mov_b32 v170, v168
  v_mfma_f32_16x16x32_bf16 v[28:31], a[204:207], v[32:35], v[28:31]
  v_mov_b32 v171, v169
  v_permlane16_swap_b32 v168, v170
  ds_read_b128 v[32:35], v4 offset:2048
  s_waitcnt lgkmcnt(3)
  v_mfma_f32_16x16x32_bf16 v[16:19], a[208:211], v[36:39], v[16:19]
  v_permlane16_swap_b32 v169, v171
  v_mfma_f32_16x16x32_bf16 v[20:23], a[212:215], v[36:39], v[20:23]
  v_add_f32 v168, v168, v170
  v_add_f32 v169, v169, v171
  v_mov_b32 v170, v168
  v_mfma_f32_16x16x32_bf16 v[24:27], a[216:219], v[36:39], v[24:27]
  v_mov_b32 v171, v169
  v_permlane32_swap_b32 v168, v170
  v_mfma_f32_16x16x32_bf16 v[28:31], a[220:223], v[36:39], v[28:31]
  v_permlane32_swap_b32 v169, v171
  ds_read_b128 v[36:39], v5 offset:2048
  s_waitcnt lgkmcnt(3)
  v_mfma_f32_16x16x32_bf16 v[16:19], a[224:227], v[40:43], v[16:19]
  s_add_u32 m0, s66, 35712
  v_add_f32 v168, v168, v170
  v_add_f32 v169, v169, v171
  v_mfma_f32_16x16x32_bf16 v[20:23], a[228:231], v[40:43], v[20:23]
  buffer_load_dwordx4 v1, s[44:47], s65 offen offset:1152 lds
  v_rcp_f32 v168, v168
  v_rcp_f32 v169, v169
  v_mfma_f32_16x16x32_bf16 v[24:27], a[232:235], v[40:43], v[24:27]
  v_mul_f32 v120, v120, v168
  v_mul_f32 v124, v124, v169
  v_mfma_f32_16x16x32_bf16 v[28:31], a[236:239], v[40:43], v[28:31]
  v_mul_f32 v121, v121, v168
  v_mul_f32 v125, v125, v169
  ds_read_b128 v[40:43], v4 offset:6144
  s_waitcnt lgkmcnt(3)
  v_mfma_f32_16x16x32_bf16 v[16:19], a[240:243], v[44:47], v[16:19]
  v_mul_f32 v122, v122, v168
  v_mul_f32 v126, v126, v169
  v_mfma_f32_16x16x32_bf16 v[20:23], a[244:247], v[44:47], v[20:23]
  v_mul_f32 v123, v123, v168
  v_mul_f32 v127, v127, v169
  v_mul_f32 v128, v128, v168
  v_mfma_f32_16x16x32_bf16 v[24:27], a[248:251], v[44:47], v[24:27]
  v_mul_f32 v129, v129, v169
  v_cvt_pk_bf16_f32 v172, v120, v121
  v_mfma_f32_16x16x32_bf16 v[28:31], a[252:255], v[44:47], v[28:31]
  v_cvt_pk_bf16_f32 v173, v122, v123
  v_cvt_pk_bf16_f32 v174, v124, v125
  v_cvt_pk_bf16_f32 v175, v126, v127
  v_cvt_pk_bf16_f32 v130, v128, v129
  ds_write_b64 v7, v[172:173] offset:2560
  ds_write_b64 v7, v[174:175] offset:2592
  ds_write_b64 v7, v[130:131] offset:2624
  s_waitcnt lgkmcnt(3)
  ds_read_b64_tr_b16 v[144:145], v8 offset:0
  ds_read_b64_tr_b16 v[146:147], v8 offset:2560
  ds_read_b64_tr_b16 v[148:149], v8 offset:32
  ds_read_b64_tr_b16 v[150:151], v8 offset:2592
  ds_read_b64_tr_b16 v[152:153], v8 offset:64
  ds_read_b64_tr_b16 v[154:155], v8 offset:2624
  ds_read_b64_tr_b16 v[156:157], v8 offset:96
  ds_read_b64_tr_b16 v[158:159], v8 offset:2656
  ds_read_b64_tr_b16 v[160:161], v8 offset:128
  ds_read_b64_tr_b16 v[162:163], v8 offset:2688
  v_cvt_pk_bf16_f32 v48, v16, v17
  v_cvt_pk_bf16_f32 v49, v18, v19
  v_cvt_pk_bf16_f32 v52, v20, v21
  v_cvt_pk_bf16_f32 v53, v22, v23
  v_cvt_pk_bf16_f32 v54, v24, v25
  v_cvt_pk_bf16_f32 v55, v26, v27
  v_cvt_pk_bf16_f32 v50, v28, v29
  v_cvt_pk_bf16_f32 v51, v30, v31
  s_nop 1
  v_mfma_f32_16x16x32_bf16 v[68:71], v[58:61], v[48:51], 0
  v_mfma_f32_16x16x32_bf16 v[72:75], v[64:67], v[48:51], 0
  v_mfma_f32_16x16x32_bf16 v[76:79], v[56:59], v[50:53], 0
  v_mfma_f32_16x16x32_bf16 v[80:83], v[62:65], v[50:53], 0
  ds_write_b64 v7, v[54:55] offset:96
  ds_write_b64 v7, v[50:51] offset:128
  s_waitcnt lgkmcnt(2)
  s_cmp_eq_u32 s74, 0
  s_cbranch_scc1 PA_NOKV
  v_mfma_f32_16x16x32_bf16 v[84:87], v[144:147], v[156:159], v[84:87]
  v_mfma_f32_16x16x32_bf16 v[88:91], v[148:151], v[156:159], v[88:91]
  v_mfma_f32_16x16x32_bf16 v[92:95], v[152:155], v[156:159], v[92:95]
  buffer_store_dwordx4 v[132:135], v6, s[32:35], s68 offen sc1
  v_mfma_f32_16x16x32_bf16 v[96:99], v[144:147], v[160:163], v[96:99]
  v_mfma_f32_16x16x32_bf16 v[100:103], v[148:151], v[160:163], v[100:103]
  v_mfma_f32_16x16x32_bf16 v[104:107], v[152:155], v[160:163], v[104:107]
  buffer_store_dwordx4 v[136:139], v6, s[32:35], s68 offen offset:1024 sc1
  v_mfma_f32_16x16x32_bf16 v[108:111], v[144:147], v[12:15], v[108:111]
  v_mfma_f32_16x16x32_bf16 v[112:115], v[148:151], v[12:15], v[112:115]
  v_mfma_f32_16x16x32_bf16 v[116:119], v[152:155], v[12:15], v[116:119]
  buffer_store_dwordx4 v[140:143], v6, s[32:35], s68 offen offset:2048 sc1
  s_and_b32 s53, s74, 1
  s_cselect_b32 s53, 0, 8192
  s_add_u32 s68, s68, 4096
  s_add_u32 s68, s68, s53
PA_NOKV:
  ds_read_b128 v[44:47], v5 offset:6144
  s_waitcnt lgkmcnt(5)
  v_mfma_f32_16x16x32_bf16 v[16:19], v[192:195], v[32:35], 0
  v_mfma_f32_16x16x32_bf16 v[20:23], v[196:199], v[32:35], 0
  v_mfma_f32_16x16x32_bf16 v[24:27], v[200:203], v[32:35], 0
  v_max3_f32 v168, v68, v69, v70
  v_min3_f32 v169, v68, v69, v70
  v_mfma_f32_16x16x32_bf16 v[28:31], v[204:207], v[32:35], 0
  v_max3_f32 v168, v168, v71, v72
  v_min3_f32 v169, v169, v71, v72
  ds_read_b128 v[32:35], v4 offset:10240
  s_waitcnt lgkmcnt(5)
  v_mfma_f32_16x16x32_bf16 v[16:19], v[208:211], v[36:39], v[16:19]
  v_mov_b32 v170, v168
  v_mov_b32 v171, v169
  v_mfma_f32_16x16x32_bf16 v[20:23], v[212:215], v[36:39], v[20:23]
  v_permlane16_swap_b32 v168, v170
  v_permlane16_swap_b32 v169, v171
  v_mfma_f32_16x16x32_bf16 v[24:27], v[216:219], v[36:39], v[24:27]
  v_max_f32 v168, v168, v170
  v_min_f32 v169, v169, v171
  v_mfma_f32_16x16x32_bf16 v[28:31], v[220:223], v[36:39], v[28:31]
  v_mov_b32 v170, v168
  v_mov_b32 v171, v169
  ds_read_b128 v[36:39], v5 offset:10240
  s_waitcnt lgkmcnt(5)
  v_mfma_f32_16x16x32_bf16 v[16:19], v[224:227], v[40:43], v[16:19]
  v_permlane32_swap_b32 v168, v170
  v_mfma_f32_16x16x32_bf16 v[20:23], v[228:231], v[40:43], v[20:23]
  v_permlane32_swap_b32 v169, v171
  v_max_f32 v168, v168, v170
  v_mfma_f32_16x16x32_bf16 v[24:27], v[232:235], v[40:43], v[24:27]
  v_min_f32 v169, v169, v171
  v_mul_f32 v168, s69, v168
  v_mfma_f32_16x16x32_bf16 v[28:31], v[236:239], v[40:43], v[28:31]
  v_mul_f32 v169, s69, v169
  v_fma_f32 v120, v68, s69, -v168
  ds_read_b128 v[40:43], v4 offset:14336
  s_waitcnt lgkmcnt(3)
  v_mfma_f32_16x16x32_bf16 v[16:19], v[240:243], v[44:47], v[16:19]
  v_fma_f32 v124, -v68, s69, v169
  v_fma_f32 v121, v69, s69, -v168
  v_mfma_f32_16x16x32_bf16 v[20:23], v[244:247], v[44:47], v[20:23]
  v_fma_f32 v125, -v69, s69, v169
  v_fma_f32 v122, v70, s69, -v168
  v_fma_f32 v126, -v70, s69, v169
  v_mfma_f32_16x16x32_bf16 v[24:27], v[248:251], v[44:47], v[24:27]
  v_fma_f32 v123, v71, s69, -v168
  v_fma_f32 v127, -v71, s69, v169
  v_mfma_f32_16x16x32_bf16 v[28:31], v[252:255], v[44:47], v[28:31]
  v_fma_f32 v128, v72, s69, -v168
  v_fma_f32 v129, -v72, s69, v169
  ds_read_b128 v[44:47], v5 offset:14336
  s_waitcnt lgkmcnt(3)
  v_mfma_f32_16x16x32_bf16 v[16:19], a[0:3], v[32:35], v[16:19]
  v_exp_f32 v120, v120
  v_mfma_f32_16x16x32_bf16 v[20:23], a[4:7], v[32:35], v[20:23]
  v_exp_f32 v121, v121
  v_exp_f32 v122, v122
  v_mfma_f32_16x16x32_bf16 v[24:27], a[8:11], v[32:35], v[24:27]
  v_exp_f32 v123, v123
  v_mfma_f32_16x16x32_bf16 v[28:31], a[12:15], v[32:35], v[28:31]
  v_exp_f32 v124, v124
  ds_read_b128 v[32:35], v4 offset:18432
  s_waitcnt lgkmcnt(3)
  v_mfma_f32_16x16x32_bf16 v[16:19], a[16:19], v[36:39], v[16:19]
  v_exp_f32 v125, v125
  v_mfma_f32_16x16x32_bf16 v[20:23], a[20:23], v[36:39], v[20:23]
  v_exp_f32 v126, v126
  v_exp_f32 v127, v127
  v_mfma_f32_16x16x32_bf16 v[24:27], a[24:27], v[36:39], v[24:27]
  v_exp_f32 v128, v128
  v_mfma_f32_16x16x32_bf16 v[28:31], a[28:31], v[36:39], v[28:31]
  v_exp_f32 v129, v129
  ds_read_b128 v[36:39], v5 offset:18432
  s_waitcnt lgkmcnt(3)
  v_mfma_f32_16x16x32_bf16 v[16:19], a[32:35], v[40:43], v[16:19]
  v_add_f32 v168, v120, v121
  v_add_f32 v169, v124, v125
  v_mfma_f32_16x16x32_bf16 v[20:23], a[36:39], v[40:43], v[20:23]
  v_add_f32 v168, v168, v122
  v_add_f32 v169, v169, v126
  v_add_f32 v168, v168, v123
  v_mfma_f32_16x16x32_bf16 v[24:27], a[40:43], v[40:43], v[24:27]
  v_add_f32 v169, v169, v127
  v_add_f32 v168, v168, v128
  v_mfma_f32_16x16x32_bf16 v[28:31], a[44:47], v[40:43], v[28:31]
  v_add_f32 v169, v169, v129
  v_mov_b32 v170, v168
  ds_read_b128 v[40:43], v4 offset:22528
  s_waitcnt lgkmcnt(3)
  v_mfma_f32_16x16x32_bf16 v[16:19], a[48:51], v[44:47], v[16:19]
  v_mov_b32 v171, v169
  v_permlane16_swap_b32 v168, v170
  v_mfma_f32_16x16x32_bf16 v[20:23], a[52:55], v[44:47], v[20:23]
  v_permlane16_swap_b32 v169, v171
  v_add_f32 v168, v168, v170
  v_mfma_f32_16x16x32_bf16 v[24:27], a[56:59], v[44:47], v[24:27]
  v_add_f32 v169, v169, v171
  v_mov_b32 v170, v168
  v_mfma_f32_16x16x32_bf16 v[28:31], a[60:63], v[44:47], v[28:31]
  v_mov_b32 v171, v169
  v_permlane32_swap_b32 v168, v170
  ds_read_b128 v[44:47], v5 offset:22528
  s_waitcnt lgkmcnt(3)
  v_mfma_f32_16x16x32_bf16 v[16:19], a[64:67], v[32:35], v[16:19]
  v_permlane32_swap_b32 v169, v171
  v_mfma_f32_16x16x32_bf16 v[20:23], a[68:71], v[32:35], v[20:23]
  v_add_f32 v168, v168, v170
  v_add_f32 v169, v169, v171
  v_rcp_f32 v168, v168
  v_mfma_f32_16x16x32_bf16 v[24:27], a[72:75], v[32:35], v[24:27]
  v_rcp_f32 v169, v169
  v_mfma_f32_16x16x32_bf16 v[28:31], a[76:79], v[32:35], v[28:31]
  v_mul_f32 v120, v120, v168
  v_mul_f32 v124, v124, v169
  ds_read_b128 v[32:35], v4 offset:26624
  s_waitcnt lgkmcnt(3)
  v_mfma_f32_16x16x32_bf16 v[16:19], a[80:83], v[36:39], v[16:19]
  v_mul_f32 v121, v121, v168
  v_mul_f32 v125, v125, v169
  v_mfma_f32_16x16x32_bf16 v[20:23], a[84:87], v[36:39], v[20:23]
  v_mul_f32 v122, v122, v168
  v_mul_f32 v126, v126, v169
  v_mul_f32 v123, v123, v168
  v_mfma_f32_16x16x32_bf16 v[24:27], a[88:91], v[36:39], v[24:27]
  v_mul_f32 v127, v127, v169
  v_mul_f32 v128, v128, v168
  v_mfma_f32_16x16x32_bf16 v[28:31], a[92:95], v[36:39], v[28:31]
  v_mul_f32 v129, v129, v169
  v_cvt_pk_bf16_f32 v132, v120, v121
  ds_read_b128 v[36:39], v5 offset:26624
  s_waitcnt lgkmcnt(3)
  v_mfma_f32_16x16x32_bf16 v[16:19], a[96:99], v[40:43], v[16:19]
  v_cvt_pk_bf16_f32 v133, v122, v123
  v_cvt_pk_bf16_f32 v134, v124, v125
  v_mfma_f32_16x16x32_bf16 v[20:23], a[100:103], v[40:43], v[20:23]
  v_cvt_pk_bf16_f32 v135, v126, v127
  v_cvt_pk_bf16_f32 v140, v128, v129
  v_max3_f32 v168, v76, v77, v78
  v_mfma_f32_16x16x32_bf16 v[24:27], a[104:107], v[40:43], v[24:27]
  v_min3_f32 v169, v76, v77, v78
  v_max3_f32 v168, v168, v79, v80
  v_mfma_f32_16x16x32_bf16 v[28:31], a[108:111], v[40:43], v[28:31]
  v_min3_f32 v169, v169, v79, v80
  v_mov_b32 v170, v168
  ds_read_b128 v[40:43], v4 offset:30720
  s_waitcnt lgkmcnt(3)
  v_mfma_f32_16x16x32_bf16 v[16:19], a[112:115], v[44:47], v[16:19]
  v_mov_b32 v171, v169
  v_permlane16_swap_b32 v168, v170
  v_mfma_f32_16x16x32_bf16 v[20:23], a[116:119], v[44:47], v[20:23]
  v_permlane16_swap_b32 v169, v171
  v_max_f32 v168, v168, v170
  v_mfma_f32_16x16x32_bf16 v[24:27], a[120:123], v[44:47], v[24:27]
  v_min_f32 v169, v169, v171
  v_mov_b32 v170, v168
  v_mfma_f32_16x16x32_bf16 v[28:31], a[124:127], v[44:47], v[28:31]
  v_mov_b32 v171, v169
  v_permlane32_swap_b32 v168, v170
  ds_read_b128 v[44:47], v5 offset:30720
  s_waitcnt lgkmcnt(3)
  v_mfma_f32_16x16x32_bf16 v[16:19], a[128:131], v[32:35], v[16:19]
  v_permlane32_swap_b32 v169, v171
  v_mfma_f32_16x16x32_bf16 v[20:23], a[132:135], v[32:35], v[20:23]
  v_max_f32 v168, v168, v170
  v_min_f32 v169, v169, v171
  v_mul_f32 v168, s69, v168
  v_mfma_f32_16x16x32_bf16 v[24:27], a[136:139], v[32:35], v[24:27]
  v_mul_f32 v169, s69, v169
  v_fma_f32 v120, v76, s69, -v168
  v_mfma_f32_16x16x32_bf16 v[28:31], a[140:143], v[32:35], v[28:31]
  v_fma_f32 v124, -v76, s69, v169
  v_fma_f32 v121, v77, s69, -v168
  ds_read_b128 v[32:35], v4 offset:34816
  s_waitcnt lgkmcnt(3)
  v_mfma_f32_16x16x32_bf16 v[16:19], a[144:147], v[36:39], v[16:19]
  v_fma_f32 v125, -v77, s69, v169
  v_fma_f32 v122, v78, s69, -v168
  v_mfma_f32_16x16x32_bf16 v[20:23], a[148:151], v[36:39], v[20:23]
  v_fma_f32 v126, -v78, s69, v169
  v_fma_f32 v123, v79, s69, -v168
  v_fma_f32 v127, -v79, s69, v169
  v_mfma_f32_16x16x32_bf16 v[24:27], a[152:155], v[36:39], v[24:27]
  v_fma_f32 v128, v80, s69, -v168
  v_fma_f32 v129, -v80, s69, v169
  v_mfma_f32_16x16x32_bf16 v[28:31], a[156:159], v[36:39], v[28:31]
  v_exp_f32 v120, v120
  ds_read_b128 v[36:39], v5 offset:34816
  s_waitcnt lgkmcnt(3)
  v_mfma_f32_16x16x32_bf16 v[16:19], a[160:163], v[40:43], v[16:19]
  v_exp_f32 v121, v121
  v_mfma_f32_16x16x32_bf16 v[20:23], a[164:167], v[40:43], v[20:23]
  v_exp_f32 v122, v122
  v_exp_f32 v123, v123
  v_mfma_f32_16x16x32_bf16 v[24:27], a[168:171], v[40:43], v[24:27]
  v_exp_f32 v124, v124
  v_mfma_f32_16x16x32_bf16 v[28:31], a[172:175], v[40:43], v[28:31]
  v_exp_f32 v125, v125
  ds_read_b128 v[40:43], v4 offset:38912
  s_waitcnt lgkmcnt(3)
  v_mfma_f32_16x16x32_bf16 v[16:19], a[176:179], v[44:47], v[16:19]
  v_exp_f32 v126, v126
  v_mfma_f32_16x16x32_bf16 v[20:23], a[180:183], v[44:47], v[20:23]
  v_exp_f32 v127, v127
  v_exp_f32 v128, v128
  v_mfma_f32_16x16x32_bf16 v[24:27], a[184:187], v[44:47], v[24:27]
  v_exp_f32 v129, v129
  v_mfma_f32_16x16x32_bf16 v[28:31], a[188:191], v[44:47], v[28:31]
  v_add_f32 v168, v120, v121
  v_add_f32 v169, v124, v125
  ds_read_b128 v[44:47], v5 offset:38912
  s_waitcnt lgkmcnt(3)
  v_mfma_f32_16x16x32_bf16 v[16:19], a[192:195], v[32:35], v[16:19]
  v_add_f32 v168, v168, v122
  v_add_f32 v169, v169, v126
  v_mfma_f32_16x16x32_bf16 v[20:23], a[196:199], v[32:35], v[20:23]
  v_add_f32 v168, v168, v123
  v_add_f32 v169, v169, v127
  v_add_f32 v168, v168, v128
  v_mfma_f32_16x16x32_bf16 v[24:27], a[200:203], v[32:35], v[24:27]
  v_add_f32 v169, v169, v129
  v_mov_b32 v170, v168
  v_mfma_f32_16x16x32_bf16 v[28:31], a[204:207], v[32:35], v[28:31]
  v_mov_b32 v171, v169
  v_permlane16_swap_b32 v168, v170
  s_waitcnt lgkmcnt(2)
  v_mfma_f32_16x16x32_bf16 v[16:19], a[208:211], v[36:39], v[16:19]
  v_permlane16_swap_b32 v169, v171
  v_mfma_f32_16x16x32_bf16 v[20:23], a[212:215], v[36:39], v[20:23]
  v_add_f32 v168, v168, v170
  v_add_f32 v169, v169, v171
  v_mov_b32 v170, v168
  v_mfma_f32_16x16x32_bf16 v[24:27], a[216:219], v[36:39], v[24:27]
  v_mov_b32 v171, v169
  v_permlane32_swap_b32 v168, v170
  v_mfma_f32_16x16x32_bf16 v[28:31], a[220:223], v[36:39], v[28:31]
  v_permlane32_swap_b32 v169, v171
  s_waitcnt lgkmcnt(1)
  v_mfma_f32_16x16x32_bf16 v[16:19], a[224:227], v[40:43], v[16:19]
  v_add_f32 v168, v168, v170
  v_add_f32 v169, v169, v171
  v_mfma_f32_16x16x32_bf16 v[20:23], a[228:231], v[40:43], v[20:23]
  v_rcp_f32 v168, v168
  v_rcp_f32 v169, v169
  v_mfma_f32_16x16x32_bf16 v[24:27], a[232:235], v[40:43], v[24:27]
  v_mul_f32 v120, v120, v168
  v_mul_f32 v124, v124, v169
  v_mfma_f32_16x16x32_bf16 v[28:31], a[236:239], v[40:43], v[28:31]
  v_mul_f32 v121, v121, v168
  v_mul_f32 v125, v125, v169
  s_waitcnt lgkmcnt(0)
  v_mfma_f32_16x16x32_bf16 v[16:19], a[240:243], v[44:47], v[16:19]
  v_mul_f32 v122, v122, v168
  v_mul_f32 v126, v126, v169
  v_mfma_f32_16x16x32_bf16 v[20:23], a[244:247], v[44:47], v[20:23]
  v_mul_f32 v123, v123, v168
  v_mul_f32 v127, v127, v169
  v_mul_f32 v128, v128, v168
  v_mfma_f32_16x16x32_bf16 v[24:27], a[248:251], v[44:47], v[24:27]
  v_mul_f32 v129, v129, v169
  v_cvt_pk_bf16_f32 v172, v120, v121
  v_mfma_f32_16x16x32_bf16 v[28:31], a[252:255], v[44:47], v[28:31]
  v_cvt_pk_bf16_f32 v173, v122, v123
  v_cvt_pk_bf16_f32 v174, v124, v125
  v_cvt_pk_bf16_f32 v175, v126, v127
  v_cvt_pk_bf16_f32 v130, v128, v129
  ds_write_b64 v7, v[172:173] offset:0
  ds_write_b64 v7, v[174:175] offset:32
  ds_write_b64 v7, v[130:131] offset:64
  v_cvt_pk_bf16_f32 v48, v16, v17
  v_cvt_pk_bf16_f32 v49, v18, v19
  v_cvt_pk_bf16_f32 v52, v20, v21
  v_cvt_pk_bf16_f32 v53, v22, v23
  v_cvt_pk_bf16_f32 v54, v24, v25
  v_cvt_pk_bf16_f32 v55, v26, v27
  v_cvt_pk_bf16_f32 v50, v28, v29
  v_cvt_pk_bf16_f32 v51, v30, v31
  s_nop 1
  v_mfma_f32_16x16x32_bf16 v[68:71], v[58:61], v[48:51], 0
  v_mfma_f32_16x16x32_bf16 v[72:75], v[64:67], v[48:51], 0
  v_mfma_f32_16x16x32_bf16 v[76:79], v[56:59], v[50:53], 0
  v_mfma_f32_16x16x32_bf16 v[80:83], v[62:65], v[50:53], 0
  ds_write_b64 v7, v[54:55] offset:2656
  ds_write_b64 v7, v[50:51] offset:2688
  s_add_u32 s74, s74, 1
  s_cmp_lt_u32 s74, 8
  s_cbranch_scc1 PA_SEG
  v_max3_f32 v168, v68, v69, v70
  v_min3_f32 v169, v68, v69, v70
  v_max3_f32 v168, v168, v71, v72
  v_min3_f32 v169, v169, v71, v72
  v_mov_b32 v170, v168
  v_mov_b32 v171, v169
  s_nop 0
  v_permlane16_swap_b32 v168, v170
  v_permlane16_swap_b32 v169, v171
  v_max_f32 v168, v168, v170
  v_min_f32 v169, v169, v171
  v_mov_b32 v170, v168
  v_mov_b32 v171, v169
  s_nop 0
  v_permlane32_swap_b32 v168, v170
  v_permlane32_swap_b32 v169, v171
  v_max_f32 v168, v168, v170
  v_min_f32 v169, v169, v171
  v_mul_f32 v168, s69, v168
  v_mul_f32 v169, s69, v169
  v_fma_f32 v120, v68, s69, -v168
  v_fma_f32 v124, -v68, s69, v169
  v_fma_f32 v121, v69, s69, -v168
  v_fma_f32 v125, -v69, s69, v169
  v_fma_f32 v122, v70, s69, -v168
  v_fma_f32 v126, -v70, s69, v169
  v_fma_f32 v123, v71, s69, -v168
  v_fma_f32 v127, -v71, s69, v169
  v_fma_f32 v128, v72, s69, -v168
  v_fma_f32 v129, -v72, s69, v169
  v_exp_f32 v120, v120
  v_exp_f32 v121, v121
  v_exp_f32 v122, v122
  v_exp_f32 v123, v123
  v_exp_f32 v124, v124
  v_exp_f32 v125, v125
  v_exp_f32 v126, v126
  v_exp_f32 v127, v127
  v_exp_f32 v128, v128
  v_exp_f32 v129, v129
  v_add_f32 v168, v120, v121
  v_add_f32 v169, v124, v125
  v_add_f32 v168, v168, v122
  v_add_f32 v169, v169, v126
  v_add_f32 v168, v168, v123
  v_add_f32 v169, v169, v127
  v_add_f32 v168, v168, v128
  v_add_f32 v169, v169, v129
  v_mov_b32 v170, v168
  v_mov_b32 v171, v169
  s_nop 0
  v_permlane16_swap_b32 v168, v170
  v_permlane16_swap_b32 v169, v171
  v_add_f32 v168, v168, v170
  v_add_f32 v169, v169, v171
  v_mov_b32 v170, v168
  v_mov_b32 v171, v169
  s_nop 0
  v_permlane32_swap_b32 v168, v170
  v_permlane32_swap_b32 v169, v171
  v_add_f32 v168, v168, v170
  v_add_f32 v169, v169, v171
  v_rcp_f32 v168, v168
  v_rcp_f32 v169, v169
  v_mul_f32 v120, v120, v168
  v_mul_f32 v124, v124, v169
  v_mul_f32 v121, v121, v168
  v_mul_f32 v125, v125, v169
  v_mul_f32 v122, v122, v168
  v_mul_f32 v126, v126, v169
  v_mul_f32 v123, v123, v168
  v_mul_f32 v127, v127, v169
  v_mul_f32 v128, v128, v168
  v_mul_f32 v129, v129, v169
  v_cvt_pk_bf16_f32 v136, v120, v121
  v_cvt_pk_bf16_f32 v137, v122, v123
  v_cvt_pk_bf16_f32 v138, v124, v125
  v_cvt_pk_bf16_f32 v139, v126, v127
  v_cvt_pk_bf16_f32 v141, v128, v129
  v_max3_f32 v168, v76, v77, v78
  v_min3_f32 v169, v76, v77, v78
  v_max3_f32 v168, v168, v79, v80
  v_min3_f32 v169, v169, v79, v80
  v_mov_b32 v170, v168
  v_mov_b32 v171, v169
  s_nop 0
  v_permlane16_swap_b32 v168, v170
  v_permlane16_swap_b32 v169, v171
  v_max_f32 v168, v168, v170
  v_min_f32 v169, v169, v171
  v_mov_b32 v170, v168
  v_mov_b32 v171, v169
  s_nop 0
  v_permlane32_swap_b32 v168, v170
  v_permlane32_swap_b32 v169, v171
  v_max_f32 v168, v168, v170
  v_min_f32 v169, v169, v171
  v_mul_f32 v168, s69, v168
  v_mul_f32 v169, s69, v169
  v_fma_f32 v120, v76, s69, -v168
  v_fma_f32 v124, -v76, s69, v169
  v_fma_f32 v121, v77, s69, -v168
  v_fma_f32 v125, -v77, s69, v169
  v_fma_f32 v122, v78, s69, -v168
  v_fma_f32 v126, -v78, s69, v169
  v_fma_f32 v123, v79, s69, -v168
  v_fma_f32 v127, -v79, s69, v169
  v_fma_f32 v128, v80, s69, -v168
  v_fma_f32 v129, -v80, s69, v169
  v_exp_f32 v120, v120
  v_exp_f32 v121, v121
  v_exp_f32 v122, v122
  v_exp_f32 v123, v123
  v_exp_f32 v124, v124
  v_exp_f32 v125, v125
  v_exp_f32 v126, v126
  v_exp_f32 v127, v127
  v_exp_f32 v128, v128
  v_exp_f32 v129, v129
  v_add_f32 v168, v120, v121
  v_add_f32 v169, v124, v125
  v_add_f32 v168, v168, v122
  v_add_f32 v169, v169, v126
  v_add_f32 v168, v168, v123
  v_add_f32 v169, v169, v127
  v_add_f32 v168, v168, v128
  v_add_f32 v169, v169, v129
  v_mov_b32 v170, v168
  v_mov_b32 v171, v169
  s_nop 0
  v_permlane16_swap_b32 v168, v170
  v_permlane16_swap_b32 v169, v171
  v_add_f32 v168, v168, v170
  v_add_f32 v169, v169, v171
  v_mov_b32 v170, v168
  v_mov_b32 v171, v169
  s_nop 0
  v_permlane32_swap_b32 v168, v170
  v_permlane32_swap_b32 v169, v171
  v_add_f32 v168, v168, v170
  v_add_f32 v169, v169, v171
  v_rcp_f32 v168, v168
  v_rcp_f32 v169, v169
  v_mul_f32 v120, v120, v168
  v_mul_f32 v124, v124, v169
  v_mul_f32 v121, v121, v168
  v_mul_f32 v125, v125, v169
  v_mul_f32 v122, v122, v168
  v_mul_f32 v126, v126, v169
  v_mul_f32 v123, v123, v168
  v_mul_f32 v127, v127, v169
  v_mul_f32 v128, v128, v168
  v_mul_f32 v129, v129, v169
  v_cvt_pk_bf16_f32 v172, v120, v121
  v_cvt_pk_bf16_f32 v173, v122, v123
  v_cvt_pk_bf16_f32 v174, v124, v125
  v_cvt_pk_bf16_f32 v175, v126, v127
  v_cvt_pk_bf16_f32 v130, v128, v129
  ds_write_b64 v7, v[172:173] offset:2560
  ds_write_b64 v7, v[174:175] offset:2592
  ds_write_b64 v7, v[130:131] offset:2624
  ds_read_b64_tr_b16 v[144:145], v8 offset:0
  ds_read_b64_tr_b16 v[146:147], v8 offset:2560
  ds_read_b64_tr_b16 v[148:149], v8 offset:32
  ds_read_b64_tr_b16 v[150:151], v8 offset:2592
  ds_read_b64_tr_b16 v[152:153], v8 offset:64
  ds_read_b64_tr_b16 v[154:155], v8 offset:2624
  ds_read_b64_tr_b16 v[156:157], v8 offset:96
  ds_read_b64_tr_b16 v[158:159], v8 offset:2656
  ds_read_b64_tr_b16 v[160:161], v8 offset:128
  ds_read_b64_tr_b16 v[162:163], v8 offset:2688
  s_waitcnt lgkmcnt(0)
  v_mfma_f32_16x16x32_bf16 v[84:87], v[144:147], v[156:159], v[84:87]
  v_mfma_f32_16x16x32_bf16 v[88:91], v[148:151], v[156:159], v[88:91]
  v_mfma_f32_16x16x32_bf16 v[92:95], v[152:155], v[156:159], v[92:95]
  buffer_store_dwordx4 v[132:135], v6, s[32:35], s68 offen sc1
  v_mfma_f32_16x16x32_bf16 v[96:99], v[144:147], v[160:163], v[96:99]
  v_mfma_f32_16x16x32_bf16 v[100:103], v[148:151], v[160:163], v[100:103]
  v_mfma_f32_16x16x32_bf16 v[104:107], v[152:155], v[160:163], v[104:107]
  buffer_store_dwordx4 v[136:139], v6, s[32:35], s68 offen offset:1024 sc1
  v_mfma_f32_16x16x32_bf16 v[108:111], v[144:147], v[12:15], v[108:111]
  v_mfma_f32_16x16x32_bf16 v[112:115], v[148:151], v[12:15], v[112:115]
  v_mfma_f32_16x16x32_bf16 v[116:119], v[152:155], v[12:15], v[116:119]
  buffer_store_dwordx4 v[140:143], v6, s[32:35], s68 offen offset:2048 sc1
  s_and_b32 s53, s74, 1
  s_cselect_b32 s53, 0, 8192
  s_add_u32 s68, s68, 4096
  s_add_u32 s68, s68, s53
  s_sub_u32 s68, s68, 65536
  s_lshl_b32 s54, s62, 2
  s_add_u32 s54, s54, s49
  s_mul_i32 s55, s54, 0x4000
  s_add_u32 s55, s55, 0x5900000
  s_lshr_b32 s53, s55, 7
  s_and_b32 s53, s53, 0x2000
  s_xor_b32 s53, s53, s51
  s_lshl_b32 s55, s55, 1
  s_or_b32 s55, s55, s53
  buffer_store_dwordx4 v[84:87], v6, s[32:35], s55 offen sc1
  buffer_store_dwordx4 v[88:91], v6, s[32:35], s55 offen offset:1024 sc1
  buffer_store_dwordx4 v[92:95], v6, s[32:35], s55 offen offset:2048 sc1
  buffer_store_dwordx4 v[96:99], v6, s[32:35], s55 offen offset:3072 sc1
  s_add_u32 s55, s55, 4096
  buffer_store_dwordx4 v[100:103], v6, s[32:35], s55 offen sc1
  buffer_store_dwordx4 v[104:107], v6, s[32:35], s55 offen offset:1024 sc1
  buffer_store_dwordx4 v[108:111], v6, s[32:35], s55 offen offset:2048 sc1
  buffer_store_dwordx4 v[112:115], v6, s[32:35], s55 offen offset:3072 sc1
  s_add_u32 s55, s55, 12288
  buffer_store_dwordx4 v[116:119], v6, s[32:35], s55 offen sc1
  s_lshl_b32 s54, s62, 7
  s_add_u32 s54, s54, s51
  s_add_u32 s54, s54, 81920
  s_cmp_eq_u32 s49, 0
  s_cselect_b32 s54, s54, 0x40000000
  v_mov_b32 v10, 0x40000000
  s_nop 0
  v_writelane_b32 v10, s54, 0
  v_mov_b32 v168, 1
  s_waitcnt vmcnt(0)
  s_barrier
  buffer_store_dword v168, v10, s[32:35], 0 offen sc1
  s_mul_i32 s76, s62, 52
  s_lshr_b32 s76, s76, 8
  s_mul_i32 s53, s76, 5
  s_sub_u32 s75, s62, s53
  s_mov_b32 s36, s10
  s_and_b32 s37, s11, 0xffff
  s_mov_b32 s38, 0xc8000
  s_mov_b32 s39, 0x20000
  v_lshrrev_b32 v44, 4, v0
  s_mul_i32 s53, s49, 20
  s_add_u32 s53, s53, 0
  v_add_u32 v44, s53, v44
  v_and_b32 v45, 7, v44
  v_lshlrev_b32 v45, 1, v45
  v_and_b32 v46, 15, v0
  v_xor_b32 v45, v45, v46
  v_mul_u32_u24 v44, 1280, v44
  v_lshl_add_u32 v44, v45, 4, v44
  s_lshl_b32 s53, s75, 8
  v_add_u32 v176, s53, v44
  v_lshrrev_b32 v44, 4, v0
  s_mul_i32 s53, s49, 20
  s_add_u32 s53, s53, 4
  v_add_u32 v44, s53, v44
  v_and_b32 v45, 7, v44
  v_lshlrev_b32 v45, 1, v45
  v_and_b32 v46, 15, v0
  v_xor_b32 v45, v45, v46
  v_mul_u32_u24 v44, 1280, v44
  v_lshl_add_u32 v44, v45, 4, v44
  s_lshl_b32 s53, s75, 8
  v_add_u32 v177, s53, v44
  v_lshrrev_b32 v44, 4, v0
  s_mul_i32 s53, s49, 20
  s_add_u32 s53, s53, 8
  v_add_u32 v44, s53, v44
  v_and_b32 v45, 7, v44
  v_lshlrev_b32 v45, 1, v45
  v_and_b32 v46, 15, v0
  v_xor_b32 v45, v45, v46
  v_mul_u32_u24 v44, 1280, v44
  v_lshl_add_u32 v44, v45, 4, v44
  s_lshl_b32 s53, s75, 8
  v_add_u32 v178, s53, v44
  v_lshrrev_b32 v44, 4, v0
  s_mul_i32 s53, s49, 20
  s_add_u32 s53, s53, 12
  v_add_u32 v44, s53, v44
  v_and_b32 v45, 7, v44
  v_lshlrev_b32 v45, 1, v45
  v_and_b32 v46, 15, v0
  v_xor_b32 v45, v45, v46
  v_mul_u32_u24 v44, 1280, v44
  v_lshl_add_u32 v44, v45, 4, v44
  s_lshl_b32 s53, s75, 8
  v_add_u32 v179, s53, v44
  v_lshrrev_b32 v44, 4, v0
  s_mul_i32 s53, s49, 20
  s_add_u32 s53, s53, 16
  v_add_u32 v44, s53, v44
  v_and_b32 v45, 7, v44
  v_lshlrev_b32 v45, 1, v45
  v_and_b32 v46, 15, v0
  v_xor_b32 v45, v45, v46
  v_mul_u32_u24 v44, 1280, v44
  v_lshl_add_u32 v44, v45, 4, v44
  s_lshl_b32 s53, s75, 8
  v_add_u32 v180, s53, v44
  v_lshrrev_b32 v40, 4, v0
  v_bfe_u32 v41, v0, 2, 2
  v_and_b32 v47, 3, v0
  v_lshl_add_u32 v44, v40, 2, v41
  v_add_u32 v44, 0, v44
  v_and_b32 v45, 7, v44
  v_lshlrev_b32 v44, 8, v44
  v_lshl_add_u32 v44, v47, 3, v44
  s_lshl_b32 s53, s49, 1
  s_add_u32 s53, s53, 0
  v_xor_b32 v46, s53, v45
  v_lshl_add_u32 v182, v46, 5, v44
  s_lshl_b32 s53, s49, 1
  s_add_u32 s53, s53, 1
  v_xor_b32 v46, s53, v45
  v_lshl_add_u32 v183, v46, 5, v44
  v_lshl_add_u32 v44, v40, 2, v41
  v_add_u32 v44, 20, v44
  v_and_b32 v45, 7, v44
  v_lshlrev_b32 v44, 8, v44
  v_lshl_add_u32 v44, v47, 3, v44
  s_lshl_b32 s53, s49, 1
  s_add_u32 s53, s53, 0
  v_xor_b32 v46, s53, v45
  v_lshl_add_u32 v184, v46, 5, v44
  s_lshl_b32 s53, s49, 1
  s_add_u32 s53, s53, 1
  v_xor_b32 v46, s53, v45
  v_lshl_add_u32 v185, v46, 5, v44
  v_mul_u32_u24 v44, 20, v40
  v_add3_u32 v44, v44, v41, 16
  v_and_b32 v45, 7, v44
  v_lshlrev_b32 v44, 8, v44
  v_lshl_add_u32 v44, v47, 3, v44
  s_lshl_b32 s53, s49, 1
  s_add_u32 s53, s53, 0
  v_xor_b32 v46, s53, v45
  v_lshl_add_u32 v186, v46, 5, v44
  s_lshl_b32 s53, s49, 1
  s_add_u32 s53, s53, 1
  v_xor_b32 v46, s53, v45
  v_lshl_add_u32 v187, v46, 5, v44
  buffer_load_dwordx4 a[0:3], v6, s[32:35], s68 offen sc1
  buffer_load_dwordx4 a[4:7], v6, s[32:35], s68 offen offset:1024 sc1
  buffer_load_dwordx4 a[8:11], v6, s[32:35], s68 offen offset:2048 sc1
  s_add_u32 s68, s68, 4096
  buffer_load_dwordx4 a[12:15], v6, s[32:35], s68 offen sc1
  buffer_load_dwordx4 a[16:19], v6, s[32:35], s68 offen offset:1024 sc1
  buffer_load_dwordx4 a[20:23], v6, s[32:35], s68 offen offset:2048 sc1
  s_add_u32 s68, s68, 12288
  buffer_load_dwordx4 a[24:27], v6, s[32:35], s68 offen sc1
  buffer_load_dwordx4 a[28:31], v6, s[32:35], s68 offen offset:1024 sc1
  buffer_load_dwordx4 a[32:35], v6, s[32:35], s68 offen offset:2048 sc1
  s_add_u32 s68, s68, 4096
  buffer_load_dwordx4 a[36:39], v6, s[32:35], s68 offen sc1
  buffer_load_dwordx4 a[40:43], v6, s[32:35], s68 offen offset:1024 sc1
  buffer_load_dwordx4 a[44:47], v6, s[32:35], s68 offen offset:2048 sc1
  s_add_u32 s68, s68, 12288
  buffer_load_dwordx4 a[48:51], v6, s[32:35], s68 offen sc1
  buffer_load_dwordx4 a[52:55], v6, s[32:35], s68 offen offset:1024 sc1
  buffer_load_dwordx4 a[56:59], v6, s[32:35], s68 offen offset:2048 sc1
  s_add_u32 s68, s68, 4096
  buffer_load_dwordx4 a[60:63], v6, s[32:35], s68 offen sc1
  buffer_load_dwordx4 a[64:67], v6, s[32:35], s68 offen offset:1024 sc1
  buffer_load_dwordx4 a[68:71], v6, s[32:35], s68 offen offset:2048 sc1
  s_add_u32 s68, s68, 12288
  buffer_load_dwordx4 a[72:75], v6, s[32:35], s68 offen sc1
  buffer_load_dwordx4 a[76:79], v6, s[32:35], s68 offen offset:1024 sc1
  buffer_load_dwordx4 a[80:83], v6, s[32:35], s68 offen offset:2048 sc1
  s_add_u32 s68, s68, 4096
  buffer_load_dwordx4 a[84:87], v6, s[32:35], s68 offen sc1
  buffer_load_dwordx4 a[88:91], v6, s[32:35], s68 offen offset:1024 sc1
  buffer_load_dwordx4 a[92:95], v6, s[32:35], s68 offen offset:2048 sc1
  s_add_u32 s68, s68, 12288
  s_lshl_b32 s54, s63, 7
  s_add_u32 s54, s54, s51
  s_add_u32 s54, s54, 81920
  v_lshl_add_u32 v168, v0, 10, s54
  s_mov_b32 s55, 1
  s_mov_b64 exec, 255
  s_mov_b32 s57, 0
PL_62:
  buffer_load_dword v169, v168, s[32:35], 0 offen sc1
  s_waitcnt vmcnt(0)
  v_cmp_gt_u32 vcc, s55, v169
  s_cbranch_vccz PR_63
  s_add_u32 s57, s57, 1
  s_cmp_lt_u32 s57, 0x80000
  s_cbranch_scc1 PL_62
  s_branch L_EXIT
PR_63:
  s_mov_b64 exec, -1
  s_add_u32 s54, s71, 0
  s_mul_i32 s55, s54, 0x4000
  s_add_u32 s55, s55, 0x5900000
  s_lshr_b32 s53, s55, 7
  s_and_b32 s53, s53, 0x2000
  s_xor_b32 s53, s53, s51
  s_lshl_b32 s55, s55, 1
  s_or_b32 s55, s55, s53
  buffer_load_dwordx4 v[84:87], v6, s[32:35], s55 offen sc1
  buffer_load_dwordx4 v[88:91], v6, s[32:35], s55 offen offset:1024 sc1
  buffer_load_dwordx4 v[92:95], v6, s[32:35], s55 offen offset:2048 sc1
  buffer_load_dwordx4 v[96:99], v6, s[32:35], s55 offen offset:3072 sc1
  s_add_u32 s55, s55, 4096
  buffer_load_dwordx4 v[100:103], v6, s[32:35], s55 offen sc1
  buffer_load_dwordx4 v[104:107], v6, s[32:35], s55 offen offset:1024 sc1
  buffer_load_dwordx4 v[108:111], v6, s[32:35], s55 offen offset:2048 sc1
  buffer_load_dwordx4 v[112:115], v6, s[32:35], s55 offen offset:3072 sc1
  s_add_u32 s55, s55, 12288
  buffer_load_dwordx4 v[116:119], v6, s[32:35], s55 offen sc1
  s_add_u32 s54, s71, 32
  s_mul_i32 s55, s54, 0x4000
  s_add_u32 s55, s55, 0x5900000
  s_lshr_b32 s53, s55, 7
  s_and_b32 s53, s53, 0x2000
  s_xor_b32 s53, s53, s51
  s_lshl_b32 s55, s55, 1
  s_or_b32 s55, s55, s53
  buffer_load_dwordx4 v[192:195], v6, s[32:35], s55 offen sc1
  buffer_load_dwordx4 v[196:199], v6, s[32:35], s55 offen offset:1024 sc1
  buffer_load_dwordx4 v[200:203], v6, s[32:35], s55 offen offset:2048 sc1
  buffer_load_dwordx4 v[204:207], v6, s[32:35], s55 offen offset:3072 sc1
  s_add_u32 s55, s55, 4096
  buffer_load_dwordx4 v[208:211], v6, s[32:35], s55 offen sc1
  buffer_load_dwordx4 v[212:215], v6, s[32:35], s55 offen offset:1024 sc1
  buffer_load_dwordx4 v[216:219], v6, s[32:35], s55 offen offset:2048 sc1
  buffer_load_dwordx4 v[220:223], v6, s[32:35], s55 offen offset:3072 sc1
  s_add_u32 s55, s55, 12288
  buffer_load_dwordx4 v[224:227], v6, s[32:35], s55 offen sc1
  s_add_u32 s54, s71, 64
  s_mul_i32 s55, s54, 0x4000
  s_add_u32 s55, s55, 0x5900000
  s_lshr_b32 s53, s55, 7
  s_and_b32 s53, s53, 0x2000
  s_xor_b32 s53, s53, s51
  s_lshl_b32 s55, s55, 1
  s_or_b32 s55, s55, s53
  buffer_load_dwordx4 v[16:19], v6, s[32:35], s55 offen sc1
  buffer_load_dwordx4 v[20:23], v6, s[32:35], s55 offen offset:1024 sc1
  buffer_load_dwordx4 v[24:27], v6, s[32:35], s55 offen offset:2048 sc1
  buffer_load_dwordx4 v[28:31], v6, s[32:35], s55 offen offset:3072 sc1
  s_add_u32 s55, s55, 4096
  buffer_load_dwordx4 v[32:35], v6, s[32:35], s55 offen sc1
  buffer_load_dwordx4 v[36:39], v6, s[32:35], s55 offen offset:1024 sc1
  buffer_load_dwordx4 v[40:43], v6, s[32:35], s55 offen offset:2048 sc1
  buffer_load_dwordx4 v[44:47], v6, s[32:35], s55 offen offset:3072 sc1
  s_add_u32 s55, s55, 12288
  buffer_load_dwordx4 v[48:51], v6, s[32:35], s55 offen sc1
  s_waitcnt vmcnt(9)
  v_pk_add_f32 v[84:85], v[84:85], v[192:193]
  v_pk_add_f32 v[86:87], v[86:87], v[194:195]
  v_pk_add_f32 v[88:89], v[88:89], v[196:197]
  v_pk_add_f32 v[90:91], v[90:91], v[198:199]
  v_pk_add_f32 v[92:93], v[92:93], v[200:201]
  v_pk_add_f32 v[94:95], v[94:95], v[202:203]
  v_pk_add_f32 v[96:97], v[96:97], v[204:205]
  v_pk_add_f32 v[98:99], v[98:99], v[206:207]
  v_pk_add_f32 v[100:101], v[100:101], v[208:209]
  v_pk_add_f32 v[102:103], v[102:103], v[210:211]
  v_pk_add_f32 v[104:105], v[104:105], v[212:213]
  v_pk_add_f32 v[106:107], v[106:107], v[214:215]
  v_pk_add_f32 v[108:109], v[108:109], v[216:217]
  v_pk_add_f32 v[110:111], v[110:111], v[218:219]
  v_pk_add_f32 v[112:113], v[112:113], v[220:221]
  v_pk_add_f32 v[114:115], v[114:115], v[222:223]
  v_pk_add_f32 v[116:117], v[116:117], v[224:225]
  v_pk_add_f32 v[118:119], v[118:119], v[226:227]
  s_add_u32 s54, s71, 96
  s_mul_i32 s55, s54, 0x4000
  s_add_u32 s55, s55, 0x5900000
  s_lshr_b32 s53, s55, 7
  s_and_b32 s53, s53, 0x2000
  s_xor_b32 s53, s53, s51
  s_lshl_b32 s55, s55, 1
  s_or_b32 s55, s55, s53
  buffer_load_dwordx4 v[192:195], v6, s[32:35], s55 offen sc1
  buffer_load_dwordx4 v[196:199], v6, s[32:35], s55 offen offset:1024 sc1
  buffer_load_dwordx4 v[200:203], v6, s[32:35], s55 offen offset:2048 sc1
  buffer_load_dwordx4 v[204:207], v6, s[32:35], s55 offen offset:3072 sc1
  s_add_u32 s55, s55, 4096
  buffer_load_dwordx4 v[208:211], v6, s[32:35], s55 offen sc1
  buffer_load_dwordx4 v[212:215], v6, s[32:35], s55 offen offset:1024 sc1
  buffer_load_dwordx4 v[216:219], v6, s[32:35], s55 offen offset:2048 sc1
  buffer_load_dwordx4 v[220:223], v6, s[32:35], s55 offen offset:3072 sc1
  s_add_u32 s55, s55, 12288
  buffer_load_dwordx4 v[224:227], v6, s[32:35], s55 offen sc1
  s_waitcnt vmcnt(9)
  v_pk_add_f32 v[84:85], v[84:85], v[16:17]
  v_pk_add_f32 v[86:87], v[86:87], v[18:19]
  v_pk_add_f32 v[88:89], v[88:89], v[20:21]
  v_pk_add_f32 v[90:91], v[90:91], v[22:23]
  v_pk_add_f32 v[92:93], v[92:93], v[24:25]
  v_pk_add_f32 v[94:95], v[94:95], v[26:27]
  v_pk_add_f32 v[96:97], v[96:97], v[28:29]
  v_pk_add_f32 v[98:99], v[98:99], v[30:31]
  v_pk_add_f32 v[100:101], v[100:101], v[32:33]
  v_pk_add_f32 v[102:103], v[102:103], v[34:35]
  v_pk_add_f32 v[104:105], v[104:105], v[36:37]
  v_pk_add_f32 v[106:107], v[106:107], v[38:39]
  v_pk_add_f32 v[108:109], v[108:109], v[40:41]
  v_pk_add_f32 v[110:111], v[110:111], v[42:43]
  v_pk_add_f32 v[112:113], v[112:113], v[44:45]
  v_pk_add_f32 v[114:115], v[114:115], v[46:47]
  v_pk_add_f32 v[116:117], v[116:117], v[48:49]
  v_pk_add_f32 v[118:119], v[118:119], v[50:51]
  s_add_u32 s54, s71, 128
  s_mul_i32 s55, s54, 0x4000
  s_add_u32 s55, s55, 0x5900000
  s_lshr_b32 s53, s55, 7
  s_and_b32 s53, s53, 0x2000
  s_xor_b32 s53, s53, s51
  s_lshl_b32 s55, s55, 1
  s_or_b32 s55, s55, s53
  buffer_load_dwordx4 v[16:19], v6, s[32:35], s55 offen sc1
  buffer_load_dwordx4 v[20:23], v6, s[32:35], s55 offen offset:1024 sc1
  buffer_load_dwordx4 v[24:27], v6, s[32:35], s55 offen offset:2048 sc1
  buffer_load_dwordx4 v[28:31], v6, s[32:35], s55 offen offset:3072 sc1
  s_add_u32 s55, s55, 4096
  buffer_load_dwordx4 v[32:35], v6, s[32:35], s55 offen sc1
  buffer_load_dwordx4 v[36:39], v6, s[32:35], s55 offen offset:1024 sc1
  buffer_load_dwordx4 v[40:43], v6, s[32:35], s55 offen offset:2048 sc1
  buffer_load_dwordx4 v[44:47], v6, s[32:35], s55 offen offset:3072 sc1
  s_add_u32 s55, s55, 12288
  buffer_load_dwordx4 v[48:51], v6, s[32:35], s55 offen sc1
  s_waitcnt vmcnt(9)
  v_pk_add_f32 v[84:85], v[84:85], v[192:193]
  v_pk_add_f32 v[86:87], v[86:87], v[194:195]
  v_pk_add_f32 v[88:89], v[88:89], v[196:197]
  v_pk_add_f32 v[90:91], v[90:91], v[198:199]
  v_pk_add_f32 v[92:93], v[92:93], v[200:201]
  v_pk_add_f32 v[94:95], v[94:95], v[202:203]
  v_pk_add_f32 v[96:97], v[96:97], v[204:205]
  v_pk_add_f32 v[98:99], v[98:99], v[206:207]
  v_pk_add_f32 v[100:101], v[100:101], v[208:209]
  v_pk_add_f32 v[102:103], v[102:103], v[210:211]
  v_pk_add_f32 v[104:105], v[104:105], v[212:213]
  v_pk_add_f32 v[106:107], v[106:107], v[214:215]
  v_pk_add_f32 v[108:109], v[108:109], v[216:217]
  v_pk_add_f32 v[110:111], v[110:111], v[218:219]
  v_pk_add_f32 v[112:113], v[112:113], v[220:221]
  v_pk_add_f32 v[114:115], v[114:115], v[222:223]
  v_pk_add_f32 v[116:117], v[116:117], v[224:225]
  v_pk_add_f32 v[118:119], v[118:119], v[226:227]
  s_add_u32 s54, s71, 160
  s_mul_i32 s55, s54, 0x4000
  s_add_u32 s55, s55, 0x5900000
  s_lshr_b32 s53, s55, 7
  s_and_b32 s53, s53, 0x2000
  s_xor_b32 s53, s53, s51
  s_lshl_b32 s55, s55, 1
  s_or_b32 s55, s55, s53
  buffer_load_dwordx4 v[192:195], v6, s[32:35], s55 offen sc1
  buffer_load_dwordx4 v[196:199], v6, s[32:35], s55 offen offset:1024 sc1
  buffer_load_dwordx4 v[200:203], v6, s[32:35], s55 offen offset:2048 sc1
  buffer_load_dwordx4 v[204:207], v6, s[32:35], s55 offen offset:3072 sc1
  s_add_u32 s55, s55, 4096
  buffer_load_dwordx4 v[208:211], v6, s[32:35], s55 offen sc1
  buffer_load_dwordx4 v[212:215], v6, s[32:35], s55 offen offset:1024 sc1
  buffer_load_dwordx4 v[216:219], v6, s[32:35], s55 offen offset:2048 sc1
  buffer_load_dwordx4 v[220:223], v6, s[32:35], s55 offen offset:3072 sc1
  s_add_u32 s55, s55, 12288
  buffer_load_dwordx4 v[224:227], v6, s[32:35], s55 offen sc1
  s_waitcnt vmcnt(9)
  v_pk_add_f32 v[84:85], v[84:85], v[16:17]
  v_pk_add_f32 v[86:87], v[86:87], v[18:19]
  v_pk_add_f32 v[88:89], v[88:89], v[20:21]
  v_pk_add_f32 v[90:91], v[90:91], v[22:23]
  v_pk_add_f32 v[92:93], v[92:93], v[24:25]
  v_pk_add_f32 v[94:95], v[94:95], v[26:27]
  v_pk_add_f32 v[96:97], v[96:97], v[28:29]
  v_pk_add_f32 v[98:99], v[98:99], v[30:31]
  v_pk_add_f32 v[100:101], v[100:101], v[32:33]
  v_pk_add_f32 v[102:103], v[102:103], v[34:35]
  v_pk_add_f32 v[104:105], v[104:105], v[36:37]
  v_pk_add_f32 v[106:107], v[106:107], v[38:39]
  v_pk_add_f32 v[108:109], v[108:109], v[40:41]
  v_pk_add_f32 v[110:111], v[110:111], v[42:43]
  v_pk_add_f32 v[112:113], v[112:113], v[44:45]
  v_pk_add_f32 v[114:115], v[114:115], v[46:47]
  v_pk_add_f32 v[116:117], v[116:117], v[48:49]
  v_pk_add_f32 v[118:119], v[118:119], v[50:51]
  s_add_u32 s54, s71, 192
  s_mul_i32 s55, s54, 0x4000
  s_add_u32 s55, s55, 0x5900000
  s_lshr_b32 s53, s55, 7
  s_and_b32 s53, s53, 0x2000
  s_xor_b32 s53, s53, s51
  s_lshl_b32 s55, s55, 1
  s_or_b32 s55, s55, s53
  buffer_load_dwordx4 v[16:19], v6, s[32:35], s55 offen sc1
  buffer_load_dwordx4 v[20:23], v6, s[32:35], s55 offen offset:1024 sc1
  buffer_load_dwordx4 v[24:27], v6, s[32:35], s55 offen offset:2048 sc1
  buffer_load_dwordx4 v[28:31], v6, s[32:35], s55 offen offset:3072 sc1
  s_add_u32 s55, s55, 4096
  buffer_load_dwordx4 v[32:35], v6, s[32:35], s55 offen sc1
  buffer_load_dwordx4 v[36:39], v6, s[32:35], s55 offen offset:1024 sc1
  buffer_load_dwordx4 v[40:43], v6, s[32:35], s55 offen offset:2048 sc1
  buffer_load_dwordx4 v[44:47], v6, s[32:35], s55 offen offset:3072 sc1
  s_add_u32 s55, s55, 12288
  buffer_load_dwordx4 v[48:51], v6, s[32:35], s55 offen sc1
  s_waitcnt vmcnt(9)
  v_pk_add_f32 v[84:85], v[84:85], v[192:193]
  v_pk_add_f32 v[86:87], v[86:87], v[194:195]
  v_pk_add_f32 v[88:89], v[88:89], v[196:197]
  v_pk_add_f32 v[90:91], v[90:91], v[198:199]
  v_pk_add_f32 v[92:93], v[92:93], v[200:201]
  v_pk_add_f32 v[94:95], v[94:95], v[202:203]
  v_pk_add_f32 v[96:97], v[96:97], v[204:205]
  v_pk_add_f32 v[98:99], v[98:99], v[206:207]
  v_pk_add_f32 v[100:101], v[100:101], v[208:209]
  v_pk_add_f32 v[102:103], v[102:103], v[210:211]
  v_pk_add_f32 v[104:105], v[104:105], v[212:213]
  v_pk_add_f32 v[106:107], v[106:107], v[214:215]
  v_pk_add_f32 v[108:109], v[108:109], v[216:217]
  v_pk_add_f32 v[110:111], v[110:111], v[218:219]
  v_pk_add_f32 v[112:113], v[112:113], v[220:221]
  v_pk_add_f32 v[114:115], v[114:115], v[222:223]
  v_pk_add_f32 v[116:117], v[116:117], v[224:225]
  v_pk_add_f32 v[118:119], v[118:119], v[226:227]
  s_add_u32 s54, s71, 224
  s_mul_i32 s55, s54, 0x4000
  s_add_u32 s55, s55, 0x5900000
  s_lshr_b32 s53, s55, 7
  s_and_b32 s53, s53, 0x2000
  s_xor_b32 s53, s53, s51
  s_lshl_b32 s55, s55, 1
  s_or_b32 s55, s55, s53
  buffer_load_dwordx4 v[192:195], v6, s[32:35], s55 offen sc1
  buffer_load_dwordx4 v[196:199], v6, s[32:35], s55 offen offset:1024 sc1
  buffer_load_dwordx4 v[200:203], v6, s[32:35], s55 offen offset:2048 sc1
  buffer_load_dwordx4 v[204:207], v6, s[32:35], s55 offen offset:3072 sc1
  s_add_u32 s55, s55, 4096
  buffer_load_dwordx4 v[208:211], v6, s[32:35], s55 offen sc1
  buffer_load_dwordx4 v[212:215], v6, s[32:35], s55 offen offset:1024 sc1
  buffer_load_dwordx4 v[216:219], v6, s[32:35], s55 offen offset:2048 sc1
  buffer_load_dwordx4 v[220:223], v6, s[32:35], s55 offen offset:3072 sc1
  s_add_u32 s55, s55, 12288
  buffer_load_dwordx4 v[224:227], v6, s[32:35], s55 offen sc1
  s_waitcnt vmcnt(9)
  v_pk_add_f32 v[84:85], v[84:85], v[16:17]
  v_pk_add_f32 v[86:87], v[86:87], v[18:19]
  v_pk_add_f32 v[88:89], v[88:89], v[20:21]
  v_pk_add_f32 v[90:91], v[90:91], v[22:23]
  v_pk_add_f32 v[92:93], v[92:93], v[24:25]
  v_pk_add_f32 v[94:95], v[94:95], v[26:27]
  v_pk_add_f32 v[96:97], v[96:97], v[28:29]
  v_pk_add_f32 v[98:99], v[98:99], v[30:31]
  v_pk_add_f32 v[100:101], v[100:101], v[32:33]
  v_pk_add_f32 v[102:103], v[102:103], v[34:35]
  v_pk_add_f32 v[104:105], v[104:105], v[36:37]
  v_pk_add_f32 v[106:107], v[106:107], v[38:39]
  v_pk_add_f32 v[108:109], v[108:109], v[40:41]
  v_pk_add_f32 v[110:111], v[110:111], v[42:43]
  v_pk_add_f32 v[112:113], v[112:113], v[44:45]
  v_pk_add_f32 v[114:115], v[114:115], v[46:47]
  v_pk_add_f32 v[116:117], v[116:117], v[48:49]
  v_pk_add_f32 v[118:119], v[118:119], v[50:51]
  s_mov_b32 s54, 0
  s_mul_i32 s53, s49, 5120
  s_add_u32 m0, s53, 0
  s_nop 0
  buffer_load_dwordx4 v176, s[36:39], s54 offen  lds
  s_add_u32 m0, m0, 1024
  s_nop 0
  buffer_load_dwordx4 v177, s[36:39], s54 offen  lds
  s_add_u32 m0, m0, 1024
  s_nop 0
  buffer_load_dwordx4 v178, s[36:39], s54 offen  lds
  s_add_u32 m0, m0, 1024
  s_nop 0
  buffer_load_dwordx4 v179, s[36:39], s54 offen  lds
  s_add_u32 m0, m0, 1024
  s_nop 0
  buffer_load_dwordx4 v180, s[36:39], s54 offen  lds
  s_mov_b32 s54, 102400
  s_mul_i32 s53, s49, 5120
  s_add_u32 m0, s53, 20480
  s_nop 0
  buffer_load_dwordx4 v176, s[36:39], s54 offen  lds
  s_add_u32 m0, m0, 1024
  s_nop 0
  buffer_load_dwordx4 v177, s[36:39], s54 offen  lds
  s_add_u32 m0, m0, 1024
  s_nop 0
  buffer_load_dwordx4 v178, s[36:39], s54 offen  lds
  s_add_u32 m0, m0, 1024
  s_nop 0
  buffer_load_dwordx4 v179, s[36:39], s54 offen  lds
  s_add_u32 m0, m0, 1024
  s_nop 0
  buffer_load_dwordx4 v180, s[36:39], s54 offen  lds
  s_mov_b32 s54, 204800
  s_mul_i32 s53, s49, 5120
  s_add_u32 m0, s53, 40960
  s_nop 0
  buffer_load_dwordx4 v176, s[36:39], s54 offen  lds
  s_add_u32 m0, m0, 1024
  s_nop 0
  buffer_load_dwordx4 v177, s[36:39], s54 offen  lds
  s_add_u32 m0, m0, 1024
  s_nop 0
  buffer_load_dwordx4 v178, s[36:39], s54 offen  lds
  s_add_u32 m0, m0, 1024
  s_nop 0
  buffer_load_dwordx4 v179, s[36:39], s54 offen  lds
  s_add_u32 m0, m0, 1024
  s_nop 0
  buffer_load_dwordx4 v180, s[36:39], s54 offen  lds
  s_mov_b32 s54, 307200
  s_mul_i32 s53, s49, 5120
  s_add_u32 m0, s53, 61440
  s_nop 0
  buffer_load_dwordx4 v176, s[36:39], s54 offen  lds
  s_add_u32 m0, m0, 1024
  s_nop 0
  buffer_load_dwordx4 v177, s[36:39], s54 offen  lds
  s_add_u32 m0, m0, 1024
  s_nop 0
  buffer_load_dwordx4 v178, s[36:39], s54 offen  lds
  s_add_u32 m0, m0, 1024
  s_nop 0
  buffer_load_dwordx4 v179, s[36:39], s54 offen  lds
  s_add_u32 m0, m0, 1024
  s_nop 0
  buffer_load_dwordx4 v180, s[36:39], s54 offen  lds
  s_mov_b32 s54, 409600
  s_mul_i32 s53, s49, 5120
  s_add_u32 m0, s53, 81920
  s_nop 0
  buffer_load_dwordx4 v176, s[36:39], s54 offen  lds
  s_add_u32 m0, m0, 1024
  s_nop 0
  buffer_load_dwordx4 v177, s[36:39], s54 offen  lds
  s_add_u32 m0, m0, 1024
  s_nop 0
  buffer_load_dwordx4 v178, s[36:39], s54 offen  lds
  s_add_u32 m0, m0, 1024
  s_nop 0
  buffer_load_dwordx4 v179, s[36:39], s54 offen  lds
  s_add_u32 m0, m0, 1024
  s_nop 0
  buffer_load_dwordx4 v180, s[36:39], s54 offen  lds
  s_mov_b32 s54, 512000
  s_mul_i32 s53, s49, 5120
  s_add_u32 m0, s53, 102400
  s_nop 0
  buffer_load_dwordx4 v176, s[36:39], s54 offen  lds
  s_add_u32 m0, m0, 1024
  s_nop 0
  buffer_load_dwordx4 v177, s[36:39], s54 offen  lds
  s_add_u32 m0, m0, 1024
  s_nop 0
  buffer_load_dwordx4 v178, s[36:39], s54 offen  lds
  s_add_u32 m0, m0, 1024
  s_nop 0
  buffer_load_dwordx4 v179, s[36:39], s54 offen  lds
  s_add_u32 m0, m0, 1024
  s_nop 0
  buffer_load_dwordx4 v180, s[36:39], s54 offen  lds
  s_mov_b32 s54, 614400
  s_mul_i32 s53, s49, 5120
  s_add_u32 m0, s53, 122880
  s_nop 0
  buffer_load_dwordx4 v176, s[36:39], s54 offen  lds
  s_add_u32 m0, m0, 1024
  s_nop 0
  buffer_load_dwordx4 v177, s[36:39], s54 offen  lds
  s_add_u32 m0, m0, 1024
  s_nop 0
  buffer_load_dwordx4 v178, s[36:39], s54 offen  lds
  s_add_u32 m0, m0, 1024
  s_nop 0
  buffer_load_dwordx4 v179, s[36:39], s54 offen  lds
  s_add_u32 m0, m0, 1024
  s_nop 0
  buffer_load_dwordx4 v180, s[36:39], s54 offen  lds
  s_mov_b32 s54, 716800
  s_mul_i32 s53, s49, 5120
  s_add_u32 m0, s53, 143360
  s_nop 0
  buffer_load_dwordx4 v176, s[36:39], s54 offen  lds
  s_add_u32 m0, m0, 1024
  s_nop 0
  buffer_load_dwordx4 v177, s[36:39], s54 offen  lds
  s_add_u32 m0, m0, 1024
  s_nop 0
  buffer_load_dwordx4 v178, s[36:39], s54 offen  lds
  s_add_u32 m0, m0, 1024
  s_nop 0
  buffer_load_dwordx4 v179, s[36:39], s54 offen  lds
  s_add_u32 m0, m0, 1024
  s_nop 0
  buffer_load_dwordx4 v180, s[36:39], s54 offen  lds
  s_waitcnt vmcnt(40)
  v_pk_add_f32 v[84:85], v[84:85], v[192:193]
  v_pk_add_f32 v[86:87], v[86:87], v[194:195]
  v_pk_add_f32 v[88:89], v[88:89], v[196:197]
  v_pk_add_f32 v[90:91], v[90:91], v[198:199]
  v_pk_add_f32 v[92:93], v[92:93], v[200:201]
  v_pk_add_f32 v[94:95], v[94:95], v[202:203]
  v_pk_add_f32 v[96:97], v[96:97], v[204:205]
  v_pk_add_f32 v[98:99], v[98:99], v[206:207]
  v_pk_add_f32 v[100:101], v[100:101], v[208:209]
  v_pk_add_f32 v[102:103], v[102:103], v[210:211]
  v_pk_add_f32 v[104:105], v[104:105], v[212:213]
  v_pk_add_f32 v[106:107], v[106:107], v[214:215]
  v_pk_add_f32 v[108:109], v[108:109], v[216:217]
  v_pk_add_f32 v[110:111], v[110:111], v[218:219]
  v_pk_add_f32 v[112:113], v[112:113], v[220:221]
  v_pk_add_f32 v[114:115], v[114:115], v[222:223]
  v_pk_add_f32 v[116:117], v[116:117], v[224:225]
  v_pk_add_f32 v[118:119], v[118:119], v[226:227]
  v_cvt_pk_bf16_f32 v56, v84, v85
  v_cvt_pk_bf16_f32 v57, v86, v87
  v_cvt_pk_bf16_f32 v58, v88, v89
  v_cvt_pk_bf16_f32 v59, v90, v91
  v_cvt_pk_bf16_f32 v60, v92, v93
  v_cvt_pk_bf16_f32 v61, v94, v95
  v_cvt_pk_bf16_f32 v62, v96, v97
  v_cvt_pk_bf16_f32 v63, v98, v99
  v_cvt_pk_bf16_f32 v64, v100, v101
  v_cvt_pk_bf16_f32 v65, v102, v103
  v_cvt_pk_bf16_f32 v66, v104, v105
  v_cvt_pk_bf16_f32 v67, v106, v107
  v_cvt_pk_bf16_f32 v68, v108, v109
  v_cvt_pk_bf16_f32 v69, v110, v111
  v_cvt_pk_bf16_f32 v70, v112, v113
  v_cvt_pk_bf16_f32 v71, v114, v115
  v_cvt_pk_bf16_f32 v72, v116, v117
  v_cvt_pk_bf16_f32 v73, v118, v119
  v_lshrrev_b32 v40, 4, v0
  v_and_b32 v41, 15, v0
  s_lshl_b32 s53, s49, 7
  v_lshl_add_u32 v41, v41, 3, s53
  v_mov_b32 v42, 0x40000000
  v_cmp_eq_u32 vcc, 2, v40
  s_nop 1
  v_cndmask_b32 v9, v42, v41, vcc
  s_mul_i32 s53, s63, 5
  s_add_u32 s54, s53, s49
  s_lshr_b32 s55, s54, 3
  s_lshl_b32 s55, s55, 13
  s_lshl_b32 s54, s54, 10
  s_add_u32 s77, s54, s55
  s_add_u32 s54, s53, 4
  s_lshr_b32 s55, s54, 3
  s_lshl_b32 s55, s55, 13
  s_lshl_b32 s54, s54, 10
  s_add_u32 s78, s54, s55
  s_lshl_b32 s54, s64, 3
  s_mul_i32 s56, s54, 0x10000
  s_add_u32 s56, s56, 0x5d00000
  s_lshr_b32 s53, s56, 7
  s_and_b32 s53, s53, 0x2000
  s_xor_b32 s53, s53, s51
  s_lshl_b32 s56, s56, 1
  s_or_b32 s56, s56, s53
  s_add_u32 s77, s77, s56
  s_add_u32 s78, s78, s56
  s_mov_b32 s79, 0x358637bd
  v_mov_b32 v121, 0
  v_mov_b32 v123, 0
  v_lshlrev_b32 v7, 3, v0
  v_accvgpr_read_b32 v120, a8
  v_accvgpr_read_b32 v122, a9
  v_mfma_f32_16x16x32_bf16 v[16:19], v[56:59], a[0:3], 0
  v_mfma_f32_16x16x32_bf16 v[20:23], v[62:65], a[0:3], 0
  v_mfma_f32_16x16x32_bf16 v[24:27], v[68:71], a[0:3], 0
  v_mfma_f32_16x16x32_bf16 v[28:31], v[56:59], a[4:7], 0
  v_mfma_f32_16x16x32_bf16 v[32:35], v[62:65], a[4:7], 0
  v_mfma_f32_16x16x32_bf16 v[36:39], v[68:71], a[4:7], 0
  v_mfma_f32_16x16x16_bf16 v[16:19], v[60:61], v[120:121], v[16:19]
  v_mfma_f32_16x16x16_bf16 v[20:23], v[66:67], v[120:121], v[20:23]
  v_mfma_f32_16x16x16_bf16 v[24:27], v[72:73], v[120:121], v[24:27]
  v_mfma_f32_16x16x16_bf16 v[28:31], v[60:61], v[122:123], v[28:31]
  v_mfma_f32_16x16x16_bf16 v[32:35], v[66:67], v[122:123], v[32:35]
  v_mfma_f32_16x16x16_bf16 v[36:39], v[72:73], v[122:123], v[36:39]
  v_add_f32 v24, s79, v24
  v_rcp_f32 v24, v24
  s_nop 0
  v_mul_f32 v16, v16, v24
  v_mul_f32 v17, v17, v24
  v_mul_f32 v18, v18, v24
  v_mul_f32 v19, v19, v24
  v_mul_f32 v20, v20, v24
  v_mul_f32 v21, v21, v24
  v_mul_f32 v22, v22, v24
  v_mul_f32 v23, v23, v24
  v_cvt_pk_bf16_f32 v132, v16, v17
  v_cvt_pk_bf16_f32 v133, v18, v19
  v_cvt_pk_bf16_f32 v136, v20, v21
  v_cvt_pk_bf16_f32 v137, v22, v23
  buffer_store_dwordx2 v[132:133], v7, s[32:35], s77 offen sc1
  buffer_store_dwordx2 v[136:137], v9, s[32:35], s78 offen sc1
  v_add_f32 v36, s79, v36
  v_rcp_f32 v36, v36
  s_nop 0
  v_mul_f32 v28, v28, v36
  v_mul_f32 v29, v29, v36
  v_mul_f32 v30, v30, v36
  v_mul_f32 v31, v31, v36
  v_mul_f32 v32, v32, v36
  v_mul_f32 v33, v33, v36
  v_mul_f32 v34, v34, v36
  v_mul_f32 v35, v35, v36
  v_cvt_pk_bf16_f32 v134, v28, v29
  v_cvt_pk_bf16_f32 v135, v30, v31
  v_cvt_pk_bf16_f32 v138, v32, v33
  v_cvt_pk_bf16_f32 v139, v34, v35
  buffer_store_dwordx2 v[134:135], v7, s[32:35], s77 offen offset:512 sc1
  buffer_store_dwordx2 v[138:139], v9, s[32:35], s78 offen offset:512 sc1
  s_add_u32 s77, s77, 131072
  s_add_u32 s78, s78, 131072
  v_accvgpr_read_b32 v120, a20
  v_accvgpr_read_b32 v122, a21
  v_mfma_f32_16x16x32_bf16 v[16:19], v[56:59], a[12:15], 0
  v_mfma_f32_16x16x32_bf16 v[20:23], v[62:65], a[12:15], 0
  v_mfma_f32_16x16x32_bf16 v[24:27], v[68:71], a[12:15], 0
  v_mfma_f32_16x16x32_bf16 v[28:31], v[56:59], a[16:19], 0
  v_mfma_f32_16x16x32_bf16 v[32:35], v[62:65], a[16:19], 0
  v_mfma_f32_16x16x32_bf16 v[36:39], v[68:71], a[16:19], 0
  v_mfma_f32_16x16x16_bf16 v[16:19], v[60:61], v[120:121], v[16:19]
  v_mfma_f32_16x16x16_bf16 v[20:23], v[66:67], v[120:121], v[20:23]
  v_mfma_f32_16x16x16_bf16 v[24:27], v[72:73], v[120:121], v[24:27]
  v_mfma_f32_16x16x16_bf16 v[28:31], v[60:61], v[122:123], v[28:31]
  v_mfma_f32_16x16x16_bf16 v[32:35], v[66:67], v[122:123], v[32:35]
  v_mfma_f32_16x16x16_bf16 v[36:39], v[72:73], v[122:123], v[36:39]
  v_add_f32 v24, s79, v24
  v_rcp_f32 v24, v24
  s_nop 0
  v_mul_f32 v16, v16, v24
  v_mul_f32 v17, v17, v24
  v_mul_f32 v18, v18, v24
  v_mul_f32 v19, v19, v24
  v_mul_f32 v20, v20, v24
  v_mul_f32 v21, v21, v24
  v_mul_f32 v22, v22, v24
  v_mul_f32 v23, v23, v24
  v_cvt_pk_bf16_f32 v144, v16, v17
  v_cvt_pk_bf16_f32 v145, v18, v19
  v_cvt_pk_bf16_f32 v148, v20, v21
  v_cvt_pk_bf16_f32 v149, v22, v23
  buffer_store_dwordx2 v[144:145], v7, s[32:35], s77 offen sc1
  buffer_store_dwordx2 v[148:149], v9, s[32:35], s78 offen sc1
  v_add_f32 v36, s79, v36
  v_rcp_f32 v36, v36
  s_nop 0
  v_mul_f32 v28, v28, v36
  v_mul_f32 v29, v29, v36
  v_mul_f32 v30, v30, v36
  v_mul_f32 v31, v31, v36
  v_mul_f32 v32, v32, v36
  v_mul_f32 v33, v33, v36
  v_mul_f32 v34, v34, v36
  v_mul_f32 v35, v35, v36
  v_cvt_pk_bf16_f32 v146, v28, v29
  v_cvt_pk_bf16_f32 v147, v30, v31
  v_cvt_pk_bf16_f32 v150, v32, v33
  v_cvt_pk_bf16_f32 v151, v34, v35
  buffer_store_dwordx2 v[146:147], v7, s[32:35], s77 offen offset:512 sc1
  buffer_store_dwordx2 v[150:151], v9, s[32:35], s78 offen offset:512 sc1
  s_add_u32 s77, s77, 131072
  s_add_u32 s78, s78, 131072
  v_accvgpr_read_b32 v120, a32
  v_accvgpr_read_b32 v122, a33
  v_mfma_f32_16x16x32_bf16 v[16:19], v[56:59], a[24:27], 0
  v_mfma_f32_16x16x32_bf16 v[20:23], v[62:65], a[24:27], 0
  v_mfma_f32_16x16x32_bf16 v[24:27], v[68:71], a[24:27], 0
  v_mfma_f32_16x16x32_bf16 v[28:31], v[56:59], a[28:31], 0
  v_mfma_f32_16x16x32_bf16 v[32:35], v[62:65], a[28:31], 0
  v_mfma_f32_16x16x32_bf16 v[36:39], v[68:71], a[28:31], 0
  v_mfma_f32_16x16x16_bf16 v[16:19], v[60:61], v[120:121], v[16:19]
  v_mfma_f32_16x16x16_bf16 v[20:23], v[66:67], v[120:121], v[20:23]
  v_mfma_f32_16x16x16_bf16 v[24:27], v[72:73], v[120:121], v[24:27]
  v_mfma_f32_16x16x16_bf16 v[28:31], v[60:61], v[122:123], v[28:31]
  v_mfma_f32_16x16x16_bf16 v[32:35], v[66:67], v[122:123], v[32:35]
  v_mfma_f32_16x16x16_bf16 v[36:39], v[72:73], v[122:123], v[36:39]
  v_add_f32 v24, s79, v24
  v_rcp_f32 v24, v24
  s_nop 0
  v_mul_f32 v16, v16, v24
  v_mul_f32 v17, v17, v24
  v_mul_f32 v18, v18, v24
  v_mul_f32 v19, v19, v24
  v_mul_f32 v20, v20, v24
  v_mul_f32 v21, v21, v24
  v_mul_f32 v22, v22, v24
  v_mul_f32 v23, v23, v24
  v_cvt_pk_bf16_f32 v132, v16, v17
  v_cvt_pk_bf16_f32 v133, v18, v19
  v_cvt_pk_bf16_f32 v136, v20, v21
  v_cvt_pk_bf16_f32 v137, v22, v23
  buffer_store_dwordx2 v[132:133], v7, s[32:35], s77 offen sc1
  buffer_store_dwordx2 v[136:137], v9, s[32:35], s78 offen sc1
  v_add_f32 v36, s79, v36
  v_rcp_f32 v36, v36
  s_nop 0
  v_mul_f32 v28, v28, v36
  v_mul_f32 v29, v29, v36
  v_mul_f32 v30, v30, v36
  v_mul_f32 v31, v31, v36
  v_mul_f32 v32, v32, v36
  v_mul_f32 v33, v33, v36
  v_mul_f32 v34, v34, v36
  v_mul_f32 v35, v35, v36
  v_cvt_pk_bf16_f32 v134, v28, v29
  v_cvt_pk_bf16_f32 v135, v30, v31
  v_cvt_pk_bf16_f32 v138, v32, v33
  v_cvt_pk_bf16_f32 v139, v34, v35
  buffer_store_dwordx2 v[134:135], v7, s[32:35], s77 offen offset:512 sc1
  buffer_store_dwordx2 v[138:139], v9, s[32:35], s78 offen offset:512 sc1
  s_add_u32 s77, s77, 131072
  s_add_u32 s78, s78, 131072
  v_accvgpr_read_b32 v120, a44
  v_accvgpr_read_b32 v122, a45
  v_mfma_f32_16x16x32_bf16 v[16:19], v[56:59], a[36:39], 0
  v_mfma_f32_16x16x32_bf16 v[20:23], v[62:65], a[36:39], 0
  v_mfma_f32_16x16x32_bf16 v[24:27], v[68:71], a[36:39], 0
  v_mfma_f32_16x16x32_bf16 v[28:31], v[56:59], a[40:43], 0
  v_mfma_f32_16x16x32_bf16 v[32:35], v[62:65], a[40:43], 0
  v_mfma_f32_16x16x32_bf16 v[36:39], v[68:71], a[40:43], 0
  v_mfma_f32_16x16x16_bf16 v[16:19], v[60:61], v[120:121], v[16:19]
  v_mfma_f32_16x16x16_bf16 v[20:23], v[66:67], v[120:121], v[20:23]
  v_mfma_f32_16x16x16_bf16 v[24:27], v[72:73], v[120:121], v[24:27]
  v_mfma_f32_16x16x16_bf16 v[28:31], v[60:61], v[122:123], v[28:31]
  v_mfma_f32_16x16x16_bf16 v[32:35], v[66:67], v[122:123], v[32:35]
  v_mfma_f32_16x16x16_bf16 v[36:39], v[72:73], v[122:123], v[36:39]
  v_add_f32 v24, s79, v24
  v_rcp_f32 v24, v24
  s_nop 0
  v_mul_f32 v16, v16, v24
  v_mul_f32 v17, v17, v24
  v_mul_f32 v18, v18, v24
  v_mul_f32 v19, v19, v24
  v_mul_f32 v20, v20, v24
  v_mul_f32 v21, v21, v24
  v_mul_f32 v22, v22, v24
  v_mul_f32 v23, v23, v24
  v_cvt_pk_bf16_f32 v144, v16, v17
  v_cvt_pk_bf16_f32 v145, v18, v19
  v_cvt_pk_bf16_f32 v148, v20, v21
  v_cvt_pk_bf16_f32 v149, v22, v23
  buffer_store_dwordx2 v[144:145], v7, s[32:35], s77 offen sc1
  buffer_store_dwordx2 v[148:149], v9, s[32:35], s78 offen sc1
  v_add_f32 v36, s79, v36
  v_rcp_f32 v36, v36
  s_nop 0
  v_mul_f32 v28, v28, v36
  v_mul_f32 v29, v29, v36
  v_mul_f32 v30, v30, v36
  v_mul_f32 v31, v31, v36
  v_mul_f32 v32, v32, v36
  v_mul_f32 v33, v33, v36
  v_mul_f32 v34, v34, v36
  v_mul_f32 v35, v35, v36
  v_cvt_pk_bf16_f32 v146, v28, v29
  v_cvt_pk_bf16_f32 v147, v30, v31
  v_cvt_pk_bf16_f32 v150, v32, v33
  v_cvt_pk_bf16_f32 v151, v34, v35
  buffer_store_dwordx2 v[146:147], v7, s[32:35], s77 offen offset:512 sc1
  buffer_store_dwordx2 v[150:151], v9, s[32:35], s78 offen offset:512 sc1
  s_add_u32 s77, s77, 131072
  s_add_u32 s78, s78, 131072
  v_accvgpr_read_b32 v120, a56
  v_accvgpr_read_b32 v122, a57
  v_mfma_f32_16x16x32_bf16 v[16:19], v[56:59], a[48:51], 0
  v_mfma_f32_16x16x32_bf16 v[20:23], v[62:65], a[48:51], 0
  v_mfma_f32_16x16x32_bf16 v[24:27], v[68:71], a[48:51], 0
  v_mfma_f32_16x16x32_bf16 v[28:31], v[56:59], a[52:55], 0
  v_mfma_f32_16x16x32_bf16 v[32:35], v[62:65], a[52:55], 0
  v_mfma_f32_16x16x32_bf16 v[36:39], v[68:71], a[52:55], 0
  v_mfma_f32_16x16x16_bf16 v[16:19], v[60:61], v[120:121], v[16:19]
  v_mfma_f32_16x16x16_bf16 v[20:23], v[66:67], v[120:121], v[20:23]
  v_mfma_f32_16x16x16_bf16 v[24:27], v[72:73], v[120:121], v[24:27]
  v_mfma_f32_16x16x16_bf16 v[28:31], v[60:61], v[122:123], v[28:31]
  v_mfma_f32_16x16x16_bf16 v[32:35], v[66:67], v[122:123], v[32:35]
  v_mfma_f32_16x16x16_bf16 v[36:39], v[72:73], v[122:123], v[36:39]
  v_add_f32 v24, s79, v24
  v_rcp_f32 v24, v24
  s_nop 0
  v_mul_f32 v16, v16, v24
  v_mul_f32 v17, v17, v24
  v_mul_f32 v18, v18, v24
  v_mul_f32 v19, v19, v24
  v_mul_f32 v20, v20, v24
  v_mul_f32 v21, v21, v24
  v_mul_f32 v22, v22, v24
  v_mul_f32 v23, v23, v24
  v_cvt_pk_bf16_f32 v132, v16, v17
  v_cvt_pk_bf16_f32 v133, v18, v19
  v_cvt_pk_bf16_f32 v136, v20, v21
  v_cvt_pk_bf16_f32 v137, v22, v23
  buffer_store_dwordx2 v[132:133], v7, s[32:35], s77 offen sc1
  buffer_store_dwordx2 v[136:137], v9, s[32:35], s78 offen sc1
  v_add_f32 v36, s79, v36
  v_rcp_f32 v36, v36
  s_nop 0
  v_mul_f32 v28, v28, v36
  v_mul_f32 v29, v29, v36
  v_mul_f32 v30, v30, v36
  v_mul_f32 v31, v31, v36
  v_mul_f32 v32, v32, v36
  v_mul_f32 v33, v33, v36
  v_mul_f32 v34, v34, v36
  v_mul_f32 v35, v35, v36
  v_cvt_pk_bf16_f32 v134, v28, v29
  v_cvt_pk_bf16_f32 v135, v30, v31
  v_cvt_pk_bf16_f32 v138, v32, v33
  v_cvt_pk_bf16_f32 v139, v34, v35
  buffer_store_dwordx2 v[134:135], v7, s[32:35], s77 offen offset:512 sc1
  buffer_store_dwordx2 v[138:139], v9, s[32:35], s78 offen offset:512 sc1
  s_add_u32 s77, s77, 131072
  s_add_u32 s78, s78, 131072
  s_waitcnt vmcnt(40)
  v_accvgpr_read_b32 v120, a68
  v_accvgpr_read_b32 v122, a69
  v_mfma_f32_16x16x32_bf16 v[16:19], v[56:59], a[60:63], 0
  v_mfma_f32_16x16x32_bf16 v[20:23], v[62:65], a[60:63], 0
  v_mfma_f32_16x16x32_bf16 v[24:27], v[68:71], a[60:63], 0
  v_mfma_f32_16x16x32_bf16 v[28:31], v[56:59], a[64:67], 0
  v_mfma_f32_16x16x32_bf16 v[32:35], v[62:65], a[64:67], 0
  v_mfma_f32_16x16x32_bf16 v[36:39], v[68:71], a[64:67], 0
  v_mfma_f32_16x16x16_bf16 v[16:19], v[60:61], v[120:121], v[16:19]
  v_mfma_f32_16x16x16_bf16 v[20:23], v[66:67], v[120:121], v[20:23]
  v_mfma_f32_16x16x16_bf16 v[24:27], v[72:73], v[120:121], v[24:27]
  v_mfma_f32_16x16x16_bf16 v[28:31], v[60:61], v[122:123], v[28:31]
  v_mfma_f32_16x16x16_bf16 v[32:35], v[66:67], v[122:123], v[32:35]
  v_mfma_f32_16x16x16_bf16 v[36:39], v[72:73], v[122:123], v[36:39]
  v_add_f32 v24, s79, v24
  v_rcp_f32 v24, v24
  s_nop 0
  v_mul_f32 v16, v16, v24
  v_mul_f32 v17, v17, v24
  v_mul_f32 v18, v18, v24
  v_mul_f32 v19, v19, v24
  v_mul_f32 v20, v20, v24
  v_mul_f32 v21, v21, v24
  v_mul_f32 v22, v22, v24
  v_mul_f32 v23, v23, v24
  v_cvt_pk_bf16_f32 v144, v16, v17
  v_cvt_pk_bf16_f32 v145, v18, v19
  v_cvt_pk_bf16_f32 v148, v20, v21
  v_cvt_pk_bf16_f32 v149, v22, v23
  buffer_store_dwordx2 v[144:145], v7, s[32:35], s77 offen sc1
  buffer_store_dwordx2 v[148:149], v9, s[32:35], s78 offen sc1
  v_add_f32 v36, s79, v36
  v_rcp_f32 v36, v36
  s_nop 0
  v_mul_f32 v28, v28, v36
  v_mul_f32 v29, v29, v36
  v_mul_f32 v30, v30, v36
  v_mul_f32 v31, v31, v36
  v_mul_f32 v32, v32, v36
  v_mul_f32 v33, v33, v36
  v_mul_f32 v34, v34, v36
  v_mul_f32 v35, v35, v36
  v_cvt_pk_bf16_f32 v146, v28, v29
  v_cvt_pk_bf16_f32 v147, v30, v31
  v_cvt_pk_bf16_f32 v150, v32, v33
  v_cvt_pk_bf16_f32 v151, v34, v35
  buffer_store_dwordx2 v[146:147], v7, s[32:35], s77 offen offset:512 sc1
  buffer_store_dwordx2 v[150:151], v9, s[32:35], s78 offen offset:512 sc1
  s_add_u32 s77, s77, 131072
  s_add_u32 s78, s78, 131072
  v_accvgpr_read_b32 v120, a80
  v_accvgpr_read_b32 v122, a81
  v_mfma_f32_16x16x32_bf16 v[16:19], v[56:59], a[72:75], 0
  v_mfma_f32_16x16x32_bf16 v[20:23], v[62:65], a[72:75], 0
  v_mfma_f32_16x16x32_bf16 v[24:27], v[68:71], a[72:75], 0
  v_mfma_f32_16x16x32_bf16 v[28:31], v[56:59], a[76:79], 0
  v_mfma_f32_16x16x32_bf16 v[32:35], v[62:65], a[76:79], 0
  v_mfma_f32_16x16x32_bf16 v[36:39], v[68:71], a[76:79], 0
  v_mfma_f32_16x16x16_bf16 v[16:19], v[60:61], v[120:121], v[16:19]
  v_mfma_f32_16x16x16_bf16 v[20:23], v[66:67], v[120:121], v[20:23]
  v_mfma_f32_16x16x16_bf16 v[24:27], v[72:73], v[120:121], v[24:27]
  v_mfma_f32_16x16x16_bf16 v[28:31], v[60:61], v[122:123], v[28:31]
  v_mfma_f32_16x16x16_bf16 v[32:35], v[66:67], v[122:123], v[32:35]
  v_mfma_f32_16x16x16_bf16 v[36:39], v[72:73], v[122:123], v[36:39]
  v_add_f32 v24, s79, v24
  v_rcp_f32 v24, v24
  s_nop 0
  v_mul_f32 v16, v16, v24
  v_mul_f32 v17, v17, v24
  v_mul_f32 v18, v18, v24
  v_mul_f32 v19, v19, v24
  v_mul_f32 v20, v20, v24
  v_mul_f32 v21, v21, v24
  v_mul_f32 v22, v22, v24
  v_mul_f32 v23, v23, v24
  v_cvt_pk_bf16_f32 v132, v16, v17
  v_cvt_pk_bf16_f32 v133, v18, v19
  v_cvt_pk_bf16_f32 v136, v20, v21
  v_cvt_pk_bf16_f32 v137, v22, v23
  buffer_store_dwordx2 v[132:133], v7, s[32:35], s77 offen sc1
  buffer_store_dwordx2 v[136:137], v9, s[32:35], s78 offen sc1
  v_add_f32 v36, s79, v36
  v_rcp_f32 v36, v36
  s_nop 0
  v_mul_f32 v28, v28, v36
  v_mul_f32 v29, v29, v36
  v_mul_f32 v30, v30, v36
  v_mul_f32 v31, v31, v36
  v_mul_f32 v32, v32, v36
  v_mul_f32 v33, v33, v36
  v_mul_f32 v34, v34, v36
  v_mul_f32 v35, v35, v36
  v_cvt_pk_bf16_f32 v134, v28, v29
  v_cvt_pk_bf16_f32 v135, v30, v31
  v_cvt_pk_bf16_f32 v138, v32, v33
  v_cvt_pk_bf16_f32 v139, v34, v35
  buffer_store_dwordx2 v[134:135], v7, s[32:35], s77 offen offset:512 sc1
  buffer_store_dwordx2 v[138:139], v9, s[32:35], s78 offen offset:512 sc1
  s_add_u32 s77, s77, 131072
  s_add_u32 s78, s78, 131072
  v_accvgpr_read_b32 v120, a92
  v_accvgpr_read_b32 v122, a93
  v_mfma_f32_16x16x32_bf16 v[16:19], v[56:59], a[84:87], 0
  v_mfma_f32_16x16x32_bf16 v[20:23], v[62:65], a[84:87], 0
  v_mfma_f32_16x16x32_bf16 v[24:27], v[68:71], a[84:87], 0
  v_mfma_f32_16x16x32_bf16 v[28:31], v[56:59], a[88:91], 0
  v_mfma_f32_16x16x32_bf16 v[32:35], v[62:65], a[88:91], 0
  v_mfma_f32_16x16x32_bf16 v[36:39], v[68:71], a[88:91], 0
  v_mfma_f32_16x16x16_bf16 v[16:19], v[60:61], v[120:121], v[16:19]
  v_mfma_f32_16x16x16_bf16 v[20:23], v[66:67], v[120:121], v[20:23]
  v_mfma_f32_16x16x16_bf16 v[24:27], v[72:73], v[120:121], v[24:27]
  v_mfma_f32_16x16x16_bf16 v[28:31], v[60:61], v[122:123], v[28:31]
  v_mfma_f32_16x16x16_bf16 v[32:35], v[66:67], v[122:123], v[32:35]
  v_mfma_f32_16x16x16_bf16 v[36:39], v[72:73], v[122:123], v[36:39]
  v_add_f32 v24, s79, v24
  v_rcp_f32 v24, v24
  s_nop 0
  v_mul_f32 v16, v16, v24
  v_mul_f32 v17, v17, v24
  v_mul_f32 v18, v18, v24
  v_mul_f32 v19, v19, v24
  v_mul_f32 v20, v20, v24
  v_mul_f32 v21, v21, v24
  v_mul_f32 v22, v22, v24
  v_mul_f32 v23, v23, v24
  v_cvt_pk_bf16_f32 v144, v16, v17
  v_cvt_pk_bf16_f32 v145, v18, v19
  v_cvt_pk_bf16_f32 v148, v20, v21
  v_cvt_pk_bf16_f32 v149, v22, v23
  buffer_store_dwordx2 v[144:145], v7, s[32:35], s77 offen sc1
  buffer_store_dwordx2 v[148:149], v9, s[32:35], s78 offen sc1
  v_add_f32 v36, s79, v36
  v_rcp_f32 v36, v36
  s_nop 0
  v_mul_f32 v28, v28, v36
  v_mul_f32 v29, v29, v36
  v_mul_f32 v30, v30, v36
  v_mul_f32 v31, v31, v36
  v_mul_f32 v32, v32, v36
  v_mul_f32 v33, v33, v36
  v_mul_f32 v34, v34, v36
  v_mul_f32 v35, v35, v36
  v_cvt_pk_bf16_f32 v146, v28, v29
  v_cvt_pk_bf16_f32 v147, v30, v31
  v_cvt_pk_bf16_f32 v150, v32, v33
  v_cvt_pk_bf16_f32 v151, v34, v35
  buffer_store_dwordx2 v[146:147], v7, s[32:35], s77 offen offset:512 sc1
  buffer_store_dwordx2 v[150:151], v9, s[32:35], s78 offen offset:512 sc1
  s_add_u32 s77, s77, 131072
  s_add_u32 s78, s78, 131072
  v_add_u32 v10, 16384, v10
  v_mov_b32 v168, 1
  s_waitcnt vmcnt(0)
  s_barrier
  buffer_store_dword v168, v10, s[32:35], 0 offen sc1
  s_cmp_ge_u32 s76, 12
  s_cbranch_scc1 L_EXIT
  v_add_u32 v32, 0x0, v182
  v_add_u32 v33, 0x0, v183
  v_add_u32 v34, 0x0, v184
  v_add_u32 v35, 0x0, v185
  v_add_u32 v36, 0x0, v186
  v_add_u32 v37, 0x0, v187
  ds_read_b64_tr_b16 a[96:97], v32 offset:0
  ds_read_b64_tr_b16 a[98:99], v34 offset:0
  ds_read_b64_tr_b16 a[104:105], v32 offset:10240
  ds_read_b64_tr_b16 a[106:107], v34 offset:10240
  ds_read_b64_tr_b16 a[224:225], v36
  ds_read_b64_tr_b16 a[100:101], v33 offset:0
  ds_read_b64_tr_b16 a[102:103], v35 offset:0
  ds_read_b64_tr_b16 a[108:109], v33 offset:10240
  ds_read_b64_tr_b16 a[110:111], v35 offset:10240
  ds_read_b64_tr_b16 a[228:229], v37
  s_waitcnt lgkmcnt(0)
  v_add_u32 v32, 0x5000, v182
  v_add_u32 v33, 0x5000, v183
  v_add_u32 v34, 0x5000, v184
  v_add_u32 v35, 0x5000, v185
  v_add_u32 v36, 0x5000, v186
  v_add_u32 v37, 0x5000, v187
  ds_read_b64_tr_b16 a[112:113], v32 offset:0
  ds_read_b64_tr_b16 a[114:115], v34 offset:0
  ds_read_b64_tr_b16 a[120:121], v32 offset:10240
  ds_read_b64_tr_b16 a[122:123], v34 offset:10240
  ds_read_b64_tr_b16 a[226:227], v36
  ds_read_b64_tr_b16 a[116:117], v33 offset:0
  ds_read_b64_tr_b16 a[118:119], v35 offset:0
  ds_read_b64_tr_b16 a[124:125], v33 offset:10240
  ds_read_b64_tr_b16 a[126:127], v35 offset:10240
  ds_read_b64_tr_b16 a[230:231], v37
  s_waitcnt lgkmcnt(0)
  v_add_u32 v32, 0xa000, v182
  v_add_u32 v33, 0xa000, v183
  v_add_u32 v34, 0xa000, v184
  v_add_u32 v35, 0xa000, v185
  v_add_u32 v36, 0xa000, v186
  v_add_u32 v37, 0xa000, v187
  ds_read_b64_tr_b16 a[128:129], v32 offset:0
  ds_read_b64_tr_b16 a[130:131], v34 offset:0
  ds_read_b64_tr_b16 a[136:137], v32 offset:10240
  ds_read_b64_tr_b16 a[138:139], v34 offset:10240
  ds_read_b64_tr_b16 a[232:233], v36
  ds_read_b64_tr_b16 a[132:133], v33 offset:0
  ds_read_b64_tr_b16 a[134:135], v35 offset:0
  ds_read_b64_tr_b16 a[140:141], v33 offset:10240
  ds_read_b64_tr_b16 a[142:143], v35 offset:10240
  ds_read_b64_tr_b16 a[236:237], v37
  s_waitcnt lgkmcnt(0)
  v_add_u32 v32, 0xf000, v182
  v_add_u32 v33, 0xf000, v183
  v_add_u32 v34, 0xf000, v184
  v_add_u32 v35, 0xf000, v185
  v_add_u32 v36, 0xf000, v186
  v_add_u32 v37, 0xf000, v187
  ds_read_b64_tr_b16 a[144:145], v32 offset:0
  ds_read_b64_tr_b16 a[146:147], v34 offset:0
  ds_read_b64_tr_b16 a[152:153], v32 offset:10240
  ds_read_b64_tr_b16 a[154:155], v34 offset:10240
  ds_read_b64_tr_b16 a[234:235], v36
  ds_read_b64_tr_b16 a[148:149], v33 offset:0
  ds_read_b64_tr_b16 a[150:151], v35 offset:0
  ds_read_b64_tr_b16 a[156:157], v33 offset:10240
  ds_read_b64_tr_b16 a[158:159], v35 offset:10240
  ds_read_b64_tr_b16 a[238:239], v37
  s_waitcnt lgkmcnt(0)
  v_add_u32 v32, 0x14000, v182
  v_add_u32 v33, 0x14000, v183
  v_add_u32 v34, 0x14000, v184
  v_add_u32 v35, 0x14000, v185
  v_add_u32 v36, 0x14000, v186
  v_add_u32 v37, 0x14000, v187
  ds_read_b64_tr_b16 a[160:161], v32 offset:0
  ds_read_b64_tr_b16 a[162:163], v34 offset:0
  ds_read_b64_tr_b16 a[168:169], v32 offset:10240
  ds_read_b64_tr_b16 a[170:171], v34 offset:10240
  ds_read_b64_tr_b16 a[240:241], v36
  ds_read_b64_tr_b16 a[164:165], v33 offset:0
  ds_read_b64_tr_b16 a[166:167], v35 offset:0
  ds_read_b64_tr_b16 a[172:173], v33 offset:10240
  ds_read_b64_tr_b16 a[174:175], v35 offset:10240
  ds_read_b64_tr_b16 a[244:245], v37
  s_waitcnt lgkmcnt(0)
  v_add_u32 v32, 0x19000, v182
  v_add_u32 v33, 0x19000, v183
  v_add_u32 v34, 0x19000, v184
  v_add_u32 v35, 0x19000, v185
  v_add_u32 v36, 0x19000, v186
  v_add_u32 v37, 0x19000, v187
  ds_read_b64_tr_b16 a[176:177], v32 offset:0
  ds_read_b64_tr_b16 a[178:179], v34 offset:0
  ds_read_b64_tr_b16 a[184:185], v32 offset:10240
  ds_read_b64_tr_b16 a[186:187], v34 offset:10240
  ds_read_b64_tr_b16 a[242:243], v36
  ds_read_b64_tr_b16 a[180:181], v33 offset:0
  ds_read_b64_tr_b16 a[182:183], v35 offset:0
  ds_read_b64_tr_b16 a[188:189], v33 offset:10240
  ds_read_b64_tr_b16 a[190:191], v35 offset:10240
  ds_read_b64_tr_b16 a[246:247], v37
  s_waitcnt lgkmcnt(0)
  v_add_u32 v32, 0x1e000, v182
  v_add_u32 v33, 0x1e000, v183
  v_add_u32 v34, 0x1e000, v184
  v_add_u32 v35, 0x1e000, v185
  v_add_u32 v36, 0x1e000, v186
  v_add_u32 v37, 0x1e000, v187
  ds_read_b64_tr_b16 a[192:193], v32 offset:0
  ds_read_b64_tr_b16 a[194:195], v34 offset:0
  ds_read_b64_tr_b16 a[200:201], v32 offset:10240
  ds_read_b64_tr_b16 a[202:203], v34 offset:10240
  ds_read_b64_tr_b16 a[248:249], v36
  ds_read_b64_tr_b16 a[196:197], v33 offset:0
  ds_read_b64_tr_b16 a[198:199], v35 offset:0
  ds_read_b64_tr_b16 a[204:205], v33 offset:10240
  ds_read_b64_tr_b16 a[206:207], v35 offset:10240
  ds_read_b64_tr_b16 a[252:253], v37
  s_waitcnt lgkmcnt(0)
  v_add_u32 v32, 0x23000, v182
  v_add_u32 v33, 0x23000, v183
  v_add_u32 v34, 0x23000, v184
  v_add_u32 v35, 0x23000, v185
  v_add_u32 v36, 0x23000, v186
  v_add_u32 v37, 0x23000, v187
  ds_read_b64_tr_b16 a[208:209], v32 offset:0
  ds_read_b64_tr_b16 a[210:211], v34 offset:0
  ds_read_b64_tr_b16 a[216:217], v32 offset:10240
  ds_read_b64_tr_b16 a[218:219], v34 offset:10240
  ds_read_b64_tr_b16 a[250:251], v36
  ds_read_b64_tr_b16 a[212:213], v33 offset:0
  ds_read_b64_tr_b16 a[214:215], v35 offset:0
  ds_read_b64_tr_b16 a[220:221], v33 offset:10240
  ds_read_b64_tr_b16 a[222:223], v35 offset:10240
  ds_read_b64_tr_b16 a[254:255], v37
  s_waitcnt lgkmcnt(0)
  s_barrier
  s_mov_b32 s44, s26
  s_and_b32 s45, s27, 0xffff
  s_mov_b32 s46, 0x500000
  s_mov_b32 s47, 0x20000
  v_and_b32 v41, 15, v0
  v_mul_u32_u24 v42, 2560, v41
  v_and_b32 v43, 1, v40
  v_lshl_add_u32 v42, v43, 5, v42
  v_lshrrev_b32 v43, 1, v40
  v_lshl_add_u32 v42, v43, 4, v42
  s_lshl_b32 s54, s75, 2
  s_add_u32 s54, s54, s49
  s_lshl_b32 s54, s54, 6
  v_add_u32 v9, s54, v42
  s_add_u32 s54, s51, 98304
  v_lshl_add_u32 v168, v0, 7, s54
  s_mov_b32 s55, 1
  s_mov_b32 s57, 0
PL_64:
  buffer_load_dword v169, v168, s[32:35], 0 offen sc1
  s_waitcnt vmcnt(0)
  v_cmp_gt_u32 vcc, s55, v169
  s_cbranch_vccz PR_65
  s_add_u32 s57, s57, 1
  s_cmp_lt_u32 s57, 0x80000
  s_cbranch_scc1 PL_64
  s_branch L_EXIT
PR_65:
  s_lshl_b32 s66, s49, 10
  s_mov_b32 s67, 0
  s_min_u32 s55, s76, 63
  s_mul_i32 s56, s55, 0x10000
  s_add_u32 s56, s56, 0x5d00000
  s_lshr_b32 s53, s56, 7
  s_and_b32 s53, s53, 0x2000
  s_xor_b32 s53, s53, s51
  s_lshl_b32 s56, s56, 1
  s_or_b32 s56, s56, s53
  s_lshl_b32 s55, s49, 10
  s_add_u32 s56, s56, s55
  s_add_u32 m0, s66, 0
  s_nop 0
  buffer_load_dwordx4 v6, s[32:35], s56 offen sc1 lds
  s_add_u32 s56, s56, 4096
  s_add_u32 m0, s66, 4096
  s_nop 0
  buffer_load_dwordx4 v6, s[32:35], s56 offen sc1 lds
  s_add_u32 s56, s56, 12288
  s_add_u32 m0, s66, 8192
  s_nop 0
  buffer_load_dwordx4 v6, s[32:35], s56 offen sc1 lds
  s_add_u32 s56, s56, 4096
  s_add_u32 m0, s66, 12288
  s_nop 0
  buffer_load_dwordx4 v6, s[32:35], s56 offen sc1 lds
  s_add_u32 s56, s56, 12288
  s_add_u32 m0, s66, 16384
  s_nop 0
  buffer_load_dwordx4 v6, s[32:35], s56 offen sc1 lds
  s_add_u32 s56, s56, 4096
  s_add_u32 m0, s66, 20480
  s_nop 0
  buffer_load_dwordx4 v6, s[32:35], s56 offen sc1 lds
  s_add_u32 s56, s56, 12288
  s_add_u32 m0, s66, 24576
  s_nop 0
  buffer_load_dwordx4 v6, s[32:35], s56 offen sc1 lds
  s_add_u32 s56, s56, 4096
  s_add_u32 m0, s66, 28672
  s_nop 0
  buffer_load_dwordx4 v6, s[32:35], s56 offen sc1 lds
  s_add_u32 s56, s56, 12288
  s_add_u32 m0, s66, 32768
  s_nop 0
  buffer_load_dwordx4 v6, s[32:35], s56 offen sc1 lds
  s_add_u32 s56, s56, 4096
  s_add_u32 m0, s66, 36864
  s_nop 0
  buffer_load_dwordx4 v6, s[32:35], s56 offen sc1 lds
  s_add_u32 s56, s56, 12288
  s_add_u32 s66, s66, 40960
  s_cmp_ge_u32 s66, 122880
  s_cselect_b32 s53, 122880, 0
  s_sub_u32 s66, s66, s53
  s_add_u32 s74, s76, 12
  s_min_u32 s55, s74, 63
  s_mul_i32 s56, s55, 0x10000
  s_add_u32 s56, s56, 0x5d00000
  s_lshr_b32 s53, s56, 7
  s_and_b32 s53, s53, 0x2000
  s_xor_b32 s53, s53, s51
  s_lshl_b32 s56, s56, 1
  s_or_b32 s56, s56, s53
  s_lshl_b32 s55, s49, 10
  s_add_u32 s56, s56, s55
  s_add_u32 m0, s66, 0
  s_nop 0
  buffer_load_dwordx4 v6, s[32:35], s56 offen sc1 lds
  s_add_u32 s56, s56, 4096
  s_add_u32 m0, s66, 4096
  s_nop 0
  buffer_load_dwordx4 v6, s[32:35], s56 offen sc1 lds
  s_add_u32 s56, s56, 12288
  s_add_u32 m0, s66, 8192
  s_nop 0
  buffer_load_dwordx4 v6, s[32:35], s56 offen sc1 lds
  s_add_u32 s56, s56, 4096
  s_add_u32 m0, s66, 12288
  s_nop 0
  buffer_load_dwordx4 v6, s[32:35], s56 offen sc1 lds
  s_add_u32 s56, s56, 12288
  s_add_u32 m0, s66, 16384
  s_nop 0
  buffer_load_dwordx4 v6, s[32:35], s56 offen sc1 lds
  s_add_u32 s56, s56, 4096
  s_add_u32 m0, s66, 20480
  s_nop 0
  buffer_load_dwordx4 v6, s[32:35], s56 offen sc1 lds
  s_add_u32 s56, s56, 12288
  s_add_u32 m0, s66, 24576
  s_nop 0
  buffer_load_dwordx4 v6, s[32:35], s56 offen sc1 lds
  s_add_u32 s56, s56, 4096
  s_add_u32 m0, s66, 28672
  s_nop 0
  buffer_load_dwordx4 v6, s[32:35], s56 offen sc1 lds
  s_add_u32 s56, s56, 12288
  s_add_u32 m0, s66, 32768
  s_nop 0
  buffer_load_dwordx4 v6, s[32:35], s56 offen sc1 lds
  s_add_u32 s56, s56, 4096
  s_add_u32 m0, s66, 36864
  s_nop 0
  buffer_load_dwordx4 v6, s[32:35], s56 offen sc1 lds
  s_add_u32 s56, s56, 12288
  s_add_u32 s66, s66, 40960
  s_cmp_ge_u32 s66, 122880
  s_cselect_b32 s53, 122880, 0
  s_sub_u32 s66, s66, s53
  s_waitcnt vmcnt(10)
PA_OUT:
  s_barrier
  s_add_u32 s74, s76, 24
  v_add_u32 v4, s67, v7
  ds_read_b64 v[192:193], v4 offset:0
  ds_read_b64 v[194:195], v4 offset:1024
  ds_read_b64 v[196:197], v4 offset:512
  ds_read_b64 v[198:199], v4 offset:1536
  ds_read_b64 v[200:201], v4 offset:2048
  ds_read_b64 v[202:203], v4 offset:3072
  ds_read_b64 v[204:205], v4 offset:2560
  ds_read_b64 v[206:207], v4 offset:3584
  s_waitcnt lgkmcnt(4)
  v_mfma_f32_16x16x32_bf16 v[16:19], a[96:99], v[192:195], 0
  ds_read_b64 v[208:209], v4 offset:5120
  s_min_u32 s55, s74, 63
  v_mfma_f32_16x16x32_bf16 v[20:23], a[100:103], v[192:195], 0
  ds_read_b64 v[210:211], v4 offset:6144
  s_mul_i32 s56, s55, 0x10000
  v_mfma_f32_16x16x32_bf16 v[24:27], a[96:99], v[196:199], 0
  ds_read_b64 v[212:213], v4 offset:5632
  s_add_u32 s56, s56, 0x5d00000
  v_mfma_f32_16x16x32_bf16 v[28:31], a[100:103], v[196:199], 0
  ds_read_b64 v[214:215], v4 offset:6656
  s_waitcnt lgkmcnt(4)
  v_mfma_f32_16x16x32_bf16 v[16:19], a[104:107], v[200:203], v[16:19]
  ds_read_b64 v[192:193], v4 offset:7168
  s_lshr_b32 s53, s56, 7
  v_mfma_f32_16x16x32_bf16 v[20:23], a[108:111], v[200:203], v[20:23]
  ds_read_b64 v[194:195], v4 offset:8192
  s_and_b32 s53, s53, 0x2000
  v_mfma_f32_16x16x32_bf16 v[24:27], a[104:107], v[204:207], v[24:27]
  ds_read_b64 v[196:197], v4 offset:7680
  s_xor_b32 s53, s53, s51
  v_mfma_f32_16x16x32_bf16 v[28:31], a[108:111], v[204:207], v[28:31]
  ds_read_b64 v[198:199], v4 offset:8704
  s_waitcnt lgkmcnt(4)
  v_mfma_f32_16x16x32_bf16 v[16:19], a[112:115], v[208:211], v[16:19]
  ds_read_b64 v[200:201], v4 offset:10240
  s_lshl_b32 s56, s56, 1
  v_mfma_f32_16x16x32_bf16 v[20:23], a[116:119], v[208:211], v[20:23]
  ds_read_b64 v[202:203], v4 offset:11264
  s_or_b32 s56, s56, s53
  v_mfma_f32_16x16x32_bf16 v[24:27], a[112:115], v[212:215], v[24:27]
  ds_read_b64 v[204:205], v4 offset:10752
  s_lshl_b32 s55, s49, 10
  v_mfma_f32_16x16x32_bf16 v[28:31], a[116:119], v[212:215], v[28:31]
  ds_read_b64 v[206:207], v4 offset:11776
  s_waitcnt lgkmcnt(4)
  v_mfma_f32_16x16x32_bf16 v[16:19], a[120:123], v[192:195], v[16:19]
  ds_read_b64 v[208:209], v4 offset:12288
  s_add_u32 s56, s56, s55
  v_mfma_f32_16x16x32_bf16 v[20:23], a[124:127], v[192:195], v[20:23]
  ds_read_b64 v[210:211], v4 offset:13312
  s_add_u32 m0, s66, 0
  v_mfma_f32_16x16x32_bf16 v[24:27], a[120:123], v[196:199], v[24:27]
  ds_read_b64 v[212:213], v4 offset:12800
  buffer_load_dwordx4 v6, s[32:35], s56 offen sc1 lds
  v_mfma_f32_16x16x32_bf16 v[28:31], a[124:127], v[196:199], v[28:31]
  ds_read_b64 v[214:215], v4 offset:13824
  s_waitcnt lgkmcnt(4)
  v_mfma_f32_16x16x32_bf16 v[16:19], a[128:131], v[200:203], v[16:19]
  ds_read_b64 v[192:193], v4 offset:15360
  s_add_u32 s56, s56, 4096
  v_mfma_f32_16x16x32_bf16 v[20:23], a[132:135], v[200:203], v[20:23]
  ds_read_b64 v[194:195], v4 offset:16384
  s_add_u32 m0, s66, 4096
  v_mfma_f32_16x16x32_bf16 v[24:27], a[128:131], v[204:207], v[24:27]
  ds_read_b64 v[196:197], v4 offset:15872
  buffer_load_dwordx4 v6, s[32:35], s56 offen sc1 lds
  v_mfma_f32_16x16x32_bf16 v[28:31], a[132:135], v[204:207], v[28:31]
  ds_read_b64 v[198:199], v4 offset:16896
  s_waitcnt lgkmcnt(4)
  v_mfma_f32_16x16x32_bf16 v[16:19], a[136:139], v[208:211], v[16:19]
  ds_read_b64 v[200:201], v4 offset:17408
  s_add_u32 s56, s56, 12288
  v_mfma_f32_16x16x32_bf16 v[20:23], a[140:143], v[208:211], v[20:23]
  ds_read_b64 v[202:203], v4 offset:18432
  s_add_u32 m0, s66, 8192
  v_mfma_f32_16x16x32_bf16 v[24:27], a[136:139], v[212:215], v[24:27]
  ds_read_b64 v[204:205], v4 offset:17920
  buffer_load_dwordx4 v6, s[32:35], s56 offen sc1 lds
  v_mfma_f32_16x16x32_bf16 v[28:31], a[140:143], v[212:215], v[28:31]
  ds_read_b64 v[206:207], v4 offset:18944
  s_waitcnt lgkmcnt(4)
  v_mfma_f32_16x16x32_bf16 v[16:19], a[144:147], v[192:195], v[16:19]
  ds_read_b64 v[208:209], v4 offset:20480
  s_add_u32 s56, s56, 4096
  v_mfma_f32_16x16x32_bf16 v[20:23], a[148:151], v[192:195], v[20:23]
  ds_read_b64 v[210:211], v4 offset:21504
  s_add_u32 m0, s66, 12288
  v_mfma_f32_16x16x32_bf16 v[24:27], a[144:147], v[196:199], v[24:27]
  ds_read_b64 v[212:213], v4 offset:20992
  buffer_load_dwordx4 v6, s[32:35], s56 offen sc1 lds
  v_mfma_f32_16x16x32_bf16 v[28:31], a[148:151], v[196:199], v[28:31]
  ds_read_b64 v[214:215], v4 offset:22016
  s_waitcnt lgkmcnt(4)
  v_mfma_f32_16x16x32_bf16 v[16:19], a[152:155], v[200:203], v[16:19]
  ds_read_b64 v[192:193], v4 offset:22528
  s_add_u32 s56, s56, 12288
  v_mfma_f32_16x16x32_bf16 v[20:23], a[156:159], v[200:203], v[20:23]
  ds_read_b64 v[194:195], v4 offset:23552
  s_add_u32 m0, s66, 16384
  v_mfma_f32_16x16x32_bf16 v[24:27], a[152:155], v[204:207], v[24:27]
  ds_read_b64 v[196:197], v4 offset:23040
  buffer_load_dwordx4 v6, s[32:35], s56 offen sc1 lds
  v_mfma_f32_16x16x32_bf16 v[28:31], a[156:159], v[204:207], v[28:31]
  ds_read_b64 v[198:199], v4 offset:24064
  s_waitcnt lgkmcnt(4)
  v_mfma_f32_16x16x32_bf16 v[16:19], a[160:163], v[208:211], v[16:19]
  ds_read_b64 v[200:201], v4 offset:25600
  s_add_u32 s56, s56, 4096
  v_mfma_f32_16x16x32_bf16 v[20:23], a[164:167], v[208:211], v[20:23]
  ds_read_b64 v[202:203], v4 offset:26624
  s_add_u32 m0, s66, 20480
  v_mfma_f32_16x16x32_bf16 v[24:27], a[160:163], v[212:215], v[24:27]
  ds_read_b64 v[204:205], v4 offset:26112
  buffer_load_dwordx4 v6, s[32:35], s56 offen sc1 lds
  v_mfma_f32_16x16x32_bf16 v[28:31], a[164:167], v[212:215], v[28:31]
  ds_read_b64 v[206:207], v4 offset:27136
  s_waitcnt lgkmcnt(4)
  v_mfma_f32_16x16x32_bf16 v[16:19], a[168:171], v[192:195], v[16:19]
  ds_read_b64 v[208:209], v4 offset:27648
  s_add_u32 s56, s56, 12288
  v_mfma_f32_16x16x32_bf16 v[20:23], a[172:175], v[192:195], v[20:23]
  ds_read_b64 v[210:211], v4 offset:28672
  s_add_u32 m0, s66, 24576
  v_mfma_f32_16x16x32_bf16 v[24:27], a[168:171], v[196:199], v[24:27]
  ds_read_b64 v[212:213], v4 offset:28160
  buffer_load_dwordx4 v6, s[32:35], s56 offen sc1 lds
  v_mfma_f32_16x16x32_bf16 v[28:31], a[172:175], v[196:199], v[28:31]
  ds_read_b64 v[214:215], v4 offset:29184
  s_waitcnt lgkmcnt(4)
  v_mfma_f32_16x16x32_bf16 v[16:19], a[176:179], v[200:203], v[16:19]
  ds_read_b64 v[192:193], v4 offset:30720
  s_add_u32 s56, s56, 4096
  v_mfma_f32_16x16x32_bf16 v[20:23], a[180:183], v[200:203], v[20:23]
  ds_read_b64 v[194:195], v4 offset:31744
  s_add_u32 m0, s66, 28672
  v_mfma_f32_16x16x32_bf16 v[24:27], a[176:179], v[204:207], v[24:27]
  ds_read_b64 v[196:197], v4 offset:31232
  buffer_load_dwordx4 v6, s[32:35], s56 offen sc1 lds
  v_mfma_f32_16x16x32_bf16 v[28:31], a[180:183], v[204:207], v[28:31]
  ds_read_b64 v[198:199], v4 offset:32256
  s_waitcnt lgkmcnt(4)
  v_mfma_f32_16x16x32_bf16 v[16:19], a[184:187], v[208:211], v[16:19]
  ds_read_b64 v[200:201], v4 offset:32768
  s_add_u32 s56, s56, 12288
  v_mfma_f32_16x16x32_bf16 v[20:23], a[188:191], v[208:211], v[20:23]
  ds_read_b64 v[202:203], v4 offset:33792
  s_add_u32 m0, s66, 32768
  v_mfma_f32_16x16x32_bf16 v[24:27], a[184:187], v[212:215], v[24:27]
  ds_read_b64 v[204:205], v4 offset:33280
  buffer_load_dwordx4 v6, s[32:35], s56 offen sc1 lds
  v_mfma_f32_16x16x32_bf16 v[28:31], a[188:191], v[212:215], v[28:31]
  ds_read_b64 v[206:207], v4 offset:34304
  s_waitcnt lgkmcnt(4)
  v_mfma_f32_16x16x32_bf16 v[16:19], a[192:195], v[192:195], v[16:19]
  ds_read_b64 v[208:209], v4 offset:35840
  s_add_u32 s56, s56, 4096
  v_mfma_f32_16x16x32_bf16 v[20:23], a[196:199], v[192:195], v[20:23]
  ds_read_b64 v[210:211], v4 offset:36864
  s_add_u32 m0, s66, 36864
  v_mfma_f32_16x16x32_bf16 v[24:27], a[192:195], v[196:199], v[24:27]
  ds_read_b64 v[212:213], v4 offset:36352
  buffer_load_dwordx4 v6, s[32:35], s56 offen sc1 lds
  v_mfma_f32_16x16x32_bf16 v[28:31], a[196:199], v[196:199], v[28:31]
  ds_read_b64 v[214:215], v4 offset:37376
  s_waitcnt lgkmcnt(4)
  v_mfma_f32_16x16x32_bf16 v[16:19], a[200:203], v[200:203], v[16:19]
  ds_read_b64 v[192:193], v4 offset:37888
  s_add_u32 s56, s56, 12288
  v_mfma_f32_16x16x32_bf16 v[20:23], a[204:207], v[200:203], v[20:23]
  ds_read_b64 v[194:195], v4 offset:38912
  s_add_u32 s66, s66, 40960
  v_mfma_f32_16x16x32_bf16 v[24:27], a[200:203], v[204:207], v[24:27]
  ds_read_b64 v[196:197], v4 offset:38400
  s_cmp_ge_u32 s66, 122880
  v_mfma_f32_16x16x32_bf16 v[28:31], a[204:207], v[204:207], v[28:31]
  ds_read_b64 v[198:199], v4 offset:39424
  s_waitcnt lgkmcnt(4)
  v_mfma_f32_16x16x32_bf16 v[16:19], a[208:211], v[208:211], v[16:19]
  ds_read_b64 v[200:201], v4 offset:4096
  s_cselect_b32 s53, 122880, 0
  v_mfma_f32_16x16x32_bf16 v[20:23], a[212:215], v[208:211], v[20:23]
  ds_read_b64 v[202:203], v4 offset:9216
  s_sub_u32 s66, s66, s53
  v_mfma_f32_16x16x32_bf16 v[24:27], a[208:211], v[212:215], v[24:27]
  ds_read_b64 v[204:205], v4 offset:4608
  s_add_u32 s67, s67, 40960
  v_mfma_f32_16x16x32_bf16 v[28:31], a[212:215], v[212:215], v[28:31]
  ds_read_b64 v[206:207], v4 offset:9728
  s_waitcnt lgkmcnt(4)
  v_mfma_f32_16x16x32_bf16 v[16:19], a[216:219], v[192:195], v[16:19]
  ds_read_b64 v[208:209], v4 offset:14336
  s_cmp_ge_u32 s67, 122880
  v_mfma_f32_16x16x32_bf16 v[20:23], a[220:223], v[192:195], v[20:23]
  ds_read_b64 v[210:211], v4 offset:19456
  s_cselect_b32 s53, 122880, 0
  v_mfma_f32_16x16x32_bf16 v[24:27], a[216:219], v[196:199], v[24:27]
  ds_read_b64 v[212:213], v4 offset:14848
  s_sub_u32 s67, s67, s53
  v_mfma_f32_16x16x32_bf16 v[28:31], a[220:223], v[196:199], v[28:31]
  ds_read_b64 v[214:215], v4 offset:19968
  s_waitcnt lgkmcnt(4)
  v_mfma_f32_16x16x32_bf16 v[16:19], a[224:227], v[200:203], v[16:19]
  ds_read_b64 v[192:193], v4 offset:24576
  v_mfma_f32_16x16x32_bf16 v[20:23], a[228:231], v[200:203], v[20:23]
  ds_read_b64 v[194:195], v4 offset:29696
  v_mfma_f32_16x16x32_bf16 v[24:27], a[224:227], v[204:207], v[24:27]
  ds_read_b64 v[196:197], v4 offset:25088
  v_mfma_f32_16x16x32_bf16 v[28:31], a[228:231], v[204:207], v[28:31]
  ds_read_b64 v[198:199], v4 offset:30208
  s_waitcnt lgkmcnt(4)
  v_mfma_f32_16x16x32_bf16 v[16:19], a[232:235], v[208:211], v[16:19]
  ds_read_b64 v[200:201], v4 offset:34816
  v_mfma_f32_16x16x32_bf16 v[20:23], a[236:239], v[208:211], v[20:23]
  ds_read_b64 v[202:203], v4 offset:39936
  v_mfma_f32_16x16x32_bf16 v[24:27], a[232:235], v[212:215], v[24:27]
  ds_read_b64 v[204:205], v4 offset:35328
  v_mfma_f32_16x16x32_bf16 v[28:31], a[236:239], v[212:215], v[28:31]
  ds_read_b64 v[206:207], v4 offset:40448
  s_waitcnt lgkmcnt(4)
  v_mfma_f32_16x16x32_bf16 v[16:19], a[240:243], v[192:195], v[16:19]
  v_mfma_f32_16x16x32_bf16 v[20:23], a[244:247], v[192:195], v[20:23]
  v_mfma_f32_16x16x32_bf16 v[24:27], a[240:243], v[196:199], v[24:27]
  v_mfma_f32_16x16x32_bf16 v[28:31], a[244:247], v[196:199], v[28:31]
  s_waitcnt lgkmcnt(0)
  v_mfma_f32_16x16x32_bf16 v[16:19], a[248:251], v[200:203], v[16:19]
  v_mfma_f32_16x16x32_bf16 v[20:23], a[252:255], v[200:203], v[20:23]
  v_mfma_f32_16x16x32_bf16 v[24:27], a[248:251], v[204:207], v[24:27]
  v_mfma_f32_16x16x32_bf16 v[28:31], a[252:255], v[204:207], v[28:31]
  s_mul_i32 s54, s76, 81920
  v_cvt_pk_bf16_f32 v168, v16, v17
  v_cvt_pk_bf16_f32 v169, v18, v19
  v_cvt_pk_bf16_f32 v170, v20, v21
  v_cvt_pk_bf16_f32 v171, v22, v23
  s_nop 0
  v_permlane16_swap_b32 v168, v170
  v_permlane16_swap_b32 v169, v171
  buffer_store_dwordx4 v[168:171], v9, s[44:47], s54 offen nt
  s_add_u32 s54, s54, 40960
  v_cvt_pk_bf16_f32 v172, v24, v25
  v_cvt_pk_bf16_f32 v173, v26, v27
  v_cvt_pk_bf16_f32 v174, v28, v29
  v_cvt_pk_bf16_f32 v175, v30, v31
  s_nop 0
  v_permlane16_swap_b32 v172, v174
  v_permlane16_swap_b32 v173, v175
  buffer_store_dwordx4 v[172:175], v9, s[44:47], s54 offen nt
  s_add_u32 s54, s54, 40960
  s_add_u32 s76, s76, 12
  s_waitcnt vmcnt(12)
  s_cmp_lt_u32 s76, 64
  s_cbranch_scc1 PA_OUT
  s_branch L_EXIT
PA_END:
R_UC:
  s_mov_b32 s40, s22
  s_and_b32 s41, s23, 0xffff
  s_mov_b32 s42, 0x780000
  s_mov_b32 s43, 0x20000
  s_mul_i32 s55, s48, 245760
  s_mul_i32 s53, s49, 320
  s_add_u32 s53, s53, 0
  v_add_u32 v60, s53, v0
  v_mul_u32_u24 v61, 26215, v60
  v_lshrrev_b32 v61, 20, v61
  v_mul_u32_u24 v62, 40, v61
  v_sub_u32 v60, v60, v62
  v_and_b32 v62, 6, v61
  v_xor_b32 v60, v60, v62
  v_mul_u32_u24 v61, 1280, v61
  v_lshl_add_u32 v64, v60, 4, v61
  v_add_u32 v64, s55, v64
  s_mul_i32 s53, s49, 320
  s_add_u32 s53, s53, 64
  v_add_u32 v60, s53, v0
  v_mul_u32_u24 v61, 26215, v60
  v_lshrrev_b32 v61, 20, v61
  v_mul_u32_u24 v62, 40, v61
  v_sub_u32 v60, v60, v62
  v_and_b32 v62, 6, v61
  v_xor_b32 v60, v60, v62
  v_mul_u32_u24 v61, 1280, v61
  v_lshl_add_u32 v65, v60, 4, v61
  v_add_u32 v65, s55, v65
  s_mul_i32 s53, s49, 320
  s_add_u32 s53, s53, 128
  v_add_u32 v60, s53, v0
  v_mul_u32_u24 v61, 26215, v60
  v_lshrrev_b32 v61, 20, v61
  v_mul_u32_u24 v62, 40, v61
  v_sub_u32 v60, v60, v62
  v_and_b32 v62, 6, v61
  v_xor_b32 v60, v60, v62
  v_mul_u32_u24 v61, 1280, v61
  v_lshl_add_u32 v66, v60, 4, v61
  v_add_u32 v66, s55, v66
  s_mul_i32 s53, s49, 320
  s_add_u32 s53, s53, 192
  v_add_u32 v60, s53, v0
  v_mul_u32_u24 v61, 26215, v60
  v_lshrrev_b32 v61, 20, v61
  v_mul_u32_u24 v62, 40, v61
  v_sub_u32 v60, v60, v62
  v_and_b32 v62, 6, v61
  v_xor_b32 v60, v60, v62
  v_mul_u32_u24 v61, 1280, v61
  v_lshl_add_u32 v67, v60, 4, v61
  v_add_u32 v67, s55, v67
  s_mul_i32 s53, s49, 320
  s_add_u32 s53, s53, 256
  v_add_u32 v60, s53, v0
  v_mul_u32_u24 v61, 26215, v60
  v_lshrrev_b32 v61, 20, v61
  v_mul_u32_u24 v62, 40, v61
  v_sub_u32 v60, v60, v62
  v_and_b32 v62, 6, v61
  v_xor_b32 v60, v60, v62
  v_mul_u32_u24 v61, 1280, v61
  v_lshl_add_u32 v68, v60, 4, v61
  v_add_u32 v68, s55, v68
  s_mul_i32 s55, s49, 5
  s_add_u32 s55, s55, 0
  v_lshrrev_b32 v60, 4, v0
  v_bfe_u32 v61, v0, 2, 2
  v_lshl_add_u32 v62, v60, 2, v61
  v_and_b32 v60, 1, v60
  v_lshrrev_b32 v61, 1, v61
  v_lshl_add_u32 v60, v60, 1, v61
  v_xor_b32 v60, s55, v60
  v_mul_u32_u24 v62, 640, v62
  v_lshl_add_u32 v62, v60, 5, v62
  v_and_b32 v60, 3, v0
  v_lshl_add_u32 v70, v60, 3, v62
  s_mul_i32 s55, s49, 5
  s_add_u32 s55, s55, 1
  v_lshrrev_b32 v60, 4, v0
  v_bfe_u32 v61, v0, 2, 2
  v_lshl_add_u32 v62, v60, 2, v61
  v_and_b32 v60, 1, v60
  v_lshrrev_b32 v61, 1, v61
  v_lshl_add_u32 v60, v60, 1, v61
  v_xor_b32 v60, s55, v60
  v_mul_u32_u24 v62, 640, v62
  v_lshl_add_u32 v62, v60, 5, v62
  v_and_b32 v60, 3, v0
  v_lshl_add_u32 v71, v60, 3, v62
  s_mul_i32 s55, s49, 5
  s_add_u32 s55, s55, 2
  v_lshrrev_b32 v60, 4, v0
  v_bfe_u32 v61, v0, 2, 2
  v_lshl_add_u32 v62, v60, 2, v61
  v_and_b32 v60, 1, v60
  v_lshrrev_b32 v61, 1, v61
  v_lshl_add_u32 v60, v60, 1, v61
  v_xor_b32 v60, s55, v60
  v_mul_u32_u24 v62, 640, v62
  v_lshl_add_u32 v62, v60, 5, v62
  v_and_b32 v60, 3, v0
  v_lshl_add_u32 v72, v60, 3, v62
  s_mul_i32 s55, s49, 5
  s_add_u32 s55, s55, 3
  v_lshrrev_b32 v60, 4, v0
  v_bfe_u32 v61, v0, 2, 2
  v_lshl_add_u32 v62, v60, 2, v61
  v_and_b32 v60, 1, v60
  v_lshrrev_b32 v61, 1, v61
  v_lshl_add_u32 v60, v60, 1, v61
  v_xor_b32 v60, s55, v60
  v_mul_u32_u24 v62, 640, v62
  v_lshl_add_u32 v62, v60, 5, v62
  v_and_b32 v60, 3, v0
  v_lshl_add_u32 v73, v60, 3, v62
  s_mul_i32 s55, s49, 5
  s_add_u32 s55, s55, 4
  v_lshrrev_b32 v60, 4, v0
  v_bfe_u32 v61, v0, 2, 2
  v_lshl_add_u32 v62, v60, 2, v61
  v_and_b32 v60, 1, v60
  v_lshrrev_b32 v61, 1, v61
  v_lshl_add_u32 v60, v60, 1, v61
  v_xor_b32 v60, s55, v60
  v_mul_u32_u24 v62, 640, v62
  v_lshl_add_u32 v62, v60, 5, v62
  v_and_b32 v60, 3, v0
  v_lshl_add_u32 v74, v60, 3, v62
  s_mov_b32 s54, 0
  s_mul_i32 s53, s49, 5120
  s_add_u32 m0, s53, 0
  s_nop 0
  buffer_load_dwordx4 v64, s[40:43], s54 offen  lds
  s_add_u32 m0, m0, 1024
  s_nop 0
  buffer_load_dwordx4 v65, s[40:43], s54 offen  lds
  s_add_u32 m0, m0, 1024
  s_nop 0
  buffer_load_dwordx4 v66, s[40:43], s54 offen  lds
  s_add_u32 m0, m0, 1024
  s_nop 0
  buffer_load_dwordx4 v67, s[40:43], s54 offen  lds
  s_add_u32 m0, m0, 1024
  s_nop 0
  buffer_load_dwordx4 v68, s[40:43], s54 offen  lds
  s_mov_b32 s54, 640
  s_mul_i32 s53, s49, 5120
  s_add_u32 m0, s53, 20480
  s_nop 0
  buffer_load_dwordx4 v64, s[40:43], s54 offen  lds
  s_add_u32 m0, m0, 1024
  s_nop 0
  buffer_load_dwordx4 v65, s[40:43], s54 offen  lds
  s_add_u32 m0, m0, 1024
  s_nop 0
  buffer_load_dwordx4 v66, s[40:43], s54 offen  lds
  s_add_u32 m0, m0, 1024
  s_nop 0
  buffer_load_dwordx4 v67, s[40:43], s54 offen  lds
  s_add_u32 m0, m0, 1024
  s_nop 0
  buffer_load_dwordx4 v68, s[40:43], s54 offen  lds
  s_mov_b32 s54, 40960
  s_mul_i32 s53, s49, 5120
  s_add_u32 m0, s53, 40960
  s_nop 0
  buffer_load_dwordx4 v64, s[40:43], s54 offen  lds
  s_add_u32 m0, m0, 1024
  s_nop 0
  buffer_load_dwordx4 v65, s[40:43], s54 offen  lds
  s_add_u32 m0, m0, 1024
  s_nop 0
  buffer_load_dwordx4 v66, s[40:43], s54 offen  lds
  s_add_u32 m0, m0, 1024
  s_nop 0
  buffer_load_dwordx4 v67, s[40:43], s54 offen  lds
  s_add_u32 m0, m0, 1024
  s_nop 0
  buffer_load_dwordx4 v68, s[40:43], s54 offen  lds
  s_mov_b32 s54, 41600
  s_mul_i32 s53, s49, 5120
  s_add_u32 m0, s53, 61440
  s_nop 0
  buffer_load_dwordx4 v64, s[40:43], s54 offen  lds
  s_add_u32 m0, m0, 1024
  s_nop 0
  buffer_load_dwordx4 v65, s[40:43], s54 offen  lds
  s_add_u32 m0, m0, 1024
  s_nop 0
  buffer_load_dwordx4 v66, s[40:43], s54 offen  lds
  s_add_u32 m0, m0, 1024
  s_nop 0
  buffer_load_dwordx4 v67, s[40:43], s54 offen  lds
  s_add_u32 m0, m0, 1024
  s_nop 0
  buffer_load_dwordx4 v68, s[40:43], s54 offen  lds
  s_mov_b32 s54, 81920
  s_mul_i32 s53, s49, 5120
  s_add_u32 m0, s53, 81920
  s_nop 0
  buffer_load_dwordx4 v64, s[40:43], s54 offen  lds
  s_add_u32 m0, m0, 1024
  s_nop 0
  buffer_load_dwordx4 v65, s[40:43], s54 offen  lds
  s_add_u32 m0, m0, 1024
  s_nop 0
  buffer_load_dwordx4 v66, s[40:43], s54 offen  lds
  s_add_u32 m0, m0, 1024
  s_nop 0
  buffer_load_dwordx4 v67, s[40:43], s54 offen  lds
  s_add_u32 m0, m0, 1024
  s_nop 0
  buffer_load_dwordx4 v68, s[40:43], s54 offen  lds
  s_mov_b32 s54, 82560
  s_mul_i32 s53, s49, 5120
  s_add_u32 m0, s53, 102400
  s_nop 0
  buffer_load_dwordx4 v64, s[40:43], s54 offen  lds
  s_add_u32 m0, m0, 1024
  s_nop 0
  buffer_load_dwordx4 v65, s[40:43], s54 offen  lds
  s_add_u32 m0, m0, 1024
  s_nop 0
  buffer_load_dwordx4 v66, s[40:43], s54 offen  lds
  s_add_u32 m0, m0, 1024
  s_nop 0
  buffer_load_dwordx4 v67, s[40:43], s54 offen  lds
  s_add_u32 m0, m0, 1024
  s_nop 0
  buffer_load_dwordx4 v68, s[40:43], s54 offen  lds
  s_mov_b32 s54, 122880
  s_mul_i32 s53, s49, 5120
  s_add_u32 m0, s53, 122880
  s_nop 0
  buffer_load_dwordx4 v64, s[40:43], s54 offen  lds
  s_add_u32 m0, m0, 1024
  s_nop 0
  buffer_load_dwordx4 v65, s[40:43], s54 offen  lds
  s_add_u32 m0, m0, 1024
  s_nop 0
  buffer_load_dwordx4 v66, s[40:43], s54 offen  lds
  s_add_u32 m0, m0, 1024
  s_nop 0
  buffer_load_dwordx4 v67, s[40:43], s54 offen  lds
  s_add_u32 m0, m0, 1024
  s_nop 0
  buffer_load_dwordx4 v68, s[40:43], s54 offen  lds
  s_mov_b32 s54, 123520
  s_mul_i32 s53, s49, 5120
  s_add_u32 m0, s53, 143360
  s_nop 0
  buffer_load_dwordx4 v64, s[40:43], s54 offen  lds
  s_add_u32 m0, m0, 1024
  s_nop 0
  buffer_load_dwordx4 v65, s[40:43], s54 offen  lds
  s_add_u32 m0, m0, 1024
  s_nop 0
  buffer_load_dwordx4 v66, s[40:43], s54 offen  lds
  s_add_u32 m0, m0, 1024
  s_nop 0
  buffer_load_dwordx4 v67, s[40:43], s54 offen  lds
  s_add_u32 m0, m0, 1024
  s_nop 0
  buffer_load_dwordx4 v68, s[40:43], s54 offen  lds
  s_waitcnt vmcnt(35)
  s_barrier
  v_add_u32 v75, 0x0, v70
  v_add_u32 v76, 0x0, v71
  v_add_u32 v77, 0x0, v72
  v_add_u32 v78, 0x0, v73
  v_add_u32 v79, 0x0, v74
  ds_read_b64_tr_b16 a[16:17], v75 offset:0
  ds_read_b64_tr_b16 a[18:19], v75 offset:10240
  ds_read_b64_tr_b16 a[40:41], v76 offset:0
  ds_read_b64_tr_b16 a[42:43], v76 offset:10240
  ds_read_b64_tr_b16 a[64:65], v77 offset:0
  ds_read_b64_tr_b16 a[66:67], v77 offset:10240
  ds_read_b64_tr_b16 a[88:89], v78 offset:0
  ds_read_b64_tr_b16 a[90:91], v78 offset:10240
  ds_read_b64_tr_b16 a[112:113], v79 offset:0
  ds_read_b64_tr_b16 a[114:115], v79 offset:10240
  s_waitcnt lgkmcnt(0)
  s_barrier
  s_mov_b32 s54, 163840
  s_mul_i32 s53, s49, 5120
  s_add_u32 m0, s53, 0
  s_nop 0
  buffer_load_dwordx4 v64, s[40:43], s54 offen  lds
  s_add_u32 m0, m0, 1024
  s_nop 0
  buffer_load_dwordx4 v65, s[40:43], s54 offen  lds
  s_add_u32 m0, m0, 1024
  s_nop 0
  buffer_load_dwordx4 v66, s[40:43], s54 offen  lds
  s_add_u32 m0, m0, 1024
  s_nop 0
  buffer_load_dwordx4 v67, s[40:43], s54 offen  lds
  s_add_u32 m0, m0, 1024
  s_nop 0
  buffer_load_dwordx4 v68, s[40:43], s54 offen  lds
  s_waitcnt vmcnt(35)
  s_barrier
  v_add_u32 v75, 0x5000, v70
  v_add_u32 v76, 0x5000, v71
  v_add_u32 v77, 0x5000, v72
  v_add_u32 v78, 0x5000, v73
  v_add_u32 v79, 0x5000, v74
  ds_read_b64_tr_b16 a[136:137], v75 offset:0
  ds_read_b64_tr_b16 a[138:139], v75 offset:10240
  ds_read_b64_tr_b16 a[160:161], v76 offset:0
  ds_read_b64_tr_b16 a[162:163], v76 offset:10240
  ds_read_b64_tr_b16 a[184:185], v77 offset:0
  ds_read_b64_tr_b16 a[186:187], v77 offset:10240
  ds_read_b64_tr_b16 a[208:209], v78 offset:0
  ds_read_b64_tr_b16 a[210:211], v78 offset:10240
  ds_read_b64_tr_b16 a[232:233], v79 offset:0
  ds_read_b64_tr_b16 a[234:235], v79 offset:10240
  s_waitcnt lgkmcnt(0)
  s_barrier
  s_mov_b32 s54, 164480
  s_mul_i32 s53, s49, 5120
  s_add_u32 m0, s53, 20480
  s_nop 0
  buffer_load_dwordx4 v64, s[40:43], s54 offen  lds
  s_add_u32 m0, m0, 1024
  s_nop 0
  buffer_load_dwordx4 v65, s[40:43], s54 offen  lds
  s_add_u32 m0, m0, 1024
  s_nop 0
  buffer_load_dwordx4 v66, s[40:43], s54 offen  lds
  s_add_u32 m0, m0, 1024
  s_nop 0
  buffer_load_dwordx4 v67, s[40:43], s54 offen  lds
  s_add_u32 m0, m0, 1024
  s_nop 0
  buffer_load_dwordx4 v68, s[40:43], s54 offen  lds
  s_waitcnt vmcnt(35)
  s_barrier
  v_add_u32 v75, 0xa000, v70
  v_add_u32 v76, 0xa000, v71
  v_add_u32 v77, 0xa000, v72
  v_add_u32 v78, 0xa000, v73
  v_add_u32 v79, 0xa000, v74
  ds_read_b64_tr_b16 a[32:33], v75 offset:0
  ds_read_b64_tr_b16 a[20:21], v75 offset:10240
  ds_read_b64_tr_b16 a[56:57], v76 offset:0
  ds_read_b64_tr_b16 a[44:45], v76 offset:10240
  ds_read_b64_tr_b16 a[80:81], v77 offset:0
  ds_read_b64_tr_b16 a[68:69], v77 offset:10240
  ds_read_b64_tr_b16 a[104:105], v78 offset:0
  ds_read_b64_tr_b16 a[92:93], v78 offset:10240
  ds_read_b64_tr_b16 a[128:129], v79 offset:0
  ds_read_b64_tr_b16 a[116:117], v79 offset:10240
  s_waitcnt lgkmcnt(0)
  s_barrier
  s_mov_b32 s54, 204800
  s_mul_i32 s53, s49, 5120
  s_add_u32 m0, s53, 40960
  s_nop 0
  buffer_load_dwordx4 v64, s[40:43], s54 offen  lds
  s_add_u32 m0, m0, 1024
  s_nop 0
  buffer_load_dwordx4 v65, s[40:43], s54 offen  lds
  s_add_u32 m0, m0, 1024
  s_nop 0
  buffer_load_dwordx4 v66, s[40:43], s54 offen  lds
  s_add_u32 m0, m0, 1024
  s_nop 0
  buffer_load_dwordx4 v67, s[40:43], s54 offen  lds
  s_add_u32 m0, m0, 1024
  s_nop 0
  buffer_load_dwordx4 v68, s[40:43], s54 offen  lds
  s_waitcnt vmcnt(35)
  s_barrier
  v_add_u32 v75, 0xf000, v70
  v_add_u32 v76, 0xf000, v71
  v_add_u32 v77, 0xf000, v72
  v_add_u32 v78, 0xf000, v73
  v_add_u32 v79, 0xf000, v74
  ds_read_b64_tr_b16 a[152:153], v75 offset:0
  ds_read_b64_tr_b16 a[140:141], v75 offset:10240
  ds_read_b64_tr_b16 a[176:177], v76 offset:0
  ds_read_b64_tr_b16 a[164:165], v76 offset:10240
  ds_read_b64_tr_b16 a[200:201], v77 offset:0
  ds_read_b64_tr_b16 a[188:189], v77 offset:10240
  ds_read_b64_tr_b16 a[224:225], v78 offset:0
  ds_read_b64_tr_b16 a[212:213], v78 offset:10240
  ds_read_b64_tr_b16 a[248:249], v79 offset:0
  ds_read_b64_tr_b16 a[236:237], v79 offset:10240
  s_waitcnt lgkmcnt(0)
  s_barrier
  s_mov_b32 s54, 205440
  s_mul_i32 s53, s49, 5120
  s_add_u32 m0, s53, 61440
  s_nop 0
  buffer_load_dwordx4 v64, s[40:43], s54 offen  lds
  s_add_u32 m0, m0, 1024
  s_nop 0
  buffer_load_dwordx4 v65, s[40:43], s54 offen  lds
  s_add_u32 m0, m0, 1024
  s_nop 0
  buffer_load_dwordx4 v66, s[40:43], s54 offen  lds
  s_add_u32 m0, m0, 1024
  s_nop 0
  buffer_load_dwordx4 v67, s[40:43], s54 offen  lds
  s_add_u32 m0, m0, 1024
  s_nop 0
  buffer_load_dwordx4 v68, s[40:43], s54 offen  lds
  s_waitcnt vmcnt(35)
  s_barrier
  v_add_u32 v75, 0x14000, v70
  v_add_u32 v76, 0x14000, v71
  v_add_u32 v77, 0x14000, v72
  v_add_u32 v78, 0x14000, v73
  v_add_u32 v79, 0x14000, v74
  ds_read_b64_tr_b16 a[22:23], v75 offset:0
  ds_read_b64_tr_b16 a[34:35], v75 offset:10240
  ds_read_b64_tr_b16 a[46:47], v76 offset:0
  ds_read_b64_tr_b16 a[58:59], v76 offset:10240
  ds_read_b64_tr_b16 a[70:71], v77 offset:0
  ds_read_b64_tr_b16 a[82:83], v77 offset:10240
  ds_read_b64_tr_b16 a[94:95], v78 offset:0
  ds_read_b64_tr_b16 a[106:107], v78 offset:10240
  ds_read_b64_tr_b16 a[118:119], v79 offset:0
  ds_read_b64_tr_b16 a[130:131], v79 offset:10240
  s_waitcnt lgkmcnt(0)
  s_waitcnt vmcnt(30)
  s_barrier
  v_add_u32 v75, 0x19000, v70
  v_add_u32 v76, 0x19000, v71
  v_add_u32 v77, 0x19000, v72
  v_add_u32 v78, 0x19000, v73
  v_add_u32 v79, 0x19000, v74
  ds_read_b64_tr_b16 a[142:143], v75 offset:0
  ds_read_b64_tr_b16 a[154:155], v75 offset:10240
  ds_read_b64_tr_b16 a[166:167], v76 offset:0
  ds_read_b64_tr_b16 a[178:179], v76 offset:10240
  ds_read_b64_tr_b16 a[190:191], v77 offset:0
  ds_read_b64_tr_b16 a[202:203], v77 offset:10240
  ds_read_b64_tr_b16 a[214:215], v78 offset:0
  ds_read_b64_tr_b16 a[226:227], v78 offset:10240
  ds_read_b64_tr_b16 a[238:239], v79 offset:0
  ds_read_b64_tr_b16 a[250:251], v79 offset:10240
  s_waitcnt lgkmcnt(0)
  s_waitcnt vmcnt(25)
  s_barrier
  v_add_u32 v75, 0x1e000, v70
  v_add_u32 v76, 0x1e000, v71
  v_add_u32 v77, 0x1e000, v72
  v_add_u32 v78, 0x1e000, v73
  v_add_u32 v79, 0x1e000, v74
  ds_read_b64_tr_b16 a[24:25], v75 offset:0
  ds_read_b64_tr_b16 a[26:27], v75 offset:10240
  ds_read_b64_tr_b16 a[48:49], v76 offset:0
  ds_read_b64_tr_b16 a[50:51], v76 offset:10240
  ds_read_b64_tr_b16 a[72:73], v77 offset:0
  ds_read_b64_tr_b16 a[74:75], v77 offset:10240
  ds_read_b64_tr_b16 a[96:97], v78 offset:0
  ds_read_b64_tr_b16 a[98:99], v78 offset:10240
  ds_read_b64_tr_b16 a[120:121], v79 offset:0
  ds_read_b64_tr_b16 a[122:123], v79 offset:10240
  s_waitcnt lgkmcnt(0)
  s_waitcnt vmcnt(20)
  s_barrier
  v_add_u32 v75, 0x23000, v70
  v_add_u32 v76, 0x23000, v71
  v_add_u32 v77, 0x23000, v72
  v_add_u32 v78, 0x23000, v73
  v_add_u32 v79, 0x23000, v74
  ds_read_b64_tr_b16 a[144:145], v75 offset:0
  ds_read_b64_tr_b16 a[146:147], v75 offset:10240
  ds_read_b64_tr_b16 a[168:169], v76 offset:0
  ds_read_b64_tr_b16 a[170:171], v76 offset:10240
  ds_read_b64_tr_b16 a[192:193], v77 offset:0
  ds_read_b64_tr_b16 a[194:195], v77 offset:10240
  ds_read_b64_tr_b16 a[216:217], v78 offset:0
  ds_read_b64_tr_b16 a[218:219], v78 offset:10240
  ds_read_b64_tr_b16 a[240:241], v79 offset:0
  ds_read_b64_tr_b16 a[242:243], v79 offset:10240
  s_waitcnt lgkmcnt(0)
  s_waitcnt vmcnt(15)
  s_barrier
  v_add_u32 v75, 0x0, v70
  v_add_u32 v76, 0x0, v71
  v_add_u32 v77, 0x0, v72
  v_add_u32 v78, 0x0, v73
  v_add_u32 v79, 0x0, v74
  ds_read_b64_tr_b16 a[36:37], v75 offset:0
  ds_read_b64_tr_b16 a[28:29], v75 offset:10240
  ds_read_b64_tr_b16 a[60:61], v76 offset:0
  ds_read_b64_tr_b16 a[52:53], v76 offset:10240
  ds_read_b64_tr_b16 a[84:85], v77 offset:0
  ds_read_b64_tr_b16 a[76:77], v77 offset:10240
  ds_read_b64_tr_b16 a[108:109], v78 offset:0
  ds_read_b64_tr_b16 a[100:101], v78 offset:10240
  ds_read_b64_tr_b16 a[132:133], v79 offset:0
  ds_read_b64_tr_b16 a[124:125], v79 offset:10240
  s_waitcnt lgkmcnt(0)
  s_waitcnt vmcnt(10)
  s_barrier
  v_add_u32 v75, 0x5000, v70
  v_add_u32 v76, 0x5000, v71
  v_add_u32 v77, 0x5000, v72
  v_add_u32 v78, 0x5000, v73
  v_add_u32 v79, 0x5000, v74
  ds_read_b64_tr_b16 a[156:157], v75 offset:0
  ds_read_b64_tr_b16 a[148:149], v75 offset:10240
  ds_read_b64_tr_b16 a[180:181], v76 offset:0
  ds_read_b64_tr_b16 a[172:173], v76 offset:10240
  ds_read_b64_tr_b16 a[204:205], v77 offset:0
  ds_read_b64_tr_b16 a[196:197], v77 offset:10240
  ds_read_b64_tr_b16 a[228:229], v78 offset:0
  ds_read_b64_tr_b16 a[220:221], v78 offset:10240
  ds_read_b64_tr_b16 a[252:253], v79 offset:0
  ds_read_b64_tr_b16 a[244:245], v79 offset:10240
  s_waitcnt lgkmcnt(0)
  s_waitcnt vmcnt(5)
  s_barrier
  v_add_u32 v75, 0xa000, v70
  v_add_u32 v76, 0xa000, v71
  v_add_u32 v77, 0xa000, v72
  v_add_u32 v78, 0xa000, v73
  v_add_u32 v79, 0xa000, v74
  ds_read_b64_tr_b16 a[30:31], v75 offset:0
  ds_read_b64_tr_b16 a[38:39], v75 offset:10240
  ds_read_b64_tr_b16 a[54:55], v76 offset:0
  ds_read_b64_tr_b16 a[62:63], v76 offset:10240
  ds_read_b64_tr_b16 a[78:79], v77 offset:0
  ds_read_b64_tr_b16 a[86:87], v77 offset:10240
  ds_read_b64_tr_b16 a[102:103], v78 offset:0
  ds_read_b64_tr_b16 a[110:111], v78 offset:10240
  ds_read_b64_tr_b16 a[126:127], v79 offset:0
  ds_read_b64_tr_b16 a[134:135], v79 offset:10240
  s_waitcnt lgkmcnt(0)
  s_waitcnt vmcnt(0)
  s_barrier
  v_add_u32 v75, 0xf000, v70
  v_add_u32 v76, 0xf000, v71
  v_add_u32 v77, 0xf000, v72
  v_add_u32 v78, 0xf000, v73
  v_add_u32 v79, 0xf000, v74
  ds_read_b64_tr_b16 a[150:151], v75 offset:0
  ds_read_b64_tr_b16 a[158:159], v75 offset:10240
  ds_read_b64_tr_b16 a[174:175], v76 offset:0
  ds_read_b64_tr_b16 a[182:183], v76 offset:10240
  ds_read_b64_tr_b16 a[198:199], v77 offset:0
  ds_read_b64_tr_b16 a[206:207], v77 offset:10240
  ds_read_b64_tr_b16 a[222:223], v78 offset:0
  ds_read_b64_tr_b16 a[230:231], v78 offset:10240
  ds_read_b64_tr_b16 a[246:247], v79 offset:0
  ds_read_b64_tr_b16 a[254:255], v79 offset:10240
  s_waitcnt lgkmcnt(0)
  s_barrier
  v_min_u32 v136, 47, v0
  v_max_u32 v136, 31, v136
  v_lshlrev_b32 v136, 2, v136
  s_mov_b32 s57, 0
WI_66:
  global_load_dword v137, v136, s[28:29] sc1
  s_add_u32 s57, s57, 1
  s_cmp_gt_u32 s57, 0x20000
  s_cbranch_scc1 L_EXIT
  s_waitcnt vmcnt(0)
  s_and_b32 s53, s24, 7
  s_add_u32 s53, s53, 40
  v_readlane_b32 s53, v137, s53
  s_nop 1
  v_cmp_gt_u32 vcc, s53, v137
  s_bfe_u32 s53, vcc_hi, 0x80008
  s_bcnt1_i32_b32 s53, s53
  v_cmp_eq_u32 vcc, 0, v137
  s_bfe_u32 s54, vcc_hi, 0x80008
  s_cbranch_scc1 WI_68
  s_cmp_lg_u32 s53, s25
  s_cbranch_scc1 L_REDO
WI_68:
  s_cbranch_vccz WI_67
  s_sleep 8
  s_branch WI_66
WI_67:
  v_readfirstlane_b32 s53, v137
  s_and_b32 s53, s53, 1
  s_lshl_b32 s50, s53, 13
  s_xor_b32 s51, s50, 0x2000
  v_lshlrev_b32 v1, 4, v0
  s_lshl_b32 s62, s48, 14
  s_lshr_b32 s54, s49, 1
  s_lshl_b32 s54, s54, 13
  s_add_u32 s62, s62, s54
  s_and_b32 s63, s49, 1
  s_lshl_b32 s63, s63, 12
  s_lshl_b32 s54, s48, 7
  s_add_u32 s54, s54, s51
  s_add_u32 s54, s54, 53248
  v_mov_b32 v6, s54
  s_add_u32 s54, s51, 21504
  v_min_u32 v7, 23, v0
  v_lshl_add_u32 v7, v7, 7, s54
  v_mov_b64 v[10:11], 0
  s_lshl_b32 s54, s48, 7
  s_add_u32 s54, s54, s50
  s_add_u32 s54, s54, 65536
  s_cmp_eq_u32 s49, 0
  s_cselect_b32 s54, s54, 0x40000000
  v_mov_b32 v2, 0x40000000
  s_nop 0
  v_writelane_b32 v2, s54, 0
  s_mov_b32 s67, 0
  s_mov_b32 s72, 0
  s_lshr_b32 s69, s48, 3
  s_lshl_b32 s69, s69, 13
  s_mul_i32 s54, s49, 163840
  s_add_u32 s69, s69, s54
  s_add_u32 s69, s69, 0x2400000
  s_and_b32 s70, s48, 7
  s_lshl_b32 s70, s70, 10
  s_mov_b32 s71, 0
  s_add_u32 s68, s71, 1
  s_min_u32 s68, s68, 64
  v_cmp_gt_u32 vcc, s68, v10
  s_cbranch_vccz UF_69
  s_cmp_ge_u32 s67, s68
  s_cbranch_scc1 WPD_71
  s_mov_b32 s57, 0
  s_mov_b32 exec_lo, 0x1
  s_mov_b32 exec_hi, 0
WPL_72:
  buffer_load_dword v136, v6, s[32:35], 0 offen sc1
  s_add_u32 s57, s57, 1
  s_cmp_gt_u32 s57, 0x80000
  s_cbranch_scc1 L_EXIT
  s_waitcnt vmcnt(0)
  v_cmp_gt_u32 vcc, s68, v136
  s_cbranch_vccnz WPL_72
  s_mov_b32 s67, s68
  s_add_u32 s53, s68, 2
  s_min_u32 s53, s53, 64
  v_cmp_gt_u32 vcc, s53, v136
  s_nop 0
  s_cmp_eq_u64 vcc, 0
  s_cselect_b32 s67, s53, s67
  s_add_u32 s53, s68, 6
  s_min_u32 s53, s53, 64
  v_cmp_gt_u32 vcc, s53, v136
  s_nop 0
  s_cmp_eq_u64 vcc, 0
  s_cselect_b32 s67, s53, s67
  s_add_u32 s53, s68, 16
  s_min_u32 s53, s53, 64
  v_cmp_gt_u32 vcc, s53, v136
  s_nop 0
  s_cmp_eq_u64 vcc, 0
  s_cselect_b32 s67, s53, s67
  s_mov_b64 exec, -1
WPD_71:
UF_69:
  s_max_u32 s68, s68, 13
  s_sub_u32 s68, s68, 13
  v_cmp_gt_u32 vcc, s68, v11
  s_cbranch_vccz UF_70
  s_cmp_ge_u32 s72, s68
  s_cbranch_scc1 WPD_73
  s_mov_b32 s57, 0
  s_mov_b32 exec_lo, 0xffffff
  s_mov_b32 exec_hi, 0
WPL_74:
  buffer_load_dword v136, v7, s[32:35], 0 offen sc1
  s_add_u32 s57, s57, 1
  s_cmp_gt_u32 s57, 0x80000
  s_cbranch_scc1 L_EXIT
  s_waitcnt vmcnt(0)
  v_cmp_gt_u32 vcc, s68, v136
  s_cbranch_vccz WPG_75
  s_sleep 8
  s_branch WPL_74
WPG_75:
  s_mov_b32 s72, s68
  s_add_u32 s53, s68, 2
  s_min_u32 s53, s53, 64
  v_cmp_gt_u32 vcc, s53, v136
  s_nop 0
  s_cmp_eq_u64 vcc, 0
  s_cselect_b32 s72, s53, s72
  s_add_u32 s53, s68, 6
  s_min_u32 s53, s53, 64
  v_cmp_gt_u32 vcc, s53, v136
  s_nop 0
  s_cmp_eq_u64 vcc, 0
  s_cselect_b32 s72, s53, s72
  s_add_u32 s53, s68, 16
  s_min_u32 s53, s53, 64
  v_cmp_gt_u32 vcc, s53, v136
  s_nop 0
  s_cmp_eq_u64 vcc, 0
  s_cselect_b32 s72, s53, s72
  s_mov_b64 exec, -1
WPD_73:
UF_70:
  s_min_u32 s55, s71, 63
  s_mul_i32 s54, s55, 0x80000
  s_add_u32 s54, s54, 0x2200000
  s_add_u32 s54, s54, s62
  s_lshr_b32 s53, s54, 7
  s_and_b32 s53, s53, 0x2000
  s_xor_b32 s53, s53, s51
  s_lshl_b32 s54, s54, 1
  s_or_b32 s54, s54, s53
  s_add_u32 s54, s54, s63
  s_mul_i32 s55, s49, 3072
  s_add_u32 m0, s55, 0
  s_add_u32 s71, s71, 1
  buffer_load_dwordx4 v1, s[32:35], s54 offen offset:0 sc1 lds
  buffer_load_dwordx4 v1, s[32:35], s54 offen offset:1024 sc1 lds
  buffer_load_dwordx4 v1, s[32:35], s54 offen offset:2048 sc1 lds
  s_waitcnt vmcnt(0)
  s_barrier
  ds_read_b128 v[40:43], v1 offset:0
  ds_read_b128 v[44:47], v1 offset:3072
  ds_read_b128 v[48:51], v1 offset:6144
  ds_read_b128 v[52:55], v1 offset:9216
  ds_read_b64 v[56:57], v1 offset:2048
  ds_read_b64 v[58:59], v1 offset:5120
  ds_read_b64 v[60:61], v1 offset:8192
  ds_read_b64 v[62:63], v1 offset:11264
  ds_read_b128 v[64:67], v1 offset:1024
  ds_read_b128 v[68:71], v1 offset:4096
  ds_read_b128 v[72:75], v1 offset:7168
  ds_read_b128 v[76:79], v1 offset:10240
  s_waitcnt lgkmcnt(8)
  ds_read_b64 v[80:81], v1 offset:2056
  ds_read_b64 v[82:83], v1 offset:5128
  ds_read_b64 v[84:85], v1 offset:8200
  ds_read_b64 v[86:87], v1 offset:11272
  s_mov_b32 s52, 0
  s_mov_b32 s66, 0x40000000
  s_waitcnt lgkmcnt(0)
  v_mfma_f32_16x16x32_bf16 v[16:19], v[40:43], a[16:19], 0
  v_mfma_f32_16x16x32_bf16 v[20:23], v[64:67], a[16:19], 0
  v_mfma_f32_16x16x32_bf16 v[16:19], v[44:47], a[20:23], v[16:19]
  v_cvt_pk_bf16_f32 v36, v24, v25
  v_mfma_f32_16x16x32_bf16 v[20:23], v[68:71], a[20:23], v[20:23]
  v_cvt_pk_bf16_f32 v37, v26, v27
  v_mfma_f32_16x16x32_bf16 v[16:19], v[48:51], a[24:27], v[16:19]
  v_cvt_pk_bf16_f32 v38, v28, v29
  v_mfma_f32_16x16x32_bf16 v[20:23], v[72:75], a[24:27], v[20:23]
  v_cvt_pk_bf16_f32 v39, v30, v31
  v_mfma_f32_16x16x32_bf16 v[16:19], v[52:55], a[28:31], v[16:19]
  buffer_store_dwordx4 v[36:39], v1, s[32:35], s66 offen sc1
  v_mfma_f32_16x16x32_bf16 v[20:23], v[76:79], a[28:31], v[20:23]
  s_add_u32 s66, s69, 0
  s_lshr_b32 s53, s66, 7
  v_mfma_f32_16x16x32_bf16 v[16:19], v[56:59], a[32:35], v[16:19]
  s_and_b32 s53, s53, 0x2000
  s_xor_b32 s53, s53, s50
  v_mfma_f32_16x16x32_bf16 v[20:23], v[80:83], a[32:35], v[20:23]
  s_lshl_b32 s66, s66, 1
  s_or_b32 s66, s66, s53
  v_mfma_f32_16x16x32_bf16 v[16:19], v[60:63], a[36:39], v[16:19]
  s_add_u32 s66, s66, s70
  v_mfma_f32_16x16x32_bf16 v[20:23], v[84:87], a[36:39], v[20:23]
  v_mfma_f32_16x16x32_bf16 v[24:27], v[40:43], a[40:43], 0
  v_mfma_f32_16x16x32_bf16 v[28:31], v[64:67], a[40:43], 0
  v_mfma_f32_16x16x32_bf16 v[24:27], v[44:47], a[44:47], v[24:27]
  v_cvt_pk_bf16_f32 v32, v16, v17
  v_mfma_f32_16x16x32_bf16 v[28:31], v[68:71], a[44:47], v[28:31]
  v_cvt_pk_bf16_f32 v33, v18, v19
  v_mfma_f32_16x16x32_bf16 v[24:27], v[48:51], a[48:51], v[24:27]
  v_cvt_pk_bf16_f32 v34, v20, v21
  v_mfma_f32_16x16x32_bf16 v[28:31], v[72:75], a[48:51], v[28:31]
  v_cvt_pk_bf16_f32 v35, v22, v23
  v_mfma_f32_16x16x32_bf16 v[24:27], v[52:55], a[52:55], v[24:27]
  buffer_store_dwordx4 v[32:35], v1, s[32:35], s66 offen sc1
  v_mfma_f32_16x16x32_bf16 v[28:31], v[76:79], a[52:55], v[28:31]
  s_add_u32 s66, s69, 32768
  s_lshr_b32 s53, s66, 7
  v_mfma_f32_16x16x32_bf16 v[24:27], v[56:59], a[56:59], v[24:27]
  s_and_b32 s53, s53, 0x2000
  s_xor_b32 s53, s53, s50
  v_mfma_f32_16x16x32_bf16 v[28:31], v[80:83], a[56:59], v[28:31]
  s_lshl_b32 s66, s66, 1
  s_or_b32 s66, s66, s53
  v_mfma_f32_16x16x32_bf16 v[24:27], v[60:63], a[60:63], v[24:27]
  s_add_u32 s66, s66, s70
  v_mfma_f32_16x16x32_bf16 v[28:31], v[84:87], a[60:63], v[28:31]
  v_mfma_f32_16x16x32_bf16 v[16:19], v[40:43], a[64:67], 0
  v_mfma_f32_16x16x32_bf16 v[20:23], v[64:67], a[64:67], 0
  v_mfma_f32_16x16x32_bf16 v[16:19], v[44:47], a[68:71], v[16:19]
  v_cvt_pk_bf16_f32 v36, v24, v25
  v_mfma_f32_16x16x32_bf16 v[20:23], v[68:71], a[68:71], v[20:23]
  v_cvt_pk_bf16_f32 v37, v26, v27
  v_mfma_f32_16x16x32_bf16 v[16:19], v[48:51], a[72:75], v[16:19]
  v_cvt_pk_bf16_f32 v38, v28, v29
  v_mfma_f32_16x16x32_bf16 v[20:23], v[72:75], a[72:75], v[20:23]
  v_cvt_pk_bf16_f32 v39, v30, v31
  v_mfma_f32_16x16x32_bf16 v[16:19], v[52:55], a[76:79], v[16:19]
  buffer_store_dwordx4 v[36:39], v1, s[32:35], s66 offen sc1
  v_mfma_f32_16x16x32_bf16 v[20:23], v[76:79], a[76:79], v[20:23]
  s_add_u32 s66, s69, 65536
  s_lshr_b32 s53, s66, 7
  v_mfma_f32_16x16x32_bf16 v[16:19], v[56:59], a[80:83], v[16:19]
  s_and_b32 s53, s53, 0x2000
  s_xor_b32 s53, s53, s50
  v_mfma_f32_16x16x32_bf16 v[20:23], v[80:83], a[80:83], v[20:23]
  s_lshl_b32 s66, s66, 1
  s_or_b32 s66, s66, s53
  v_mfma_f32_16x16x32_bf16 v[16:19], v[60:63], a[84:87], v[16:19]
  s_add_u32 s66, s66, s70
  v_mfma_f32_16x16x32_bf16 v[20:23], v[84:87], a[84:87], v[20:23]
  v_mfma_f32_16x16x32_bf16 v[24:27], v[40:43], a[88:91], 0
  v_mfma_f32_16x16x32_bf16 v[28:31], v[64:67], a[88:91], 0
  v_mfma_f32_16x16x32_bf16 v[24:27], v[44:47], a[92:95], v[24:27]
  v_cvt_pk_bf16_f32 v32, v16, v17
  v_mfma_f32_16x16x32_bf16 v[28:31], v[68:71], a[92:95], v[28:31]
  v_cvt_pk_bf16_f32 v33, v18, v19
  v_mfma_f32_16x16x32_bf16 v[24:27], v[48:51], a[96:99], v[24:27]
  v_cvt_pk_bf16_f32 v34, v20, v21
  v_mfma_f32_16x16x32_bf16 v[28:31], v[72:75], a[96:99], v[28:31]
  v_cvt_pk_bf16_f32 v35, v22, v23
  v_mfma_f32_16x16x32_bf16 v[24:27], v[52:55], a[100:103], v[24:27]
  buffer_store_dwordx4 v[32:35], v1, s[32:35], s66 offen sc1
  v_mfma_f32_16x16x32_bf16 v[28:31], v[76:79], a[100:103], v[28:31]
  s_add_u32 s66, s69, 98304
  s_lshr_b32 s53, s66, 7
  v_mfma_f32_16x16x32_bf16 v[24:27], v[56:59], a[104:107], v[24:27]
  s_and_b32 s53, s53, 0x2000
  s_xor_b32 s53, s53, s50
  v_mfma_f32_16x16x32_bf16 v[28:31], v[80:83], a[104:107], v[28:31]
  s_lshl_b32 s66, s66, 1
  s_or_b32 s66, s66, s53
  v_mfma_f32_16x16x32_bf16 v[24:27], v[60:63], a[108:111], v[24:27]
  s_add_u32 s66, s66, s70
  v_mfma_f32_16x16x32_bf16 v[28:31], v[84:87], a[108:111], v[28:31]
  v_mfma_f32_16x16x32_bf16 v[16:19], v[40:43], a[112:115], 0
  v_mfma_f32_16x16x32_bf16 v[20:23], v[64:67], a[112:115], 0
  v_mfma_f32_16x16x32_bf16 v[16:19], v[44:47], a[116:119], v[16:19]
  v_cvt_pk_bf16_f32 v36, v24, v25
  v_mfma_f32_16x16x32_bf16 v[20:23], v[68:71], a[116:119], v[20:23]
  v_cvt_pk_bf16_f32 v37, v26, v27
  v_mfma_f32_16x16x32_bf16 v[16:19], v[48:51], a[120:123], v[16:19]
  v_cvt_pk_bf16_f32 v38, v28, v29
  v_mfma_f32_16x16x32_bf16 v[20:23], v[72:75], a[120:123], v[20:23]
  v_cvt_pk_bf16_f32 v39, v30, v31
  v_mfma_f32_16x16x32_bf16 v[16:19], v[52:55], a[124:127], v[16:19]
  buffer_store_dwordx4 v[36:39], v1, s[32:35], s66 offen sc1
  v_mfma_f32_16x16x32_bf16 v[20:23], v[76:79], a[124:127], v[20:23]
  s_add_u32 s66, s69, 131072
  s_lshr_b32 s53, s66, 7
  v_mfma_f32_16x16x32_bf16 v[16:19], v[56:59], a[128:131], v[16:19]
  s_and_b32 s53, s53, 0x2000
  s_xor_b32 s53, s53, s50
  v_mfma_f32_16x16x32_bf16 v[20:23], v[80:83], a[128:131], v[20:23]
  s_lshl_b32 s66, s66, 1
  s_or_b32 s66, s66, s53
  v_mfma_f32_16x16x32_bf16 v[16:19], v[60:63], a[132:135], v[16:19]
  s_add_u32 s66, s66, s70
  v_mfma_f32_16x16x32_bf16 v[20:23], v[84:87], a[132:135], v[20:23]
  v_mfma_f32_16x16x32_bf16 v[24:27], v[40:43], a[136:139], 0
  v_mfma_f32_16x16x32_bf16 v[28:31], v[64:67], a[136:139], 0
  v_mfma_f32_16x16x32_bf16 v[24:27], v[44:47], a[140:143], v[24:27]
  v_cvt_pk_bf16_f32 v32, v16, v17
  v_mfma_f32_16x16x32_bf16 v[28:31], v[68:71], a[140:143], v[28:31]
  v_cvt_pk_bf16_f32 v33, v18, v19
  v_mfma_f32_16x16x32_bf16 v[24:27], v[48:51], a[144:147], v[24:27]
  v_cvt_pk_bf16_f32 v34, v20, v21
  v_mfma_f32_16x16x32_bf16 v[28:31], v[72:75], a[144:147], v[28:31]
  v_cvt_pk_bf16_f32 v35, v22, v23
  v_mfma_f32_16x16x32_bf16 v[24:27], v[52:55], a[148:151], v[24:27]
  buffer_store_dwordx4 v[32:35], v1, s[32:35], s66 offen sc1
  v_mfma_f32_16x16x32_bf16 v[28:31], v[76:79], a[148:151], v[28:31]
  s_add_u32 s66, s69, 655360
  s_lshr_b32 s53, s66, 7
  v_mfma_f32_16x16x32_bf16 v[24:27], v[56:59], a[152:155], v[24:27]
  s_and_b32 s53, s53, 0x2000
  s_xor_b32 s53, s53, s50
  v_mfma_f32_16x16x32_bf16 v[28:31], v[80:83], a[152:155], v[28:31]
  s_lshl_b32 s66, s66, 1
  s_or_b32 s66, s66, s53
  v_mfma_f32_16x16x32_bf16 v[24:27], v[60:63], a[156:159], v[24:27]
  s_add_u32 s66, s66, s70
  v_mfma_f32_16x16x32_bf16 v[28:31], v[84:87], a[156:159], v[28:31]
  v_mfma_f32_16x16x32_bf16 v[16:19], v[40:43], a[160:163], 0
  v_mfma_f32_16x16x32_bf16 v[20:23], v[64:67], a[160:163], 0
  v_mfma_f32_16x16x32_bf16 v[16:19], v[44:47], a[164:167], v[16:19]
  v_cvt_pk_bf16_f32 v36, v24, v25
  v_mfma_f32_16x16x32_bf16 v[20:23], v[68:71], a[164:167], v[20:23]
  v_cvt_pk_bf16_f32 v37, v26, v27
  v_mfma_f32_16x16x32_bf16 v[16:19], v[48:51], a[168:171], v[16:19]
  v_cvt_pk_bf16_f32 v38, v28, v29
  v_mfma_f32_16x16x32_bf16 v[20:23], v[72:75], a[168:171], v[20:23]
  v_cvt_pk_bf16_f32 v39, v30, v31
  v_mfma_f32_16x16x32_bf16 v[16:19], v[52:55], a[172:175], v[16:19]
  buffer_store_dwordx4 v[36:39], v1, s[32:35], s66 offen sc1
  v_mfma_f32_16x16x32_bf16 v[20:23], v[76:79], a[172:175], v[20:23]
  s_add_u32 s66, s69, 688128
  s_lshr_b32 s53, s66, 7
  v_mfma_f32_16x16x32_bf16 v[16:19], v[56:59], a[176:179], v[16:19]
  s_and_b32 s53, s53, 0x2000
  s_xor_b32 s53, s53, s50
  v_mfma_f32_16x16x32_bf16 v[20:23], v[80:83], a[176:179], v[20:23]
  s_lshl_b32 s66, s66, 1
  s_or_b32 s66, s66, s53
  v_mfma_f32_16x16x32_bf16 v[16:19], v[60:63], a[180:183], v[16:19]
  s_add_u32 s66, s66, s70
  v_mfma_f32_16x16x32_bf16 v[20:23], v[84:87], a[180:183], v[20:23]
  v_mfma_f32_16x16x32_bf16 v[24:27], v[40:43], a[184:187], 0
  v_mfma_f32_16x16x32_bf16 v[28:31], v[64:67], a[184:187], 0
  v_mfma_f32_16x16x32_bf16 v[24:27], v[44:47], a[188:191], v[24:27]
  v_cvt_pk_bf16_f32 v32, v16, v17
  v_mfma_f32_16x16x32_bf16 v[28:31], v[68:71], a[188:191], v[28:31]
  v_cvt_pk_bf16_f32 v33, v18, v19
  v_mfma_f32_16x16x32_bf16 v[24:27], v[48:51], a[192:195], v[24:27]
  v_cvt_pk_bf16_f32 v34, v20, v21
  v_mfma_f32_16x16x32_bf16 v[28:31], v[72:75], a[192:195], v[28:31]
  v_cvt_pk_bf16_f32 v35, v22, v23
  v_mfma_f32_16x16x32_bf16 v[24:27], v[52:55], a[196:199], v[24:27]
  buffer_store_dwordx4 v[32:35], v1, s[32:35], s66 offen sc1
  v_mfma_f32_16x16x32_bf16 v[28:31], v[76:79], a[196:199], v[28:31]
  s_add_u32 s66, s69, 720896
  s_lshr_b32 s53, s66, 7
  v_mfma_f32_16x16x32_bf16 v[24:27], v[56:59], a[200:203], v[24:27]
  s_and_b32 s53, s53, 0x2000
  s_xor_b32 s53, s53, s50
  v_mfma_f32_16x16x32_bf16 v[28:31], v[80:83], a[200:203], v[28:31]
  s_lshl_b32 s66, s66, 1
  s_or_b32 s66, s66, s53
  v_mfma_f32_16x16x32_bf16 v[24:27], v[60:63], a[204:207], v[24:27]
  s_add_u32 s66, s66, s70
  v_mfma_f32_16x16x32_bf16 v[28:31], v[84:87], a[204:207], v[28:31]
  v_mfma_f32_16x16x32_bf16 v[16:19], v[40:43], a[208:211], 0
  v_mfma_f32_16x16x32_bf16 v[20:23], v[64:67], a[208:211], 0
  v_mfma_f32_16x16x32_bf16 v[16:19], v[44:47], a[212:215], v[16:19]
  v_cvt_pk_bf16_f32 v36, v24, v25
  v_mfma_f32_16x16x32_bf16 v[20:23], v[68:71], a[212:215], v[20:23]
  v_cvt_pk_bf16_f32 v37, v26, v27
  v_mfma_f32_16x16x32_bf16 v[16:19], v[48:51], a[216:219], v[16:19]
  v_cvt_pk_bf16_f32 v38, v28, v29
  v_mfma_f32_16x16x32_bf16 v[20:23], v[72:75], a[216:219], v[20:23]
  v_cvt_pk_bf16_f32 v39, v30, v31
  v_mfma_f32_16x16x32_bf16 v[16:19], v[52:55], a[220:223], v[16:19]
  buffer_store_dwordx4 v[36:39], v1, s[32:35], s66 offen sc1
  v_mfma_f32_16x16x32_bf16 v[20:23], v[76:79], a[220:223], v[20:23]
  s_add_u32 s66, s69, 753664
  s_lshr_b32 s53, s66, 7
  v_mfma_f32_16x16x32_bf16 v[16:19], v[56:59], a[224:227], v[16:19]
  s_and_b32 s53, s53, 0x2000
  s_xor_b32 s53, s53, s50
  v_mfma_f32_16x16x32_bf16 v[20:23], v[80:83], a[224:227], v[20:23]
  s_lshl_b32 s66, s66, 1
  s_or_b32 s66, s66, s53
  v_mfma_f32_16x16x32_bf16 v[16:19], v[60:63], a[228:231], v[16:19]
  s_add_u32 s66, s66, s70
  v_mfma_f32_16x16x32_bf16 v[20:23], v[84:87], a[228:231], v[20:23]
  v_mfma_f32_16x16x32_bf16 v[24:27], v[40:43], a[232:235], 0
  v_mfma_f32_16x16x32_bf16 v[28:31], v[64:67], a[232:235], 0
  v_mfma_f32_16x16x32_bf16 v[24:27], v[44:47], a[236:239], v[24:27]
  v_cvt_pk_bf16_f32 v32, v16, v17
  v_mfma_f32_16x16x32_bf16 v[28:31], v[68:71], a[236:239], v[28:31]
  v_cvt_pk_bf16_f32 v33, v18, v19
  v_mfma_f32_16x16x32_bf16 v[24:27], v[48:51], a[240:243], v[24:27]
  v_cvt_pk_bf16_f32 v34, v20, v21
  v_mfma_f32_16x16x32_bf16 v[28:31], v[72:75], a[240:243], v[28:31]
  v_cvt_pk_bf16_f32 v35, v22, v23
  v_mfma_f32_16x16x32_bf16 v[24:27], v[52:55], a[244:247], v[24:27]
  buffer_store_dwordx4 v[32:35], v1, s[32:35], s66 offen sc1
  v_mfma_f32_16x16x32_bf16 v[28:31], v[76:79], a[244:247], v[28:31]
  s_add_u32 s66, s69, 786432
  s_lshr_b32 s53, s66, 7
  v_mfma_f32_16x16x32_bf16 v[24:27], v[56:59], a[248:251], v[24:27]
  s_and_b32 s53, s53, 0x2000
  s_xor_b32 s53, s53, s50
  v_mfma_f32_16x16x32_bf16 v[28:31], v[80:83], a[248:251], v[28:31]
  s_lshl_b32 s66, s66, 1
  s_or_b32 s66, s66, s53
  v_mfma_f32_16x16x32_bf16 v[24:27], v[60:63], a[252:255], v[24:27]
  s_add_u32 s66, s66, s70
  v_mfma_f32_16x16x32_bf16 v[28:31], v[84:87], a[252:255], v[28:31]
  s_waitcnt lgkmcnt(0)
  s_add_u32 s52, s52, 1
  s_and_b32 s53, s52, 15
  s_cselect_b32 s53, 0, 0x1400000
  s_add_u32 s69, s69, 0x140000
  s_sub_u32 s69, s69, s53
  s_nop 7
  v_cvt_pk_bf16_f32 v36, v24, v25
  v_cvt_pk_bf16_f32 v37, v26, v27
  v_cvt_pk_bf16_f32 v38, v28, v29
  v_cvt_pk_bf16_f32 v39, v30, v31
  buffer_store_dwordx4 v[36:39], v1, s[32:35], s66 offen sc1
  v_mov_b32 v3, s52
  buffer_load_dword v10, v6, s[32:35], 0 offen sc1
  s_waitcnt vmcnt(0)
  s_barrier
  s_add_u32 s68, s71, 1
  v_cmp_gt_u32 vcc, s68, v10
  s_cbranch_vccz UP_76
  buffer_store_dword v3, v2, s[32:35], 0 offen sc1
  s_add_u32 s68, s71, 1
  s_min_u32 s68, s68, 64
  v_cmp_gt_u32 vcc, s68, v10
  s_cbranch_vccz UF_78
  s_cmp_ge_u32 s67, s68
  s_cbranch_scc1 WPD_80
  s_mov_b32 s57, 0
  s_mov_b32 exec_lo, 0x1
  s_mov_b32 exec_hi, 0
WPL_81:
  buffer_load_dword v136, v6, s[32:35], 0 offen sc1
  s_add_u32 s57, s57, 1
  s_cmp_gt_u32 s57, 0x80000
  s_cbranch_scc1 L_EXIT
  s_waitcnt vmcnt(0)
  v_cmp_gt_u32 vcc, s68, v136
  s_cbranch_vccnz WPL_81
  s_mov_b32 s67, s68
  s_add_u32 s53, s68, 2
  s_min_u32 s53, s53, 64
  v_cmp_gt_u32 vcc, s53, v136
  s_nop 0
  s_cmp_eq_u64 vcc, 0
  s_cselect_b32 s67, s53, s67
  s_add_u32 s53, s68, 6
  s_min_u32 s53, s53, 64
  v_cmp_gt_u32 vcc, s53, v136
  s_nop 0
  s_cmp_eq_u64 vcc, 0
  s_cselect_b32 s67, s53, s67
  s_add_u32 s53, s68, 16
  s_min_u32 s53, s53, 64
  v_cmp_gt_u32 vcc, s53, v136
  s_nop 0
  s_cmp_eq_u64 vcc, 0
  s_cselect_b32 s67, s53, s67
  s_mov_b64 exec, -1
WPD_80:
UF_78:
  s_max_u32 s68, s68, 13
  s_sub_u32 s68, s68, 13
  v_cmp_gt_u32 vcc, s68, v11
  s_cbranch_vccz UF_79
  s_cmp_ge_u32 s72, s68
  s_cbranch_scc1 WPD_82
  s_mov_b32 s57, 0
  s_mov_b32 exec_lo, 0xffffff
  s_mov_b32 exec_hi, 0
WPL_83:
  buffer_load_dword v136, v7, s[32:35], 0 offen sc1
  s_add_u32 s57, s57, 1
  s_cmp_gt_u32 s57, 0x80000
  s_cbranch_scc1 L_EXIT
  s_waitcnt vmcnt(0)
  v_cmp_gt_u32 vcc, s68, v136
  s_cbranch_vccz WPG_84
  s_sleep 8
  s_branch WPL_83
WPG_84:
  s_mov_b32 s72, s68
  s_add_u32 s53, s68, 2
  s_min_u32 s53, s53, 64
  v_cmp_gt_u32 vcc, s53, v136
  s_nop 0
  s_cmp_eq_u64 vcc, 0
  s_cselect_b32 s72, s53, s72
  s_add_u32 s53, s68, 6
  s_min_u32 s53, s53, 64
  v_cmp_gt_u32 vcc, s53, v136
  s_nop 0
  s_cmp_eq_u64 vcc, 0
  s_cselect_b32 s72, s53, s72
  s_add_u32 s53, s68, 16
  s_min_u32 s53, s53, 64
  v_cmp_gt_u32 vcc, s53, v136
  s_nop 0
  s_cmp_eq_u64 vcc, 0
  s_cselect_b32 s72, s53, s72
  s_mov_b64 exec, -1
WPD_82:
UF_79:
  s_min_u32 s55, s71, 63
  s_mul_i32 s54, s55, 0x80000
  s_add_u32 s54, s54, 0x2200000
  s_add_u32 s54, s54, s62
  s_lshr_b32 s53, s54, 7
  s_and_b32 s53, s53, 0x2000
  s_xor_b32 s53, s53, s51
  s_lshl_b32 s54, s54, 1
  s_or_b32 s54, s54, s53
  s_add_u32 s54, s54, s63
  s_mul_i32 s55, s49, 3072
  s_add_u32 m0, s55, 12288
  s_add_u32 s71, s71, 1
  buffer_load_dwordx4 v1, s[32:35], s54 offen offset:0 sc1 lds
  buffer_load_dwordx4 v1, s[32:35], s54 offen offset:1024 sc1 lds
  buffer_load_dwordx4 v1, s[32:35], s54 offen offset:2048 sc1 lds
  buffer_load_dword v10, v6, s[32:35], 0 offen sc1
  buffer_load_dword v11, v7, s[32:35], 0 offen sc1
  s_waitcnt vmcnt(0)
  s_branch UP_77
UP_76:
  s_add_u32 s68, s71, 1
  s_min_u32 s68, s68, 64
  v_cmp_gt_u32 vcc, s68, v10
  s_cbranch_vccz UF_85
  s_cmp_ge_u32 s67, s68
  s_cbranch_scc1 WPD_87
  s_mov_b32 s57, 0
  s_mov_b32 exec_lo, 0x1
  s_mov_b32 exec_hi, 0
WPL_88:
  buffer_load_dword v136, v6, s[32:35], 0 offen sc1
  s_add_u32 s57, s57, 1
  s_cmp_gt_u32 s57, 0x80000
  s_cbranch_scc1 L_EXIT
  s_waitcnt vmcnt(0)
  v_cmp_gt_u32 vcc, s68, v136
  s_cbranch_vccnz WPL_88
  s_mov_b32 s67, s68
  s_add_u32 s53, s68, 2
  s_min_u32 s53, s53, 64
  v_cmp_gt_u32 vcc, s53, v136
  s_nop 0
  s_cmp_eq_u64 vcc, 0
  s_cselect_b32 s67, s53, s67
  s_add_u32 s53, s68, 6
  s_min_u32 s53, s53, 64
  v_cmp_gt_u32 vcc, s53, v136
  s_nop 0
  s_cmp_eq_u64 vcc, 0
  s_cselect_b32 s67, s53, s67
  s_add_u32 s53, s68, 16
  s_min_u32 s53, s53, 64
  v_cmp_gt_u32 vcc, s53, v136
  s_nop 0
  s_cmp_eq_u64 vcc, 0
  s_cselect_b32 s67, s53, s67
  s_mov_b64 exec, -1
WPD_87:
UF_85:
  s_max_u32 s68, s68, 13
  s_sub_u32 s68, s68, 13
  v_cmp_gt_u32 vcc, s68, v11
  s_cbranch_vccz UF_86
  s_cmp_ge_u32 s72, s68
  s_cbranch_scc1 WPD_89
  s_mov_b32 s57, 0
  s_mov_b32 exec_lo, 0xffffff
  s_mov_b32 exec_hi, 0
WPL_90:
  buffer_load_dword v136, v7, s[32:35], 0 offen sc1
  s_add_u32 s57, s57, 1
  s_cmp_gt_u32 s57, 0x80000
  s_cbranch_scc1 L_EXIT
  s_waitcnt vmcnt(0)
  v_cmp_gt_u32 vcc, s68, v136
  s_cbranch_vccz WPG_91
  s_sleep 8
  s_branch WPL_90
WPG_91:
  s_mov_b32 s72, s68
  s_add_u32 s53, s68, 2
  s_min_u32 s53, s53, 64
  v_cmp_gt_u32 vcc, s53, v136
  s_nop 0
  s_cmp_eq_u64 vcc, 0
  s_cselect_b32 s72, s53, s72
  s_add_u32 s53, s68, 6
  s_min_u32 s53, s53, 64
  v_cmp_gt_u32 vcc, s53, v136
  s_nop 0
  s_cmp_eq_u64 vcc, 0
  s_cselect_b32 s72, s53, s72
  s_add_u32 s53, s68, 16
  s_min_u32 s53, s53, 64
  v_cmp_gt_u32 vcc, s53, v136
  s_nop 0
  s_cmp_eq_u64 vcc, 0
  s_cselect_b32 s72, s53, s72
  s_mov_b64 exec, -1
WPD_89:
UF_86:
  s_min_u32 s55, s71, 63
  s_mul_i32 s54, s55, 0x80000
  s_add_u32 s54, s54, 0x2200000
  s_add_u32 s54, s54, s62
  s_lshr_b32 s53, s54, 7
  s_and_b32 s53, s53, 0x2000
  s_xor_b32 s53, s53, s51
  s_lshl_b32 s54, s54, 1
  s_or_b32 s54, s54, s53
  s_add_u32 s54, s54, s63
  s_mul_i32 s55, s49, 3072
  s_add_u32 m0, s55, 12288
  s_add_u32 s71, s71, 1
  buffer_load_dwordx4 v1, s[32:35], s54 offen offset:0 sc1 lds
  buffer_load_dwordx4 v1, s[32:35], s54 offen offset:1024 sc1 lds
  buffer_load_dwordx4 v1, s[32:35], s54 offen offset:2048 sc1 lds
  buffer_load_dword v10, v6, s[32:35], 0 offen sc1
  buffer_load_dword v11, v7, s[32:35], 0 offen sc1
  buffer_store_dword v3, v2, s[32:35], 0 offen sc1
  s_waitcnt vmcnt(1)
UP_77:
  s_barrier
  ds_read_b128 v[88:91], v1 offset:12288
  ds_read_b128 v[92:95], v1 offset:15360
  ds_read_b128 v[96:99], v1 offset:18432
  ds_read_b128 v[100:103], v1 offset:21504
  ds_read_b64 v[104:105], v1 offset:14336
  ds_read_b64 v[106:107], v1 offset:17408
  ds_read_b64 v[108:109], v1 offset:20480
  ds_read_b64 v[110:111], v1 offset:23552
  ds_read_b128 v[112:115], v1 offset:13312
  ds_read_b128 v[116:119], v1 offset:16384
  ds_read_b128 v[120:123], v1 offset:19456
  ds_read_b128 v[124:127], v1 offset:22528
  s_waitcnt lgkmcnt(8)
  ds_read_b64 v[128:129], v1 offset:14344
  ds_read_b64 v[130:131], v1 offset:17416
  ds_read_b64 v[132:133], v1 offset:20488
  ds_read_b64 v[134:135], v1 offset:23560
  s_waitcnt lgkmcnt(0)
  s_branch UC_ODD
UC_SEG:
  v_mfma_f32_16x16x32_bf16 v[16:19], v[40:43], a[16:19], 0
  v_mfma_f32_16x16x32_bf16 v[20:23], v[64:67], a[16:19], 0
  v_mfma_f32_16x16x32_bf16 v[16:19], v[44:47], a[20:23], v[16:19]
  v_cvt_pk_bf16_f32 v36, v24, v25
  v_mfma_f32_16x16x32_bf16 v[20:23], v[68:71], a[20:23], v[20:23]
  v_cvt_pk_bf16_f32 v37, v26, v27
  v_mfma_f32_16x16x32_bf16 v[16:19], v[48:51], a[24:27], v[16:19]
  v_cvt_pk_bf16_f32 v38, v28, v29
  v_mfma_f32_16x16x32_bf16 v[20:23], v[72:75], a[24:27], v[20:23]
  v_cvt_pk_bf16_f32 v39, v30, v31
  v_mfma_f32_16x16x32_bf16 v[16:19], v[52:55], a[28:31], v[16:19]
  buffer_store_dwordx4 v[36:39], v1, s[32:35], s66 offen sc1
  v_mfma_f32_16x16x32_bf16 v[20:23], v[76:79], a[28:31], v[20:23]
  s_add_u32 s66, s69, 0
  s_lshr_b32 s53, s66, 7
  v_mfma_f32_16x16x32_bf16 v[16:19], v[56:59], a[32:35], v[16:19]
  s_and_b32 s53, s53, 0x2000
  s_xor_b32 s53, s53, s50
  v_mfma_f32_16x16x32_bf16 v[20:23], v[80:83], a[32:35], v[20:23]
  s_lshl_b32 s66, s66, 1
  s_or_b32 s66, s66, s53
  v_mfma_f32_16x16x32_bf16 v[16:19], v[60:63], a[36:39], v[16:19]
  s_add_u32 s66, s66, s70
  v_mfma_f32_16x16x32_bf16 v[20:23], v[84:87], a[36:39], v[20:23]
  s_waitcnt vmcnt(6)
  s_add_u32 s68, s71, 1
  s_min_u32 s68, s68, 64
  v_cmp_gt_u32 vcc, s68, v10
  s_cbranch_vccz UF_92
  s_cmp_ge_u32 s67, s68
  s_cbranch_scc1 WPD_94
  s_mov_b32 s57, 0
  s_mov_b32 exec_lo, 0x1
  s_mov_b32 exec_hi, 0
WPL_95:
  buffer_load_dword v136, v6, s[32:35], 0 offen sc1
  s_add_u32 s57, s57, 1
  s_cmp_gt_u32 s57, 0x80000
  s_cbranch_scc1 L_EXIT
  s_waitcnt vmcnt(0)
  v_cmp_gt_u32 vcc, s68, v136
  s_cbranch_vccnz WPL_95
  s_mov_b32 s67, s68
  s_add_u32 s53, s68, 2
  s_min_u32 s53, s53, 64
  v_cmp_gt_u32 vcc, s53, v136
  s_nop 0
  s_cmp_eq_u64 vcc, 0
  s_cselect_b32 s67, s53, s67
  s_add_u32 s53, s68, 6
  s_min_u32 s53, s53, 64
  v_cmp_gt_u32 vcc, s53, v136
  s_nop 0
  s_cmp_eq_u64 vcc, 0
  s_cselect_b32 s67, s53, s67
  s_add_u32 s53, s68, 16
  s_min_u32 s53, s53, 64
  v_cmp_gt_u32 vcc, s53, v136
  s_nop 0
  s_cmp_eq_u64 vcc, 0
  s_cselect_b32 s67, s53, s67
  s_mov_b64 exec, -1
WPD_94:
UF_92:
  s_max_u32 s68, s68, 13
  s_sub_u32 s68, s68, 13
  v_cmp_gt_u32 vcc, s68, v11
  s_cbranch_vccz UF_93
  s_cmp_ge_u32 s72, s68
  s_cbranch_scc1 WPD_96
  s_mov_b32 s57, 0
  s_mov_b32 exec_lo, 0xffffff
  s_mov_b32 exec_hi, 0
WPL_97:
  buffer_load_dword v136, v7, s[32:35], 0 offen sc1
  s_add_u32 s57, s57, 1
  s_cmp_gt_u32 s57, 0x80000
  s_cbranch_scc1 L_EXIT
  s_waitcnt vmcnt(0)
  v_cmp_gt_u32 vcc, s68, v136
  s_cbranch_vccz WPG_98
  s_sleep 8
  s_branch WPL_97
WPG_98:
  s_mov_b32 s72, s68
  s_add_u32 s53, s68, 2
  s_min_u32 s53, s53, 64
  v_cmp_gt_u32 vcc, s53, v136
  s_nop 0
  s_cmp_eq_u64 vcc, 0
  s_cselect_b32 s72, s53, s72
  s_add_u32 s53, s68, 6
  s_min_u32 s53, s53, 64
  v_cmp_gt_u32 vcc, s53, v136
  s_nop 0
  s_cmp_eq_u64 vcc, 0
  s_cselect_b32 s72, s53, s72
  s_add_u32 s53, s68, 16
  s_min_u32 s53, s53, 64
  v_cmp_gt_u32 vcc, s53, v136
  s_nop 0
  s_cmp_eq_u64 vcc, 0
  s_cselect_b32 s72, s53, s72
  s_mov_b64 exec, -1
WPD_96:
UF_93:
  s_min_u32 s55, s71, 63
  s_mul_i32 s54, s55, 0x80000
  s_add_u32 s54, s54, 0x2200000
  s_add_u32 s54, s54, s62
  s_lshr_b32 s53, s54, 7
  s_and_b32 s53, s53, 0x2000
  s_xor_b32 s53, s53, s51
  s_lshl_b32 s54, s54, 1
  s_or_b32 s54, s54, s53
  s_add_u32 s54, s54, s63
  s_mul_i32 s55, s49, 3072
  s_add_u32 m0, s55, 12288
  s_add_u32 s71, s71, 1
  buffer_load_dwordx4 v1, s[32:35], s54 offen offset:0 sc1 lds
  buffer_load_dwordx4 v1, s[32:35], s54 offen offset:1024 sc1 lds
  buffer_load_dwordx4 v1, s[32:35], s54 offen offset:2048 sc1 lds
  v_mfma_f32_16x16x32_bf16 v[24:27], v[40:43], a[40:43], 0
  v_mov_b32 v3, s52
  v_mfma_f32_16x16x32_bf16 v[28:31], v[64:67], a[40:43], 0
  v_mfma_f32_16x16x32_bf16 v[24:27], v[44:47], a[44:47], v[24:27]
  v_cvt_pk_bf16_f32 v32, v16, v17
  v_mfma_f32_16x16x32_bf16 v[28:31], v[68:71], a[44:47], v[28:31]
  v_cvt_pk_bf16_f32 v33, v18, v19
  v_mfma_f32_16x16x32_bf16 v[24:27], v[48:51], a[48:51], v[24:27]
  v_cvt_pk_bf16_f32 v34, v20, v21
  v_mfma_f32_16x16x32_bf16 v[28:31], v[72:75], a[48:51], v[28:31]
  v_cvt_pk_bf16_f32 v35, v22, v23
  v_mfma_f32_16x16x32_bf16 v[24:27], v[52:55], a[52:55], v[24:27]
  buffer_store_dwordx4 v[32:35], v1, s[32:35], s66 offen sc1
  v_mfma_f32_16x16x32_bf16 v[28:31], v[76:79], a[52:55], v[28:31]
  s_add_u32 s66, s69, 32768
  s_lshr_b32 s53, s66, 7
  v_mfma_f32_16x16x32_bf16 v[24:27], v[56:59], a[56:59], v[24:27]
  s_and_b32 s53, s53, 0x2000
  s_xor_b32 s53, s53, s50
  v_mfma_f32_16x16x32_bf16 v[28:31], v[80:83], a[56:59], v[28:31]
  s_lshl_b32 s66, s66, 1
  s_or_b32 s66, s66, s53
  v_mfma_f32_16x16x32_bf16 v[24:27], v[60:63], a[60:63], v[24:27]
  s_add_u32 s66, s66, s70
  v_mfma_f32_16x16x32_bf16 v[28:31], v[84:87], a[60:63], v[28:31]
  v_mfma_f32_16x16x32_bf16 v[16:19], v[40:43], a[64:67], 0
  v_mfma_f32_16x16x32_bf16 v[20:23], v[64:67], a[64:67], 0
  v_mfma_f32_16x16x32_bf16 v[16:19], v[44:47], a[68:71], v[16:19]
  v_cvt_pk_bf16_f32 v36, v24, v25
  v_mfma_f32_16x16x32_bf16 v[20:23], v[68:71], a[68:71], v[20:23]
  v_cvt_pk_bf16_f32 v37, v26, v27
  v_mfma_f32_16x16x32_bf16 v[16:19], v[48:51], a[72:75], v[16:19]
  v_cvt_pk_bf16_f32 v38, v28, v29
  v_mfma_f32_16x16x32_bf16 v[20:23], v[72:75], a[72:75], v[20:23]
  v_cvt_pk_bf16_f32 v39, v30, v31
  v_mfma_f32_16x16x32_bf16 v[16:19], v[52:55], a[76:79], v[16:19]
  buffer_store_dwordx4 v[36:39], v1, s[32:35], s66 offen sc1
  v_mfma_f32_16x16x32_bf16 v[20:23], v[76:79], a[76:79], v[20:23]
  s_add_u32 s66, s69, 65536
  s_lshr_b32 s53, s66, 7
  v_mfma_f32_16x16x32_bf16 v[16:19], v[56:59], a[80:83], v[16:19]
  s_and_b32 s53, s53, 0x2000
  s_xor_b32 s53, s53, s50
  v_mfma_f32_16x16x32_bf16 v[20:23], v[80:83], a[80:83], v[20:23]
  s_lshl_b32 s66, s66, 1
  s_or_b32 s66, s66, s53
  v_mfma_f32_16x16x32_bf16 v[16:19], v[60:63], a[84:87], v[16:19]
  s_add_u32 s66, s66, s70
  v_mfma_f32_16x16x32_bf16 v[20:23], v[84:87], a[84:87], v[20:23]
  v_mfma_f32_16x16x32_bf16 v[24:27], v[40:43], a[88:91], 0
  v_mfma_f32_16x16x32_bf16 v[28:31], v[64:67], a[88:91], 0
  v_mfma_f32_16x16x32_bf16 v[24:27], v[44:47], a[92:95], v[24:27]
  v_cvt_pk_bf16_f32 v32, v16, v17
  v_mfma_f32_16x16x32_bf16 v[28:31], v[68:71], a[92:95], v[28:31]
  v_cvt_pk_bf16_f32 v33, v18, v19
  v_mfma_f32_16x16x32_bf16 v[24:27], v[48:51], a[96:99], v[24:27]
  v_cvt_pk_bf16_f32 v34, v20, v21
  v_mfma_f32_16x16x32_bf16 v[28:31], v[72:75], a[96:99], v[28:31]
  v_cvt_pk_bf16_f32 v35, v22, v23
  v_mfma_f32_16x16x32_bf16 v[24:27], v[52:55], a[100:103], v[24:27]
  buffer_store_dwordx4 v[32:35], v1, s[32:35], s66 offen sc1
  v_mfma_f32_16x16x32_bf16 v[28:31], v[76:79], a[100:103], v[28:31]
  s_add_u32 s66, s69, 98304
  s_lshr_b32 s53, s66, 7
  v_mfma_f32_16x16x32_bf16 v[24:27], v[56:59], a[104:107], v[24:27]
  s_and_b32 s53, s53, 0x2000
  s_xor_b32 s53, s53, s50
  v_mfma_f32_16x16x32_bf16 v[28:31], v[80:83], a[104:107], v[28:31]
  s_lshl_b32 s66, s66, 1
  s_or_b32 s66, s66, s53
  v_mfma_f32_16x16x32_bf16 v[24:27], v[60:63], a[108:111], v[24:27]
  s_add_u32 s66, s66, s70
  v_mfma_f32_16x16x32_bf16 v[28:31], v[84:87], a[108:111], v[28:31]
  v_mfma_f32_16x16x32_bf16 v[16:19], v[40:43], a[112:115], 0
  v_mfma_f32_16x16x32_bf16 v[20:23], v[64:67], a[112:115], 0
  v_mfma_f32_16x16x32_bf16 v[16:19], v[44:47], a[116:119], v[16:19]
  v_cvt_pk_bf16_f32 v36, v24, v25
  v_mfma_f32_16x16x32_bf16 v[20:23], v[68:71], a[116:119], v[20:23]
  v_cvt_pk_bf16_f32 v37, v26, v27
  v_mfma_f32_16x16x32_bf16 v[16:19], v[48:51], a[120:123], v[16:19]
  v_cvt_pk_bf16_f32 v38, v28, v29
  v_mfma_f32_16x16x32_bf16 v[20:23], v[72:75], a[120:123], v[20:23]
  v_cvt_pk_bf16_f32 v39, v30, v31
  v_mfma_f32_16x16x32_bf16 v[16:19], v[52:55], a[124:127], v[16:19]
  buffer_store_dwordx4 v[36:39], v1, s[32:35], s66 offen sc1
  v_mfma_f32_16x16x32_bf16 v[20:23], v[76:79], a[124:127], v[20:23]
  s_add_u32 s66, s69, 131072
  s_lshr_b32 s53, s66, 7
  v_mfma_f32_16x16x32_bf16 v[16:19], v[56:59], a[128:131], v[16:19]
  s_and_b32 s53, s53, 0x2000
  s_xor_b32 s53, s53, s50
  v_mfma_f32_16x16x32_bf16 v[20:23], v[80:83], a[128:131], v[20:23]
  s_lshl_b32 s66, s66, 1
  s_or_b32 s66, s66, s53
  v_mfma_f32_16x16x32_bf16 v[16:19], v[60:63], a[132:135], v[16:19]
  s_add_u32 s66, s66, s70
  v_mfma_f32_16x16x32_bf16 v[20:23], v[84:87], a[132:135], v[20:23]
  v_mfma_f32_16x16x32_bf16 v[24:27], v[40:43], a[136:139], 0
  v_mfma_f32_16x16x32_bf16 v[28:31], v[64:67], a[136:139], 0
  v_mfma_f32_16x16x32_bf16 v[24:27], v[44:47], a[140:143], v[24:27]
  v_cvt_pk_bf16_f32 v32, v16, v17
  v_mfma_f32_16x16x32_bf16 v[28:31], v[68:71], a[140:143], v[28:31]
  v_cvt_pk_bf16_f32 v33, v18, v19
  v_mfma_f32_16x16x32_bf16 v[24:27], v[48:51], a[144:147], v[24:27]
  v_cvt_pk_bf16_f32 v34, v20, v21
  v_mfma_f32_16x16x32_bf16 v[28:31], v[72:75], a[144:147], v[28:31]
  v_cvt_pk_bf16_f32 v35, v22, v23
  v_mfma_f32_16x16x32_bf16 v[24:27], v[52:55], a[148:151], v[24:27]
  buffer_store_dwordx4 v[32:35], v1, s[32:35], s66 offen sc1
  v_mfma_f32_16x16x32_bf16 v[28:31], v[76:79], a[148:151], v[28:31]
  s_add_u32 s66, s69, 655360
  s_lshr_b32 s53, s66, 7
  v_mfma_f32_16x16x32_bf16 v[24:27], v[56:59], a[152:155], v[24:27]
  s_and_b32 s53, s53, 0x2000
  s_xor_b32 s53, s53, s50
  v_mfma_f32_16x16x32_bf16 v[28:31], v[80:83], a[152:155], v[28:31]
  s_lshl_b32 s66, s66, 1
  s_or_b32 s66, s66, s53
  v_mfma_f32_16x16x32_bf16 v[24:27], v[60:63], a[156:159], v[24:27]
  s_add_u32 s66, s66, s70
  v_mfma_f32_16x16x32_bf16 v[28:31], v[84:87], a[156:159], v[28:31]
  v_mfma_f32_16x16x32_bf16 v[16:19], v[40:43], a[160:163], 0
  s_waitcnt vmcnt(5)
  s_barrier
  buffer_load_dword v10, v6, s[32:35], 0 offen sc1
  buffer_load_dword v11, v7, s[32:35], 0 offen sc1
  buffer_store_dword v3, v2, s[32:35], 0 offen sc1
  v_mfma_f32_16x16x32_bf16 v[20:23], v[64:67], a[160:163], 0
  ds_read_b128 v[88:91], v1 offset:12288
  v_mfma_f32_16x16x32_bf16 v[16:19], v[44:47], a[164:167], v[16:19]
  ds_read_b128 v[92:95], v1 offset:15360
  v_cvt_pk_bf16_f32 v36, v24, v25
  v_mfma_f32_16x16x32_bf16 v[20:23], v[68:71], a[164:167], v[20:23]
  ds_read_b128 v[96:99], v1 offset:18432
  v_cvt_pk_bf16_f32 v37, v26, v27
  v_mfma_f32_16x16x32_bf16 v[16:19], v[48:51], a[168:171], v[16:19]
  ds_read_b128 v[100:103], v1 offset:21504
  v_cvt_pk_bf16_f32 v38, v28, v29
  v_mfma_f32_16x16x32_bf16 v[20:23], v[72:75], a[168:171], v[20:23]
  ds_read_b64 v[104:105], v1 offset:14336
  v_cvt_pk_bf16_f32 v39, v30, v31
  v_mfma_f32_16x16x32_bf16 v[16:19], v[52:55], a[172:175], v[16:19]
  buffer_store_dwordx4 v[36:39], v1, s[32:35], s66 offen sc1
  v_mfma_f32_16x16x32_bf16 v[20:23], v[76:79], a[172:175], v[20:23]
  s_add_u32 s66, s69, 688128
  s_lshr_b32 s53, s66, 7
  v_mfma_f32_16x16x32_bf16 v[16:19], v[56:59], a[176:179], v[16:19]
  s_and_b32 s53, s53, 0x2000
  s_xor_b32 s53, s53, s50
  v_mfma_f32_16x16x32_bf16 v[20:23], v[80:83], a[176:179], v[20:23]
  s_lshl_b32 s66, s66, 1
  s_or_b32 s66, s66, s53
  v_mfma_f32_16x16x32_bf16 v[16:19], v[60:63], a[180:183], v[16:19]
  s_add_u32 s66, s66, s70
  v_mfma_f32_16x16x32_bf16 v[20:23], v[84:87], a[180:183], v[20:23]
  v_mfma_f32_16x16x32_bf16 v[24:27], v[40:43], a[184:187], 0
  v_mfma_f32_16x16x32_bf16 v[28:31], v[64:67], a[184:187], 0
  ds_read_b64 v[106:107], v1 offset:17408
  v_mfma_f32_16x16x32_bf16 v[24:27], v[44:47], a[188:191], v[24:27]
  ds_read_b64 v[108:109], v1 offset:20480
  v_cvt_pk_bf16_f32 v32, v16, v17
  v_mfma_f32_16x16x32_bf16 v[28:31], v[68:71], a[188:191], v[28:31]
  ds_read_b64 v[110:111], v1 offset:23552
  v_cvt_pk_bf16_f32 v33, v18, v19
  v_mfma_f32_16x16x32_bf16 v[24:27], v[48:51], a[192:195], v[24:27]
  ds_read_b128 v[112:115], v1 offset:13312
  v_cvt_pk_bf16_f32 v34, v20, v21
  v_mfma_f32_16x16x32_bf16 v[28:31], v[72:75], a[192:195], v[28:31]
  ds_read_b128 v[116:119], v1 offset:16384
  v_cvt_pk_bf16_f32 v35, v22, v23
  v_mfma_f32_16x16x32_bf16 v[24:27], v[52:55], a[196:199], v[24:27]
  buffer_store_dwordx4 v[32:35], v1, s[32:35], s66 offen sc1
  v_mfma_f32_16x16x32_bf16 v[28:31], v[76:79], a[196:199], v[28:31]
  s_add_u32 s66, s69, 720896
  s_lshr_b32 s53, s66, 7
  v_mfma_f32_16x16x32_bf16 v[24:27], v[56:59], a[200:203], v[24:27]
  s_and_b32 s53, s53, 0x2000
  s_xor_b32 s53, s53, s50
  v_mfma_f32_16x16x32_bf16 v[28:31], v[80:83], a[200:203], v[28:31]
  s_lshl_b32 s66, s66, 1
  s_or_b32 s66, s66, s53
  v_mfma_f32_16x16x32_bf16 v[24:27], v[60:63], a[204:207], v[24:27]
  s_add_u32 s66, s66, s70
  v_mfma_f32_16x16x32_bf16 v[28:31], v[84:87], a[204:207], v[28:31]
  v_mfma_f32_16x16x32_bf16 v[16:19], v[40:43], a[208:211], 0
  v_mfma_f32_16x16x32_bf16 v[20:23], v[64:67], a[208:211], 0
  ds_read_b128 v[120:123], v1 offset:19456
  v_mfma_f32_16x16x32_bf16 v[16:19], v[44:47], a[212:215], v[16:19]
  ds_read_b128 v[124:127], v1 offset:22528
  v_cvt_pk_bf16_f32 v36, v24, v25
  v_mfma_f32_16x16x32_bf16 v[20:23], v[68:71], a[212:215], v[20:23]
  ds_read_b64 v[128:129], v1 offset:14344
  v_cvt_pk_bf16_f32 v37, v26, v27
  v_mfma_f32_16x16x32_bf16 v[16:19], v[48:51], a[216:219], v[16:19]
  ds_read_b64 v[130:131], v1 offset:17416
  v_cvt_pk_bf16_f32 v38, v28, v29
  v_mfma_f32_16x16x32_bf16 v[20:23], v[72:75], a[216:219], v[20:23]
  ds_read_b64 v[132:133], v1 offset:20488
  v_cvt_pk_bf16_f32 v39, v30, v31
  v_mfma_f32_16x16x32_bf16 v[16:19], v[52:55], a[220:223], v[16:19]
  buffer_store_dwordx4 v[36:39], v1, s[32:35], s66 offen sc1
  v_mfma_f32_16x16x32_bf16 v[20:23], v[76:79], a[220:223], v[20:23]
  s_add_u32 s66, s69, 753664
  s_lshr_b32 s53, s66, 7
  v_mfma_f32_16x16x32_bf16 v[16:19], v[56:59], a[224:227], v[16:19]
  s_and_b32 s53, s53, 0x2000
  s_xor_b32 s53, s53, s50
  v_mfma_f32_16x16x32_bf16 v[20:23], v[80:83], a[224:227], v[20:23]
  s_lshl_b32 s66, s66, 1
  s_or_b32 s66, s66, s53
  v_mfma_f32_16x16x32_bf16 v[16:19], v[60:63], a[228:231], v[16:19]
  s_add_u32 s66, s66, s70
  v_mfma_f32_16x16x32_bf16 v[20:23], v[84:87], a[228:231], v[20:23]
  v_mfma_f32_16x16x32_bf16 v[24:27], v[40:43], a[232:235], 0
  v_mfma_f32_16x16x32_bf16 v[28:31], v[64:67], a[232:235], 0
  ds_read_b64 v[134:135], v1 offset:23560
  v_mfma_f32_16x16x32_bf16 v[24:27], v[44:47], a[236:239], v[24:27]
  v_cvt_pk_bf16_f32 v32, v16, v17
  v_mfma_f32_16x16x32_bf16 v[28:31], v[68:71], a[236:239], v[28:31]
  v_cvt_pk_bf16_f32 v33, v18, v19
  v_mfma_f32_16x16x32_bf16 v[24:27], v[48:51], a[240:243], v[24:27]
  v_cvt_pk_bf16_f32 v34, v20, v21
  v_mfma_f32_16x16x32_bf16 v[28:31], v[72:75], a[240:243], v[28:31]
  v_cvt_pk_bf16_f32 v35, v22, v23
  v_mfma_f32_16x16x32_bf16 v[24:27], v[52:55], a[244:247], v[24:27]
  buffer_store_dwordx4 v[32:35], v1, s[32:35], s66 offen sc1
  v_mfma_f32_16x16x32_bf16 v[28:31], v[76:79], a[244:247], v[28:31]
  s_add_u32 s66, s69, 786432
  s_lshr_b32 s53, s66, 7
  v_mfma_f32_16x16x32_bf16 v[24:27], v[56:59], a[248:251], v[24:27]
  s_and_b32 s53, s53, 0x2000
  s_xor_b32 s53, s53, s50
  v_mfma_f32_16x16x32_bf16 v[28:31], v[80:83], a[248:251], v[28:31]
  s_lshl_b32 s66, s66, 1
  s_or_b32 s66, s66, s53
  v_mfma_f32_16x16x32_bf16 v[24:27], v[60:63], a[252:255], v[24:27]
  s_add_u32 s66, s66, s70
  v_mfma_f32_16x16x32_bf16 v[28:31], v[84:87], a[252:255], v[28:31]
  s_waitcnt lgkmcnt(0)
  s_add_u32 s52, s52, 1
  s_and_b32 s53, s52, 15
  s_cselect_b32 s53, 0, 0x1400000
  s_add_u32 s69, s69, 0x140000
  s_sub_u32 s69, s69, s53
UC_ODD:
  v_mfma_f32_16x16x32_bf16 v[16:19], v[88:91], a[16:19], 0
  v_mfma_f32_16x16x32_bf16 v[20:23], v[112:115], a[16:19], 0
  v_mfma_f32_16x16x32_bf16 v[16:19], v[92:95], a[20:23], v[16:19]
  v_cvt_pk_bf16_f32 v36, v24, v25
  v_mfma_f32_16x16x32_bf16 v[20:23], v[116:119], a[20:23], v[20:23]
  v_cvt_pk_bf16_f32 v37, v26, v27
  v_mfma_f32_16x16x32_bf16 v[16:19], v[96:99], a[24:27], v[16:19]
  v_cvt_pk_bf16_f32 v38, v28, v29
  v_mfma_f32_16x16x32_bf16 v[20:23], v[120:123], a[24:27], v[20:23]
  v_cvt_pk_bf16_f32 v39, v30, v31
  v_mfma_f32_16x16x32_bf16 v[16:19], v[100:103], a[28:31], v[16:19]
  buffer_store_dwordx4 v[36:39], v1, s[32:35], s66 offen sc1
  v_mfma_f32_16x16x32_bf16 v[20:23], v[124:127], a[28:31], v[20:23]
  s_add_u32 s66, s69, 0
  s_lshr_b32 s53, s66, 7
  v_mfma_f32_16x16x32_bf16 v[16:19], v[104:107], a[32:35], v[16:19]
  s_and_b32 s53, s53, 0x2000
  s_xor_b32 s53, s53, s50
  v_mfma_f32_16x16x32_bf16 v[20:23], v[128:131], a[32:35], v[20:23]
  s_lshl_b32 s66, s66, 1
  s_or_b32 s66, s66, s53
  v_mfma_f32_16x16x32_bf16 v[16:19], v[108:111], a[36:39], v[16:19]
  s_add_u32 s66, s66, s70
  v_mfma_f32_16x16x32_bf16 v[20:23], v[132:135], a[36:39], v[20:23]
  s_waitcnt vmcnt(6)
  s_add_u32 s68, s71, 1
  s_min_u32 s68, s68, 64
  v_cmp_gt_u32 vcc, s68, v10
  s_cbranch_vccz UF_99
  s_cmp_ge_u32 s67, s68
  s_cbranch_scc1 WPD_101
  s_mov_b32 s57, 0
  s_mov_b32 exec_lo, 0x1
  s_mov_b32 exec_hi, 0
WPL_102:
  buffer_load_dword v136, v6, s[32:35], 0 offen sc1
  s_add_u32 s57, s57, 1
  s_cmp_gt_u32 s57, 0x80000
  s_cbranch_scc1 L_EXIT
  s_waitcnt vmcnt(0)
  v_cmp_gt_u32 vcc, s68, v136
  s_cbranch_vccnz WPL_102
  s_mov_b32 s67, s68
  s_add_u32 s53, s68, 2
  s_min_u32 s53, s53, 64
  v_cmp_gt_u32 vcc, s53, v136
  s_nop 0
  s_cmp_eq_u64 vcc, 0
  s_cselect_b32 s67, s53, s67
  s_add_u32 s53, s68, 6
  s_min_u32 s53, s53, 64
  v_cmp_gt_u32 vcc, s53, v136
  s_nop 0
  s_cmp_eq_u64 vcc, 0
  s_cselect_b32 s67, s53, s67
  s_add_u32 s53, s68, 16
  s_min_u32 s53, s53, 64
  v_cmp_gt_u32 vcc, s53, v136
  s_nop 0
  s_cmp_eq_u64 vcc, 0
  s_cselect_b32 s67, s53, s67
  s_mov_b64 exec, -1
WPD_101:
UF_99:
  s_max_u32 s68, s68, 13
  s_sub_u32 s68, s68, 13
  v_cmp_gt_u32 vcc, s68, v11
  s_cbranch_vccz UF_100
  s_cmp_ge_u32 s72, s68
  s_cbranch_scc1 WPD_103
  s_mov_b32 s57, 0
  s_mov_b32 exec_lo, 0xffffff
  s_mov_b32 exec_hi, 0
WPL_104:
  buffer_load_dword v136, v7, s[32:35], 0 offen sc1
  s_add_u32 s57, s57, 1
  s_cmp_gt_u32 s57, 0x80000
  s_cbranch_scc1 L_EXIT
  s_waitcnt vmcnt(0)
  v_cmp_gt_u32 vcc, s68, v136
  s_cbranch_vccz WPG_105
  s_sleep 8
  s_branch WPL_104
WPG_105:
  s_mov_b32 s72, s68
  s_add_u32 s53, s68, 2
  s_min_u32 s53, s53, 64
  v_cmp_gt_u32 vcc, s53, v136
  s_nop 0
  s_cmp_eq_u64 vcc, 0
  s_cselect_b32 s72, s53, s72
  s_add_u32 s53, s68, 6
  s_min_u32 s53, s53, 64
  v_cmp_gt_u32 vcc, s53, v136
  s_nop 0
  s_cmp_eq_u64 vcc, 0
  s_cselect_b32 s72, s53, s72
  s_add_u32 s53, s68, 16
  s_min_u32 s53, s53, 64
  v_cmp_gt_u32 vcc, s53, v136
  s_nop 0
  s_cmp_eq_u64 vcc, 0
  s_cselect_b32 s72, s53, s72
  s_mov_b64 exec, -1
WPD_103:
UF_100:
  s_min_u32 s55, s71, 63
  s_mul_i32 s54, s55, 0x80000
  s_add_u32 s54, s54, 0x2200000
  s_add_u32 s54, s54, s62
  s_lshr_b32 s53, s54, 7
  s_and_b32 s53, s53, 0x2000
  s_xor_b32 s53, s53, s51
  s_lshl_b32 s54, s54, 1
  s_or_b32 s54, s54, s53
  s_add_u32 s54, s54, s63
  s_mul_i32 s55, s49, 3072
  s_add_u32 m0, s55, 0
  s_add_u32 s71, s71, 1
  buffer_load_dwordx4 v1, s[32:35], s54 offen offset:0 sc1 lds
  buffer_load_dwordx4 v1, s[32:35], s54 offen offset:1024 sc1 lds
  buffer_load_dwordx4 v1, s[32:35], s54 offen offset:2048 sc1 lds
  v_mfma_f32_16x16x32_bf16 v[24:27], v[88:91], a[40:43], 0
  v_mov_b32 v3, s52
  v_mfma_f32_16x16x32_bf16 v[28:31], v[112:115], a[40:43], 0
  v_mfma_f32_16x16x32_bf16 v[24:27], v[92:95], a[44:47], v[24:27]
  v_cvt_pk_bf16_f32 v32, v16, v17
  v_mfma_f32_16x16x32_bf16 v[28:31], v[116:119], a[44:47], v[28:31]
  v_cvt_pk_bf16_f32 v33, v18, v19
  v_mfma_f32_16x16x32_bf16 v[24:27], v[96:99], a[48:51], v[24:27]
  v_cvt_pk_bf16_f32 v34, v20, v21
  v_mfma_f32_16x16x32_bf16 v[28:31], v[120:123], a[48:51], v[28:31]
  v_cvt_pk_bf16_f32 v35, v22, v23
  v_mfma_f32_16x16x32_bf16 v[24:27], v[100:103], a[52:55], v[24:27]
  buffer_store_dwordx4 v[32:35], v1, s[32:35], s66 offen sc1
  v_mfma_f32_16x16x32_bf16 v[28:31], v[124:127], a[52:55], v[28:31]
  s_add_u32 s66, s69, 32768
  s_lshr_b32 s53, s66, 7
  v_mfma_f32_16x16x32_bf16 v[24:27], v[104:107], a[56:59], v[24:27]
  s_and_b32 s53, s53, 0x2000
  s_xor_b32 s53, s53, s50
  v_mfma_f32_16x16x32_bf16 v[28:31], v[128:131], a[56:59], v[28:31]
  s_lshl_b32 s66, s66, 1
  s_or_b32 s66, s66, s53
  v_mfma_f32_16x16x32_bf16 v[24:27], v[108:111], a[60:63], v[24:27]
  s_add_u32 s66, s66, s70
  v_mfma_f32_16x16x32_bf16 v[28:31], v[132:135], a[60:63], v[28:31]
  v_mfma_f32_16x16x32_bf16 v[16:19], v[88:91], a[64:67], 0
  v_mfma_f32_16x16x32_bf16 v[20:23], v[112:115], a[64:67], 0
  v_mfma_f32_16x16x32_bf16 v[16:19], v[92:95], a[68:71], v[16:19]
  v_cvt_pk_bf16_f32 v36, v24, v25
  v_mfma_f32_16x16x32_bf16 v[20:23], v[116:119], a[68:71], v[20:23]
  v_cvt_pk_bf16_f32 v37, v26, v27
  v_mfma_f32_16x16x32_bf16 v[16:19], v[96:99], a[72:75], v[16:19]
  v_cvt_pk_bf16_f32 v38, v28, v29
  v_mfma_f32_16x16x32_bf16 v[20:23], v[120:123], a[72:75], v[20:23]
  v_cvt_pk_bf16_f32 v39, v30, v31
  v_mfma_f32_16x16x32_bf16 v[16:19], v[100:103], a[76:79], v[16:19]
  buffer_store_dwordx4 v[36:39], v1, s[32:35], s66 offen sc1
  v_mfma_f32_16x16x32_bf16 v[20:23], v[124:127], a[76:79], v[20:23]
  s_add_u32 s66, s69, 65536
  s_lshr_b32 s53, s66, 7
  v_mfma_f32_16x16x32_bf16 v[16:19], v[104:107], a[80:83], v[16:19]
  s_and_b32 s53, s53, 0x2000
  s_xor_b32 s53, s53, s50
  v_mfma_f32_16x16x32_bf16 v[20:23], v[128:131], a[80:83], v[20:23]
  s_lshl_b32 s66, s66, 1
  s_or_b32 s66, s66, s53
  v_mfma_f32_16x16x32_bf16 v[16:19], v[108:111], a[84:87], v[16:19]
  s_add_u32 s66, s66, s70
  v_mfma_f32_16x16x32_bf16 v[20:23], v[132:135], a[84:87], v[20:23]
  v_mfma_f32_16x16x32_bf16 v[24:27], v[88:91], a[88:91], 0
  v_mfma_f32_16x16x32_bf16 v[28:31], v[112:115], a[88:91], 0
  v_mfma_f32_16x16x32_bf16 v[24:27], v[92:95], a[92:95], v[24:27]
  v_cvt_pk_bf16_f32 v32, v16, v17
  v_mfma_f32_16x16x32_bf16 v[28:31], v[116:119], a[92:95], v[28:31]
  v_cvt_pk_bf16_f32 v33, v18, v19
  v_mfma_f32_16x16x32_bf16 v[24:27], v[96:99], a[96:99], v[24:27]
  v_cvt_pk_bf16_f32 v34, v20, v21
  v_mfma_f32_16x16x32_bf16 v[28:31], v[120:123], a[96:99], v[28:31]
  v_cvt_pk_bf16_f32 v35, v22, v23
  v_mfma_f32_16x16x32_bf16 v[24:27], v[100:103], a[100:103], v[24:27]
  buffer_store_dwordx4 v[32:35], v1, s[32:35], s66 offen sc1
  v_mfma_f32_16x16x32_bf16 v[28:31], v[124:127], a[100:103], v[28:31]
  s_add_u32 s66, s69, 98304
  s_lshr_b32 s53, s66, 7
  v_mfma_f32_16x16x32_bf16 v[24:27], v[104:107], a[104:107], v[24:27]
  s_and_b32 s53, s53, 0x2000
  s_xor_b32 s53, s53, s50
  v_mfma_f32_16x16x32_bf16 v[28:31], v[128:131], a[104:107], v[28:31]
  s_lshl_b32 s66, s66, 1
  s_or_b32 s66, s66, s53
  v_mfma_f32_16x16x32_bf16 v[24:27], v[108:111], a[108:111], v[24:27]
  s_add_u32 s66, s66, s70
  v_mfma_f32_16x16x32_bf16 v[28:31], v[132:135], a[108:111], v[28:31]
  v_mfma_f32_16x16x32_bf16 v[16:19], v[88:91], a[112:115], 0
  v_mfma_f32_16x16x32_bf16 v[20:23], v[112:115], a[112:115], 0
  v_mfma_f32_16x16x32_bf16 v[16:19], v[92:95], a[116:119], v[16:19]
  v_cvt_pk_bf16_f32 v36, v24, v25
  v_mfma_f32_16x16x32_bf16 v[20:23], v[116:119], a[116:119], v[20:23]
  v_cvt_pk_bf16_f32 v37, v26, v27
  v_mfma_f32_16x16x32_bf16 v[16:19], v[96:99], a[120:123], v[16:19]
  v_cvt_pk_bf16_f32 v38, v28, v29
  v_mfma_f32_16x16x32_bf16 v[20:23], v[120:123], a[120:123], v[20:23]
  v_cvt_pk_bf16_f32 v39, v30, v31
  v_mfma_f32_16x16x32_bf16 v[16:19], v[100:103], a[124:127], v[16:19]
  buffer_store_dwordx4 v[36:39], v1, s[32:35], s66 offen sc1
  v_mfma_f32_16x16x32_bf16 v[20:23], v[124:127], a[124:127], v[20:23]
  s_add_u32 s66, s69, 131072
  s_lshr_b32 s53, s66, 7
  v_mfma_f32_16x16x32_bf16 v[16:19], v[104:107], a[128:131], v[16:19]
  s_and_b32 s53, s53, 0x2000
  s_xor_b32 s53, s53, s50
  v_mfma_f32_16x16x32_bf16 v[20:23], v[128:131], a[128:131], v[20:23]
  s_lshl_b32 s66, s66, 1
  s_or_b32 s66, s66, s53
  v_mfma_f32_16x16x32_bf16 v[16:19], v[108:111], a[132:135], v[16:19]
  s_add_u32 s66, s66, s70
  v_mfma_f32_16x16x32_bf16 v[20:23], v[132:135], a[132:135], v[20:23]
  v_mfma_f32_16x16x32_bf16 v[24:27], v[88:91], a[136:139], 0
  v_mfma_f32_16x16x32_bf16 v[28:31], v[112:115], a[136:139], 0
  v_mfma_f32_16x16x32_bf16 v[24:27], v[92:95], a[140:143], v[24:27]
  v_cvt_pk_bf16_f32 v32, v16, v17
  v_mfma_f32_16x16x32_bf16 v[28:31], v[116:119], a[140:143], v[28:31]
  v_cvt_pk_bf16_f32 v33, v18, v19
  v_mfma_f32_16x16x32_bf16 v[24:27], v[96:99], a[144:147], v[24:27]
  v_cvt_pk_bf16_f32 v34, v20, v21
  v_mfma_f32_16x16x32_bf16 v[28:31], v[120:123], a[144:147], v[28:31]
  v_cvt_pk_bf16_f32 v35, v22, v23
  v_mfma_f32_16x16x32_bf16 v[24:27], v[100:103], a[148:151], v[24:27]
  buffer_store_dwordx4 v[32:35], v1, s[32:35], s66 offen sc1
  v_mfma_f32_16x16x32_bf16 v[28:31], v[124:127], a[148:151], v[28:31]
  s_add_u32 s66, s69, 655360
  s_lshr_b32 s53, s66, 7
  v_mfma_f32_16x16x32_bf16 v[24:27], v[104:107], a[152:155], v[24:27]
  s_and_b32 s53, s53, 0x2000
  s_xor_b32 s53, s53, s50
  v_mfma_f32_16x16x32_bf16 v[28:31], v[128:131], a[152:155], v[28:31]
  s_lshl_b32 s66, s66, 1
  s_or_b32 s66, s66, s53
  v_mfma_f32_16x16x32_bf16 v[24:27], v[108:111], a[156:159], v[24:27]
  s_add_u32 s66, s66, s70
  v_mfma_f32_16x16x32_bf16 v[28:31], v[132:135], a[156:159], v[28:31]
  v_mfma_f32_16x16x32_bf16 v[16:19], v[88:91], a[160:163], 0
  s_waitcnt vmcnt(5)
  s_barrier
  buffer_load_dword v10, v6, s[32:35], 0 offen sc1
  buffer_load_dword v11, v7, s[32:35], 0 offen sc1
  buffer_store_dword v3, v2, s[32:35], 0 offen sc1
  v_mfma_f32_16x16x32_bf16 v[20:23], v[112:115], a[160:163], 0
  ds_read_b128 v[40:43], v1 offset:0
  v_mfma_f32_16x16x32_bf16 v[16:19], v[92:95], a[164:167], v[16:19]
  ds_read_b128 v[44:47], v1 offset:3072
  v_cvt_pk_bf16_f32 v36, v24, v25
  v_mfma_f32_16x16x32_bf16 v[20:23], v[116:119], a[164:167], v[20:23]
  ds_read_b128 v[48:51], v1 offset:6144
  v_cvt_pk_bf16_f32 v37, v26, v27
  v_mfma_f32_16x16x32_bf16 v[16:19], v[96:99], a[168:171], v[16:19]
  ds_read_b128 v[52:55], v1 offset:9216
  v_cvt_pk_bf16_f32 v38, v28, v29
  v_mfma_f32_16x16x32_bf16 v[20:23], v[120:123], a[168:171], v[20:23]
  ds_read_b64 v[56:57], v1 offset:2048
  v_cvt_pk_bf16_f32 v39, v30, v31
  v_mfma_f32_16x16x32_bf16 v[16:19], v[100:103], a[172:175], v[16:19]
  buffer_store_dwordx4 v[36:39], v1, s[32:35], s66 offen sc1
  v_mfma_f32_16x16x32_bf16 v[20:23], v[124:127], a[172:175], v[20:23]
  s_add_u32 s66, s69, 688128
  s_lshr_b32 s53, s66, 7
  v_mfma_f32_16x16x32_bf16 v[16:19], v[104:107], a[176:179], v[16:19]
  s_and_b32 s53, s53, 0x2000
  s_xor_b32 s53, s53, s50
  v_mfma_f32_16x16x32_bf16 v[20:23], v[128:131], a[176:179], v[20:23]
  s_lshl_b32 s66, s66, 1
  s_or_b32 s66, s66, s53
  v_mfma_f32_16x16x32_bf16 v[16:19], v[108:111], a[180:183], v[16:19]
  s_add_u32 s66, s66, s70
  v_mfma_f32_16x16x32_bf16 v[20:23], v[132:135], a[180:183], v[20:23]
  v_mfma_f32_16x16x32_bf16 v[24:27], v[88:91], a[184:187], 0
  v_mfma_f32_16x16x32_bf16 v[28:31], v[112:115], a[184:187], 0
  ds_read_b64 v[58:59], v1 offset:5120
  v_mfma_f32_16x16x32_bf16 v[24:27], v[92:95], a[188:191], v[24:27]
  ds_read_b64 v[60:61], v1 offset:8192
  v_cvt_pk_bf16_f32 v32, v16, v17
  v_mfma_f32_16x16x32_bf16 v[28:31], v[116:119], a[188:191], v[28:31]
  ds_read_b64 v[62:63], v1 offset:11264
  v_cvt_pk_bf16_f32 v33, v18, v19
  v_mfma_f32_16x16x32_bf16 v[24:27], v[96:99], a[192:195], v[24:27]
  ds_read_b128 v[64:67], v1 offset:1024
  v_cvt_pk_bf16_f32 v34, v20, v21
  v_mfma_f32_16x16x32_bf16 v[28:31], v[120:123], a[192:195], v[28:31]
  ds_read_b128 v[68:71], v1 offset:4096
  v_cvt_pk_bf16_f32 v35, v22, v23
  v_mfma_f32_16x16x32_bf16 v[24:27], v[100:103], a[196:199], v[24:27]
  buffer_store_dwordx4 v[32:35], v1, s[32:35], s66 offen sc1
  v_mfma_f32_16x16x32_bf16 v[28:31], v[124:127], a[196:199], v[28:31]
  s_add_u32 s66, s69, 720896
  s_lshr_b32 s53, s66, 7
  v_mfma_f32_16x16x32_bf16 v[24:27], v[104:107], a[200:203], v[24:27]
  s_and_b32 s53, s53, 0x2000
  s_xor_b32 s53, s53, s50
  v_mfma_f32_16x16x32_bf16 v[28:31], v[128:131], a[200:203], v[28:31]
  s_lshl_b32 s66, s66, 1
  s_or_b32 s66, s66, s53
  v_mfma_f32_16x16x32_bf16 v[24:27], v[108:111], a[204:207], v[24:27]
  s_add_u32 s66, s66, s70
  v_mfma_f32_16x16x32_bf16 v[28:31], v[132:135], a[204:207], v[28:31]
  v_mfma_f32_16x16x32_bf16 v[16:19], v[88:91], a[208:211], 0
  v_mfma_f32_16x16x32_bf16 v[20:23], v[112:115], a[208:211], 0
  ds_read_b128 v[72:75], v1 offset:7168
  v_mfma_f32_16x16x32_bf16 v[16:19], v[92:95], a[212:215], v[16:19]
  ds_read_b128 v[76:79], v1 offset:10240
  v_cvt_pk_bf16_f32 v36, v24, v25
  v_mfma_f32_16x16x32_bf16 v[20:23], v[116:119], a[212:215], v[20:23]
  ds_read_b64 v[80:81], v1 offset:2056
  v_cvt_pk_bf16_f32 v37, v26, v27
  v_mfma_f32_16x16x32_bf16 v[16:19], v[96:99], a[216:219], v[16:19]
  ds_read_b64 v[82:83], v1 offset:5128
  v_cvt_pk_bf16_f32 v38, v28, v29
  v_mfma_f32_16x16x32_bf16 v[20:23], v[120:123], a[216:219], v[20:23]
  ds_read_b64 v[84:85], v1 offset:8200
  v_cvt_pk_bf16_f32 v39, v30, v31
  v_mfma_f32_16x16x32_bf16 v[16:19], v[100:103], a[220:223], v[16:19]
  buffer_store_dwordx4 v[36:39], v1, s[32:35], s66 offen sc1
  v_mfma_f32_16x16x32_bf16 v[20:23], v[124:127], a[220:223], v[20:23]
  s_add_u32 s66, s69, 753664
  s_lshr_b32 s53, s66, 7
  v_mfma_f32_16x16x32_bf16 v[16:19], v[104:107], a[224:227], v[16:19]
  s_and_b32 s53, s53, 0x2000
  s_xor_b32 s53, s53, s50
  v_mfma_f32_16x16x32_bf16 v[20:23], v[128:131], a[224:227], v[20:23]
  s_lshl_b32 s66, s66, 1
  s_or_b32 s66, s66, s53
  v_mfma_f32_16x16x32_bf16 v[16:19], v[108:111], a[228:231], v[16:19]
  s_add_u32 s66, s66, s70
  v_mfma_f32_16x16x32_bf16 v[20:23], v[132:135], a[228:231], v[20:23]
  v_mfma_f32_16x16x32_bf16 v[24:27], v[88:91], a[232:235], 0
  v_mfma_f32_16x16x32_bf16 v[28:31], v[112:115], a[232:235], 0
  ds_read_b64 v[86:87], v1 offset:11272
  v_mfma_f32_16x16x32_bf16 v[24:27], v[92:95], a[236:239], v[24:27]
  v_cvt_pk_bf16_f32 v32, v16, v17
  v_mfma_f32_16x16x32_bf16 v[28:31], v[116:119], a[236:239], v[28:31]
  v_cvt_pk_bf16_f32 v33, v18, v19
  v_mfma_f32_16x16x32_bf16 v[24:27], v[96:99], a[240:243], v[24:27]
  v_cvt_pk_bf16_f32 v34, v20, v21
  v_mfma_f32_16x16x32_bf16 v[28:31], v[120:123], a[240:243], v[28:31]
  v_cvt_pk_bf16_f32 v35, v22, v23
  v_mfma_f32_16x16x32_bf16 v[24:27], v[100:103], a[244:247], v[24:27]
  buffer_store_dwordx4 v[32:35], v1, s[32:35], s66 offen sc1
  v_mfma_f32_16x16x32_bf16 v[28:31], v[124:127], a[244:247], v[28:31]
  s_add_u32 s66, s69, 786432
  s_lshr_b32 s53, s66, 7
  v_mfma_f32_16x16x32_bf16 v[24:27], v[104:107], a[248:251], v[24:27]
  s_and_b32 s53, s53, 0x2000
  s_xor_b32 s53, s53, s50
  v_mfma_f32_16x16x32_bf16 v[28:31], v[128:131], a[248:251], v[28:31]
  s_lshl_b32 s66, s66, 1
  s_or_b32 s66, s66, s53
  v_mfma_f32_16x16x32_bf16 v[24:27], v[108:111], a[252:255], v[24:27]
  s_add_u32 s66, s66, s70
  v_mfma_f32_16x16x32_bf16 v[28:31], v[132:135], a[252:255], v[28:31]
  s_waitcnt lgkmcnt(0)
  s_add_u32 s52, s52, 1
  s_and_b32 s53, s52, 15
  s_cselect_b32 s53, 0, 0x1400000
  s_add_u32 s69, s69, 0x140000
  s_sub_u32 s69, s69, s53
  s_cmp_lt_u32 s52, 64
  s_cbranch_scc1 UC_SEG
  s_nop 7
  v_cvt_pk_bf16_f32 v36, v24, v25
  v_cvt_pk_bf16_f32 v37, v26, v27
  v_cvt_pk_bf16_f32 v38, v28, v29
  v_cvt_pk_bf16_f32 v39, v30, v31
  buffer_store_dwordx4 v[36:39], v1, s[32:35], s66 offen sc1
  v_mov_b32 v3, s52
  s_waitcnt vmcnt(0)
  s_barrier
  buffer_store_dword v3, v2, s[32:35], 0 offen sc1
  s_branch L_EXIT
R_QC:
  s_mov_b32 s44, s12
  s_and_b32 s45, s13, 0xffff
  s_mov_b32 s46, 0x280000
  s_mov_b32 s47, 0x20000
  s_lshl_b32 s53, s48, 2
  s_add_u32 s53, s53, s49
  s_lshl_b32 s53, s53, 13
  v_lshlrev_b32 v16, 7, v0
  buffer_load_dword v17, v16, s[44:47], s53 offen
  s_add_u32 s53, s53, 1048576
  buffer_load_dword v17, v16, s[44:47], s53 offen
  s_add_u32 s53, s53, 1048576
  buffer_load_dword v17, v16, s[44:47], s53 offen
  s_add_u32 s53, s53, 1048576
  s_mov_b32 s36, s16
  s_and_b32 s37, s17, 0xffff
  s_mov_b32 s38, 0x780000
  s_mov_b32 s39, 0x20000
  v_lshrrev_b32 v140, 3, v0
  s_lshl_b32 s53, s49, 3
  v_add_u32 v140, s53, v140
  v_bfe_u32 v141, v140, 1, 3
  v_and_b32 v142, 7, v0
  v_xor_b32 v141, v141, v142
  v_mul_u32_u24 v140, 1280, v140
  v_lshl_add_u32 v1, v141, 4, v140
  v_and_b32 v140, 15, v0
  v_lshrrev_b32 v141, 1, v140
  v_lshrrev_b32 v142, 4, v0
  v_xor_b32 v141, v141, v142
  v_lshlrev_b32 v140, 7, v140
  v_lshl_add_u32 v2, v141, 4, v140
  v_xor_b32 v3, 64, v2
  s_mov_b32 s56, 0
  s_lshl_b32 s55, s49, 10
  s_waitcnt vmcnt(0)
  s_add_u32 m0, s55, 0
  s_nop 0
  buffer_load_dwordx4 v1, s[44:47], s56 offen offset:0 lds
  s_add_u32 m0, s55, 3968
  s_nop 0
  buffer_load_dwordx4 v1, s[44:47], s56 offen offset:128 lds
  s_add_u32 m0, s55, 7936
  s_nop 0
  buffer_load_dwordx4 v1, s[44:47], s56 offen offset:256 lds
  s_add_u32 m0, s55, 11904
  s_nop 0
  buffer_load_dwordx4 v1, s[44:47], s56 offen offset:384 lds
  s_add_u32 m0, s55, 15872
  s_nop 0
  buffer_load_dwordx4 v1, s[44:47], s56 offen offset:512 lds
  s_add_u32 m0, s55, 19840
  s_nop 0
  buffer_load_dwordx4 v1, s[44:47], s56 offen offset:640 lds
  s_add_u32 m0, s55, 23808
  s_nop 0
  buffer_load_dwordx4 v1, s[44:47], s56 offen offset:768 lds
  s_add_u32 m0, s55, 27776
  s_nop 0
  buffer_load_dwordx4 v1, s[44:47], s56 offen offset:896 lds
  s_add_u32 m0, s55, 31744
  s_nop 0
  buffer_load_dwordx4 v1, s[44:47], s56 offen offset:1024 lds
  s_add_u32 m0, s55, 35712
  s_nop 0
  buffer_load_dwordx4 v1, s[44:47], s56 offen offset:1152 lds
  v_min_u32 v140, 47, v0
  v_max_u32 v140, 31, v140
  v_lshlrev_b32 v140, 2, v140
  s_mov_b32 s57, 0
WI_106:
  global_load_dword v141, v140, s[28:29] sc1
  s_add_u32 s57, s57, 1
  s_cmp_gt_u32 s57, 0x20000
  s_cbranch_scc1 L_EXIT
  s_waitcnt vmcnt(0)
  s_and_b32 s53, s24, 7
  s_add_u32 s53, s53, 40
  v_readlane_b32 s53, v141, s53
  s_nop 1
  v_cmp_gt_u32 vcc, s53, v141
  s_bfe_u32 s53, vcc_hi, 0x80008
  s_bcnt1_i32_b32 s53, s53
  v_cmp_eq_u32 vcc, 0, v141
  s_bfe_u32 s54, vcc_hi, 0x80008
  s_cbranch_scc1 WI_108
  s_cmp_lg_u32 s53, s25
  s_cbranch_scc1 L_REDO
WI_108:
  s_cbranch_vccz WI_107
  s_sleep 8
  s_branch WI_106
WI_107:
  v_readfirstlane_b32 s53, v141
  s_and_b32 s53, s53, 1
  s_lshl_b32 s50, s53, 13
  s_xor_b32 s51, s50, 0x2000
  v_lshlrev_b32 v16, 7, v0
  s_lshl_b32 s62, s48, 2
  s_add_u32 s62, s62, s49
  s_lshl_b32 s62, s62, 13
  s_mov_b32 s40, s6
  s_and_b32 s41, s7, 0xffff
  s_mov_b32 s42, 0x258000
  s_mov_b32 s43, 0x20000
  s_add_u32 s63, s62, 0
  buffer_load_dword v17, v16, s[40:43], s63 offen
  s_add_u32 s63, s62, 1048576
  buffer_load_dword v17, v16, s[40:43], s63 offen
  s_add_u32 s63, s62, 2097152
  buffer_load_dword v17, v16, s[40:43], s63 offen
  s_mov_b32 s40, s4
  s_and_b32 s41, s5, 0xffff
  s_mov_b32 s42, 0x280000
  s_mov_b32 s43, 0x20000
  s_add_u32 s63, s62, 0
  buffer_load_dword v17, v16, s[40:43], s63 offen
  s_add_u32 s63, s62, 1048576
  buffer_load_dword v17, v16, s[40:43], s63 offen
  s_add_u32 s63, s62, 2097152
  buffer_load_dword v17, v16, s[40:43], s63 offen
  s_mov_b32 s40, s10
  s_and_b32 s41, s11, 0xffff
  s_mov_b32 s42, 0xc8000
  s_mov_b32 s43, 0x20000
  s_add_u32 s63, s62, 0
  buffer_load_dword v17, v16, s[40:43], s63 offen
  s_mov_b32 s40, s8
  s_and_b32 s41, s9, 0xffff
  s_mov_b32 s42, 0x6400
  s_mov_b32 s43, 0x20000
  s_add_u32 s63, s62, 0
  buffer_load_dword v17, v16, s[40:43], s63 offen
  s_mov_b32 s62, 0
  s_mov_b32 s63, 1
  s_mov_b32 s64, 2
  s_mov_b32 s65, 3
  s_mov_b32 s66, 4
  s_mov_b32 s67, 5
  s_mov_b32 s68, 6
  s_mov_b32 s69, 7
  s_mov_b32 s70, 8
  s_mov_b32 s71, 9
  s_mul_i32 s55, s48, 384
  s_mul_i32 s53, s49, 384
  s_add_u32 s53, s53, 0
  v_add_u32 v60, s53, v0
  v_mul_u32_u24 v61, 43691, v60
  v_lshrrev_b32 v61, 20, v61
  v_mul_u32_u24 v62, 24, v61
  v_sub_u32 v60, v60, v62
  v_and_b32 v62, 2, v61
  v_lshrrev_b32 v63, 1, v61
  v_and_b32 v63, 4, v63
  v_or_b32 v62, v62, v63
  v_xor_b32 v60, v60, v62
  v_mul_u32_u24 v61, 12288, v61
  v_lshl_add_u32 v40, v60, 4, v61
  v_add_u32 v40, s55, v40
  s_mul_i32 s53, s49, 384
  s_add_u32 s53, s53, 64
  v_add_u32 v60, s53, v0
  v_mul_u32_u24 v61, 43691, v60
  v_lshrrev_b32 v61, 20, v61
  v_mul_u32_u24 v62, 24, v61
  v_sub_u32 v60, v60, v62
  v_and_b32 v62, 2, v61
  v_lshrrev_b32 v63, 1, v61
  v_and_b32 v63, 4, v63
  v_or_b32 v62, v62, v63
  v_xor_b32 v60, v60, v62
  v_mul_u32_u24 v61, 12288, v61
  v_lshl_add_u32 v41, v60, 4, v61
  v_add_u32 v41, s55, v41
  s_mul_i32 s53, s49, 384
  s_add_u32 s53, s53, 128
  v_add_u32 v60, s53, v0
  v_mul_u32_u24 v61, 43691, v60
  v_lshrrev_b32 v61, 20, v61
  v_mul_u32_u24 v62, 24, v61
  v_sub_u32 v60, v60, v62
  v_and_b32 v62, 2, v61
  v_lshrrev_b32 v63, 1, v61
  v_and_b32 v63, 4, v63
  v_or_b32 v62, v62, v63
  v_xor_b32 v60, v60, v62
  v_mul_u32_u24 v61, 12288, v61
  v_lshl_add_u32 v42, v60, 4, v61
  v_add_u32 v42, s55, v42
  s_mul_i32 s53, s49, 384
  s_add_u32 s53, s53, 192
  v_add_u32 v60, s53, v0
  v_mul_u32_u24 v61, 43691, v60
  v_lshrrev_b32 v61, 20, v61
  v_mul_u32_u24 v62, 24, v61
  v_sub_u32 v60, v60, v62
  v_and_b32 v62, 2, v61
  v_lshrrev_b32 v63, 1, v61
  v_and_b32 v63, 4, v63
  v_or_b32 v62, v62, v63
  v_xor_b32 v60, v60, v62
  v_mul_u32_u24 v61, 12288, v61
  v_lshl_add_u32 v43, v60, 4, v61
  v_add_u32 v43, s55, v43
  s_mul_i32 s53, s49, 384
  s_add_u32 s53, s53, 256
  v_add_u32 v60, s53, v0
  v_mul_u32_u24 v61, 43691, v60
  v_lshrrev_b32 v61, 20, v61
  v_mul_u32_u24 v62, 24, v61
  v_sub_u32 v60, v60, v62
  v_and_b32 v62, 2, v61
  v_lshrrev_b32 v63, 1, v61
  v_and_b32 v63, 4, v63
  v_or_b32 v62, v62, v63
  v_xor_b32 v60, v60, v62
  v_mul_u32_u24 v61, 12288, v61
  v_lshl_add_u32 v44, v60, 4, v61
  v_add_u32 v44, s55, v44
  s_mul_i32 s53, s49, 384
  s_add_u32 s53, s53, 320
  v_add_u32 v60, s53, v0
  v_mul_u32_u24 v61, 43691, v60
  v_lshrrev_b32 v61, 20, v61
  v_mul_u32_u24 v62, 24, v61
  v_sub_u32 v60, v60, v62
  v_and_b32 v62, 2, v61
  v_lshrrev_b32 v63, 1, v61
  v_and_b32 v63, 4, v63
  v_or_b32 v62, v62, v63
  v_xor_b32 v60, v60, v62
  v_mul_u32_u24 v61, 12288, v61
  v_lshl_add_u32 v45, v60, 4, v61
  v_add_u32 v45, s55, v45
  s_mul_i32 s55, s49, 3
  s_add_u32 s55, s55, 0
  v_lshrrev_b32 v60, 4, v0
  v_bfe_u32 v61, v0, 2, 2
  v_lshl_add_u32 v62, v60, 3, v61
  v_and_b32 v60, 1, v60
  v_lshrrev_b32 v61, 1, v61
  v_lshl_add_u32 v60, v60, 1, v61
  v_xor_b32 v60, s55, v60
  v_mul_u32_u24 v62, 384, v62
  v_lshl_add_u32 v62, v60, 5, v62
  v_and_b32 v60, 3, v0
  v_lshl_add_u32 v46, v60, 3, v62
  s_mul_i32 s55, s49, 3
  s_add_u32 s55, s55, 1
  v_lshrrev_b32 v60, 4, v0
  v_bfe_u32 v61, v0, 2, 2
  v_lshl_add_u32 v62, v60, 3, v61
  v_and_b32 v60, 1, v60
  v_lshrrev_b32 v61, 1, v61
  v_lshl_add_u32 v60, v60, 1, v61
  v_xor_b32 v60, s55, v60
  v_mul_u32_u24 v62, 384, v62
  v_lshl_add_u32 v62, v60, 5, v62
  v_and_b32 v60, 3, v0
  v_lshl_add_u32 v47, v60, 3, v62
  s_mul_i32 s55, s49, 3
  s_add_u32 s55, s55, 2
  v_lshrrev_b32 v60, 4, v0
  v_bfe_u32 v61, v0, 2, 2
  v_lshl_add_u32 v62, v60, 3, v61
  v_and_b32 v60, 1, v60
  v_lshrrev_b32 v61, 1, v61
  v_lshl_add_u32 v60, v60, 1, v61
  v_xor_b32 v60, s55, v60
  v_mul_u32_u24 v62, 384, v62
  v_lshl_add_u32 v62, v60, 5, v62
  v_and_b32 v60, 3, v0
  v_lshl_add_u32 v48, v60, 3, v62
  s_mul_i32 s54, s62, 786432
  s_mul_i32 s53, s49, 6144
  s_add_u32 m0, s53, 40960
  s_nop 0
  buffer_load_dwordx4 v40, s[36:39], s54 offen  lds
  s_add_u32 m0, m0, 1024
  s_nop 0
  buffer_load_dwordx4 v41, s[36:39], s54 offen  lds
  s_add_u32 m0, m0, 1024
  s_nop 0
  buffer_load_dwordx4 v42, s[36:39], s54 offen  lds
  s_add_u32 m0, m0, 1024
  s_nop 0
  buffer_load_dwordx4 v43, s[36:39], s54 offen  lds
  s_add_u32 m0, m0, 1024
  s_nop 0
  buffer_load_dwordx4 v44, s[36:39], s54 offen  lds
  s_add_u32 m0, m0, 1024
  s_nop 0
  buffer_load_dwordx4 v45, s[36:39], s54 offen  lds
  s_mul_i32 s54, s63, 786432
  s_mul_i32 s53, s49, 6144
  s_add_u32 m0, s53, 65536
  s_nop 0
  buffer_load_dwordx4 v40, s[36:39], s54 offen  lds
  s_add_u32 m0, m0, 1024
  s_nop 0
  buffer_load_dwordx4 v41, s[36:39], s54 offen  lds
  s_add_u32 m0, m0, 1024
  s_nop 0
  buffer_load_dwordx4 v42, s[36:39], s54 offen  lds
  s_add_u32 m0, m0, 1024
  s_nop 0
  buffer_load_dwordx4 v43, s[36:39], s54 offen  lds
  s_add_u32 m0, m0, 1024
  s_nop 0
  buffer_load_dwordx4 v44, s[36:39], s54 offen  lds
  s_add_u32 m0, m0, 1024
  s_nop 0
  buffer_load_dwordx4 v45, s[36:39], s54 offen  lds
  s_mul_i32 s54, s64, 786432
  s_mul_i32 s53, s49, 6144
  s_add_u32 m0, s53, 90112
  s_nop 0
  buffer_load_dwordx4 v40, s[36:39], s54 offen  lds
  s_add_u32 m0, m0, 1024
  s_nop 0
  buffer_load_dwordx4 v41, s[36:39], s54 offen  lds
  s_add_u32 m0, m0, 1024
  s_nop 0
  buffer_load_dwordx4 v42, s[36:39], s54 offen  lds
  s_add_u32 m0, m0, 1024
  s_nop 0
  buffer_load_dwordx4 v43, s[36:39], s54 offen  lds
  s_add_u32 m0, m0, 1024
  s_nop 0
  buffer_load_dwordx4 v44, s[36:39], s54 offen  lds
  s_add_u32 m0, m0, 1024
  s_nop 0
  buffer_load_dwordx4 v45, s[36:39], s54 offen  lds
  s_mul_i32 s54, s65, 786432
  s_mul_i32 s53, s49, 6144
  s_add_u32 m0, s53, 114688
  s_nop 0
  buffer_load_dwordx4 v40, s[36:39], s54 offen  lds
  s_add_u32 m0, m0, 1024
  s_nop 0
  buffer_load_dwordx4 v41, s[36:39], s54 offen  lds
  s_add_u32 m0, m0, 1024
  s_nop 0
  buffer_load_dwordx4 v42, s[36:39], s54 offen  lds
  s_add_u32 m0, m0, 1024
  s_nop 0
  buffer_load_dwordx4 v43, s[36:39], s54 offen  lds
  s_add_u32 m0, m0, 1024
  s_nop 0
  buffer_load_dwordx4 v44, s[36:39], s54 offen  lds
  s_add_u32 m0, m0, 1024
  s_nop 0
  buffer_load_dwordx4 v45, s[36:39], s54 offen  lds
  s_mul_i32 s54, s66, 786432
  s_mul_i32 s53, s49, 6144
  s_add_u32 m0, s53, 139264
  s_nop 0
  buffer_load_dwordx4 v40, s[36:39], s54 offen  lds
  s_add_u32 m0, m0, 1024
  s_nop 0
  buffer_load_dwordx4 v41, s[36:39], s54 offen  lds
  s_add_u32 m0, m0, 1024
  s_nop 0
  buffer_load_dwordx4 v42, s[36:39], s54 offen  lds
  s_add_u32 m0, m0, 1024
  s_nop 0
  buffer_load_dwordx4 v43, s[36:39], s54 offen  lds
  s_add_u32 m0, m0, 1024
  s_nop 0
  buffer_load_dwordx4 v44, s[36:39], s54 offen  lds
  s_add_u32 m0, m0, 1024
  s_nop 0
  buffer_load_dwordx4 v45, s[36:39], s54 offen  lds
  s_waitcnt vmcnt(24)
  s_barrier
  v_add_u32 v49, 0xa000, v46
  v_add_u32 v50, 0xa000, v47
  v_add_u32 v51, 0xa000, v48
  ds_read_b64_tr_b16 a[16:17], v49 offset:0
  ds_read_b64_tr_b16 a[18:19], v49 offset:1536
  ds_read_b64_tr_b16 a[20:21], v49 offset:12288
  ds_read_b64_tr_b16 a[22:23], v49 offset:13824
  ds_read_b64_tr_b16 a[24:25], v50 offset:0
  ds_read_b64_tr_b16 a[26:27], v50 offset:1536
  ds_read_b64_tr_b16 a[28:29], v50 offset:12288
  ds_read_b64_tr_b16 a[30:31], v50 offset:13824
  ds_read_b64_tr_b16 a[32:33], v51 offset:0
  ds_read_b64_tr_b16 a[34:35], v51 offset:1536
  ds_read_b64_tr_b16 a[36:37], v51 offset:12288
  ds_read_b64_tr_b16 a[38:39], v51 offset:13824
  s_waitcnt lgkmcnt(0)
  s_barrier
  s_mul_i32 s54, s67, 786432
  s_mul_i32 s53, s49, 6144
  s_add_u32 m0, s53, 40960
  s_nop 0
  buffer_load_dwordx4 v40, s[36:39], s54 offen  lds
  s_add_u32 m0, m0, 1024
  s_nop 0
  buffer_load_dwordx4 v41, s[36:39], s54 offen  lds
  s_add_u32 m0, m0, 1024
  s_nop 0
  buffer_load_dwordx4 v42, s[36:39], s54 offen  lds
  s_add_u32 m0, m0, 1024
  s_nop 0
  buffer_load_dwordx4 v43, s[36:39], s54 offen  lds
  s_add_u32 m0, m0, 1024
  s_nop 0
  buffer_load_dwordx4 v44, s[36:39], s54 offen  lds
  s_add_u32 m0, m0, 1024
  s_nop 0
  buffer_load_dwordx4 v45, s[36:39], s54 offen  lds
  s_waitcnt vmcnt(24)
  s_barrier
  v_add_u32 v49, 0x10000, v46
  v_add_u32 v50, 0x10000, v47
  v_add_u32 v51, 0x10000, v48
  ds_read_b64_tr_b16 a[40:41], v49 offset:0
  ds_read_b64_tr_b16 a[42:43], v49 offset:1536
  ds_read_b64_tr_b16 a[44:45], v49 offset:12288
  ds_read_b64_tr_b16 a[46:47], v49 offset:13824
  ds_read_b64_tr_b16 a[48:49], v50 offset:0
  ds_read_b64_tr_b16 a[50:51], v50 offset:1536
  ds_read_b64_tr_b16 a[52:53], v50 offset:12288
  ds_read_b64_tr_b16 a[54:55], v50 offset:13824
  ds_read_b64_tr_b16 a[56:57], v51 offset:0
  ds_read_b64_tr_b16 a[58:59], v51 offset:1536
  ds_read_b64_tr_b16 a[60:61], v51 offset:12288
  ds_read_b64_tr_b16 a[62:63], v51 offset:13824
  s_waitcnt lgkmcnt(0)
  s_barrier
  s_mul_i32 s54, s68, 786432
  s_mul_i32 s53, s49, 6144
  s_add_u32 m0, s53, 65536
  s_nop 0
  buffer_load_dwordx4 v40, s[36:39], s54 offen  lds
  s_add_u32 m0, m0, 1024
  s_nop 0
  buffer_load_dwordx4 v41, s[36:39], s54 offen  lds
  s_add_u32 m0, m0, 1024
  s_nop 0
  buffer_load_dwordx4 v42, s[36:39], s54 offen  lds
  s_add_u32 m0, m0, 1024
  s_nop 0
  buffer_load_dwordx4 v43, s[36:39], s54 offen  lds
  s_add_u32 m0, m0, 1024
  s_nop 0
  buffer_load_dwordx4 v44, s[36:39], s54 offen  lds
  s_add_u32 m0, m0, 1024
  s_nop 0
  buffer_load_dwordx4 v45, s[36:39], s54 offen  lds
  s_waitcnt vmcnt(24)
  s_barrier
  v_add_u32 v49, 0x16000, v46
  v_add_u32 v50, 0x16000, v47
  v_add_u32 v51, 0x16000, v48
  ds_read_b64_tr_b16 a[64:65], v49 offset:0
  ds_read_b64_tr_b16 a[66:67], v49 offset:1536
  ds_read_b64_tr_b16 a[68:69], v49 offset:12288
  ds_read_b64_tr_b16 a[70:71], v49 offset:13824
  ds_read_b64_tr_b16 a[72:73], v50 offset:0
  ds_read_b64_tr_b16 a[74:75], v50 offset:1536
  ds_read_b64_tr_b16 a[76:77], v50 offset:12288
  ds_read_b64_tr_b16 a[78:79], v50 offset:13824
  ds_read_b64_tr_b16 a[80:81], v51 offset:0
  ds_read_b64_tr_b16 a[82:83], v51 offset:1536
  ds_read_b64_tr_b16 a[84:85], v51 offset:12288
  ds_read_b64_tr_b16 a[86:87], v51 offset:13824
  s_waitcnt lgkmcnt(0)
  s_barrier
  s_mul_i32 s54, s69, 786432
  s_mul_i32 s53, s49, 6144
  s_add_u32 m0, s53, 90112
  s_nop 0
  buffer_load_dwordx4 v40, s[36:39], s54 offen  lds
  s_add_u32 m0, m0, 1024
  s_nop 0
  buffer_load_dwordx4 v41, s[36:39], s54 offen  lds
  s_add_u32 m0, m0, 1024
  s_nop 0
  buffer_load_dwordx4 v42, s[36:39], s54 offen  lds
  s_add_u32 m0, m0, 1024
  s_nop 0
  buffer_load_dwordx4 v43, s[36:39], s54 offen  lds
  s_add_u32 m0, m0, 1024
  s_nop 0
  buffer_load_dwordx4 v44, s[36:39], s54 offen  lds
  s_add_u32 m0, m0, 1024
  s_nop 0
  buffer_load_dwordx4 v45, s[36:39], s54 offen  lds
  s_waitcnt vmcnt(24)
  s_barrier
  v_add_u32 v49, 0x1c000, v46
  v_add_u32 v50, 0x1c000, v47
  v_add_u32 v51, 0x1c000, v48
  ds_read_b64_tr_b16 a[88:89], v49 offset:0
  ds_read_b64_tr_b16 a[90:91], v49 offset:1536
  ds_read_b64_tr_b16 a[92:93], v49 offset:12288
  ds_read_b64_tr_b16 a[94:95], v49 offset:13824
  ds_read_b64_tr_b16 a[96:97], v50 offset:0
  ds_read_b64_tr_b16 a[98:99], v50 offset:1536
  ds_read_b64_tr_b16 a[100:101], v50 offset:12288
  ds_read_b64_tr_b16 a[102:103], v50 offset:13824
  ds_read_b64_tr_b16 a[104:105], v51 offset:0
  ds_read_b64_tr_b16 a[106:107], v51 offset:1536
  ds_read_b64_tr_b16 a[108:109], v51 offset:12288
  ds_read_b64_tr_b16 a[110:111], v51 offset:13824
  s_waitcnt lgkmcnt(0)
  s_barrier
  s_mul_i32 s54, s70, 786432
  s_mul_i32 s53, s49, 6144
  s_add_u32 m0, s53, 114688
  s_nop 0
  buffer_load_dwordx4 v40, s[36:39], s54 offen  lds
  s_add_u32 m0, m0, 1024
  s_nop 0
  buffer_load_dwordx4 v41, s[36:39], s54 offen  lds
  s_add_u32 m0, m0, 1024
  s_nop 0
  buffer_load_dwordx4 v42, s[36:39], s54 offen  lds
  s_add_u32 m0, m0, 1024
  s_nop 0
  buffer_load_dwordx4 v43, s[36:39], s54 offen  lds
  s_add_u32 m0, m0, 1024
  s_nop 0
  buffer_load_dwordx4 v44, s[36:39], s54 offen  lds
  s_add_u32 m0, m0, 1024
  s_nop 0
  buffer_load_dwordx4 v45, s[36:39], s54 offen  lds
  s_waitcnt vmcnt(24)
  s_barrier
  v_add_u32 v49, 0x22000, v46
  v_add_u32 v50, 0x22000, v47
  v_add_u32 v51, 0x22000, v48
  ds_read_b64_tr_b16 a[112:113], v49 offset:0
  ds_read_b64_tr_b16 a[114:115], v49 offset:1536
  ds_read_b64_tr_b16 a[116:117], v49 offset:12288
  ds_read_b64_tr_b16 a[118:119], v49 offset:13824
  ds_read_b64_tr_b16 a[120:121], v50 offset:0
  ds_read_b64_tr_b16 a[122:123], v50 offset:1536
  ds_read_b64_tr_b16 a[124:125], v50 offset:12288
  ds_read_b64_tr_b16 a[126:127], v50 offset:13824
  ds_read_b64_tr_b16 a[128:129], v51 offset:0
  ds_read_b64_tr_b16 a[130:131], v51 offset:1536
  ds_read_b64_tr_b16 a[132:133], v51 offset:12288
  ds_read_b64_tr_b16 a[134:135], v51 offset:13824
  s_waitcnt lgkmcnt(0)
  s_barrier
  s_mul_i32 s54, s71, 786432
  s_mul_i32 s53, s49, 6144
  s_add_u32 m0, s53, 139264
  s_nop 0
  buffer_load_dwordx4 v40, s[36:39], s54 offen  lds
  s_add_u32 m0, m0, 1024
  s_nop 0
  buffer_load_dwordx4 v41, s[36:39], s54 offen  lds
  s_add_u32 m0, m0, 1024
  s_nop 0
  buffer_load_dwordx4 v42, s[36:39], s54 offen  lds
  s_add_u32 m0, m0, 1024
  s_nop 0
  buffer_load_dwordx4 v43, s[36:39], s54 offen  lds
  s_add_u32 m0, m0, 1024
  s_nop 0
  buffer_load_dwordx4 v44, s[36:39], s54 offen  lds
  s_add_u32 m0, m0, 1024
  s_nop 0
  buffer_load_dwordx4 v45, s[36:39], s54 offen  lds
  s_waitcnt vmcnt(24)
  s_barrier
  v_add_u32 v49, 0xa000, v46
  v_add_u32 v50, 0xa000, v47
  v_add_u32 v51, 0xa000, v48
  ds_read_b64_tr_b16 a[136:137], v49 offset:0
  ds_read_b64_tr_b16 a[138:139], v49 offset:1536
  ds_read_b64_tr_b16 a[140:141], v49 offset:12288
  ds_read_b64_tr_b16 a[142:143], v49 offset:13824
  ds_read_b64_tr_b16 a[144:145], v50 offset:0
  ds_read_b64_tr_b16 a[146:147], v50 offset:1536
  ds_read_b64_tr_b16 a[148:149], v50 offset:12288
  ds_read_b64_tr_b16 a[150:151], v50 offset:13824
  ds_read_b64_tr_b16 a[152:153], v51 offset:0
  ds_read_b64_tr_b16 a[154:155], v51 offset:1536
  ds_read_b64_tr_b16 a[156:157], v51 offset:12288
  ds_read_b64_tr_b16 a[158:159], v51 offset:13824
  s_waitcnt lgkmcnt(0)
  s_waitcnt vmcnt(18)
  s_barrier
  v_add_u32 v49, 0x10000, v46
  v_add_u32 v50, 0x10000, v47
  v_add_u32 v51, 0x10000, v48
  ds_read_b64_tr_b16 a[160:161], v49 offset:0
  ds_read_b64_tr_b16 a[162:163], v49 offset:1536
  ds_read_b64_tr_b16 a[164:165], v49 offset:12288
  ds_read_b64_tr_b16 a[166:167], v49 offset:13824
  ds_read_b64_tr_b16 a[168:169], v50 offset:0
  ds_read_b64_tr_b16 a[170:171], v50 offset:1536
  ds_read_b64_tr_b16 a[172:173], v50 offset:12288
  ds_read_b64_tr_b16 a[174:175], v50 offset:13824
  ds_read_b64_tr_b16 a[176:177], v51 offset:0
  ds_read_b64_tr_b16 a[178:179], v51 offset:1536
  ds_read_b64_tr_b16 a[180:181], v51 offset:12288
  ds_read_b64_tr_b16 a[182:183], v51 offset:13824
  s_waitcnt lgkmcnt(0)
  s_waitcnt vmcnt(12)
  s_barrier
  v_add_u32 v49, 0x16000, v46
  v_add_u32 v50, 0x16000, v47
  v_add_u32 v51, 0x16000, v48
  ds_read_b64_tr_b16 a[184:185], v49 offset:0
  ds_read_b64_tr_b16 a[186:187], v49 offset:1536
  ds_read_b64_tr_b16 a[188:189], v49 offset:12288
  ds_read_b64_tr_b16 a[190:191], v49 offset:13824
  ds_read_b64_tr_b16 a[192:193], v50 offset:0
  ds_read_b64_tr_b16 a[194:195], v50 offset:1536
  ds_read_b64_tr_b16 a[196:197], v50 offset:12288
  ds_read_b64_tr_b16 a[198:199], v50 offset:13824
  ds_read_b64_tr_b16 a[200:201], v51 offset:0
  ds_read_b64_tr_b16 a[202:203], v51 offset:1536
  ds_read_b64_tr_b16 a[204:205], v51 offset:12288
  ds_read_b64_tr_b16 a[206:207], v51 offset:13824
  s_waitcnt lgkmcnt(0)
  s_waitcnt vmcnt(6)
  s_barrier
  v_add_u32 v49, 0x1c000, v46
  v_add_u32 v50, 0x1c000, v47
  v_add_u32 v51, 0x1c000, v48
  ds_read_b64_tr_b16 a[208:209], v49 offset:0
  ds_read_b64_tr_b16 a[210:211], v49 offset:1536
  ds_read_b64_tr_b16 a[212:213], v49 offset:12288
  ds_read_b64_tr_b16 a[214:215], v49 offset:13824
  ds_read_b64_tr_b16 a[216:217], v50 offset:0
  ds_read_b64_tr_b16 a[218:219], v50 offset:1536
  ds_read_b64_tr_b16 a[220:221], v50 offset:12288
  ds_read_b64_tr_b16 a[222:223], v50 offset:13824
  ds_read_b64_tr_b16 a[224:225], v51 offset:0
  ds_read_b64_tr_b16 a[226:227], v51 offset:1536
  ds_read_b64_tr_b16 a[228:229], v51 offset:12288
  ds_read_b64_tr_b16 a[230:231], v51 offset:13824
  s_waitcnt lgkmcnt(0)
  s_waitcnt vmcnt(0)
  s_barrier
  v_add_u32 v49, 0x22000, v46
  v_add_u32 v50, 0x22000, v47
  v_add_u32 v51, 0x22000, v48
  ds_read_b64_tr_b16 a[232:233], v49 offset:0
  ds_read_b64_tr_b16 a[234:235], v49 offset:1536
  ds_read_b64_tr_b16 a[236:237], v49 offset:12288
  ds_read_b64_tr_b16 a[238:239], v49 offset:13824
  ds_read_b64_tr_b16 a[240:241], v50 offset:0
  ds_read_b64_tr_b16 a[242:243], v50 offset:1536
  ds_read_b64_tr_b16 a[244:245], v50 offset:12288
  ds_read_b64_tr_b16 a[246:247], v50 offset:13824
  ds_read_b64_tr_b16 a[248:249], v51 offset:0
  ds_read_b64_tr_b16 a[250:251], v51 offset:1536
  ds_read_b64_tr_b16 a[252:253], v51 offset:12288
  ds_read_b64_tr_b16 a[254:255], v51 offset:13824
  s_waitcnt lgkmcnt(0)
  s_barrier
  s_mov_b32 s64, 0
  s_lshl_b32 s65, s49, 10
  v_lshlrev_b32 v6, 4, v0
  s_lshl_b32 s62, s48, 14
  s_lshr_b32 s54, s49, 1
  s_lshl_b32 s54, s54, 13
  s_add_u32 s62, s62, s54
  s_and_b32 s63, s49, 1
  s_lshl_b32 s63, s63, 12
  s_lshl_b32 s54, s48, 7
  s_add_u32 s54, s54, s51
  s_add_u32 s54, s54, 49152
  v_mov_b32 v9, s54
  s_lshl_b32 s54, s48, 7
  s_add_u32 s54, s54, s51
  s_add_u32 s54, s54, 32768
  v_mov_b32 v10, s54
  s_lshl_b32 s54, s48, 7
  s_add_u32 s54, s54, s50
  s_add_u32 s54, s54, 69632
  v_mov_b32 v158, 0x40000000
  s_nop 0
  v_writelane_b32 v158, s54, 0
  s_cmp_eq_u32 s49, 0
  s_cselect_b32 s54, s54, 0x40000000
  v_mov_b32 v7, 0x40000000
  s_nop 0
  v_writelane_b32 v7, s54, 0
  v_mov_b32 v159, 102400
  s_lshr_b32 s70, s48, 1
  s_lshl_b32 s70, s70, 13
  s_and_b32 s88, s48, 1
  s_lshl_b32 s88, s88, 2
  s_add_u32 s88, s88, s49
  s_lshl_b32 s88, s88, 10
  s_sub_u32 s88, s88, 128
  s_mul_i32 s54, s49, 5120
  s_add_u32 s54, s54, 81920
  v_add_u32 v11, s54, v6
  v_lshrrev_b32 v40, 3, v0
  v_and_b32 v41, 7, v0
  s_and_b32 s54, s49, 1
  s_lshl_b32 s54, s54, 7
  v_lshl_add_u32 v42, v41, 4, s54
  s_lshr_b32 s55, s49, 1
  s_lshl_b32 s55, s55, 10
  v_lshl_add_u32 v43, v40, 8, v42
  v_cmp_gt_u32 vcc, 4, v40
  s_add_u32 s56, s55, 81920
  v_add_u32 v44, s56, v43
  v_add_u32 v45, s56, v42
  v_add_u32 v45, 3584, v45
  v_cndmask_b32 v12, v45, v44, vcc
  v_add_u32 v44, 83968, v43
  v_add_u32 v45, 256, v45
  v_cndmask_b32 v13, v45, v44, vcc
  v_mov_b32 v44, 0xd04e79ff
  v_mov_b32 v45, 0xff800000
  v_cndmask_b32 v14, v45, v44, vcc
  s_lshr_b32 s53, s48, 2
  s_lshl_b32 s54, s53, 14
  s_and_b32 s56, s48, 3
  s_lshl_b32 s69, s56, 11
  s_add_u32 s54, s54, s69
  s_add_u32 s54, s54, s55
  v_add_u32 v44, s54, v43
  s_lshr_b32 s54, s53, 2
  s_lshl_b32 s54, s54, 14
  s_and_b32 s53, s53, 3
  s_lshl_b32 s53, s53, 11
  s_add_u32 s54, s54, s53
  s_add_u32 s54, s54, s55
  s_lshl_b32 s56, s56, 8
  s_add_u32 s54, s54, s56
  s_add_u32 s54, s54, 131072
  v_add_u32 v45, s54, v42
  v_cndmask_b32 v44, v45, v44, vcc
  v_mov_b32 v45, 0x40000000
  v_cmp_lt_u32 vcc, 4, v40
  s_nop 1
  v_cndmask_b32 v15, v44, v45, vcc
  s_lshl_b32 s54, s49, 3
  v_add_u32 v44, s54, v41
  v_lshlrev_b32 v45, 2, v40
  v_sub_u32 v44, v44, v45
  v_mov_b32 v45, -1
  v_cndmask_b32 v44, v44, v45, vcc
  v_mov_b32 v45, 63
  v_cmp_eq_u32 vcc, 4, v40
  s_nop 1
  v_cndmask_b32 v44, v44, v45, vcc
  v_cmp_le_i32 s[72:73], 0, v44
  v_cmp_le_i32 s[74:75], 1, v44
  v_cmp_le_i32 s[76:77], 2, v44
  v_cmp_le_i32 s[78:79], 3, v44
  v_cmp_le_i32 s[80:81], 16, v44
  v_cmp_le_i32 s[82:83], 17, v44
  v_cmp_le_i32 s[84:85], 18, v44
  v_cmp_le_i32 s[86:87], 19, v44
  s_mov_b32 s71, 0x3dd53b95
  s_mov_b32 s52, 0
  s_mov_b32 s66, 0
  s_mov_b32 s67, 0
  s_mov_b32 s68, 0
  v_mov_b32 v4, v2
  v_mov_b32 v5, v3
  s_mul_i32 s54, s49, 3072
  s_add_u32 s54, s54, 102464
  v_add_u32 v162, s54, v6
  s_mov_b32 s4, 3
  v_mov_b32 v163, 1
  v_mov_b32 v164, 0
  ds_read_b128 v[40:43], v4 offset:0
  ds_read_b128 v[44:47], v5 offset:0
  ds_read_b128 v[48:51], v4 offset:4096
QC_PRO:
  ds_read_b128 v[52:55], v5 offset:4096
  s_waitcnt lgkmcnt(3)
  v_mfma_f32_16x16x32_bf16 v[16:19], a[16:19], v[40:43], 0
  s_add_u32 s64, s64, 40960
  v_mfma_f32_16x16x32_bf16 v[20:23], a[24:27], v[40:43], 0
  s_xor_b32 s65, s65, 40960
  v_mfma_f32_16x16x32_bf16 v[24:27], a[32:35], v[40:43], 0
  s_xor_b32 s66, s66, 40960
  ds_read_b128 v[40:43], v4 offset:8192
  s_waitcnt lgkmcnt(3)
  v_mfma_f32_16x16x32_bf16 v[16:19], a[20:23], v[44:47], v[16:19]
  s_and_b32 s55, s4, 3
  v_cvt_pk_bf16_f32 v148, v28, v29
  v_cvt_pk_bf16_f32 v149, v30, v31
  v_mfma_f32_16x16x32_bf16 v[20:23], a[28:31], v[44:47], v[20:23]
  s_mul_i32 s55, s55, 12288
  v_cvt_pk_bf16_f32 v150, v32, v33
  v_cvt_pk_bf16_f32 v151, v34, v35
  v_mfma_f32_16x16x32_bf16 v[24:27], a[36:39], v[44:47], v[24:27]
  v_add_u32 v160, s55, v162
  ds_read_b128 v[44:47], v5 offset:8192
  s_waitcnt lgkmcnt(3)
  v_mfma_f32_16x16x32_bf16 v[16:19], a[40:43], v[48:51], v[16:19]
  v_cvt_pk_bf16_f32 v154, v36, v37
  v_cvt_pk_bf16_f32 v155, v38, v39
  v_mfma_f32_16x16x32_bf16 v[20:23], a[48:51], v[48:51], v[20:23]
  v_mfma_f32_16x16x32_bf16 v[24:27], a[56:59], v[48:51], v[24:27]
  ds_read_b128 v[48:51], v4 offset:12288
  s_waitcnt lgkmcnt(3)
  v_mfma_f32_16x16x32_bf16 v[16:19], a[44:47], v[52:55], v[16:19]
  ds_write_b128 v160, v[144:147] offset:0
  v_mfma_f32_16x16x32_bf16 v[20:23], a[52:55], v[52:55], v[20:23]
  v_mfma_f32_16x16x32_bf16 v[24:27], a[60:63], v[52:55], v[24:27]
  ds_write_b128 v160, v[148:151] offset:1024
  ds_read_b128 v[52:55], v5 offset:12288
  s_waitcnt lgkmcnt(5)
  v_mfma_f32_16x16x32_bf16 v[16:19], a[64:67], v[40:43], v[16:19]
  v_mfma_f32_16x16x32_bf16 v[20:23], a[72:75], v[40:43], v[20:23]
  v_mfma_f32_16x16x32_bf16 v[24:27], a[80:83], v[40:43], v[24:27]
  ds_write_b128 v160, v[152:155] offset:2048
  ds_read_b128 v[40:43], v4 offset:16384
  s_waitcnt lgkmcnt(6)
  v_mfma_f32_16x16x32_bf16 v[16:19], a[68:71], v[44:47], v[16:19]
  v_mfma_f32_16x16x32_bf16 v[20:23], a[76:79], v[44:47], v[20:23]
  v_mfma_f32_16x16x32_bf16 v[24:27], a[84:87], v[44:47], v[24:27]
  s_add_u32 m0, s65, 0
  ds_read_b128 v[44:47], v5 offset:16384
  s_waitcnt lgkmcnt(6)
  v_mfma_f32_16x16x32_bf16 v[16:19], a[88:91], v[48:51], v[16:19]
  buffer_load_dwordx4 v1, s[44:47], s64 offen offset:0 lds
  v_mfma_f32_16x16x32_bf16 v[20:23], a[96:99], v[48:51], v[20:23]
  s_add_u32 m0, s65, 3968
  s_nop 0
  buffer_load_dwordx4 v1, s[44:47], s64 offen offset:128 lds
  v_mfma_f32_16x16x32_bf16 v[24:27], a[104:107], v[48:51], v[24:27]
  s_add_u32 m0, s65, 7936
  ds_read_b128 v[48:51], v4 offset:20480
  s_waitcnt lgkmcnt(4)
  v_mfma_f32_16x16x32_bf16 v[16:19], a[92:95], v[52:55], v[16:19]
  buffer_load_dwordx4 v1, s[44:47], s64 offen offset:256 lds
  v_mfma_f32_16x16x32_bf16 v[20:23], a[100:103], v[52:55], v[20:23]
  v_mfma_f32_16x16x32_bf16 v[24:27], a[108:111], v[52:55], v[24:27]
  s_add_u32 m0, s65, 11904
  ds_read_b128 v[52:55], v5 offset:20480
  s_waitcnt lgkmcnt(3)
  v_mfma_f32_16x16x32_bf16 v[16:19], a[112:115], v[40:43], v[16:19]
  buffer_load_dwordx4 v1, s[44:47], s64 offen offset:384 lds
  v_mfma_f32_16x16x32_bf16 v[20:23], a[120:123], v[40:43], v[20:23]
  v_mfma_f32_16x16x32_bf16 v[24:27], a[128:131], v[40:43], v[24:27]
  s_add_u32 m0, s65, 15872
  ds_read_b128 v[40:43], v4 offset:24576
  s_waitcnt lgkmcnt(3)
  v_mfma_f32_16x16x32_bf16 v[16:19], a[116:119], v[44:47], v[16:19]
  buffer_load_dwordx4 v1, s[44:47], s64 offen offset:512 lds
  v_mfma_f32_16x16x32_bf16 v[20:23], a[124:127], v[44:47], v[20:23]
  v_mfma_f32_16x16x32_bf16 v[24:27], a[132:135], v[44:47], v[24:27]
  s_add_u32 m0, s65, 19840
  ds_read_b128 v[44:47], v5 offset:24576
  s_waitcnt lgkmcnt(3)
  v_mfma_f32_16x16x32_bf16 v[16:19], a[136:139], v[48:51], v[16:19]
  buffer_load_dwordx4 v1, s[44:47], s64 offen offset:640 lds
  v_mfma_f32_16x16x32_bf16 v[20:23], a[144:147], v[48:51], v[20:23]
  v_mfma_f32_16x16x32_bf16 v[24:27], a[152:155], v[48:51], v[24:27]
  s_add_u32 m0, s65, 23808
  ds_read_b128 v[48:51], v4 offset:28672
  s_waitcnt lgkmcnt(3)
  v_mfma_f32_16x16x32_bf16 v[16:19], a[140:143], v[52:55], v[16:19]
  buffer_load_dwordx4 v1, s[44:47], s64 offen offset:768 lds
  v_mfma_f32_16x16x32_bf16 v[20:23], a[148:151], v[52:55], v[20:23]
  v_mfma_f32_16x16x32_bf16 v[24:27], a[156:159], v[52:55], v[24:27]
  s_add_u32 m0, s65, 27776
  ds_read_b128 v[52:55], v5 offset:28672
  s_waitcnt lgkmcnt(3)
  v_mfma_f32_16x16x32_bf16 v[16:19], a[160:163], v[40:43], v[16:19]
  buffer_load_dwordx4 v1, s[44:47], s64 offen offset:896 lds
  v_mfma_f32_16x16x32_bf16 v[20:23], a[168:171], v[40:43], v[20:23]
  v_mfma_f32_16x16x32_bf16 v[24:27], a[176:179], v[40:43], v[24:27]
  s_add_u32 m0, s65, 31744
  ds_read_b128 v[40:43], v4 offset:32768
  s_waitcnt lgkmcnt(3)
  v_mfma_f32_16x16x32_bf16 v[16:19], a[164:167], v[44:47], v[16:19]
  buffer_load_dwordx4 v1, s[44:47], s64 offen offset:1024 lds
  v_mfma_f32_16x16x32_bf16 v[20:23], a[172:175], v[44:47], v[20:23]
  v_mfma_f32_16x16x32_bf16 v[24:27], a[180:183], v[44:47], v[24:27]
  s_add_u32 m0, s65, 35712
  ds_read_b128 v[44:47], v5 offset:32768
  s_waitcnt lgkmcnt(3)
  v_mfma_f32_16x16x32_bf16 v[16:19], a[184:187], v[48:51], v[16:19]
  buffer_load_dwordx4 v1, s[44:47], s64 offen offset:1152 lds
  v_mfma_f32_16x16x32_bf16 v[20:23], a[192:195], v[48:51], v[20:23]
  v_mfma_f32_16x16x32_bf16 v[24:27], a[200:203], v[48:51], v[24:27]
  ds_read_b128 v[48:51], v4 offset:36864
  s_waitcnt lgkmcnt(3)
  v_mfma_f32_16x16x32_bf16 v[16:19], a[188:191], v[52:55], v[16:19]
  v_mfma_f32_16x16x32_bf16 v[20:23], a[196:199], v[52:55], v[20:23]
  v_mfma_f32_16x16x32_bf16 v[24:27], a[204:207], v[52:55], v[24:27]
  ds_read_b128 v[52:55], v5 offset:36864
  s_waitcnt lgkmcnt(3)
  v_mfma_f32_16x16x32_bf16 v[16:19], a[208:211], v[40:43], v[16:19]
  v_mfma_f32_16x16x32_bf16 v[20:23], a[216:219], v[40:43], v[20:23]
  v_mfma_f32_16x16x32_bf16 v[24:27], a[224:227], v[40:43], v[24:27]
  ds_read_b128 v[40:43], v4 offset:2048
  s_waitcnt lgkmcnt(3)
  v_mfma_f32_16x16x32_bf16 v[16:19], a[212:215], v[44:47], v[16:19]
  v_mfma_f32_16x16x32_bf16 v[20:23], a[220:223], v[44:47], v[20:23]
  v_mfma_f32_16x16x32_bf16 v[24:27], a[228:231], v[44:47], v[24:27]
  ds_read_b128 v[44:47], v5 offset:2048
  s_waitcnt lgkmcnt(3)
  v_mfma_f32_16x16x32_bf16 v[16:19], a[232:235], v[48:51], v[16:19]
  v_mfma_f32_16x16x32_bf16 v[20:23], a[240:243], v[48:51], v[20:23]
  v_mfma_f32_16x16x32_bf16 v[24:27], a[248:251], v[48:51], v[24:27]
  ds_read_b128 v[48:51], v4 offset:6144
  s_waitcnt lgkmcnt(3)
  v_mfma_f32_16x16x32_bf16 v[16:19], a[236:239], v[52:55], v[16:19]
  v_mfma_f32_16x16x32_bf16 v[20:23], a[244:247], v[52:55], v[20:23]
  v_mfma_f32_16x16x32_bf16 v[24:27], a[252:255], v[52:55], v[24:27]
  ds_read_b128 v[52:55], v5 offset:6144
  s_waitcnt lgkmcnt(3)
  v_mfma_f32_16x16x32_bf16 v[28:31], a[16:19], v[40:43], 0
  v_mfma_f32_16x16x32_bf16 v[32:35], a[24:27], v[40:43], 0
  v_mfma_f32_16x16x32_bf16 v[36:39], a[32:35], v[40:43], 0
  ds_read_b128 v[40:43], v4 offset:10240
  s_waitcnt lgkmcnt(3)
  v_mfma_f32_16x16x32_bf16 v[28:31], a[20:23], v[44:47], v[28:31]
  v_cvt_pk_bf16_f32 v144, v16, v17
  v_cvt_pk_bf16_f32 v145, v18, v19
  v_mfma_f32_16x16x32_bf16 v[32:35], a[28:31], v[44:47], v[32:35]
  v_cvt_pk_bf16_f32 v146, v20, v21
  v_cvt_pk_bf16_f32 v147, v22, v23
  v_mfma_f32_16x16x32_bf16 v[36:39], a[36:39], v[44:47], v[36:39]
  v_cvt_pk_bf16_f32 v152, v24, v25
  ds_read_b128 v[44:47], v5 offset:10240
  s_waitcnt lgkmcnt(3)
  v_mfma_f32_16x16x32_bf16 v[28:31], a[40:43], v[48:51], v[28:31]
  v_cvt_pk_bf16_f32 v153, v26, v27
  v_mfma_f32_16x16x32_bf16 v[32:35], a[48:51], v[48:51], v[32:35]
  v_mfma_f32_16x16x32_bf16 v[36:39], a[56:59], v[48:51], v[36:39]
  ds_read_b128 v[48:51], v4 offset:14336
  s_waitcnt lgkmcnt(3)
  v_mfma_f32_16x16x32_bf16 v[28:31], a[44:47], v[52:55], v[28:31]
  v_mfma_f32_16x16x32_bf16 v[32:35], a[52:55], v[52:55], v[32:35]
  v_mfma_f32_16x16x32_bf16 v[36:39], a[60:63], v[52:55], v[36:39]
  ds_read_b128 v[52:55], v5 offset:14336
  s_waitcnt lgkmcnt(3)
  v_mfma_f32_16x16x32_bf16 v[28:31], a[64:67], v[40:43], v[28:31]
  v_mfma_f32_16x16x32_bf16 v[32:35], a[72:75], v[40:43], v[32:35]
  v_mfma_f32_16x16x32_bf16 v[36:39], a[80:83], v[40:43], v[36:39]
  ds_read_b128 v[40:43], v4 offset:18432
  s_waitcnt lgkmcnt(3)
  v_mfma_f32_16x16x32_bf16 v[28:31], a[68:71], v[44:47], v[28:31]
  v_mfma_f32_16x16x32_bf16 v[32:35], a[76:79], v[44:47], v[32:35]
  v_mfma_f32_16x16x32_bf16 v[36:39], a[84:87], v[44:47], v[36:39]
  ds_read_b128 v[44:47], v5 offset:18432
  s_waitcnt lgkmcnt(3)
  v_mfma_f32_16x16x32_bf16 v[28:31], a[88:91], v[48:51], v[28:31]
  v_mfma_f32_16x16x32_bf16 v[32:35], a[96:99], v[48:51], v[32:35]
  v_mfma_f32_16x16x32_bf16 v[36:39], a[104:107], v[48:51], v[36:39]
  ds_read_b128 v[48:51], v4 offset:22528
  s_waitcnt lgkmcnt(3)
  v_mfma_f32_16x16x32_bf16 v[28:31], a[92:95], v[52:55], v[28:31]
  v_mfma_f32_16x16x32_bf16 v[32:35], a[100:103], v[52:55], v[32:35]
  v_mfma_f32_16x16x32_bf16 v[36:39], a[108:111], v[52:55], v[36:39]
  ds_read_b128 v[52:55], v5 offset:22528
  s_waitcnt lgkmcnt(3)
  v_mfma_f32_16x16x32_bf16 v[28:31], a[112:115], v[40:43], v[28:31]
  v_mfma_f32_16x16x32_bf16 v[32:35], a[120:123], v[40:43], v[32:35]
  v_mfma_f32_16x16x32_bf16 v[36:39], a[128:131], v[40:43], v[36:39]
  ds_read_b128 v[40:43], v4 offset:26624
  s_waitcnt lgkmcnt(3)
  v_mfma_f32_16x16x32_bf16 v[28:31], a[116:119], v[44:47], v[28:31]
  v_mfma_f32_16x16x32_bf16 v[32:35], a[124:127], v[44:47], v[32:35]
  v_mfma_f32_16x16x32_bf16 v[36:39], a[132:135], v[44:47], v[36:39]
  ds_read_b128 v[44:47], v5 offset:26624
  s_waitcnt lgkmcnt(3)
  v_mfma_f32_16x16x32_bf16 v[28:31], a[136:139], v[48:51], v[28:31]
  v_mfma_f32_16x16x32_bf16 v[32:35], a[144:147], v[48:51], v[32:35]
  v_mfma_f32_16x16x32_bf16 v[36:39], a[152:155], v[48:51], v[36:39]
  ds_read_b128 v[48:51], v4 offset:30720
  s_waitcnt lgkmcnt(3)
  v_mfma_f32_16x16x32_bf16 v[28:31], a[140:143], v[52:55], v[28:31]
  v_mfma_f32_16x16x32_bf16 v[32:35], a[148:151], v[52:55], v[32:35]
  v_mfma_f32_16x16x32_bf16 v[36:39], a[156:159], v[52:55], v[36:39]
  ds_read_b128 v[52:55], v5 offset:30720
  s_waitcnt lgkmcnt(3)
  v_mfma_f32_16x16x32_bf16 v[28:31], a[160:163], v[40:43], v[28:31]
  v_mfma_f32_16x16x32_bf16 v[32:35], a[168:171], v[40:43], v[32:35]
  v_mfma_f32_16x16x32_bf16 v[36:39], a[176:179], v[40:43], v[36:39]
  ds_read_b128 v[40:43], v4 offset:34816
  s_waitcnt lgkmcnt(3)
  v_mfma_f32_16x16x32_bf16 v[28:31], a[164:167], v[44:47], v[28:31]
  v_mfma_f32_16x16x32_bf16 v[32:35], a[172:175], v[44:47], v[32:35]
  v_mfma_f32_16x16x32_bf16 v[36:39], a[180:183], v[44:47], v[36:39]
  ds_read_b128 v[44:47], v5 offset:34816
  s_waitcnt lgkmcnt(3)
  v_mfma_f32_16x16x32_bf16 v[28:31], a[184:187], v[48:51], v[28:31]
  v_mfma_f32_16x16x32_bf16 v[32:35], a[192:195], v[48:51], v[32:35]
  v_mfma_f32_16x16x32_bf16 v[36:39], a[200:203], v[48:51], v[36:39]
  ds_read_b128 v[48:51], v4 offset:38912
  s_waitcnt lgkmcnt(3)
  v_mfma_f32_16x16x32_bf16 v[28:31], a[188:191], v[52:55], v[28:31]
  v_mfma_f32_16x16x32_bf16 v[32:35], a[196:199], v[52:55], v[32:35]
  v_mfma_f32_16x16x32_bf16 v[36:39], a[204:207], v[52:55], v[36:39]
  ds_read_b128 v[52:55], v5 offset:38912
  s_waitcnt lgkmcnt(3)
  v_mfma_f32_16x16x32_bf16 v[28:31], a[208:211], v[40:43], v[28:31]
  v_add_u32 v4, s66, v2
  v_mfma_f32_16x16x32_bf16 v[32:35], a[216:219], v[40:43], v[32:35]
  v_add_u32 v5, s66, v3
  v_mfma_f32_16x16x32_bf16 v[36:39], a[224:227], v[40:43], v[36:39]
  s_waitcnt vmcnt(0) lgkmcnt(0)
  s_barrier
  ds_read_b128 v[40:43], v4 offset:0
  s_waitcnt lgkmcnt(3)
  v_mfma_f32_16x16x32_bf16 v[28:31], a[212:215], v[44:47], v[28:31]
  v_mfma_f32_16x16x32_bf16 v[32:35], a[220:223], v[44:47], v[32:35]
  v_mfma_f32_16x16x32_bf16 v[36:39], a[228:231], v[44:47], v[36:39]
  ds_read_b128 v[44:47], v5 offset:0
  s_waitcnt lgkmcnt(3)
  v_mfma_f32_16x16x32_bf16 v[28:31], a[232:235], v[48:51], v[28:31]
  v_mfma_f32_16x16x32_bf16 v[32:35], a[240:243], v[48:51], v[32:35]
  v_mfma_f32_16x16x32_bf16 v[36:39], a[248:251], v[48:51], v[36:39]
  ds_read_b128 v[48:51], v4 offset:4096
  s_waitcnt lgkmcnt(3)
  v_mfma_f32_16x16x32_bf16 v[28:31], a[236:239], v[52:55], v[28:31]
  v_mfma_f32_16x16x32_bf16 v[32:35], a[244:247], v[52:55], v[32:35]
  v_mfma_f32_16x16x32_bf16 v[36:39], a[252:255], v[52:55], v[36:39]
  s_add_u32 s4, s4, 1
  s_cmp_lt_u32 s4, 6
  s_cbranch_scc1 QC_PRO
  s_mov_b32 s59, 0x40000000
  v_mov_b32 v8, 0
QC_SEG:
  ds_read_b128 v[52:55], v5 offset:4096
  s_waitcnt lgkmcnt(3)
  v_mfma_f32_16x16x32_bf16 v[16:19], a[16:19], v[40:43], 0
  ds_read_b128 v[108:111], v12 offset:0
  v_mfma_f32_16x16x32_bf16 v[20:23], a[24:27], v[40:43], 0
  ds_read_b128 v[112:115], v13 offset:0
  v_mfma_f32_16x16x32_bf16 v[24:27], a[32:35], v[40:43], 0
  ds_read_b128 v[116:119], v12 offset:5120
  ds_read_b128 v[40:43], v4 offset:8192
  s_waitcnt lgkmcnt(6)
  v_mfma_f32_16x16x32_bf16 v[16:19], a[20:23], v[44:47], v[16:19]
  ds_read_b128 v[120:123], v13 offset:5120
  v_cvt_pk_bf16_f32 v148, v28, v29
  v_cvt_pk_bf16_f32 v149, v30, v31
  v_mfma_f32_16x16x32_bf16 v[20:23], a[28:31], v[44:47], v[20:23]
  ds_read_b128 v[124:127], v12 offset:10240
  v_cvt_pk_bf16_f32 v150, v32, v33
  v_cvt_pk_bf16_f32 v151, v34, v35
  v_mfma_f32_16x16x32_bf16 v[24:27], a[36:39], v[44:47], v[24:27]
  ds_read_b128 v[128:131], v13 offset:10240
  ds_read_b128 v[44:47], v5 offset:8192
  s_waitcnt lgkmcnt(9)
  v_mfma_f32_16x16x32_bf16 v[16:19], a[40:43], v[48:51], v[16:19]
  ds_read_b128 v[132:135], v12 offset:15360
  ds_read_b128 v[136:139], v13 offset:15360
  ds_write_b32 v159, v164
  v_cvt_pk_bf16_f32 v154, v36, v37
  v_cvt_pk_bf16_f32 v155, v38, v39
  v_mfma_f32_16x16x32_bf16 v[20:23], a[48:51], v[48:51], v[20:23]
  s_add_u32 s69, s52, 1
  s_mul_i32 s6, s52, 0x80000
  s_add_u32 s6, s6, 0x180000
  v_mov_b32 v157, v8
  v_mov_b32 v8, s52
  v_mfma_f32_16x16x32_bf16 v[24:27], a[56:59], v[48:51], v[24:27]
  s_add_u32 s6, s6, s62
  ds_read_b128 v[48:51], v4 offset:12288
  s_waitcnt lgkmcnt(12)
  v_mfma_f32_16x16x32_bf16 v[16:19], a[44:47], v[52:55], v[16:19]
  s_lshr_b32 s53, s6, 7
  s_and_b32 s53, s53, 0x2000
  s_xor_b32 s53, s53, s51
  v_mfma_f32_16x16x32_bf16 v[20:23], a[52:55], v[52:55], v[20:23]
  s_lshl_b32 s6, s6, 1
  s_or_b32 s6, s6, s53
  s_add_u32 s6, s6, s63
  v_mfma_f32_16x16x32_bf16 v[24:27], a[60:63], v[52:55], v[24:27]
  s_cmp_lt_u32 s67, s69
  s_cbranch_scc1 QC_KW
QC_KB:
  ds_read_b128 v[52:55], v5 offset:12288
  s_waitcnt lgkmcnt(9)
  v_mfma_f32_16x16x32_bf16 v[16:19], a[64:67], v[40:43], v[16:19]
  buffer_load_dwordx4 v[68:71], v6, s[32:35], s6 offen sc1
  buffer_load_dwordx4 v[72:75], v6, s[32:35], s6 offen offset:1024 sc1
  buffer_load_dwordx4 v[76:79], v6, s[32:35], s6 offen offset:2048 sc1
  v_mfma_f32_16x16x32_bf16 v[20:23], a[72:75], v[40:43], v[20:23]
  buffer_load_dword v156, v10, s[32:35], 0 offen sc1
  s_add_u32 s69, s69, 1
  s_and_b32 s89, s52, 15
  v_mfma_f32_16x16x32_bf16 v[24:27], a[80:83], v[40:43], v[24:27]
  s_mul_i32 s89, s89, 0x20000
  ds_read_b128 v[40:43], v4 offset:16384
  s_waitcnt lgkmcnt(6)
  v_mfma_f32_16x16x32_bf16 v[16:19], a[68:71], v[44:47], v[16:19]
  s_add_u32 s89, s89, 0x6400000
  s_add_u32 s89, s89, s70
  s_lshr_b32 s53, s89, 7
  v_mfma_f32_16x16x32_bf16 v[20:23], a[76:79], v[44:47], v[20:23]
  s_and_b32 s53, s53, 0x2000
  s_xor_b32 s53, s53, s50
  s_lshl_b32 s89, s89, 1
  v_mfma_f32_16x16x32_bf16 v[24:27], a[84:87], v[44:47], v[24:27]
  s_or_b32 s89, s89, s53
  ds_read_b128 v[44:47], v5 offset:16384
  s_waitcnt lgkmcnt(3)
  v_mfma_f32_16x16x32_bf16 v[16:19], a[88:91], v[48:51], v[16:19]
  s_add_u32 s89, s89, s88
  s_mov_b32 s58, 0
  s_and_b32 s55, s52, 3
  v_mfma_f32_16x16x32_bf16 v[20:23], a[96:99], v[48:51], v[20:23]
  s_mul_i32 s55, s55, 12288
  v_add_u32 v161, s55, v162
  ds_read_b128 v[56:59], v161 offset:0
  v_mfma_f32_16x16x32_bf16 v[24:27], a[104:107], v[48:51], v[24:27]
  ds_read_b128 v[60:63], v161 offset:1024
  ds_read_b128 v[48:51], v4 offset:20480
  s_waitcnt lgkmcnt(5)
  v_mfma_f32_16x16x32_bf16 v[16:19], a[92:95], v[52:55], v[16:19]
  ds_read_b128 v[64:67], v161 offset:2048
  v_add_f32 v108, v108, v116
  v_add_f32 v109, v109, v117
  v_mfma_f32_16x16x32_bf16 v[20:23], a[100:103], v[52:55], v[20:23]
  s_add_u32 s64, s64, 40960
  v_add_f32 v110, v110, v118
  v_add_f32 v111, v111, v119
  v_mfma_f32_16x16x32_bf16 v[24:27], a[108:111], v[52:55], v[24:27]
  s_xor_b32 s65, s65, 40960
  ds_read_b128 v[52:55], v5 offset:20480
  s_waitcnt lgkmcnt(6)
  v_mfma_f32_16x16x32_bf16 v[16:19], a[112:115], v[40:43], v[16:19]
  s_xor_b32 s66, s66, 40960
  v_add_f32 v112, v112, v120
  v_add_f32 v113, v113, v121
  v_mfma_f32_16x16x32_bf16 v[20:23], a[120:123], v[40:43], v[20:23]
  s_add_u32 m0, s65, 0
  v_add_f32 v114, v114, v122
  v_add_f32 v115, v115, v123
  v_mfma_f32_16x16x32_bf16 v[24:27], a[128:131], v[40:43], v[24:27]
  buffer_load_dwordx4 v1, s[44:47], s64 offen offset:0 lds
  ds_read_b128 v[40:43], v4 offset:24576
  s_waitcnt lgkmcnt(6)
  v_mfma_f32_16x16x32_bf16 v[16:19], a[116:119], v[44:47], v[16:19]
  v_add_f32 v108, v108, v124
  v_add_f32 v109, v109, v125
  v_mfma_f32_16x16x32_bf16 v[20:23], a[124:127], v[44:47], v[20:23]
  s_add_u32 m0, s65, 3968
  v_add_f32 v110, v110, v126
  v_add_f32 v111, v111, v127
  v_mfma_f32_16x16x32_bf16 v[24:27], a[132:135], v[44:47], v[24:27]
  buffer_load_dwordx4 v1, s[44:47], s64 offen offset:128 lds
  ds_read_b128 v[44:47], v5 offset:24576
  s_waitcnt lgkmcnt(4)
  v_mfma_f32_16x16x32_bf16 v[16:19], a[136:139], v[48:51], v[16:19]
  v_add_f32 v112, v112, v128
  v_add_f32 v113, v113, v129
  v_mfma_f32_16x16x32_bf16 v[20:23], a[144:147], v[48:51], v[20:23]
  s_add_u32 m0, s65, 7936
  v_add_f32 v114, v114, v130
  v_add_f32 v115, v115, v131
  v_mfma_f32_16x16x32_bf16 v[24:27], a[152:155], v[48:51], v[24:27]
  buffer_load_dwordx4 v1, s[44:47], s64 offen offset:256 lds
  ds_read_b128 v[48:51], v4 offset:28672
  s_waitcnt lgkmcnt(3)
  v_mfma_f32_16x16x32_bf16 v[16:19], a[140:143], v[52:55], v[16:19]
  v_add_f32 v108, v108, v132
  v_add_f32 v109, v109, v133
  v_mfma_f32_16x16x32_bf16 v[20:23], a[148:151], v[52:55], v[20:23]
  s_add_u32 m0, s65, 11904
  v_add_f32 v110, v110, v134
  v_add_f32 v111, v111, v135
  v_mfma_f32_16x16x32_bf16 v[24:27], a[156:159], v[52:55], v[24:27]
  buffer_load_dwordx4 v1, s[44:47], s64 offen offset:384 lds
  ds_read_b128 v[52:55], v5 offset:28672
  s_waitcnt lgkmcnt(3)
  v_mfma_f32_16x16x32_bf16 v[16:19], a[160:163], v[40:43], v[16:19]
  v_add_f32 v112, v112, v136
  v_add_f32 v113, v113, v137
  v_mfma_f32_16x16x32_bf16 v[20:23], a[168:171], v[40:43], v[20:23]
  s_add_u32 m0, s65, 15872
  v_add_f32 v114, v114, v138
  v_add_f32 v115, v115, v139
  v_mfma_f32_16x16x32_bf16 v[24:27], a[176:179], v[40:43], v[24:27]
  buffer_load_dwordx4 v1, s[44:47], s64 offen offset:512 lds
  ds_read_b128 v[40:43], v4 offset:32768
  s_waitcnt lgkmcnt(3)
  v_mfma_f32_16x16x32_bf16 v[16:19], a[164:167], v[44:47], v[16:19]
  v_cndmask_b32 v108, v14, v108, s[72:73]
  v_cndmask_b32 v109, v14, v109, s[74:75]
  v_mfma_f32_16x16x32_bf16 v[20:23], a[172:175], v[44:47], v[20:23]
  s_add_u32 m0, s65, 19840
  v_cndmask_b32 v110, v14, v110, s[76:77]
  v_cndmask_b32 v111, v14, v111, s[78:79]
  v_mfma_f32_16x16x32_bf16 v[24:27], a[180:183], v[44:47], v[24:27]
  buffer_load_dwordx4 v1, s[44:47], s64 offen offset:640 lds
  ds_read_b128 v[44:47], v5 offset:32768
  s_waitcnt lgkmcnt(3)
  v_mfma_f32_16x16x32_bf16 v[16:19], a[184:187], v[48:51], v[16:19]
  v_cndmask_b32 v112, v14, v112, s[80:81]
  v_cndmask_b32 v113, v14, v113, s[82:83]
  v_mfma_f32_16x16x32_bf16 v[20:23], a[192:195], v[48:51], v[20:23]
  s_add_u32 m0, s65, 23808
  v_cndmask_b32 v114, v14, v114, s[84:85]
  v_cndmask_b32 v115, v14, v115, s[86:87]
  v_mfma_f32_16x16x32_bf16 v[24:27], a[200:203], v[48:51], v[24:27]
  buffer_load_dwordx4 v1, s[44:47], s64 offen offset:768 lds
  ds_read_b128 v[48:51], v4 offset:36864
  s_waitcnt lgkmcnt(3)
  v_mfma_f32_16x16x32_bf16 v[16:19], a[188:191], v[52:55], v[16:19]
  v_max3_f32 v116, v108, v109, v110
  v_max3_f32 v116, v116, v111, v112
  v_mfma_f32_16x16x32_bf16 v[20:23], a[196:199], v[52:55], v[20:23]
  s_waitcnt vmcnt(7)
  v_max3_f32 v116, v116, v113, v114
  v_max_f32 v116, v116, v115
  v_mfma_f32_16x16x32_bf16 v[24:27], a[204:207], v[52:55], v[24:27]
  v_cmp_gt_u32 vcc, s69, v156
  ds_read_b128 v[52:55], v5 offset:36864
  s_waitcnt lgkmcnt(3)
  v_mfma_f32_16x16x32_bf16 v[16:19], a[208:211], v[40:43], v[16:19]
  s_barrier
  v_max_f32_dpp v116, v116, v116 row_ror:8 row_mask:0xf bank_mask:0xf
  v_mov_b32 v117, v116
  v_mfma_f32_16x16x32_bf16 v[20:23], a[216:219], v[40:43], v[20:23]
  s_cbranch_vccnz QC_NOKM
  buffer_load_dwordx4 v[80:83], v6, s[32:35], s89 offen offset:128 sc1
  buffer_load_dwordx2 v[84:85], v6, s[32:35], s89 offen sc1
  s_mov_b32 s58, 1
QC_NOKM:
  v_permlane16_swap_b32 v116, v117
  v_mfma_f32_16x16x32_bf16 v[24:27], a[224:227], v[40:43], v[24:27]
  s_add_u32 m0, s65, 27776
  ds_read_b128 v[40:43], v4 offset:2048
  s_waitcnt lgkmcnt(3)
  v_mfma_f32_16x16x32_bf16 v[16:19], a[212:215], v[44:47], v[16:19]
  buffer_load_dwordx4 v1, s[44:47], s64 offen offset:896 lds
  v_max_f32 v116, v116, v117
  v_mov_b32 v117, v116
  v_mfma_f32_16x16x32_bf16 v[20:23], a[220:223], v[44:47], v[20:23]
  s_nop 0
  v_permlane32_swap_b32 v116, v117
  v_mfma_f32_16x16x32_bf16 v[24:27], a[228:231], v[44:47], v[24:27]
  s_add_u32 m0, s65, 31744
  ds_read_b128 v[44:47], v5 offset:2048
  s_waitcnt lgkmcnt(3)
  v_mfma_f32_16x16x32_bf16 v[16:19], a[232:235], v[48:51], v[16:19]
  buffer_load_dwordx4 v1, s[44:47], s64 offen offset:1024 lds
  v_max_f32 v116, v116, v117
  v_mul_f32 v116, s71, v116
  v_mfma_f32_16x16x32_bf16 v[20:23], a[240:243], v[48:51], v[20:23]
  v_fma_f32 v108, v108, s71, -v116
  v_fma_f32 v109, v109, s71, -v116
  v_mfma_f32_16x16x32_bf16 v[24:27], a[248:251], v[48:51], v[24:27]
  s_add_u32 m0, s65, 35712
  ds_read_b128 v[48:51], v4 offset:6144
  s_waitcnt lgkmcnt(3)
  v_mfma_f32_16x16x32_bf16 v[16:19], a[236:239], v[52:55], v[16:19]
  buffer_load_dwordx4 v1, s[44:47], s64 offen offset:1152 lds
  v_fma_f32 v110, v110, s71, -v116
  v_fma_f32 v111, v111, s71, -v116
  v_mfma_f32_16x16x32_bf16 v[20:23], a[244:247], v[52:55], v[20:23]
  v_fma_f32 v112, v112, s71, -v116
  v_fma_f32 v113, v113, s71, -v116
  v_mfma_f32_16x16x32_bf16 v[24:27], a[252:255], v[52:55], v[24:27]
  buffer_store_dword v157, v7, s[32:35], 0 offen sc1
  ds_read_b128 v[52:55], v5 offset:6144
  s_waitcnt lgkmcnt(3)
  v_mfma_f32_16x16x32_bf16 v[28:31], a[16:19], v[40:43], 0
  v_mfma_f32_16x16x32_bf16 v[88:91], v[68:71], v[56:59], 0
  v_mfma_f32_16x16x32_bf16 v[92:95], v[68:71], v[60:63], 0
  v_mfma_f32_16x16x32_bf16 v[96:99], v[72:75], v[60:63], 0
  v_mfma_f32_16x16x16_bf16 v[88:91], v[76:77], v[64:65], v[88:91]
  v_mfma_f32_16x16x16_bf16 v[92:95], v[76:77], v[66:67], v[92:95]
  v_mfma_f32_16x16x16_bf16 v[96:99], v[78:79], v[66:67], v[96:99]
  v_fma_f32 v114, v114, s71, -v116
  v_fma_f32 v115, v115, s71, -v116
  v_mfma_f32_16x16x32_bf16 v[32:35], a[24:27], v[40:43], 0
  s_and_b32 s55, s4, 3
  v_exp_f32 v108, v108
  v_mfma_f32_16x16x32_bf16 v[36:39], a[32:35], v[40:43], 0
  s_mul_i32 s55, s55, 12288
  ds_read_b128 v[40:43], v4 offset:10240
  s_waitcnt lgkmcnt(3)
  v_mfma_f32_16x16x32_bf16 v[28:31], a[20:23], v[44:47], v[28:31]
  v_add_u32 v160, s55, v162
  v_exp_f32 v109, v109
  v_mfma_f32_16x16x32_bf16 v[32:35], a[28:31], v[44:47], v[32:35]
  ds_write_b128 v160, v[144:147] offset:0
  v_exp_f32 v110, v110
  v_mfma_f32_16x16x32_bf16 v[36:39], a[36:39], v[44:47], v[36:39]
  v_exp_f32 v111, v111
  ds_read_b128 v[44:47], v5 offset:10240
  s_waitcnt lgkmcnt(4)
  v_mfma_f32_16x16x32_bf16 v[28:31], a[40:43], v[48:51], v[28:31]
  v_exp_f32 v112, v112
  v_mfma_f32_16x16x32_bf16 v[32:35], a[48:51], v[48:51], v[32:35]
  ds_write_b128 v160, v[148:151] offset:1024
  v_exp_f32 v113, v113
  v_mfma_f32_16x16x32_bf16 v[36:39], a[56:59], v[48:51], v[36:39]
  v_exp_f32 v114, v114
  ds_read_b128 v[48:51], v4 offset:14336
  s_waitcnt lgkmcnt(5)
  v_mfma_f32_16x16x32_bf16 v[28:31], a[44:47], v[52:55], v[28:31]
  v_exp_f32 v115, v115
  v_mfma_f32_16x16x32_bf16 v[32:35], a[52:55], v[52:55], v[32:35]
  ds_write_b128 v160, v[152:155] offset:2048
  v_add_f32 v116, v108, v109
  v_add_f32 v116, v116, v110
  v_mfma_f32_16x16x32_bf16 v[36:39], a[60:63], v[52:55], v[36:39]
  v_add_f32 v116, v116, v111
  ds_read_b128 v[52:55], v5 offset:14336
  s_waitcnt lgkmcnt(6)
  v_mfma_f32_16x16x32_bf16 v[28:31], a[64:67], v[40:43], v[28:31]
  v_add_f32 v116, v116, v112
  v_add_f32 v116, v116, v113
  v_mfma_f32_16x16x32_bf16 v[32:35], a[72:75], v[40:43], v[32:35]
  ds_write_b128 v11, v[88:91] offset:0
  v_add_f32 v116, v116, v114
  v_add_f32 v116, v116, v115
  v_mfma_f32_16x16x32_bf16 v[36:39], a[80:83], v[40:43], v[36:39]
  s_nop 0
  v_add_f32_dpp v116, v116, v116 row_ror:8 row_mask:0xf bank_mask:0xf
  ds_read_b128 v[40:43], v4 offset:18432
  s_waitcnt lgkmcnt(6)
  v_mfma_f32_16x16x32_bf16 v[28:31], a[68:71], v[44:47], v[28:31]
  v_mov_b32 v117, v116
  s_nop 1
  v_permlane16_swap_b32 v116, v117
  v_mfma_f32_16x16x32_bf16 v[32:35], a[76:79], v[44:47], v[32:35]
  ds_write_b128 v11, v[92:95] offset:1024
  v_add_f32 v116, v116, v117
  v_mov_b32 v117, v116
  v_mfma_f32_16x16x32_bf16 v[36:39], a[84:87], v[44:47], v[36:39]
  s_nop 0
  v_permlane32_swap_b32 v116, v117
  ds_read_b128 v[44:47], v5 offset:18432
  s_waitcnt lgkmcnt(6)
  v_mfma_f32_16x16x32_bf16 v[28:31], a[88:91], v[48:51], v[28:31]
  v_add_f32 v116, v116, v117
  v_rcp_f32 v116, v116
  v_mfma_f32_16x16x32_bf16 v[32:35], a[96:99], v[48:51], v[32:35]
  ds_write_b128 v11, v[96:99] offset:2048
  v_mul_f32 v108, v108, v116
  v_mul_f32 v109, v109, v116
  v_mfma_f32_16x16x32_bf16 v[36:39], a[104:107], v[48:51], v[36:39]
  ds_read_b128 v[48:51], v4 offset:22528
  s_waitcnt lgkmcnt(6)
  v_mfma_f32_16x16x32_bf16 v[28:31], a[92:95], v[52:55], v[28:31]
  v_mul_f32 v110, v110, v116
  v_mul_f32 v111, v111, v116
  v_mfma_f32_16x16x32_bf16 v[32:35], a[100:103], v[52:55], v[32:35]
  v_mul_f32 v112, v112, v116
  v_mul_f32 v113, v113, v116
  v_mfma_f32_16x16x32_bf16 v[36:39], a[108:111], v[52:55], v[36:39]
  v_mul_f32 v114, v114, v116
  ds_read_b128 v[52:55], v5 offset:22528
  s_waitcnt lgkmcnt(5)
  v_mfma_f32_16x16x32_bf16 v[28:31], a[112:115], v[40:43], v[28:31]
  v_mul_f32 v115, v115, v116
  v_cvt_pk_bf16_f32 v120, v108, v109
  v_mfma_f32_16x16x32_bf16 v[32:35], a[120:123], v[40:43], v[32:35]
  v_cvt_pk_bf16_f32 v121, v110, v111
  v_cvt_pk_bf16_f32 v122, v112, v113
  v_mfma_f32_16x16x32_bf16 v[36:39], a[128:131], v[40:43], v[36:39]
  v_cvt_pk_bf16_f32 v123, v114, v115
  ds_read_b128 v[40:43], v4 offset:26624
  s_waitcnt lgkmcnt(4)
  v_mfma_f32_16x16x32_bf16 v[28:31], a[116:119], v[44:47], v[28:31]
  buffer_store_dwordx4 v[120:123], v15, s[32:35], s59 offen sc1
  s_cmp_eq_u32 s58, 0
  s_cbranch_scc1 QC_WAIT
  s_waitcnt vmcnt(2)
QC_HAVE:
  v_mfma_f32_16x16x32_bf16 v[100:103], v[80:83], v[56:59], 0
  v_mfma_f32_16x16x32_bf16 v[104:107], v[80:83], v[60:63], 0
  v_mfma_f32_16x16x16_bf16 v[100:103], v[84:85], v[64:65], v[100:103]
  v_mfma_f32_16x16x16_bf16 v[104:107], v[84:85], v[66:67], v[104:107]
  v_mfma_f32_16x16x32_bf16 v[32:35], a[124:127], v[44:47], v[32:35]
  v_cvt_pk_bf16_f32 v144, v16, v17
  v_cvt_pk_bf16_f32 v145, v18, v19
  v_mfma_f32_16x16x32_bf16 v[36:39], a[132:135], v[44:47], v[36:39]
  v_cvt_pk_bf16_f32 v146, v20, v21
  ds_read_b128 v[44:47], v5 offset:26624
  s_waitcnt lgkmcnt(3)
  v_mfma_f32_16x16x32_bf16 v[28:31], a[136:139], v[48:51], v[28:31]
  v_cvt_pk_bf16_f32 v147, v22, v23
  v_cvt_pk_bf16_f32 v152, v24, v25
  v_mfma_f32_16x16x32_bf16 v[32:35], a[144:147], v[48:51], v[32:35]
  v_cvt_pk_bf16_f32 v153, v26, v27
  ds_write_b128 v11, v[100:103] offset:3072
  v_mfma_f32_16x16x32_bf16 v[36:39], a[152:155], v[48:51], v[36:39]
  s_and_b32 s59, s52, 15
  ds_read_b128 v[48:51], v4 offset:30720
  s_waitcnt lgkmcnt(4)
  v_mfma_f32_16x16x32_bf16 v[28:31], a[140:143], v[52:55], v[28:31]
  s_mul_i32 s59, s59, 0x20000
  s_add_u32 s59, s59, 0x7800000
  v_mfma_f32_16x16x32_bf16 v[32:35], a[148:151], v[52:55], v[32:35]
  s_lshr_b32 s53, s59, 7
  s_and_b32 s53, s53, 0x2000
  v_mfma_f32_16x16x32_bf16 v[36:39], a[156:159], v[52:55], v[36:39]
  s_xor_b32 s53, s53, s50
  ds_read_b128 v[52:55], v5 offset:30720
  s_waitcnt lgkmcnt(4)
  v_mfma_f32_16x16x32_bf16 v[28:31], a[160:163], v[40:43], v[28:31]
  s_lshl_b32 s59, s59, 1
  s_or_b32 s59, s59, s53
  v_mfma_f32_16x16x32_bf16 v[32:35], a[168:171], v[40:43], v[32:35]
  ds_write_b128 v11, v[104:107] offset:4096
  v_mfma_f32_16x16x32_bf16 v[36:39], a[176:179], v[40:43], v[36:39]
  ds_read_b128 v[40:43], v4 offset:34816
  s_waitcnt lgkmcnt(5)
  v_mfma_f32_16x16x32_bf16 v[28:31], a[164:167], v[44:47], v[28:31]
  v_mfma_f32_16x16x32_bf16 v[32:35], a[172:175], v[44:47], v[32:35]
  v_mfma_f32_16x16x32_bf16 v[36:39], a[180:183], v[44:47], v[36:39]
  ds_read_b128 v[44:47], v5 offset:34816
  s_waitcnt lgkmcnt(4)
  v_mfma_f32_16x16x32_bf16 v[28:31], a[184:187], v[48:51], v[28:31]
  v_mfma_f32_16x16x32_bf16 v[32:35], a[192:195], v[48:51], v[32:35]
  v_mfma_f32_16x16x32_bf16 v[36:39], a[200:203], v[48:51], v[36:39]
  ds_read_b128 v[48:51], v4 offset:38912
  s_waitcnt lgkmcnt(4)
  v_mfma_f32_16x16x32_bf16 v[28:31], a[188:191], v[52:55], v[28:31]
  v_mfma_f32_16x16x32_bf16 v[32:35], a[196:199], v[52:55], v[32:35]
  v_mfma_f32_16x16x32_bf16 v[36:39], a[204:207], v[52:55], v[36:39]
  ds_read_b128 v[52:55], v5 offset:38912
  s_waitcnt lgkmcnt(3)
  v_mfma_f32_16x16x32_bf16 v[28:31], a[208:211], v[40:43], v[28:31]
  v_add_u32 v4, s66, v2
  v_mfma_f32_16x16x32_bf16 v[32:35], a[216:219], v[40:43], v[32:35]
  v_add_u32 v5, s66, v3
  v_mfma_f32_16x16x32_bf16 v[36:39], a[224:227], v[40:43], v[36:39]
  s_waitcnt lgkmcnt(0)
  s_barrier
  ds_read_b128 v[40:43], v4 offset:0
  s_waitcnt lgkmcnt(3)
  v_mfma_f32_16x16x32_bf16 v[28:31], a[212:215], v[44:47], v[28:31]
  v_mfma_f32_16x16x32_bf16 v[32:35], a[220:223], v[44:47], v[32:35]
  v_mfma_f32_16x16x32_bf16 v[36:39], a[228:231], v[44:47], v[36:39]
  ds_read_b128 v[44:47], v5 offset:0
  s_waitcnt lgkmcnt(3)
  v_mfma_f32_16x16x32_bf16 v[28:31], a[232:235], v[48:51], v[28:31]
  v_mfma_f32_16x16x32_bf16 v[32:35], a[240:243], v[48:51], v[32:35]
  v_mfma_f32_16x16x32_bf16 v[36:39], a[248:251], v[48:51], v[36:39]
  ds_read_b128 v[48:51], v4 offset:4096
  s_waitcnt lgkmcnt(3)
  v_mfma_f32_16x16x32_bf16 v[28:31], a[236:239], v[52:55], v[28:31]
  v_mfma_f32_16x16x32_bf16 v[32:35], a[244:247], v[52:55], v[32:35]
  v_mfma_f32_16x16x32_bf16 v[36:39], a[252:255], v[52:55], v[36:39]
  s_add_u32 s4, s4, 1
  s_add_u32 s52, s52, 1
  s_cmp_lt_u32 s52, 61
  s_cbranch_scc1 QC_SEG
  s_and_b32 s55, s4, 3
  s_mul_i32 s55, s55, 12288
  v_add_u32 v160, s55, v162
  s_nop 4
  v_cvt_pk_bf16_f32 v148, v28, v29
  v_cvt_pk_bf16_f32 v149, v30, v31
  v_cvt_pk_bf16_f32 v150, v32, v33
  v_cvt_pk_bf16_f32 v151, v34, v35
  v_cvt_pk_bf16_f32 v154, v36, v37
  v_cvt_pk_bf16_f32 v155, v38, v39
  ds_write_b128 v160, v[144:147] offset:0
  ds_write_b128 v160, v[148:151] offset:1024
  ds_write_b128 v160, v[152:155] offset:2048
  s_waitcnt lgkmcnt(0)
QC_LAST:
  ds_read_b128 v[108:111], v12 offset:0
  ds_read_b128 v[112:115], v13 offset:0
  ds_read_b128 v[116:119], v12 offset:5120
  ds_read_b128 v[120:123], v13 offset:5120
  ds_read_b128 v[124:127], v12 offset:10240
  ds_read_b128 v[128:131], v13 offset:10240
  ds_read_b128 v[132:135], v12 offset:15360
  ds_read_b128 v[136:139], v13 offset:15360
  s_add_u32 s69, s52, 1
  s_mul_i32 s6, s52, 0x80000
  s_add_u32 s6, s6, 0x180000
  s_add_u32 s6, s6, s62
  s_lshr_b32 s53, s6, 7
  s_and_b32 s53, s53, 0x2000
  s_xor_b32 s53, s53, s51
  s_lshl_b32 s6, s6, 1
  s_or_b32 s6, s6, s53
  s_add_u32 s6, s6, s63
  s_cmp_ge_u32 s67, s69
  s_cbranch_scc1 WPD_109
  s_mov_b32 s57, 0
  s_mov_b32 exec_lo, 0x1
  s_mov_b32 exec_hi, 0
WPL_110:
  buffer_load_dword v140, v9, s[32:35], 0 offen sc1
  s_add_u32 s57, s57, 1
  s_cmp_gt_u32 s57, 0x80000
  s_cbranch_scc1 L_EXIT
  s_waitcnt vmcnt(0)
  v_cmp_gt_u32 vcc, s69, v140
  s_cbranch_vccnz WPL_110
  s_mov_b32 s67, s69
  s_add_u32 s53, s69, 2
  s_min_u32 s53, s53, 64
  v_cmp_gt_u32 vcc, s53, v140
  s_nop 0
  s_cmp_eq_u64 vcc, 0
  s_cselect_b32 s67, s53, s67
  s_add_u32 s53, s69, 6
  s_min_u32 s53, s53, 64
  v_cmp_gt_u32 vcc, s53, v140
  s_nop 0
  s_cmp_eq_u64 vcc, 0
  s_cselect_b32 s67, s53, s67
  s_add_u32 s53, s69, 16
  s_min_u32 s53, s53, 64
  v_cmp_gt_u32 vcc, s53, v140
  s_nop 0
  s_cmp_eq_u64 vcc, 0
  s_cselect_b32 s67, s53, s67
  s_mov_b64 exec, -1
WPD_109:
  buffer_load_dwordx4 v[68:71], v6, s[32:35], s6 offen sc1
  buffer_load_dwordx4 v[72:75], v6, s[32:35], s6 offen offset:1024 sc1
  buffer_load_dwordx4 v[76:79], v6, s[32:35], s6 offen offset:2048 sc1
  buffer_load_dword v156, v10, s[32:35], 0 offen sc1
  s_add_u32 s69, s69, 1
  s_and_b32 s89, s52, 15
  s_mul_i32 s89, s89, 0x20000
  s_add_u32 s89, s89, 0x6400000
  s_add_u32 s89, s89, s70
  s_lshr_b32 s53, s89, 7
  s_and_b32 s53, s53, 0x2000
  s_xor_b32 s53, s53, s50
  s_lshl_b32 s89, s89, 1
  s_or_b32 s89, s89, s53
  s_add_u32 s89, s89, s88
  s_mov_b32 s58, 0
  v_mov_b32 v157, v8
  v_mov_b32 v8, s52
  s_and_b32 s55, s52, 3
  s_mul_i32 s55, s55, 12288
  v_add_u32 v161, s55, v162
  ds_read_b128 v[56:59], v161 offset:0
  ds_read_b128 v[60:63], v161 offset:1024
  ds_read_b128 v[64:67], v161 offset:2048
  s_waitcnt lgkmcnt(0)
  v_add_f32 v108, v108, v116
  v_add_f32 v109, v109, v117
  v_add_f32 v110, v110, v118
  v_add_f32 v111, v111, v119
  v_add_f32 v112, v112, v120
  v_add_f32 v113, v113, v121
  v_add_f32 v114, v114, v122
  v_add_f32 v115, v115, v123
  v_add_f32 v108, v108, v124
  v_add_f32 v109, v109, v125
  v_add_f32 v110, v110, v126
  v_add_f32 v111, v111, v127
  v_add_f32 v112, v112, v128
  v_add_f32 v113, v113, v129
  v_add_f32 v114, v114, v130
  v_add_f32 v115, v115, v131
  v_add_f32 v108, v108, v132
  v_add_f32 v109, v109, v133
  v_add_f32 v110, v110, v134
  v_add_f32 v111, v111, v135
  v_add_f32 v112, v112, v136
  v_add_f32 v113, v113, v137
  v_add_f32 v114, v114, v138
  v_add_f32 v115, v115, v139
  v_cndmask_b32 v108, v14, v108, s[72:73]
  v_cndmask_b32 v109, v14, v109, s[74:75]
  v_cndmask_b32 v110, v14, v110, s[76:77]
  v_cndmask_b32 v111, v14, v111, s[78:79]
  v_cndmask_b32 v112, v14, v112, s[80:81]
  v_cndmask_b32 v113, v14, v113, s[82:83]
  v_cndmask_b32 v114, v14, v114, s[84:85]
  v_cndmask_b32 v115, v14, v115, s[86:87]
  v_max3_f32 v116, v108, v109, v110
  v_max3_f32 v116, v116, v111, v112
  v_max3_f32 v116, v116, v113, v114
  v_max_f32 v116, v116, v115
  s_nop 1
  v_max_f32_dpp v116, v116, v116 row_ror:8 row_mask:0xf bank_mask:0xf
  v_mov_b32 v117, v116
  s_nop 1
  v_permlane16_swap_b32 v116, v117
  v_max_f32 v116, v116, v117
  v_mov_b32 v117, v116
  s_nop 1
  v_permlane32_swap_b32 v116, v117
  v_max_f32 v116, v116, v117
  v_mul_f32 v116, s71, v116
  v_fma_f32 v108, v108, s71, -v116
  v_fma_f32 v109, v109, s71, -v116
  v_fma_f32 v110, v110, s71, -v116
  v_fma_f32 v111, v111, s71, -v116
  v_fma_f32 v112, v112, s71, -v116
  v_fma_f32 v113, v113, s71, -v116
  v_fma_f32 v114, v114, s71, -v116
  v_fma_f32 v115, v115, s71, -v116
  v_exp_f32 v108, v108
  v_exp_f32 v109, v109
  v_exp_f32 v110, v110
  v_exp_f32 v111, v111
  v_exp_f32 v112, v112
  v_exp_f32 v113, v113
  v_exp_f32 v114, v114
  v_exp_f32 v115, v115
  v_add_f32 v116, v108, v109
  v_add_f32 v116, v116, v110
  v_add_f32 v116, v116, v111
  v_add_f32 v116, v116, v112
  v_add_f32 v116, v116, v113
  v_add_f32 v116, v116, v114
  v_add_f32 v116, v116, v115
  s_nop 1
  v_add_f32_dpp v116, v116, v116 row_ror:8 row_mask:0xf bank_mask:0xf
  v_mov_b32 v117, v116
  s_nop 1
  v_permlane16_swap_b32 v116, v117
  v_add_f32 v116, v116, v117
  v_mov_b32 v117, v116
  s_nop 1
  v_permlane32_swap_b32 v116, v117
  v_add_f32 v116, v116, v117
  v_rcp_f32 v116, v116
  s_nop 0
  v_mul_f32 v108, v108, v116
  v_mul_f32 v109, v109, v116
  v_mul_f32 v110, v110, v116
  v_mul_f32 v111, v111, v116
  v_mul_f32 v112, v112, v116
  v_mul_f32 v113, v113, v116
  v_mul_f32 v114, v114, v116
  v_mul_f32 v115, v115, v116
  v_cvt_pk_bf16_f32 v120, v108, v109
  v_cvt_pk_bf16_f32 v121, v110, v111
  v_cvt_pk_bf16_f32 v122, v112, v113
  v_cvt_pk_bf16_f32 v123, v114, v115
  s_waitcnt vmcnt(0)
  v_readfirstlane_b32 s68, v156
  s_barrier
  s_cmp_lt_u32 s68, s69
  s_cbranch_scc1 QC_L1
  buffer_load_dwordx4 v[80:83], v6, s[32:35], s89 offen offset:128 sc1
  buffer_load_dwordx2 v[84:85], v6, s[32:35], s89 offen sc1
QC_L1:
  buffer_store_dword v157, v7, s[32:35], 0 offen sc1
  v_mfma_f32_16x16x32_bf16 v[88:91], v[68:71], v[56:59], 0
  v_mfma_f32_16x16x32_bf16 v[92:95], v[68:71], v[60:63], 0
  v_mfma_f32_16x16x32_bf16 v[96:99], v[72:75], v[60:63], 0
  v_mfma_f32_16x16x16_bf16 v[88:91], v[76:77], v[64:65], v[88:91]
  v_mfma_f32_16x16x16_bf16 v[92:95], v[76:77], v[66:67], v[92:95]
  v_mfma_f32_16x16x16_bf16 v[96:99], v[78:79], v[66:67], v[96:99]
  s_nop 0
  ds_write_b128 v11, v[88:91] offset:0
  s_nop 2
  ds_write_b128 v11, v[92:95] offset:1024
  s_nop 1
  ds_write_b128 v11, v[96:99] offset:2048
  s_cmp_ge_u32 s68, s69
  s_cbranch_scc1 QC_L2
  s_cmp_ge_u32 s68, s69
  s_cbranch_scc1 WPD_111
  s_mov_b32 s57, 0
  s_mov_b32 exec_lo, 0x1
  s_mov_b32 exec_hi, 0
WPL_112:
  buffer_load_dword v140, v10, s[32:35], 0 offen sc1
  s_add_u32 s57, s57, 1
  s_cmp_gt_u32 s57, 0x80000
  s_cbranch_scc1 L_EXIT
  s_waitcnt vmcnt(0)
  v_cmp_gt_u32 vcc, s69, v140
  s_cbranch_vccnz WPL_112
  s_mov_b32 s68, s69
  s_add_u32 s53, s69, 2
  s_min_u32 s53, s53, 64
  v_cmp_gt_u32 vcc, s53, v140
  s_nop 0
  s_cmp_eq_u64 vcc, 0
  s_cselect_b32 s68, s53, s68
  s_add_u32 s53, s69, 6
  s_min_u32 s53, s53, 64
  v_cmp_gt_u32 vcc, s53, v140
  s_nop 0
  s_cmp_eq_u64 vcc, 0
  s_cselect_b32 s68, s53, s68
  s_add_u32 s53, s69, 16
  s_min_u32 s53, s53, 64
  v_cmp_gt_u32 vcc, s53, v140
  s_nop 0
  s_cmp_eq_u64 vcc, 0
  s_cselect_b32 s68, s53, s68
  s_mov_b64 exec, -1
WPD_111:
  buffer_load_dwordx4 v[80:83], v6, s[32:35], s89 offen offset:128 sc1
  buffer_load_dwordx2 v[84:85], v6, s[32:35], s89 offen sc1
  buffer_store_dwordx4 v[120:123], v15, s[32:35], s59 offen sc1
  s_waitcnt vmcnt(1)
  s_branch QC_L3
QC_L2:
  buffer_store_dwordx4 v[120:123], v15, s[32:35], s59 offen sc1
  s_waitcnt vmcnt(2)
QC_L3:
  v_mfma_f32_16x16x32_bf16 v[100:103], v[80:83], v[56:59], 0
  v_mfma_f32_16x16x32_bf16 v[104:107], v[80:83], v[60:63], 0
  v_mfma_f32_16x16x16_bf16 v[100:103], v[84:85], v[64:65], v[100:103]
  v_mfma_f32_16x16x16_bf16 v[104:107], v[84:85], v[66:67], v[104:107]
  s_and_b32 s59, s52, 15
  s_mul_i32 s59, s59, 0x20000
  s_add_u32 s59, s59, 0x7800000
  s_lshr_b32 s53, s59, 7
  s_and_b32 s53, s53, 0x2000
  s_xor_b32 s53, s53, s50
  s_lshl_b32 s59, s59, 1
  s_or_b32 s59, s59, s53
  ds_write_b128 v11, v[100:103] offset:3072
  ds_write_b128 v11, v[104:107] offset:4096
  s_waitcnt lgkmcnt(0)
  s_barrier
  s_add_u32 s52, s52, 1
  s_cmp_lt_u32 s52, 64
  s_cbranch_scc1 QC_LAST
  ds_read_b128 v[108:111], v12 offset:0
  ds_read_b128 v[112:115], v13 offset:0
  ds_read_b128 v[116:119], v12 offset:5120
  ds_read_b128 v[120:123], v13 offset:5120
  ds_read_b128 v[124:127], v12 offset:10240
  ds_read_b128 v[128:131], v13 offset:10240
  ds_read_b128 v[132:135], v12 offset:15360
  ds_read_b128 v[136:139], v13 offset:15360
  v_mov_b32 v8, s52
  s_waitcnt lgkmcnt(0)
  v_add_f32 v108, v108, v116
  v_add_f32 v109, v109, v117
  v_add_f32 v110, v110, v118
  v_add_f32 v111, v111, v119
  v_add_f32 v112, v112, v120
  v_add_f32 v113, v113, v121
  v_add_f32 v114, v114, v122
  v_add_f32 v115, v115, v123
  v_add_f32 v108, v108, v124
  v_add_f32 v109, v109, v125
  v_add_f32 v110, v110, v126
  v_add_f32 v111, v111, v127
  v_add_f32 v112, v112, v128
  v_add_f32 v113, v113, v129
  v_add_f32 v114, v114, v130
  v_add_f32 v115, v115, v131
  v_add_f32 v108, v108, v132
  v_add_f32 v109, v109, v133
  v_add_f32 v110, v110, v134
  v_add_f32 v111, v111, v135
  v_add_f32 v112, v112, v136
  v_add_f32 v113, v113, v137
  v_add_f32 v114, v114, v138
  v_add_f32 v115, v115, v139
  v_cndmask_b32 v108, v14, v108, s[72:73]
  v_cndmask_b32 v109, v14, v109, s[74:75]
  v_cndmask_b32 v110, v14, v110, s[76:77]
  v_cndmask_b32 v111, v14, v111, s[78:79]
  v_cndmask_b32 v112, v14, v112, s[80:81]
  v_cndmask_b32 v113, v14, v113, s[82:83]
  v_cndmask_b32 v114, v14, v114, s[84:85]
  v_cndmask_b32 v115, v14, v115, s[86:87]
  v_max3_f32 v116, v108, v109, v110
  v_max3_f32 v116, v116, v111, v112
  v_max3_f32 v116, v116, v113, v114
  v_max_f32 v116, v116, v115
  s_nop 1
  v_max_f32_dpp v116, v116, v116 row_ror:8 row_mask:0xf bank_mask:0xf
  v_mov_b32 v117, v116
  s_nop 1
  v_permlane16_swap_b32 v116, v117
  v_max_f32 v116, v116, v117
  v_mov_b32 v117, v116
  s_nop 1
  v_permlane32_swap_b32 v116, v117
  v_max_f32 v116, v116, v117
  v_mul_f32 v116, s71, v116
  v_fma_f32 v108, v108, s71, -v116
  v_fma_f32 v109, v109, s71, -v116
  v_fma_f32 v110, v110, s71, -v116
  v_fma_f32 v111, v111, s71, -v116
  v_fma_f32 v112, v112, s71, -v116
  v_fma_f32 v113, v113, s71, -v116
  v_fma_f32 v114, v114, s71, -v116
  v_fma_f32 v115, v115, s71, -v116
  v_exp_f32 v108, v108
  v_exp_f32 v109, v109
  v_exp_f32 v110, v110
  v_exp_f32 v111, v111
  v_exp_f32 v112, v112
  v_exp_f32 v113, v113
  v_exp_f32 v114, v114
  v_exp_f32 v115, v115
  v_add_f32 v116, v108, v109
  v_add_f32 v116, v116, v110
  v_add_f32 v116, v116, v111
  v_add_f32 v116, v116, v112
  v_add_f32 v116, v116, v113
  v_add_f32 v116, v116, v114
  v_add_f32 v116, v116, v115
  s_nop 1
  v_add_f32_dpp v116, v116, v116 row_ror:8 row_mask:0xf bank_mask:0xf
  v_mov_b32 v117, v116
  s_nop 1
  v_permlane16_swap_b32 v116, v117
  v_add_f32 v116, v116, v117
  v_mov_b32 v117, v116
  s_nop 1
  v_permlane32_swap_b32 v116, v117
  v_add_f32 v116, v116, v117
  v_rcp_f32 v116, v116
  s_nop 0
  v_mul_f32 v108, v108, v116
  v_mul_f32 v109, v109, v116
  v_mul_f32 v110, v110, v116
  v_mul_f32 v111, v111, v116
  v_mul_f32 v112, v112, v116
  v_mul_f32 v113, v113, v116
  v_mul_f32 v114, v114, v116
  v_mul_f32 v115, v115, v116
  v_cvt_pk_bf16_f32 v120, v108, v109
  v_cvt_pk_bf16_f32 v121, v110, v111
  v_cvt_pk_bf16_f32 v122, v112, v113
  v_cvt_pk_bf16_f32 v123, v114, v115
  buffer_store_dwordx4 v[120:123], v15, s[32:35], s59 offen sc1
  s_waitcnt vmcnt(0)
  s_barrier
  buffer_store_dword v8, v7, s[32:35], 0 offen sc1
  s_branch L_EXIT
QC_KW:
  s_cmp_ge_u32 s67, s69
  s_cbranch_scc1 WPD_113
  s_mov_b32 s57, 0
  s_mov_b32 exec_lo, 0x1
  s_mov_b32 exec_hi, 0
WPL_114:
  buffer_load_dword v140, v9, s[32:35], 0 offen sc1
  s_add_u32 s57, s57, 1
  s_cmp_gt_u32 s57, 0x80000
  s_cbranch_scc1 L_EXIT
  s_waitcnt vmcnt(0)
  v_cmp_gt_u32 vcc, s69, v140
  s_cbranch_vccnz WPL_114
  s_mov_b32 s67, s69
  s_add_u32 s53, s69, 2
  s_min_u32 s53, s53, 64
  v_cmp_gt_u32 vcc, s53, v140
  s_nop 0
  s_cmp_eq_u64 vcc, 0
  s_cselect_b32 s67, s53, s67
  s_add_u32 s53, s69, 6
  s_min_u32 s53, s53, 64
  v_cmp_gt_u32 vcc, s53, v140
  s_nop 0
  s_cmp_eq_u64 vcc, 0
  s_cselect_b32 s67, s53, s67
  s_add_u32 s53, s69, 16
  s_min_u32 s53, s53, 64
  v_cmp_gt_u32 vcc, s53, v140
  s_nop 0
  s_cmp_eq_u64 vcc, 0
  s_cselect_b32 s67, s53, s67
  s_mov_b64 exec, -1
WPD_113:
  s_branch QC_KB
QC_WAIT:
  s_waitcnt vmcnt(0)
  s_mov_b64 exec, 1
  ds_add_rtn_u32 v140, v159, v163
  s_waitcnt lgkmcnt(0)
  v_readfirstlane_b32 s53, v140
  s_mov_b64 exec, -1
  s_cmp_lg_u32 s53, 3
  s_cbranch_scc1 QC_W2
  buffer_store_dword v8, v158, s[32:35], 0 offen sc1
QC_W2:
  s_cmp_ge_u32 s68, s69
  s_cbranch_scc1 WPD_115
  s_mov_b32 s57, 0
  s_mov_b32 exec_lo, 0x1
  s_mov_b32 exec_hi, 0
WPL_116:
  buffer_load_dword v140, v10, s[32:35], 0 offen sc1
  s_add_u32 s57, s57, 1
  s_cmp_gt_u32 s57, 0x80000
  s_cbranch_scc1 L_EXIT
  s_waitcnt vmcnt(0)
  v_cmp_gt_u32 vcc, s69, v140
  s_cbranch_vccz WPG_117
  s_sleep 1
  s_branch WPL_116
WPG_117:
  s_mov_b32 s68, s69
  s_add_u32 s53, s69, 2
  s_min_u32 s53, s53, 64
  v_cmp_gt_u32 vcc, s53, v140
  s_nop 0
  s_cmp_eq_u64 vcc, 0
  s_cselect_b32 s68, s53, s68
  s_add_u32 s53, s69, 6
  s_min_u32 s53, s53, 64
  v_cmp_gt_u32 vcc, s53, v140
  s_nop 0
  s_cmp_eq_u64 vcc, 0
  s_cselect_b32 s68, s53, s68
  s_add_u32 s53, s69, 16
  s_min_u32 s53, s53, 64
  v_cmp_gt_u32 vcc, s53, v140
  s_nop 0
  s_cmp_eq_u64 vcc, 0
  s_cselect_b32 s68, s53, s68
  s_mov_b64 exec, -1
WPD_115:
  buffer_load_dwordx4 v[80:83], v6, s[32:35], s89 offen offset:128 sc1
  buffer_load_dwordx2 v[84:85], v6, s[32:35], s89 offen sc1
  s_waitcnt vmcnt(0)
  s_branch QC_HAVE
R_FC:
  s_lshr_b32 s53, s48, 4
  s_or_b32 s53, s53, s49
  s_cbranch_scc1 BI_ZERO
  s_lshr_b32 s53, s48, 2
  s_lshl_b32 s53, s53, 1
  s_and_b32 s54, s53, 3
  s_lshl_b32 s54, s54, 11
  s_lshr_b32 s53, s53, 2
  s_lshl_b32 s53, s53, 14
  s_add_u32 s54, s54, s53
  s_and_b32 s53, s48, 3
  s_lshl_b32 s53, s53, 7
  s_add_u32 s54, s54, s53
  s_add_u32 s54, s54, 132160
  s_mov_b64 exec, 3
  v_lshlrev_b32 v3, 13, v0
  v_mov_b32 v4, 0
  buffer_atomic_or v4, v3, s[32:35], s54 offen sc0
  s_waitcnt vmcnt(0)
  s_mov_b64 exec, 1
  s_mov_b32 s62, 0xffff
  s_mov_b32 s63, 0xffff
  s_mov_b32 s64, 0
  s_and_b32 s65, s48, 4
  s_lshl_b32 s66, s65, 11
  s_xor_b32 s54, s54, s66
BI_PROBE:
  v_mov_b32 v4, 0
  s_memtime s[70:71]
  s_waitcnt lgkmcnt(0)
  buffer_atomic_or v4, v3, s[32:35], s54 offen sc0
  s_waitcnt vmcnt(0)
  s_memtime s[72:73]
  s_waitcnt lgkmcnt(0)
  s_sub_u32 s72, s72, s70
  s_min_u32 s72, s62, s72
  s_mov_b32 s62, s63
  s_mov_b32 s63, s72
  s_xor_b32 s54, s54, 0x2000
  s_add_u32 s64, s64, 1
  s_bitcmp1_b32 s64, 0
  s_cbranch_scc1 BI_PROBE
  s_cmp_ge_u32 s64, 16
  s_cbranch_scc1 BI_SAY
  s_min_u32 s67, s62, s63
  s_max_u32 s68, s62, s63
  s_cmp_gt_u32 s67, 650
  s_cbranch_scc1 BI_PROBE
  s_sub_u32 s68, s68, s67
  s_cmp_lt_u32 s68, 130
  s_cbranch_scc1 BI_PROBE
BI_SAY:
  s_cmp_gt_u32 s62, s63
  s_cselect_b32 s67, 3, 2
  s_lshr_b32 s65, s65, 2
  s_xor_b32 s67, s67, s65
  v_mov_b32 v4, s67
  v_mov_b32 v5, 0
  global_atomic_cmpswap v3, v[4:5], s[28:29] offset:124 sc1
  s_mov_b64 exec, -1
BI_ZERO:
  s_barrier
  v_min_u32 v20, 47, v0
  v_max_u32 v20, 40, v20
  v_lshlrev_b32 v20, 2, v20
  s_mov_b32 s57, 0
WI_118:
  global_load_dword v21, v20, s[28:29] sc1
  s_add_u32 s57, s57, 1
  s_cmp_gt_u32 s57, 0x20000
  s_cbranch_scc1 L_EXIT
  s_waitcnt vmcnt(0)
  s_and_b32 s53, s24, 7
  s_add_u32 s53, s53, 40
  v_readlane_b32 s53, v21, s53
  s_nop 1
  v_cmp_gt_u32 vcc, s53, v21
  s_bfe_u32 s53, vcc_hi, 0x80008
  s_bcnt1_i32_b32 s53, s53
  v_cmp_eq_u32 vcc, 0, v21
  s_bfe_u32 s54, vcc_hi, 0x80008
  s_cbranch_scc1 WI_120
  s_cmp_lg_u32 s53, s25
  s_cbranch_scc1 L_REDO
WI_120:
  s_cbranch_vccz WI_119
  s_sleep 2
  s_branch WI_118
WI_119:
  s_cmp_lt_u32 s48, 16
  s_cbranch_scc1 BI_END
  v_lshrrev_b32 v3, 2, v0
  v_lshlrev_b32 v3, 7, v3
  v_and_b32 v4, 3, v0
  v_lshl_add_u32 v3, v4, 4, v3
  v_mov_b32 v8, 0
  v_mov_b32 v9, 0
  v_mov_b32 v10, 0
  v_mov_b32 v11, 0
  s_sub_u32 s55, s48, 16
  s_lshl_b32 s55, s55, 2
  s_add_u32 s55, s55, s49
  s_lshl_b32 s55, s55, 11
  buffer_store_dwordx4 v[8:11], v3, s[32:35], s55 offen sc1
  s_add_u32 s55, s55, 65536
  buffer_store_dwordx4 v[8:11], v3, s[32:35], s55 offen sc1
  s_add_u32 s55, s55, 65536
  buffer_store_dwordx4 v[8:11], v3, s[32:35], s55 offen sc1
  s_add_u32 s55, s55, 65536
  s_mov_b32 s62, 1
  s_waitcnt vmcnt(0)
  s_barrier
  s_cmp_lg_u32 s49, 0
  s_cbranch_scc1 BI_END
  s_mov_b64 exec, 1
  s_lshl_b32 s56, s48, 2
  v_mov_b32 v1, s56
  v_mov_b32 v2, s62
  global_store_dword v1, v2, s[28:29] offset:64 sc1
  s_mov_b64 exec, -1
BI_END:
  s_barrier
  s_add_u32 s65, s48, 40
  s_sub_u32 s62, s49, 0
  s_cmp_ge_u32 s65, 32
  s_cbranch_scc1 HV_121
  s_mov_b32 s36, s16
  s_and_b32 s37, s17, 0xffff
  s_mov_b32 s38, 0x780000
  s_mov_b32 s39, 0x20000
  s_mul_i32 s63, s65, 384
  v_mul_u32_u24 v2, 12288, v0
  v_add_u32 v2, s63, v2
  s_and_b32 s66, s65, 3
  s_mul_i32 s66, s66, 5
  s_lshr_b32 s66, s66, 1
HA_122:
  s_mul_i32 s63, s62, 86
  s_lshr_b32 s63, s63, 8
  s_mul_i32 s64, s63, 3
  s_sub_u32 s64, s62, s64
  s_lshl_b32 s64, s64, 7
  s_add_u32 s63, s63, s66
  s_cmp_ge_u32 s63, 10
  s_cselect_b32 s67, 10, 0
  s_sub_u32 s63, s63, s67
  s_mul_i32 s63, s63, 786432
  s_add_u32 s63, s63, s64
  buffer_load_dword v3, v2, s[36:39], s63 offen
  s_waitcnt vmcnt(0)
  s_add_u32 s62, s62, 4
  s_cmp_lt_u32 s62, 30
  s_cbranch_scc1 HA_122
  s_branch HD_124
HV_121:
  s_mov_b32 s36, s22
  s_and_b32 s37, s23, 0xffff
  s_mov_b32 s38, 0x780000
  s_mov_b32 s39, 0x20000
  s_sub_u32 s63, s65, 32
  s_mul_i32 s63, s63, 245760
  v_lshl_add_u32 v2, v0, 7, s63
  s_add_u32 s62, s62, 0
HB_123:
  s_lshl_b32 s63, s62, 13
  buffer_load_dword v3, v2, s[36:39], s63 offen
  s_waitcnt vmcnt(0)
  s_add_u32 s62, s62, 4
  s_cmp_lt_u32 s62, 30
  s_cbranch_scc1 HB_123
HD_124:
  s_waitcnt vmcnt(0)
  v_min_u32 v172, 47, v0
  v_max_u32 v172, 31, v172
  v_lshlrev_b32 v172, 2, v172
  s_mov_b32 s57, 0
WI_125:
  global_load_dword v173, v172, s[28:29] sc1
  s_add_u32 s57, s57, 1
  s_cmp_gt_u32 s57, 0x20000
  s_cbranch_scc1 L_EXIT
  s_waitcnt vmcnt(0)
  s_and_b32 s53, s24, 7
  s_add_u32 s53, s53, 40
  v_readlane_b32 s53, v173, s53
  s_nop 1
  v_cmp_gt_u32 vcc, s53, v173
  s_bfe_u32 s53, vcc_hi, 0x80008
  s_bcnt1_i32_b32 s53, s53
  v_cmp_eq_u32 vcc, 0, v173
  s_bfe_u32 s54, vcc_hi, 0x80008
  s_cbranch_scc1 WI_127
  s_cmp_lg_u32 s53, s25
  s_cbranch_scc1 L_REDO
WI_127:
  s_cbranch_vccz WI_126
  s_sleep 8
  s_branch WI_125
WI_126:
  v_readfirstlane_b32 s53, v173
  s_and_b32 s53, s53, 1
  s_lshl_b32 s50, s53, 13
  s_xor_b32 s51, s50, 0x2000
  s_mov_b32 s44, s26
  s_and_b32 s45, s27, 0xffff
  s_mov_b32 s46, 0x500000
  s_mov_b32 s47, 0x20000
  s_lshr_b32 s62, s48, 2
  s_and_b32 s53, s48, 3
  s_mul_i32 s68, s53, 10
  s_lshl_b32 s53, s49, 1
  s_add_u32 s67, s68, s53
  s_add_u32 s68, s68, 8
  s_lshr_b32 s56, s49, 1
  s_add_u32 s55, s68, s56
  v_lshlrev_b32 v1, 4, v0
  s_lshl_b32 s56, s56, 15
  s_add_u32 s56, s56, 81920
  v_add_u32 v12, s56, v1
  s_and_b32 s56, s49, 1
  s_mul_i32 s69, s56, 40960
  s_sub_u32 s70, 40960, s69
  s_lshl_b32 s56, s56, 10
  v_add_u32 v168, s56, v1
  v_xor_b32 v169, 1024, v168
  v_add_u32 v170, 0x10000, v168
  v_add_u32 v171, 0x10000, v169
  v_lshrrev_b32 v40, 4, v0
  v_and_b32 v41, 15, v0
  v_lshlrev_b32 v42, 2, v41
  v_lshl_add_u32 v42, v40, 8, v42
  s_lshl_b32 s54, s67, 14
  v_add_u32 v5, s54, v42
  s_lshl_b32 s54, s55, 14
  v_add_u32 v6, s54, v42
  v_mul_u32_u24 v42, 2560, v41
  v_lshl_add_u32 v44, v40, 3, v42
  s_lshl_b32 s54, s55, 5
  s_add_u32 s54, s54, 1280
  v_add_u32 v8, s54, v44
  v_and_b32 v43, 1, v40
  v_lshl_add_u32 v42, v43, 5, v42
  v_lshrrev_b32 v43, 1, v40
  v_lshl_add_u32 v42, v43, 4, v42
  s_lshl_b32 s54, s67, 5
  s_add_u32 s54, s54, 1280
  v_add_u32 v7, s54, v42
  s_lshl_b32 s67, s67, 15
  s_lshl_b32 s68, s68, 15
  s_lshl_b32 s54, s49, 14
  s_add_u32 s68, s68, s54
  s_bitcmp1_b32 s2, 2
  s_cselect_b32 s54, s51, s50
  s_and_b32 s53, s2, 7
  s_lshl_b32 s53, s53, 7
  s_add_u32 s54, s54, s53
  s_add_u32 s54, s54, 114688
  v_mov_b32 v11, s54
  s_add_u32 s54, s50, 65536
  v_lshl_add_u32 v2, v0, 7, s54
  s_add_u32 s54, s50, 36864
  v_lshl_add_u32 v3, v0, 7, s54
  s_add_u32 s54, s50, 69632
  v_lshl_add_u32 v4, v0, 7, s54
  s_mov_b32 s64, 0
  s_mov_b32 s65, 0
  s_mov_b32 s66, 0
  s_mov_b32 s52, 0
  s_lshl_b32 s54, s48, 7
  s_add_u32 s54, s54, s51
  s_add_u32 s54, s54, 21504
  s_cmp_eq_u32 s49, 0
  s_cselect_b32 s54, s54, 0x40000000
  v_mov_b32 v9, 0x40000000
  s_nop 0
  v_writelane_b32 v9, s54, 0
  v_mov_b32 v10, s62
  buffer_store_dword v10, v9, s[32:35], 0 offen sc1
FC_SEG:
  v_add_u32 v10, 6, v10
  s_min_u32 s63, s62, 61
  s_cmp_ge_u32 s65, s63
  s_cbranch_scc1 WPD_128
  s_mov_b32 s57, 0
  s_mov_b32 exec_lo, 0x1
  s_mov_b32 exec_hi, 0
WPL_129:
  buffer_load_dword v172, v11, s[32:35], 0 offen sc1
  s_add_u32 s57, s57, 1
  s_cmp_gt_u32 s57, 0x80000
  s_cbranch_scc1 L_EXIT
  s_waitcnt vmcnt(0)
  v_cmp_gt_u32 vcc, s63, v172
  s_cbranch_vccz WPG_130
  s_sleep 8
  s_branch WPL_129
WPG_130:
  s_mov_b32 s65, s63
  s_add_u32 s53, s63, 2
  s_min_u32 s53, s53, 64
  v_cmp_gt_u32 vcc, s53, v172
  s_nop 0
  s_cmp_eq_u64 vcc, 0
  s_cselect_b32 s65, s53, s65
  s_add_u32 s53, s63, 6
  s_min_u32 s53, s53, 64
  v_cmp_gt_u32 vcc, s53, v172
  s_nop 0
  s_cmp_eq_u64 vcc, 0
  s_cselect_b32 s65, s53, s65
  s_add_u32 s53, s63, 16
  s_min_u32 s53, s53, 64
  v_cmp_gt_u32 vcc, s53, v172
  s_nop 0
  s_cmp_eq_u64 vcc, 0
  s_cselect_b32 s65, s53, s65
  s_mov_b64 exec, -1
WPD_128:
  s_add_u32 s63, s62, 1
  s_cmp_ge_u32 s64, s63
  s_cbranch_scc1 WPD_131
  s_mov_b32 s57, 0
  s_mov_b32 exec_lo, 0xffffffff
  s_mov_b32 exec_hi, 0
WPL_132:
  buffer_load_dword v172, v2, s[32:35], 0 offen sc1
  s_add_u32 s57, s57, 1
  s_cmp_gt_u32 s57, 0x80000
  s_cbranch_scc1 L_EXIT
  s_waitcnt vmcnt(0)
  v_cmp_gt_u32 vcc, s63, v172
  s_cbranch_vccz WPG_133
  s_sleep 8
  s_branch WPL_132
WPG_133:
  s_mov_b32 s64, s63
  s_add_u32 s53, s63, 2
  s_min_u32 s53, s53, 64
  v_cmp_gt_u32 vcc, s53, v172
  s_nop 0
  s_cmp_eq_u64 vcc, 0
  s_cselect_b32 s64, s53, s64
  s_add_u32 s53, s63, 6
  s_min_u32 s53, s53, 64
  v_cmp_gt_u32 vcc, s53, v172
  s_nop 0
  s_cmp_eq_u64 vcc, 0
  s_cselect_b32 s64, s53, s64
  s_add_u32 s53, s63, 16
  s_min_u32 s53, s53, 64
  v_cmp_gt_u32 vcc, s53, v172
  s_nop 0
  s_cmp_eq_u64 vcc, 0
  s_cselect_b32 s64, s53, s64
  s_mov_b64 exec, -1
WPD_131:
  s_barrier
  s_and_b32 s56, s62, 15
  s_mul_i32 s56, s56, 0x140000
  s_add_u32 s56, s56, 0x2400000
  s_add_u32 s56, s56, s68
  s_lshr_b32 s53, s56, 7
  s_and_b32 s53, s53, 0x2000
  s_xor_b32 s53, s53, s50
  s_lshl_b32 s56, s56, 1
  s_or_b32 s56, s56, s53
  s_lshl_b32 s55, s49, 14
  s_add_u32 m0, s55, 81920
  s_nop 0
  buffer_load_dwordx4 v1, s[32:35], s56 offen offset:0 sc1 lds
  buffer_load_dwordx4 v1, s[32:35], s56 offen offset:1024 sc1 lds
  buffer_load_dwordx4 v1, s[32:35], s56 offen offset:2048 sc1 lds
  buffer_load_dwordx4 v1, s[32:35], s56 offen offset:3072 sc1 lds
  s_add_u32 s56, s56, 4096
  s_add_u32 m0, s55, 86016
  s_nop 0
  buffer_load_dwordx4 v1, s[32:35], s56 offen offset:0 sc1 lds
  buffer_load_dwordx4 v1, s[32:35], s56 offen offset:1024 sc1 lds
  buffer_load_dwordx4 v1, s[32:35], s56 offen offset:2048 sc1 lds
  buffer_load_dwordx4 v1, s[32:35], s56 offen offset:3072 sc1 lds
  s_add_u32 s56, s56, 12288
  s_add_u32 m0, s55, 90112
  s_nop 0
  buffer_load_dwordx4 v1, s[32:35], s56 offen offset:0 sc1 lds
  buffer_load_dwordx4 v1, s[32:35], s56 offen offset:1024 sc1 lds
  buffer_load_dwordx4 v1, s[32:35], s56 offen offset:2048 sc1 lds
  buffer_load_dwordx4 v1, s[32:35], s56 offen offset:3072 sc1 lds
  s_add_u32 s56, s56, 4096
  s_add_u32 m0, s55, 94208
  s_nop 0
  buffer_load_dwordx4 v1, s[32:35], s56 offen offset:0 sc1 lds
  buffer_load_dwordx4 v1, s[32:35], s56 offen offset:1024 sc1 lds
  buffer_load_dwordx4 v1, s[32:35], s56 offen offset:2048 sc1 lds
  buffer_load_dwordx4 v1, s[32:35], s56 offen offset:3072 sc1 lds
  s_add_u32 s56, s56, 12288
  s_and_b32 s56, s62, 15
  s_mul_i32 s56, s56, 0x140000
  s_add_u32 s56, s56, 0x2400000
  s_add_u32 s56, s56, s67
  s_lshr_b32 s53, s56, 7
  s_and_b32 s53, s53, 0x2000
  s_xor_b32 s53, s53, s50
  s_lshl_b32 s56, s56, 1
  s_or_b32 s56, s56, s53
  buffer_load_dwordx4 a[0:3], v1, s[32:35], s56 offen sc1
  buffer_load_dwordx4 a[4:7], v1, s[32:35], s56 offen offset:1024 sc1
  buffer_load_dwordx4 a[8:11], v1, s[32:35], s56 offen offset:2048 sc1
  buffer_load_dwordx4 a[12:15], v1, s[32:35], s56 offen offset:3072 sc1
  s_add_u32 s56, s56, 4096
  buffer_load_dwordx4 a[16:19], v1, s[32:35], s56 offen sc1
  buffer_load_dwordx4 a[20:23], v1, s[32:35], s56 offen offset:1024 sc1
  buffer_load_dwordx4 a[24:27], v1, s[32:35], s56 offen offset:2048 sc1
  buffer_load_dwordx4 a[28:31], v1, s[32:35], s56 offen offset:3072 sc1
  s_add_u32 s56, s56, 12288
  buffer_load_dwordx4 a[32:35], v1, s[32:35], s56 offen sc1
  buffer_load_dwordx4 a[36:39], v1, s[32:35], s56 offen offset:1024 sc1
  buffer_load_dwordx4 a[40:43], v1, s[32:35], s56 offen offset:2048 sc1
  buffer_load_dwordx4 a[44:47], v1, s[32:35], s56 offen offset:3072 sc1
  s_add_u32 s56, s56, 4096
  buffer_load_dwordx4 a[48:51], v1, s[32:35], s56 offen sc1
  buffer_load_dwordx4 a[52:55], v1, s[32:35], s56 offen offset:1024 sc1
  buffer_load_dwordx4 a[56:59], v1, s[32:35], s56 offen offset:2048 sc1
  buffer_load_dwordx4 a[60:63], v1, s[32:35], s56 offen offset:3072 sc1
  s_add_u32 s56, s56, 12288
  buffer_load_dwordx4 a[64:67], v1, s[32:35], s56 offen sc1
  buffer_load_dwordx4 a[68:71], v1, s[32:35], s56 offen offset:1024 sc1
  buffer_load_dwordx4 a[72:75], v1, s[32:35], s56 offen offset:2048 sc1
  buffer_load_dwordx4 a[76:79], v1, s[32:35], s56 offen offset:3072 sc1
  s_add_u32 s56, s56, 4096
  buffer_load_dwordx4 a[80:83], v1, s[32:35], s56 offen sc1
  buffer_load_dwordx4 a[84:87], v1, s[32:35], s56 offen offset:1024 sc1
  buffer_load_dwordx4 a[88:91], v1, s[32:35], s56 offen offset:2048 sc1
  buffer_load_dwordx4 a[92:95], v1, s[32:35], s56 offen offset:3072 sc1
  s_add_u32 s56, s56, 12288
  buffer_load_dwordx4 a[96:99], v1, s[32:35], s56 offen sc1
  buffer_load_dwordx4 a[100:103], v1, s[32:35], s56 offen offset:1024 sc1
  buffer_load_dwordx4 a[104:107], v1, s[32:35], s56 offen offset:2048 sc1
  buffer_load_dwordx4 a[108:111], v1, s[32:35], s56 offen offset:3072 sc1
  s_add_u32 s56, s56, 4096
  buffer_load_dwordx4 a[112:115], v1, s[32:35], s56 offen sc1
  buffer_load_dwordx4 a[116:119], v1, s[32:35], s56 offen offset:1024 sc1
  buffer_load_dwordx4 a[120:123], v1, s[32:35], s56 offen offset:2048 sc1
  buffer_load_dwordx4 a[124:127], v1, s[32:35], s56 offen offset:3072 sc1
  s_add_u32 s56, s56, 12288
  s_waitcnt vmcnt(32)
  buffer_load_dwordx4 a[128:131], v1, s[32:35], s56 offen sc1
  buffer_load_dwordx4 a[132:135], v1, s[32:35], s56 offen offset:1024 sc1
  buffer_load_dwordx4 a[136:139], v1, s[32:35], s56 offen offset:2048 sc1
  buffer_load_dwordx4 a[140:143], v1, s[32:35], s56 offen offset:3072 sc1
  s_add_u32 s56, s56, 4096
  buffer_load_dwordx4 a[144:147], v1, s[32:35], s56 offen sc1
  buffer_load_dwordx4 a[148:151], v1, s[32:35], s56 offen offset:1024 sc1
  buffer_load_dwordx4 a[152:155], v1, s[32:35], s56 offen offset:2048 sc1
  buffer_load_dwordx4 a[156:159], v1, s[32:35], s56 offen offset:3072 sc1
  s_add_u32 s56, s56, 12288
  buffer_load_dwordx4 a[160:163], v1, s[32:35], s56 offen sc1
  buffer_load_dwordx4 a[164:167], v1, s[32:35], s56 offen offset:1024 sc1
  buffer_load_dwordx4 a[168:171], v1, s[32:35], s56 offen offset:2048 sc1
  buffer_load_dwordx4 a[172:175], v1, s[32:35], s56 offen offset:3072 sc1
  s_add_u32 s56, s56, 4096
  buffer_load_dwordx4 a[176:179], v1, s[32:35], s56 offen sc1
  buffer_load_dwordx4 a[180:183], v1, s[32:35], s56 offen offset:1024 sc1
  buffer_load_dwordx4 a[184:187], v1, s[32:35], s56 offen offset:2048 sc1
  buffer_load_dwordx4 a[188:191], v1, s[32:35], s56 offen offset:3072 sc1
  s_add_u32 s56, s56, 12288
  buffer_load_dwordx4 a[192:195], v1, s[32:35], s56 offen sc1
  buffer_load_dwordx4 a[196:199], v1, s[32:35], s56 offen offset:1024 sc1
  buffer_load_dwordx4 a[200:203], v1, s[32:35], s56 offen offset:2048 sc1
  buffer_load_dwordx4 a[204:207], v1, s[32:35], s56 offen offset:3072 sc1
  s_add_u32 s56, s56, 4096
  buffer_load_dwordx4 a[208:211], v1, s[32:35], s56 offen sc1
  buffer_load_dwordx4 a[212:215], v1, s[32:35], s56 offen offset:1024 sc1
  buffer_load_dwordx4 a[216:219], v1, s[32:35], s56 offen offset:2048 sc1
  buffer_load_dwordx4 a[220:223], v1, s[32:35], s56 offen offset:3072 sc1
  s_add_u32 s56, s56, 12288
  s_waitcnt vmcnt(32)
  buffer_load_dwordx4 a[224:227], v1, s[32:35], s56 offen sc1
  buffer_load_dwordx4 a[228:231], v1, s[32:35], s56 offen offset:1024 sc1
  buffer_load_dwordx4 a[232:235], v1, s[32:35], s56 offen offset:2048 sc1
  buffer_load_dwordx4 a[236:239], v1, s[32:35], s56 offen offset:3072 sc1
  s_add_u32 s56, s56, 4096
  buffer_load_dwordx4 a[240:243], v1, s[32:35], s56 offen sc1
  buffer_load_dwordx4 a[244:247], v1, s[32:35], s56 offen offset:1024 sc1
  buffer_load_dwordx4 a[248:251], v1, s[32:35], s56 offen offset:2048 sc1
  buffer_load_dwordx4 a[252:255], v1, s[32:35], s56 offen offset:3072 sc1
  s_add_u32 s56, s56, 12288
  s_and_b32 s54, s62, 15
  s_mul_i32 s54, s54, 0x80000
  s_add_u32 s54, s54, 0xc00000
  s_lshr_b32 s53, s54, 7
  s_and_b32 s53, s53, 0x2000
  s_xor_b32 s53, s53, s50
  s_lshl_b32 s54, s54, 1
  s_or_b32 s54, s54, s53
  s_add_u32 s55, s54, 0
  v_add_u32 v184, s55, v5
  s_add_u32 s55, s54, 4096
  v_add_u32 v185, s55, v5
  s_add_u32 s55, s54, 16384
  v_add_u32 v186, s55, v5
  s_add_u32 s55, s54, 20480
  v_add_u32 v187, s55, v5
  s_add_u32 s55, s54, 0
  v_add_u32 v188, s55, v6
  s_add_u32 s55, s54, 4096
  v_add_u32 v189, s55, v6
  s_cmp_eq_u32 s63, 64
  s_cbranch_scc1 FC_YL
  s_cmp_ge_u32 s65, s63
  s_cbranch_scc1 WPD_134
  s_mov_b32 s57, 0
  s_mov_b32 exec_lo, 0x1
  s_mov_b32 exec_hi, 0
WPL_135:
  buffer_load_dword v172, v11, s[32:35], 0 offen sc1
  s_add_u32 s57, s57, 1
  s_cmp_gt_u32 s57, 0x80000
  s_cbranch_scc1 L_EXIT
  s_waitcnt vmcnt(0)
  v_cmp_gt_u32 vcc, s63, v172
  s_cbranch_vccz WPG_136
  s_sleep 8
  s_branch WPL_135
WPG_136:
  s_mov_b32 s65, s63
  s_add_u32 s53, s63, 2
  s_min_u32 s53, s53, 64
  v_cmp_gt_u32 vcc, s53, v172
  s_nop 0
  s_cmp_eq_u64 vcc, 0
  s_cselect_b32 s65, s53, s65
  s_add_u32 s53, s63, 6
  s_min_u32 s53, s53, 64
  v_cmp_gt_u32 vcc, s53, v172
  s_nop 0
  s_cmp_eq_u64 vcc, 0
  s_cselect_b32 s65, s53, s65
  s_add_u32 s53, s63, 16
  s_min_u32 s53, s53, 64
  v_cmp_gt_u32 vcc, s53, v172
  s_nop 0
  s_cmp_eq_u64 vcc, 0
  s_cselect_b32 s65, s53, s65
  s_mov_b64 exec, -1
WPD_134:
FC_YOK:
  s_waitcnt vmcnt(32)
  buffer_load_dword v68, v184, s[32:35], 0 offen sc1
  buffer_load_dword v69, v184, s[32:35], 0 offen offset:64 sc1
  buffer_load_dword v70, v184, s[32:35], 0 offen offset:128 sc1
  buffer_load_dword v71, v184, s[32:35], 0 offen offset:192 sc1
  buffer_load_dword v72, v184, s[32:35], 0 offen offset:1024 sc1
  buffer_load_dword v73, v184, s[32:35], 0 offen offset:1088 sc1
  buffer_load_dword v74, v184, s[32:35], 0 offen offset:1152 sc1
  buffer_load_dword v75, v184, s[32:35], 0 offen offset:1216 sc1
  buffer_load_dword v76, v184, s[32:35], 0 offen offset:2048 sc1
  buffer_load_dword v77, v184, s[32:35], 0 offen offset:2112 sc1
  buffer_load_dword v78, v184, s[32:35], 0 offen offset:2176 sc1
  buffer_load_dword v79, v184, s[32:35], 0 offen offset:2240 sc1
  buffer_load_dword v80, v184, s[32:35], 0 offen offset:3072 sc1
  buffer_load_dword v81, v184, s[32:35], 0 offen offset:3136 sc1
  buffer_load_dword v82, v184, s[32:35], 0 offen offset:3200 sc1
  buffer_load_dword v83, v184, s[32:35], 0 offen offset:3264 sc1
  buffer_load_dword v84, v185, s[32:35], 0 offen sc1
  buffer_load_dword v85, v185, s[32:35], 0 offen offset:64 sc1
  buffer_load_dword v86, v185, s[32:35], 0 offen offset:128 sc1
  buffer_load_dword v87, v185, s[32:35], 0 offen offset:192 sc1
  buffer_load_dword v88, v185, s[32:35], 0 offen offset:1024 sc1
  buffer_load_dword v89, v185, s[32:35], 0 offen offset:1088 sc1
  buffer_load_dword v90, v185, s[32:35], 0 offen offset:1152 sc1
  buffer_load_dword v91, v185, s[32:35], 0 offen offset:1216 sc1
  s_waitcnt vmcnt(32)
  buffer_load_dword v92, v185, s[32:35], 0 offen offset:2048 sc1
  buffer_load_dword v93, v185, s[32:35], 0 offen offset:2112 sc1
  buffer_load_dword v94, v185, s[32:35], 0 offen offset:2176 sc1
  buffer_load_dword v95, v185, s[32:35], 0 offen offset:2240 sc1
  buffer_load_dword v96, v185, s[32:35], 0 offen offset:3072 sc1
  buffer_load_dword v97, v185, s[32:35], 0 offen offset:3136 sc1
  buffer_load_dword v98, v185, s[32:35], 0 offen offset:3200 sc1
  buffer_load_dword v99, v185, s[32:35], 0 offen offset:3264 sc1
  buffer_load_dword v100, v186, s[32:35], 0 offen sc1
  buffer_load_dword v101, v186, s[32:35], 0 offen offset:64 sc1
  buffer_load_dword v102, v186, s[32:35], 0 offen offset:128 sc1
  buffer_load_dword v103, v186, s[32:35], 0 offen offset:192 sc1
  buffer_load_dword v104, v186, s[32:35], 0 offen offset:1024 sc1
  buffer_load_dword v105, v186, s[32:35], 0 offen offset:1088 sc1
  buffer_load_dword v106, v186, s[32:35], 0 offen offset:1152 sc1
  buffer_load_dword v107, v186, s[32:35], 0 offen offset:1216 sc1
  buffer_load_dword v108, v186, s[32:35], 0 offen offset:2048 sc1
  buffer_load_dword v109, v186, s[32:35], 0 offen offset:2112 sc1
  buffer_load_dword v110, v186, s[32:35], 0 offen offset:2176 sc1
  buffer_load_dword v111, v186, s[32:35], 0 offen offset:2240 sc1
  buffer_load_dword v112, v186, s[32:35], 0 offen offset:3072 sc1
  buffer_load_dword v113, v186, s[32:35], 0 offen offset:3136 sc1
  buffer_load_dword v114, v186, s[32:35], 0 offen offset:3200 sc1
  buffer_load_dword v115, v186, s[32:35], 0 offen offset:3264 sc1
  s_waitcnt vmcnt(32)
  buffer_load_dword v116, v187, s[32:35], 0 offen sc1
  buffer_load_dword v117, v187, s[32:35], 0 offen offset:64 sc1
  buffer_load_dword v118, v187, s[32:35], 0 offen offset:128 sc1
  buffer_load_dword v119, v187, s[32:35], 0 offen offset:192 sc1
  buffer_load_dword v120, v187, s[32:35], 0 offen offset:1024 sc1
  buffer_load_dword v121, v187, s[32:35], 0 offen offset:1088 sc1
  buffer_load_dword v122, v187, s[32:35], 0 offen offset:1152 sc1
  buffer_load_dword v123, v187, s[32:35], 0 offen offset:1216 sc1
  buffer_load_dword v124, v187, s[32:35], 0 offen offset:2048 sc1
  buffer_load_dword v125, v187, s[32:35], 0 offen offset:2112 sc1
  buffer_load_dword v126, v187, s[32:35], 0 offen offset:2176 sc1
  buffer_load_dword v127, v187, s[32:35], 0 offen offset:2240 sc1
  buffer_load_dword v128, v187, s[32:35], 0 offen offset:3072 sc1
  buffer_load_dword v129, v187, s[32:35], 0 offen offset:3136 sc1
  buffer_load_dword v130, v187, s[32:35], 0 offen offset:3200 sc1
  buffer_load_dword v131, v187, s[32:35], 0 offen offset:3264 sc1
  buffer_load_dword v132, v188, s[32:35], 0 offen sc1
  buffer_load_dword v133, v188, s[32:35], 0 offen offset:64 sc1
  buffer_load_dword v134, v188, s[32:35], 0 offen offset:128 sc1
  buffer_load_dword v135, v188, s[32:35], 0 offen offset:192 sc1
  buffer_load_dword v136, v188, s[32:35], 0 offen offset:1024 sc1
  buffer_load_dword v137, v188, s[32:35], 0 offen offset:1088 sc1
  buffer_load_dword v138, v188, s[32:35], 0 offen offset:1152 sc1
  buffer_load_dword v139, v188, s[32:35], 0 offen offset:1216 sc1
  s_waitcnt vmcnt(32)
  buffer_load_dword v140, v188, s[32:35], 0 offen offset:2048 sc1
  buffer_load_dword v141, v188, s[32:35], 0 offen offset:2112 sc1
  buffer_load_dword v142, v188, s[32:35], 0 offen offset:2176 sc1
  buffer_load_dword v143, v188, s[32:35], 0 offen offset:2240 sc1
  buffer_load_dword v144, v188, s[32:35], 0 offen offset:3072 sc1
  buffer_load_dword v145, v188, s[32:35], 0 offen offset:3136 sc1
  buffer_load_dword v146, v188, s[32:35], 0 offen offset:3200 sc1
  buffer_load_dword v147, v188, s[32:35], 0 offen offset:3264 sc1
  buffer_load_dword v148, v189, s[32:35], 0 offen sc1
  buffer_load_dword v149, v189, s[32:35], 0 offen offset:64 sc1
  buffer_load_dword v150, v189, s[32:35], 0 offen offset:128 sc1
  buffer_load_dword v151, v189, s[32:35], 0 offen offset:192 sc1
  buffer_load_dword v152, v189, s[32:35], 0 offen offset:1024 sc1
  buffer_load_dword v153, v189, s[32:35], 0 offen offset:1088 sc1
  buffer_load_dword v154, v189, s[32:35], 0 offen offset:1152 sc1
  buffer_load_dword v155, v189, s[32:35], 0 offen offset:1216 sc1
  buffer_load_dword v156, v189, s[32:35], 0 offen offset:2048 sc1
  buffer_load_dword v157, v189, s[32:35], 0 offen offset:2112 sc1
  buffer_load_dword v158, v189, s[32:35], 0 offen offset:2176 sc1
  buffer_load_dword v159, v189, s[32:35], 0 offen offset:2240 sc1
  buffer_load_dword v160, v189, s[32:35], 0 offen offset:3072 sc1
  buffer_load_dword v161, v189, s[32:35], 0 offen offset:3136 sc1
  buffer_load_dword v162, v189, s[32:35], 0 offen offset:3200 sc1
  buffer_load_dword v163, v189, s[32:35], 0 offen offset:3264 sc1
  s_cmp_ge_u32 s66, s63
  s_cbranch_scc1 WPD_137
  s_mov_b32 s57, 0
  s_mov_b32 exec_lo, 0xffffffff
  s_mov_b32 exec_hi, 0
WPL_138:
  buffer_load_dword v172, v4, s[32:35], 0 offen sc1
  s_add_u32 s57, s57, 1
  s_cmp_gt_u32 s57, 0x80000
  s_cbranch_scc1 L_EXIT
  s_waitcnt vmcnt(0)
  v_cmp_gt_u32 vcc, s63, v172
  s_cbranch_vccz WPG_139
  s_sleep 4
  s_branch WPL_138
WPG_139:
  s_mov_b32 s66, s63
  s_add_u32 s53, s63, 2
  s_min_u32 s53, s53, 64
  v_cmp_gt_u32 vcc, s53, v172
  s_nop 0
  s_cmp_eq_u64 vcc, 0
  s_cselect_b32 s66, s53, s66
  s_add_u32 s53, s63, 6
  s_min_u32 s53, s53, 64
  v_cmp_gt_u32 vcc, s53, v172
  s_nop 0
  s_cmp_eq_u64 vcc, 0
  s_cselect_b32 s66, s53, s66
  s_add_u32 s53, s63, 16
  s_min_u32 s53, s53, 64
  v_cmp_gt_u32 vcc, s53, v172
  s_nop 0
  s_cmp_eq_u64 vcc, 0
  s_cselect_b32 s66, s53, s66
  s_mov_b64 exec, -1
WPD_137:
  s_and_b32 s56, s62, 15
  s_mul_i32 s56, s56, 0x20000
  s_add_u32 s56, s56, 0x7800000
  s_lshr_b32 s53, s56, 7
  s_and_b32 s53, s53, 0x2000
  s_xor_b32 s53, s53, s50
  s_lshl_b32 s56, s56, 1
  s_or_b32 s56, s56, s53
  s_lshl_b32 s55, s49, 10
  s_add_u32 s56, s56, s55
  s_waitcnt vmcnt(32)
  s_add_u32 m0, s55, 0
  s_nop 0
  buffer_load_dwordx4 v1, s[32:35], s56 offen sc1 lds
  s_add_u32 s56, s56, 4096
  s_add_u32 m0, s55, 4096
  s_nop 0
  buffer_load_dwordx4 v1, s[32:35], s56 offen sc1 lds
  s_add_u32 s56, s56, 12288
  s_add_u32 m0, s55, 8192
  s_nop 0
  buffer_load_dwordx4 v1, s[32:35], s56 offen sc1 lds
  s_add_u32 s56, s56, 4096
  s_add_u32 m0, s55, 12288
  s_nop 0
  buffer_load_dwordx4 v1, s[32:35], s56 offen sc1 lds
  s_add_u32 s56, s56, 12288
  s_add_u32 m0, s55, 16384
  s_nop 0
  buffer_load_dwordx4 v1, s[32:35], s56 offen sc1 lds
  s_add_u32 s56, s56, 4096
  s_add_u32 m0, s55, 20480
  s_nop 0
  buffer_load_dwordx4 v1, s[32:35], s56 offen sc1 lds
  s_add_u32 s56, s56, 12288
  s_add_u32 m0, s55, 24576
  s_nop 0
  buffer_load_dwordx4 v1, s[32:35], s56 offen sc1 lds
  s_add_u32 s56, s56, 4096
  s_add_u32 m0, s55, 28672
  s_nop 0
  buffer_load_dwordx4 v1, s[32:35], s56 offen sc1 lds
  s_add_u32 s56, s56, 12288
  s_add_u32 m0, s55, 32768
  s_nop 0
  buffer_load_dwordx4 v1, s[32:35], s56 offen sc1 lds
  s_add_u32 s56, s56, 4096
  s_add_u32 m0, s55, 36864
  s_nop 0
  buffer_load_dwordx4 v1, s[32:35], s56 offen sc1 lds
  s_add_u32 s56, s56, 12288
  s_add_u32 m0, s55, 40960
  s_nop 0
  buffer_load_dwordx4 v1, s[32:35], s56 offen sc1 lds
  s_add_u32 s56, s56, 4096
  s_add_u32 m0, s55, 45056
  s_nop 0
  buffer_load_dwordx4 v1, s[32:35], s56 offen sc1 lds
  s_add_u32 s56, s56, 12288
  s_add_u32 m0, s55, 49152
  s_nop 0
  buffer_load_dwordx4 v1, s[32:35], s56 offen sc1 lds
  s_add_u32 s56, s56, 4096
  s_add_u32 m0, s55, 53248
  s_nop 0
  buffer_load_dwordx4 v1, s[32:35], s56 offen sc1 lds
  s_add_u32 s56, s56, 12288
  s_add_u32 m0, s55, 57344
  s_nop 0
  buffer_load_dwordx4 v1, s[32:35], s56 offen sc1 lds
  s_add_u32 s56, s56, 4096
  s_add_u32 m0, s55, 61440
  s_nop 0
  buffer_load_dwordx4 v1, s[32:35], s56 offen sc1 lds
  s_add_u32 s56, s56, 12288
  s_add_u32 m0, s55, 65536
  s_nop 0
  buffer_load_dwordx4 v1, s[32:35], s56 offen sc1 lds
  s_add_u32 s56, s56, 4096
  s_add_u32 m0, s55, 69632
  s_nop 0
  buffer_load_dwordx4 v1, s[32:35], s56 offen sc1 lds
  s_add_u32 s56, s56, 12288
  s_add_u32 m0, s55, 73728
  s_nop 0
  buffer_load_dwordx4 v1, s[32:35], s56 offen sc1 lds
  s_add_u32 s56, s56, 4096
  s_add_u32 m0, s55, 77824
  s_nop 0
  buffer_load_dwordx4 v1, s[32:35], s56 offen sc1 lds
  s_add_u32 s56, s56, 12288
  s_waitcnt vmcnt(16)
  s_barrier
  ds_read_b128 v[36:39], v168 offset:0
  ds_read_b128 v[40:43], v169 offset:0
  ds_read_b128 v[192:195], v12 offset:0
  ds_read_b128 v[44:47], v168 offset:2048
  ds_read_b128 v[48:51], v169 offset:2048
  ds_read_b128 v[196:199], v12 offset:1024
  ds_read_b128 v[52:55], v168 offset:4096
  ds_read_b128 v[56:59], v169 offset:4096
  ds_read_b128 v[200:203], v12 offset:2048
  s_waitcnt lgkmcnt(6)
  v_mfma_f32_16x16x32_bf16 v[16:19], a[0:3], v[36:39], 0
  v_mfma_f32_16x16x32_bf16 v[20:23], a[128:131], v[36:39], 0
  v_mfma_f32_16x16x32_bf16 v[24:27], a[0:3], v[40:43], 0
  v_mfma_f32_16x16x32_bf16 v[28:31], a[128:131], v[40:43], 0
  v_mfma_f32_16x16x32_bf16 v[32:35], v[192:195], v[36:39], 0
  ds_read_b128 v[60:63], v168 offset:6144
  ds_read_b128 v[64:67], v169 offset:6144
  ds_read_b128 v[204:207], v12 offset:3072
  s_waitcnt lgkmcnt(6)
  v_mfma_f32_16x16x32_bf16 v[16:19], a[4:7], v[44:47], v[16:19]
  v_mfma_f32_16x16x32_bf16 v[20:23], a[132:135], v[44:47], v[20:23]
  v_mfma_f32_16x16x32_bf16 v[24:27], a[4:7], v[48:51], v[24:27]
  v_mfma_f32_16x16x32_bf16 v[28:31], a[132:135], v[48:51], v[28:31]
  v_mfma_f32_16x16x32_bf16 v[32:35], v[196:199], v[44:47], v[32:35]
  ds_read_b128 v[36:39], v168 offset:8192
  ds_read_b128 v[40:43], v169 offset:8192
  ds_read_b128 v[192:195], v12 offset:4096
  s_waitcnt lgkmcnt(6)
  v_mfma_f32_16x16x32_bf16 v[16:19], a[8:11], v[52:55], v[16:19]
  v_mfma_f32_16x16x32_bf16 v[20:23], a[136:139], v[52:55], v[20:23]
  v_mfma_f32_16x16x32_bf16 v[24:27], a[8:11], v[56:59], v[24:27]
  v_mfma_f32_16x16x32_bf16 v[28:31], a[136:139], v[56:59], v[28:31]
  v_mfma_f32_16x16x32_bf16 v[32:35], v[200:203], v[52:55], v[32:35]
  ds_read_b128 v[44:47], v168 offset:10240
  ds_read_b128 v[48:51], v169 offset:10240
  ds_read_b128 v[196:199], v12 offset:5120
  s_waitcnt lgkmcnt(6)
  v_mfma_f32_16x16x32_bf16 v[16:19], a[12:15], v[60:63], v[16:19]
  v_mfma_f32_16x16x32_bf16 v[20:23], a[140:143], v[60:63], v[20:23]
  v_mfma_f32_16x16x32_bf16 v[24:27], a[12:15], v[64:67], v[24:27]
  v_mfma_f32_16x16x32_bf16 v[28:31], a[140:143], v[64:67], v[28:31]
  v_mfma_f32_16x16x32_bf16 v[32:35], v[204:207], v[60:63], v[32:35]
  ds_read_b128 v[52:55], v168 offset:12288
  ds_read_b128 v[56:59], v169 offset:12288
  ds_read_b128 v[200:203], v12 offset:6144
  s_waitcnt lgkmcnt(6)
  v_mfma_f32_16x16x32_bf16 v[16:19], a[16:19], v[36:39], v[16:19]
  v_mfma_f32_16x16x32_bf16 v[20:23], a[144:147], v[36:39], v[20:23]
  v_mfma_f32_16x16x32_bf16 v[24:27], a[16:19], v[40:43], v[24:27]
  v_mfma_f32_16x16x32_bf16 v[28:31], a[144:147], v[40:43], v[28:31]
  v_mfma_f32_16x16x32_bf16 v[32:35], v[192:195], v[36:39], v[32:35]
  ds_read_b128 v[60:63], v168 offset:14336
  ds_read_b128 v[64:67], v169 offset:14336
  ds_read_b128 v[204:207], v12 offset:7168
  s_waitcnt lgkmcnt(6)
  v_mfma_f32_16x16x32_bf16 v[16:19], a[20:23], v[44:47], v[16:19]
  v_mfma_f32_16x16x32_bf16 v[20:23], a[148:151], v[44:47], v[20:23]
  v_mfma_f32_16x16x32_bf16 v[24:27], a[20:23], v[48:51], v[24:27]
  v_mfma_f32_16x16x32_bf16 v[28:31], a[148:151], v[48:51], v[28:31]
  v_mfma_f32_16x16x32_bf16 v[32:35], v[196:199], v[44:47], v[32:35]
  s_waitcnt lgkmcnt(3)
  v_mfma_f32_16x16x32_bf16 v[16:19], a[24:27], v[52:55], v[16:19]
  v_mfma_f32_16x16x32_bf16 v[20:23], a[152:155], v[52:55], v[20:23]
  v_mfma_f32_16x16x32_bf16 v[24:27], a[24:27], v[56:59], v[24:27]
  v_mfma_f32_16x16x32_bf16 v[28:31], a[152:155], v[56:59], v[28:31]
  v_mfma_f32_16x16x32_bf16 v[32:35], v[200:203], v[52:55], v[32:35]
  s_waitcnt lgkmcnt(0)
  v_mfma_f32_16x16x32_bf16 v[16:19], a[28:31], v[60:63], v[16:19]
  v_mfma_f32_16x16x32_bf16 v[20:23], a[156:159], v[60:63], v[20:23]
  v_mfma_f32_16x16x32_bf16 v[24:27], a[28:31], v[64:67], v[24:27]
  v_mfma_f32_16x16x32_bf16 v[28:31], a[156:159], v[64:67], v[28:31]
  v_mfma_f32_16x16x32_bf16 v[32:35], v[204:207], v[60:63], v[32:35]
  s_waitcnt vmcnt(12)
  s_barrier
  ds_read_b128 v[36:39], v168 offset:16384
  ds_read_b128 v[40:43], v169 offset:16384
  ds_read_b128 v[192:195], v12 offset:8192
  ds_read_b128 v[44:47], v168 offset:18432
  ds_read_b128 v[48:51], v169 offset:18432
  ds_read_b128 v[196:199], v12 offset:9216
  ds_read_b128 v[52:55], v168 offset:20480
  ds_read_b128 v[56:59], v169 offset:20480
  ds_read_b128 v[200:203], v12 offset:10240
  s_waitcnt lgkmcnt(6)
  v_mfma_f32_16x16x32_bf16 v[16:19], a[32:35], v[36:39], v[16:19]
  v_mfma_f32_16x16x32_bf16 v[20:23], a[160:163], v[36:39], v[20:23]
  v_mfma_f32_16x16x32_bf16 v[24:27], a[32:35], v[40:43], v[24:27]
  v_mfma_f32_16x16x32_bf16 v[28:31], a[160:163], v[40:43], v[28:31]
  v_mfma_f32_16x16x32_bf16 v[32:35], v[192:195], v[36:39], v[32:35]
  ds_read_b128 v[60:63], v168 offset:22528
  ds_read_b128 v[64:67], v169 offset:22528
  ds_read_b128 v[204:207], v12 offset:11264
  s_waitcnt lgkmcnt(6)
  v_mfma_f32_16x16x32_bf16 v[16:19], a[36:39], v[44:47], v[16:19]
  v_mfma_f32_16x16x32_bf16 v[20:23], a[164:167], v[44:47], v[20:23]
  v_mfma_f32_16x16x32_bf16 v[24:27], a[36:39], v[48:51], v[24:27]
  v_mfma_f32_16x16x32_bf16 v[28:31], a[164:167], v[48:51], v[28:31]
  v_mfma_f32_16x16x32_bf16 v[32:35], v[196:199], v[44:47], v[32:35]
  ds_read_b128 v[36:39], v168 offset:24576
  ds_read_b128 v[40:43], v169 offset:24576
  ds_read_b128 v[192:195], v12 offset:12288
  s_waitcnt lgkmcnt(6)
  v_mfma_f32_16x16x32_bf16 v[16:19], a[40:43], v[52:55], v[16:19]
  v_mfma_f32_16x16x32_bf16 v[20:23], a[168:171], v[52:55], v[20:23]
  v_mfma_f32_16x16x32_bf16 v[24:27], a[40:43], v[56:59], v[24:27]
  v_mfma_f32_16x16x32_bf16 v[28:31], a[168:171], v[56:59], v[28:31]
  v_mfma_f32_16x16x32_bf16 v[32:35], v[200:203], v[52:55], v[32:35]
  ds_read_b128 v[44:47], v168 offset:26624
  ds_read_b128 v[48:51], v169 offset:26624
  ds_read_b128 v[196:199], v12 offset:13312
  s_waitcnt lgkmcnt(6)
  v_mfma_f32_16x16x32_bf16 v[16:19], a[44:47], v[60:63], v[16:19]
  v_mfma_f32_16x16x32_bf16 v[20:23], a[172:175], v[60:63], v[20:23]
  v_mfma_f32_16x16x32_bf16 v[24:27], a[44:47], v[64:67], v[24:27]
  v_mfma_f32_16x16x32_bf16 v[28:31], a[172:175], v[64:67], v[28:31]
  v_mfma_f32_16x16x32_bf16 v[32:35], v[204:207], v[60:63], v[32:35]
  ds_read_b128 v[52:55], v168 offset:28672
  ds_read_b128 v[56:59], v169 offset:28672
  ds_read_b128 v[200:203], v12 offset:14336
  s_waitcnt lgkmcnt(6)
  v_mfma_f32_16x16x32_bf16 v[16:19], a[48:51], v[36:39], v[16:19]
  v_mfma_f32_16x16x32_bf16 v[20:23], a[176:179], v[36:39], v[20:23]
  v_mfma_f32_16x16x32_bf16 v[24:27], a[48:51], v[40:43], v[24:27]
  v_mfma_f32_16x16x32_bf16 v[28:31], a[176:179], v[40:43], v[28:31]
  v_mfma_f32_16x16x32_bf16 v[32:35], v[192:195], v[36:39], v[32:35]
  ds_read_b128 v[60:63], v168 offset:30720
  ds_read_b128 v[64:67], v169 offset:30720
  ds_read_b128 v[204:207], v12 offset:15360
  s_waitcnt lgkmcnt(6)
  v_mfma_f32_16x16x32_bf16 v[16:19], a[52:55], v[44:47], v[16:19]
  v_mfma_f32_16x16x32_bf16 v[20:23], a[180:183], v[44:47], v[20:23]
  v_mfma_f32_16x16x32_bf16 v[24:27], a[52:55], v[48:51], v[24:27]
  v_mfma_f32_16x16x32_bf16 v[28:31], a[180:183], v[48:51], v[28:31]
  v_mfma_f32_16x16x32_bf16 v[32:35], v[196:199], v[44:47], v[32:35]
  s_waitcnt lgkmcnt(3)
  v_mfma_f32_16x16x32_bf16 v[16:19], a[56:59], v[52:55], v[16:19]
  v_mfma_f32_16x16x32_bf16 v[20:23], a[184:187], v[52:55], v[20:23]
  v_mfma_f32_16x16x32_bf16 v[24:27], a[56:59], v[56:59], v[24:27]
  v_mfma_f32_16x16x32_bf16 v[28:31], a[184:187], v[56:59], v[28:31]
  v_mfma_f32_16x16x32_bf16 v[32:35], v[200:203], v[52:55], v[32:35]
  s_waitcnt lgkmcnt(0)
  v_mfma_f32_16x16x32_bf16 v[16:19], a[60:63], v[60:63], v[16:19]
  v_mfma_f32_16x16x32_bf16 v[20:23], a[188:191], v[60:63], v[20:23]
  v_mfma_f32_16x16x32_bf16 v[24:27], a[60:63], v[64:67], v[24:27]
  v_mfma_f32_16x16x32_bf16 v[28:31], a[188:191], v[64:67], v[28:31]
  v_mfma_f32_16x16x32_bf16 v[32:35], v[204:207], v[60:63], v[32:35]
  s_waitcnt vmcnt(8)
  s_barrier
  ds_read_b128 v[36:39], v168 offset:32768
  ds_read_b128 v[40:43], v169 offset:32768
  ds_read_b128 v[192:195], v12 offset:16384
  ds_read_b128 v[44:47], v168 offset:34816
  ds_read_b128 v[48:51], v169 offset:34816
  ds_read_b128 v[196:199], v12 offset:17408
  ds_read_b128 v[52:55], v168 offset:36864
  ds_read_b128 v[56:59], v169 offset:36864
  ds_read_b128 v[200:203], v12 offset:18432
  s_waitcnt lgkmcnt(6)
  v_mfma_f32_16x16x32_bf16 v[16:19], a[64:67], v[36:39], v[16:19]
  v_mfma_f32_16x16x32_bf16 v[20:23], a[192:195], v[36:39], v[20:23]
  v_mfma_f32_16x16x32_bf16 v[24:27], a[64:67], v[40:43], v[24:27]
  v_mfma_f32_16x16x32_bf16 v[28:31], a[192:195], v[40:43], v[28:31]
  v_mfma_f32_16x16x32_bf16 v[32:35], v[192:195], v[36:39], v[32:35]
  ds_read_b128 v[60:63], v168 offset:38912
  ds_read_b128 v[64:67], v169 offset:38912
  ds_read_b128 v[204:207], v12 offset:19456
  s_waitcnt lgkmcnt(6)
  v_mfma_f32_16x16x32_bf16 v[16:19], a[68:71], v[44:47], v[16:19]
  v_mfma_f32_16x16x32_bf16 v[20:23], a[196:199], v[44:47], v[20:23]
  v_mfma_f32_16x16x32_bf16 v[24:27], a[68:71], v[48:51], v[24:27]
  v_mfma_f32_16x16x32_bf16 v[28:31], a[196:199], v[48:51], v[28:31]
  v_mfma_f32_16x16x32_bf16 v[32:35], v[196:199], v[44:47], v[32:35]
  ds_read_b128 v[36:39], v168 offset:40960
  ds_read_b128 v[40:43], v169 offset:40960
  ds_read_b128 v[192:195], v12 offset:20480
  s_waitcnt lgkmcnt(6)
  v_mfma_f32_16x16x32_bf16 v[16:19], a[72:75], v[52:55], v[16:19]
  v_mfma_f32_16x16x32_bf16 v[20:23], a[200:203], v[52:55], v[20:23]
  v_mfma_f32_16x16x32_bf16 v[24:27], a[72:75], v[56:59], v[24:27]
  v_mfma_f32_16x16x32_bf16 v[28:31], a[200:203], v[56:59], v[28:31]
  v_mfma_f32_16x16x32_bf16 v[32:35], v[200:203], v[52:55], v[32:35]
  ds_read_b128 v[44:47], v168 offset:43008
  ds_read_b128 v[48:51], v169 offset:43008
  ds_read_b128 v[196:199], v12 offset:21504
  s_waitcnt lgkmcnt(6)
  v_mfma_f32_16x16x32_bf16 v[16:19], a[76:79], v[60:63], v[16:19]
  v_mfma_f32_16x16x32_bf16 v[20:23], a[204:207], v[60:63], v[20:23]
  v_mfma_f32_16x16x32_bf16 v[24:27], a[76:79], v[64:67], v[24:27]
  v_mfma_f32_16x16x32_bf16 v[28:31], a[204:207], v[64:67], v[28:31]
  v_mfma_f32_16x16x32_bf16 v[32:35], v[204:207], v[60:63], v[32:35]
  ds_read_b128 v[52:55], v168 offset:45056
  ds_read_b128 v[56:59], v169 offset:45056
  ds_read_b128 v[200:203], v12 offset:22528
  s_waitcnt lgkmcnt(6)
  v_mfma_f32_16x16x32_bf16 v[16:19], a[80:83], v[36:39], v[16:19]
  v_mfma_f32_16x16x32_bf16 v[20:23], a[208:211], v[36:39], v[20:23]
  v_mfma_f32_16x16x32_bf16 v[24:27], a[80:83], v[40:43], v[24:27]
  v_mfma_f32_16x16x32_bf16 v[28:31], a[208:211], v[40:43], v[28:31]
  v_mfma_f32_16x16x32_bf16 v[32:35], v[192:195], v[36:39], v[32:35]
  ds_read_b128 v[60:63], v168 offset:47104
  ds_read_b128 v[64:67], v169 offset:47104
  ds_read_b128 v[204:207], v12 offset:23552
  s_waitcnt lgkmcnt(6)
  v_mfma_f32_16x16x32_bf16 v[16:19], a[84:87], v[44:47], v[16:19]
  v_mfma_f32_16x16x32_bf16 v[20:23], a[212:215], v[44:47], v[20:23]
  v_mfma_f32_16x16x32_bf16 v[24:27], a[84:87], v[48:51], v[24:27]
  v_mfma_f32_16x16x32_bf16 v[28:31], a[212:215], v[48:51], v[28:31]
  v_mfma_f32_16x16x32_bf16 v[32:35], v[196:199], v[44:47], v[32:35]
  s_waitcnt lgkmcnt(3)
  v_mfma_f32_16x16x32_bf16 v[16:19], a[88:91], v[52:55], v[16:19]
  v_mfma_f32_16x16x32_bf16 v[20:23], a[216:219], v[52:55], v[20:23]
  v_mfma_f32_16x16x32_bf16 v[24:27], a[88:91], v[56:59], v[24:27]
  v_mfma_f32_16x16x32_bf16 v[28:31], a[216:219], v[56:59], v[28:31]
  v_mfma_f32_16x16x32_bf16 v[32:35], v[200:203], v[52:55], v[32:35]
  s_waitcnt lgkmcnt(0)
  v_mfma_f32_16x16x32_bf16 v[16:19], a[92:95], v[60:63], v[16:19]
  v_mfma_f32_16x16x32_bf16 v[20:23], a[220:223], v[60:63], v[20:23]
  v_mfma_f32_16x16x32_bf16 v[24:27], a[92:95], v[64:67], v[24:27]
  v_mfma_f32_16x16x32_bf16 v[28:31], a[220:223], v[64:67], v[28:31]
  v_mfma_f32_16x16x32_bf16 v[32:35], v[204:207], v[60:63], v[32:35]
  s_waitcnt vmcnt(4)
  s_barrier
  ds_read_b128 v[36:39], v168 offset:49152
  ds_read_b128 v[40:43], v169 offset:49152
  ds_read_b128 v[192:195], v12 offset:24576
  ds_read_b128 v[44:47], v168 offset:51200
  ds_read_b128 v[48:51], v169 offset:51200
  ds_read_b128 v[196:199], v12 offset:25600
  ds_read_b128 v[52:55], v168 offset:53248
  ds_read_b128 v[56:59], v169 offset:53248
  ds_read_b128 v[200:203], v12 offset:26624
  s_waitcnt lgkmcnt(6)
  v_mfma_f32_16x16x32_bf16 v[16:19], a[96:99], v[36:39], v[16:19]
  v_mfma_f32_16x16x32_bf16 v[20:23], a[224:227], v[36:39], v[20:23]
  v_mfma_f32_16x16x32_bf16 v[24:27], a[96:99], v[40:43], v[24:27]
  v_mfma_f32_16x16x32_bf16 v[28:31], a[224:227], v[40:43], v[28:31]
  v_mfma_f32_16x16x32_bf16 v[32:35], v[192:195], v[36:39], v[32:35]
  ds_read_b128 v[60:63], v168 offset:55296
  ds_read_b128 v[64:67], v169 offset:55296
  ds_read_b128 v[204:207], v12 offset:27648
  s_waitcnt lgkmcnt(6)
  v_mfma_f32_16x16x32_bf16 v[16:19], a[100:103], v[44:47], v[16:19]
  v_mfma_f32_16x16x32_bf16 v[20:23], a[228:231], v[44:47], v[20:23]
  v_mfma_f32_16x16x32_bf16 v[24:27], a[100:103], v[48:51], v[24:27]
  v_mfma_f32_16x16x32_bf16 v[28:31], a[228:231], v[48:51], v[28:31]
  v_mfma_f32_16x16x32_bf16 v[32:35], v[196:199], v[44:47], v[32:35]
  ds_read_b128 v[36:39], v168 offset:57344
  ds_read_b128 v[40:43], v169 offset:57344
  ds_read_b128 v[192:195], v12 offset:28672
  s_waitcnt lgkmcnt(6)
  v_mfma_f32_16x16x32_bf16 v[16:19], a[104:107], v[52:55], v[16:19]
  v_mfma_f32_16x16x32_bf16 v[20:23], a[232:235], v[52:55], v[20:23]
  v_mfma_f32_16x16x32_bf16 v[24:27], a[104:107], v[56:59], v[24:27]
  v_mfma_f32_16x16x32_bf16 v[28:31], a[232:235], v[56:59], v[28:31]
  v_mfma_f32_16x16x32_bf16 v[32:35], v[200:203], v[52:55], v[32:35]
  ds_read_b128 v[44:47], v168 offset:59392
  ds_read_b128 v[48:51], v169 offset:59392
  ds_read_b128 v[196:199], v12 offset:29696
  s_waitcnt lgkmcnt(6)
  v_mfma_f32_16x16x32_bf16 v[16:19], a[108:111], v[60:63], v[16:19]
  v_mfma_f32_16x16x32_bf16 v[20:23], a[236:239], v[60:63], v[20:23]
  v_mfma_f32_16x16x32_bf16 v[24:27], a[108:111], v[64:67], v[24:27]
  v_mfma_f32_16x16x32_bf16 v[28:31], a[236:239], v[64:67], v[28:31]
  v_mfma_f32_16x16x32_bf16 v[32:35], v[204:207], v[60:63], v[32:35]
  ds_read_b128 v[52:55], v168 offset:61440
  ds_read_b128 v[56:59], v169 offset:61440
  ds_read_b128 v[200:203], v12 offset:30720
  s_waitcnt lgkmcnt(6)
  v_mfma_f32_16x16x32_bf16 v[16:19], a[112:115], v[36:39], v[16:19]
  v_mfma_f32_16x16x32_bf16 v[20:23], a[240:243], v[36:39], v[20:23]
  v_mfma_f32_16x16x32_bf16 v[24:27], a[112:115], v[40:43], v[24:27]
  v_mfma_f32_16x16x32_bf16 v[28:31], a[240:243], v[40:43], v[28:31]
  v_mfma_f32_16x16x32_bf16 v[32:35], v[192:195], v[36:39], v[32:35]
  ds_read_b128 v[60:63], v168 offset:63488
  ds_read_b128 v[64:67], v169 offset:63488
  ds_read_b128 v[204:207], v12 offset:31744
  s_waitcnt lgkmcnt(6)
  v_mfma_f32_16x16x32_bf16 v[16:19], a[116:119], v[44:47], v[16:19]
  v_mfma_f32_16x16x32_bf16 v[20:23], a[244:247], v[44:47], v[20:23]
  v_mfma_f32_16x16x32_bf16 v[24:27], a[116:119], v[48:51], v[24:27]
  v_mfma_f32_16x16x32_bf16 v[28:31], a[244:247], v[48:51], v[28:31]
  v_mfma_f32_16x16x32_bf16 v[32:35], v[196:199], v[44:47], v[32:35]
  s_waitcnt lgkmcnt(3)
  v_mfma_f32_16x16x32_bf16 v[16:19], a[120:123], v[52:55], v[16:19]
  v_mfma_f32_16x16x32_bf16 v[20:23], a[248:251], v[52:55], v[20:23]
  v_mfma_f32_16x16x32_bf16 v[24:27], a[120:123], v[56:59], v[24:27]
  v_mfma_f32_16x16x32_bf16 v[28:31], a[248:251], v[56:59], v[28:31]
  v_mfma_f32_16x16x32_bf16 v[32:35], v[200:203], v[52:55], v[32:35]
  s_waitcnt lgkmcnt(0)
  v_mfma_f32_16x16x32_bf16 v[16:19], a[124:127], v[60:63], v[16:19]
  v_mfma_f32_16x16x32_bf16 v[20:23], a[252:255], v[60:63], v[20:23]
  v_mfma_f32_16x16x32_bf16 v[24:27], a[124:127], v[64:67], v[24:27]
  v_mfma_f32_16x16x32_bf16 v[28:31], a[252:255], v[64:67], v[28:31]
  v_mfma_f32_16x16x32_bf16 v[32:35], v[204:207], v[60:63], v[32:35]
  s_waitcnt vmcnt(0)
  s_barrier
  buffer_store_dword v10, v9, s[32:35], 0 offen sc1
  ds_read_b128 v[36:39], v170 offset:0
  ds_read_b128 v[40:43], v171 offset:0
  ds_read_b128 v[44:47], v170 offset:2048
  ds_read_b128 v[48:51], v171 offset:2048
  ds_read_b128 v[52:55], v170 offset:4096
  ds_read_b128 v[56:59], v171 offset:4096
  s_waitcnt lgkmcnt(4)
  v_mfma_f32_16x16x32_bf16 v[16:19], v[68:71], v[36:39], v[16:19]
  v_mfma_f32_16x16x32_bf16 v[20:23], v[100:103], v[36:39], v[20:23]
  v_mfma_f32_16x16x32_bf16 v[24:27], v[68:71], v[40:43], v[24:27]
  v_mfma_f32_16x16x32_bf16 v[28:31], v[100:103], v[40:43], v[28:31]
  v_mfma_f32_16x16x32_bf16 v[32:35], v[132:135], v[36:39], v[32:35]
  ds_read_b128 v[60:63], v170 offset:6144
  ds_read_b128 v[64:67], v171 offset:6144
  s_waitcnt lgkmcnt(4)
  v_mfma_f32_16x16x32_bf16 v[16:19], v[72:75], v[44:47], v[16:19]
  v_mfma_f32_16x16x32_bf16 v[20:23], v[104:107], v[44:47], v[20:23]
  v_mfma_f32_16x16x32_bf16 v[24:27], v[72:75], v[48:51], v[24:27]
  v_mfma_f32_16x16x32_bf16 v[28:31], v[104:107], v[48:51], v[28:31]
  v_mfma_f32_16x16x32_bf16 v[32:35], v[136:139], v[44:47], v[32:35]
  ds_read_b128 v[36:39], v170 offset:8192
  ds_read_b128 v[40:43], v171 offset:8192
  s_waitcnt lgkmcnt(4)
  v_mfma_f32_16x16x32_bf16 v[16:19], v[76:79], v[52:55], v[16:19]
  v_mfma_f32_16x16x32_bf16 v[20:23], v[108:111], v[52:55], v[20:23]
  v_mfma_f32_16x16x32_bf16 v[24:27], v[76:79], v[56:59], v[24:27]
  v_mfma_f32_16x16x32_bf16 v[28:31], v[108:111], v[56:59], v[28:31]
  v_mfma_f32_16x16x32_bf16 v[32:35], v[140:143], v[52:55], v[32:35]
  ds_read_b128 v[44:47], v170 offset:10240
  ds_read_b128 v[48:51], v171 offset:10240
  s_waitcnt lgkmcnt(4)
  v_mfma_f32_16x16x32_bf16 v[16:19], v[80:83], v[60:63], v[16:19]
  v_mfma_f32_16x16x32_bf16 v[20:23], v[112:115], v[60:63], v[20:23]
  v_mfma_f32_16x16x32_bf16 v[24:27], v[80:83], v[64:67], v[24:27]
  v_mfma_f32_16x16x32_bf16 v[28:31], v[112:115], v[64:67], v[28:31]
  v_mfma_f32_16x16x32_bf16 v[32:35], v[144:147], v[60:63], v[32:35]
  ds_read_b128 v[52:55], v170 offset:12288
  ds_read_b128 v[56:59], v171 offset:12288
  s_waitcnt lgkmcnt(4)
  v_mfma_f32_16x16x32_bf16 v[16:19], v[84:87], v[36:39], v[16:19]
  v_mfma_f32_16x16x32_bf16 v[20:23], v[116:119], v[36:39], v[20:23]
  v_mfma_f32_16x16x32_bf16 v[24:27], v[84:87], v[40:43], v[24:27]
  v_mfma_f32_16x16x32_bf16 v[28:31], v[116:119], v[40:43], v[28:31]
  v_mfma_f32_16x16x32_bf16 v[32:35], v[148:151], v[36:39], v[32:35]
  ds_read_b128 v[60:63], v170 offset:14336
  ds_read_b128 v[64:67], v171 offset:14336
  s_waitcnt lgkmcnt(4)
  v_mfma_f32_16x16x32_bf16 v[16:19], v[88:91], v[44:47], v[16:19]
  v_mfma_f32_16x16x32_bf16 v[20:23], v[120:123], v[44:47], v[20:23]
  v_mfma_f32_16x16x32_bf16 v[24:27], v[88:91], v[48:51], v[24:27]
  v_mfma_f32_16x16x32_bf16 v[28:31], v[120:123], v[48:51], v[28:31]
  v_mfma_f32_16x16x32_bf16 v[32:35], v[152:155], v[44:47], v[32:35]
  s_waitcnt lgkmcnt(2)
  v_mfma_f32_16x16x32_bf16 v[16:19], v[92:95], v[52:55], v[16:19]
  v_mfma_f32_16x16x32_bf16 v[20:23], v[124:127], v[52:55], v[20:23]
  v_mfma_f32_16x16x32_bf16 v[24:27], v[92:95], v[56:59], v[24:27]
  v_mfma_f32_16x16x32_bf16 v[28:31], v[124:127], v[56:59], v[28:31]
  v_mfma_f32_16x16x32_bf16 v[32:35], v[156:159], v[52:55], v[32:35]
  s_waitcnt lgkmcnt(0)
  v_mfma_f32_16x16x32_bf16 v[16:19], v[96:99], v[60:63], v[16:19]
  v_mfma_f32_16x16x32_bf16 v[20:23], v[128:131], v[60:63], v[20:23]
  v_mfma_f32_16x16x32_bf16 v[24:27], v[96:99], v[64:67], v[24:27]
  v_mfma_f32_16x16x32_bf16 v[28:31], v[128:131], v[64:67], v[28:31]
  v_mfma_f32_16x16x32_bf16 v[32:35], v[160:163], v[60:63], v[32:35]
  s_mul_i32 s54, s62, 81920
  s_add_u32 s55, s54, s70
  s_add_u32 s54, s54, s69
  v_cvt_pk_bf16_f32 v172, v16, v17
  v_cvt_pk_bf16_f32 v173, v18, v19
  v_cvt_pk_bf16_f32 v174, v20, v21
  v_cvt_pk_bf16_f32 v175, v22, v23
  s_nop 0
  v_permlane16_swap_b32 v172, v174
  v_permlane16_swap_b32 v173, v175
  buffer_store_dwordx4 v[172:175], v7, s[44:47], s54 offen nt
  v_cvt_pk_bf16_f32 v176, v24, v25
  v_cvt_pk_bf16_f32 v177, v26, v27
  v_cvt_pk_bf16_f32 v178, v28, v29
  v_cvt_pk_bf16_f32 v179, v30, v31
  s_nop 0
  v_permlane16_swap_b32 v176, v178
  v_permlane16_swap_b32 v177, v179
  buffer_store_dwordx4 v[176:179], v7, s[44:47], s55 offen nt
  v_cvt_pk_bf16_f32 v180, v32, v33
  v_cvt_pk_bf16_f32 v181, v34, v35
  buffer_store_dwordx2 v[180:181], v8, s[44:47], s54 offen nt
  s_add_u32 s52, s52, 1
  s_add_u32 s62, s62, 6
  s_cmp_lt_u32 s62, 64
  s_cbranch_scc1 FC_SEG
  s_branch L_EXIT
FC_YL:
  s_cmp_ge_u32 s65, s63
  s_cbranch_scc1 WPD_140
  s_mov_b32 s57, 0
  s_mov_b32 exec_lo, 0xffffffff
  s_mov_b32 exec_hi, 0
WPL_141:
  buffer_load_dwordx4 v[172:175], v3, s[32:35], 0 offen sc1
  s_add_u32 s57, s57, 1
  s_cmp_gt_u32 s57, 0x80000
  s_cbranch_scc1 L_EXIT
  s_waitcnt vmcnt(0)
  v_min3_u32 v172, v172, v173, v174
  v_min_u32 v172, v172, v175
  v_cmp_gt_u32 vcc, s63, v172
  s_cbranch_vccz WPG_142
  s_sleep 2
  s_branch WPL_141
WPG_142:
  s_mov_b32 s65, s63
  s_add_u32 s53, s63, 2
  s_min_u32 s53, s53, 64
  v_cmp_gt_u32 vcc, s53, v172
  s_nop 0
  s_cmp_eq_u64 vcc, 0
  s_cselect_b32 s65, s53, s65
  s_add_u32 s53, s63, 6
  s_min_u32 s53, s53, 64
  v_cmp_gt_u32 vcc, s53, v172
  s_nop 0
  s_cmp_eq_u64 vcc, 0
  s_cselect_b32 s65, s53, s65
  s_add_u32 s53, s63, 16
  s_min_u32 s53, s53, 64
  v_cmp_gt_u32 vcc, s53, v172
  s_nop 0
  s_cmp_eq_u64 vcc, 0
  s_cselect_b32 s65, s53, s65
  s_mov_b64 exec, -1
WPD_140:
  s_branch FC_YOK
L_END:
.section .rodata,"a"
.p2align 6
.amdhsa_kernel concat_heads__linear_kernel_hedgehog__memory_aug_recurrent_mem_tr__prompt_kernel
  .amdhsa_next_free_vgpr 512
  .amdhsa_next_free_sgpr 102
  .amdhsa_accum_offset 256
  .amdhsa_group_segment_fixed_size 0
  .amdhsa_kernarg_size 112
  .amdhsa_user_sgpr_count 2
  .amdhsa_user_sgpr_kernarg_segment_ptr 1
  .amdhsa_system_sgpr_workgroup_id_x 1
  .amdhsa_float_denorm_mode_32 3
.end_amdhsa_kernel
```
